```python
import torch

def _softmax(x, axis=-1):
    return torch.softmax(x, dim=axis)
def _gelu(x):
    return torch.nn.functional.gelu(x, approximate="tanh")
def _silu(x):
    return torch.nn.functional.silu(x)
def _sigmoid(x):
    return torch.sigmoid(x)
def _layernorm(x, axis=-1, eps=1e-5):
    m = x.mean(dim=axis, keepdim=True)
    v = x.var(dim=axis, keepdim=True, unbiased=False)
    return (x - m) / torch.sqrt(v + eps)
def _scatter_add(tgt, idx, src, axis=0):
    return tgt.clone().index_add_(axis, idx, src)
def _segment_sum(src, seg, n):
    out = torch.zeros((n,) + src.shape[1:], dtype=src.dtype)
    return out.index_add_(0, seg, src)
def _pad(x, pw):
    flat = tuple(v for pair in reversed(pw) for v in pair)
    return torch.nn.functional.pad(x, flat)

kernel_name = 'concat_heads__mha_block_cached__gqa_block_cached__near_ridge'

def setup_inputs():

    _w = (lambda a: (lambda t: t.to(torch.bfloat16) if t.is_floating_point() else t)(torch.as_tensor(a)))
    def _A_setup():
        B, Sq, D = 16, 112, 512
        H, Sk, Dh = 32, 512, 128
        return {
            "x": _w((lambda *s: torch.randn(*s, dtype=torch.bfloat16) * 0.8)(B, Sq, D)),
            "k_cache": _w((lambda *s: torch.randn(*s, dtype=torch.bfloat16) * 0.8)(B, H, Sk, Dh)),
            "v_cache": _w((lambda *s: torch.randn(*s, dtype=torch.bfloat16) * 0.05)(B, H, Sk, Dh)),
            "wq": _w((lambda *s: torch.randn(*s, dtype=torch.bfloat16) * 0.8)(D, H * Dh) * (D ** -0.5)),
            "wo": _w((lambda *s: torch.randn(*s, dtype=torch.bfloat16) * 0.05)(H * Dh, D) * ((H * Dh) ** -0.5)),
        }
    _A_in = _A_setup()

    def _B_setup():
        B, Sq, D = 16, 112, 512
        Hq, Hkv, Sk, Dh = 32, 32, 512, 128
        assert Hq % Hkv == 0, (Hq, Hkv)
        return {
            "x": _w((lambda *s: torch.randn(*s, dtype=torch.bfloat16) * 0.8)(B, Sq, D)),
            "k_cache": _w((lambda *s: torch.randn(*s, dtype=torch.bfloat16) * 0.8)(B, Hkv, Sk, Dh)),
            "v_cache": _w((lambda *s: torch.randn(*s, dtype=torch.bfloat16) * 0.05)(B, Hkv, Sk, Dh)),
            "wq": _w((lambda *s: torch.randn(*s, dtype=torch.bfloat16) * 0.8)(D, Hq * Dh) * (D ** -0.5)),
            "wo": _w((lambda *s: torch.randn(*s, dtype=torch.bfloat16) * 0.05)(Hq * Dh, D) * ((Hq * Dh) ** -0.5)),
        }
    _B_in = _B_setup()

    return {
        "A_x": _A_in["x"],
        "A_k_cache": _A_in["k_cache"],
        "A_v_cache": _A_in["v_cache"],
        "A_wq": _A_in["wq"],
        "A_wo": _A_in["wo"],
        "B_x": _B_in["x"],
        "B_k_cache": _B_in["k_cache"],
        "B_v_cache": _B_in["v_cache"],
        "B_wq": _B_in["wq"],
        "B_wo": _B_in["wo"],
    }

def reference(A_x, A_k_cache, A_v_cache, A_wq, A_wo, B_x, B_k_cache, B_v_cache, B_wq, B_wo):
    def _A_ref(x, k_cache, v_cache, wq, wo):
        B, Sq, D = x.shape
        H, Dh = 32, 128
        q = (lambda x, *d: x.permute(*d))((x @ wq).reshape(B, Sq, H, Dh), 0, 2, 1, 3)
        scores = torch.einsum("bhqd,bhkd->bhqk", q, k_cache) * (Dh ** -0.5)
        p = _softmax(scores, axis=-1)
        o = torch.einsum("bhqk,bhkd->bhqd", p, v_cache)
        return (lambda x, *d: x.permute(*d))(o, 0, 2, 1, 3).reshape(B, Sq, H * Dh) @ wo

    def _B_ref(x, k_cache, v_cache, wq, wo):
        B, Sq, D = x.shape
        Hq, Dh = 32, 128
        Hkv = k_cache.shape[1]
        rep = Hq // Hkv
        q = (lambda x, *d: x.permute(*d))((x @ wq).reshape(B, Sq, Hq, Dh), 0, 2, 1, 3)
        k = (lambda x, n, axis: torch.repeat_interleave(x, n, dim=axis))(k_cache, rep, axis=1)
        v = (lambda x, n, axis: torch.repeat_interleave(x, n, dim=axis))(v_cache, rep, axis=1)
        scores = torch.einsum("bhqd,bhkd->bhqk", q, k) * (Dh ** -0.5)
        p = _softmax(scores, axis=-1)
        o = torch.einsum("bhqk,bhkd->bhqd", p, v)
        return (lambda x, *d: x.permute(*d))(o, 0, 2, 1, 3).reshape(B, Sq, Hq * Dh) @ wo

    a = _A_ref(A_x, A_k_cache, A_v_cache, A_wq, A_wo)
    b = _B_ref(B_x, B_k_cache, B_v_cache, B_wq, B_wo)
    return torch.concatenate([a, b], axis=-1)
```

```asm
; @launch grid=(256,1,1) block=(512,1,1) lds=163840
.amdgcn_target "amdgcn-amd-amdhsa--gfx950"
.text
.macro mf d,a,b,c
 v_mfma_f32_16x16x32_bf16 v[\d:\d+3],v[\a:\a+3],v[\b:\b+3],v[\c:\c+3]
.endm
.macro mz d,a,b
 v_mfma_f32_16x16x32_bf16 v[\d:\d+3],v[\a:\a+3],v[\b:\b+3],0
.endm
.macro tr d,a,o
 ds_read_b64_tr_b16 v[\d:\d+1],v\a offset:\o
.endm
.macro cv d,a,b
 v_cvt_pk_bf16_f32 v\d,v\a,v\b
.endm
.globl concat_heads__mha_block_cached__gqa_block_cached__near_ridge_kernel
.p2align 8
.type concat_heads__mha_block_cached__gqa_block_cached__near_ridge_kernel,@function
concat_heads__mha_block_cached__gqa_block_cached__near_ridge_kernel:
 s_cmp_lt_u32 s2,256
 s_cbranch_scc1 L_go
 s_endpgm
 s_nop 0
L_go:
 s_mov_b32 s3,0
 s_nop 0
X_top:
 s_load_dwordx16 s[48:63],s[0:1],0
 s_load_dwordx8 s[64:71],s[0:1],64
 s_load_dwordx2 s[72:73],s[0:1],96
 s_getpc_b64 s[74:75]
L_pc:
 s_lshr_b32 s40,s2,3
 s_lshl_b32 s40,s40,13
 v_lshlrev_b32 v4,4,v0
 v_add_u32 v4,s40,v4
 v_min_u32 v4,L_codeend-L_pc-16,v4
 global_load_dwordx4 v[236:239],v4,s[74:75]
 v_lshrrev_b32 v3,6,v0
 s_lshr_b32 s34,s2,2
 s_and_b32 s34,s34,1
 v_readfirstlane_b32 s32,v3
 s_lshr_b32 s35,s2,4
 s_and_b32 s37,s2,3
 s_lshl_b32 s37,s37,1
 s_lshr_b32 s47,s2,3
 s_and_b32 s47,s47,1
 s_add_u32 s37,s37,s47
 s_lshl_b32 s36,s37,2
 s_and_b32 s33,s32,3
 v_and_b32 v1,63,v0
 v_lshlrev_b32 v14,4,v1
 v_lshrrev_b32 v3,4,v1
 v_and_b32 v6,0xf0,v14
 v_lshlrev_b32 v5,6,v3
 v_xor_b32 v4,v6,v5
 v_lshl_add_u32 v4,v3,12,v4
 v_lshl_add_u32 v6,v3,13,v6
 s_lshl_b32 s42,s33,13
 s_lshl_b32 s40,s33,15
 v_add_u32 v20,s40,v4
 v_xor_b32 v21,16,v20
 v_xor_b32 v22,32,v20
 v_xor_b32 v23,48,v20
 v_and_b32 v4,0x70,v14
 v_bfe_u32 v5,v1,3,1
 v_lshl_add_u32 v4,v5,13,v4
 v_bfe_u32 v5,v1,4,1
 v_lshl_add_u32 v4,v5,17,v4
 v_lshrrev_b32 v5,5,v1
 v_lshl_add_u32 v2,v5,15,v4
 s_lshl_b32 s45,s36,8
 s_mul_i32 s41,s33,4224
 s_lshl_b32 s44,s33,18
 s_add_u32 s44,s44,s45
 s_lshl_b32 s43,s35,3
 s_add_u32 s43,s43,s32
 s_lshl_b32 s43,s43,15
 s_add_u32 s43,s43,s45
 s_lshl_b32 s47,s47,1
 s_and_b32 s46,s2,3
 s_xor_b32 s47,s47,s46
 s_lshl_b32 s101,s47,8
 s_lshl_b32 s100,s47,20
 s_mul_i32 s46,s35,114688
 s_waitcnt lgkmcnt(0)
 s_cmp_eq_u32 s34,1
 s_cselect_b32 s16,s64,s54
 s_cselect_b32 s17,s65,s55
 s_mov_b32 s18,0x400000
 s_mov_b32 s19,0x20000
 s_cselect_b32 s48,s58,s48
 s_cselect_b32 s49,s59,s49
 s_cselect_b32 s50,s60,s50
 s_cselect_b32 s51,s61,s51
 s_cselect_b32 s52,s62,s52
 s_cselect_b32 s53,s63,s53
 s_cselect_b32 s56,s66,s56
 s_cselect_b32 s57,s67,s57
 s_add_u32 s24,s48,s46
 s_addc_u32 s25,s49,0
 s_mov_b32 s26,114688
 s_mov_b32 s27,0x20000
 s_lshl_b32 s40,s35,5
 s_add_u32 s40,s40,s36
 s_lshl_b32 s40,s40,17
 s_add_u32 s8,s50,s40
 s_addc_u32 s9,s51,0
 s_mov_b32 s10,0x80000
 s_mov_b32 s11,0x20000
 s_add_u32 s12,s52,s40
 s_addc_u32 s13,s53,0
 s_mov_b32 s14,0x80000
 s_mov_b32 s15,0x20000
 s_mov_b32 s52,s101
 s_mov_b32 s53,s100
 s_cmp_ge_u32 s32,4
 s_cbranch_scc1 L_noissue
 buffer_load_dwordx4 v[240:243],v6,s[16:19],s43 offen
 s_add_u32 s43,s43,131072
 buffer_load_dwordx4 v[244:247],v6,s[16:19],s43 offen
 s_xor_b32 s46,s53,0
 s_add_u32 s46,s46,s44
 s_add_u32 m0,s41,67584
 s_add_u32 s40,s46,0
 buffer_load_dwordx4 v2,s[16:19],s40 offen lds
 s_add_u32 m0,s41,68640
 s_add_u32 s40,s46,16384
 buffer_load_dwordx4 v2,s[16:19],s40 offen lds
 s_add_u32 m0,s41,69696
 s_add_u32 s40,s46,65536
 buffer_load_dwordx4 v2,s[16:19],s40 offen lds
 s_add_u32 m0,s41,70752
 s_add_u32 s40,s46,81920
 buffer_load_dwordx4 v2,s[16:19],s40 offen lds
 s_xor_b32 s40,s52,0
 s_add_u32 m0,s42,33792
 s_nop 0
 buffer_load_dwordx4 v20,s[24:27],s40 offen lds
 buffer_load_dwordx4 v21,s[24:27],s40 offen offset:1024 lds
 buffer_load_dwordx4 v22,s[24:27],s40 offen offset:2048 lds
 buffer_load_dwordx4 v23,s[24:27],s40 offen offset:3072 lds
 s_xor_b32 s40,s52,16384
 s_add_u32 m0,s42,37888
 s_nop 0
 buffer_load_dwordx4 v20,s[24:27],s40 offen lds
 buffer_load_dwordx4 v21,s[24:27],s40 offen offset:1024 lds
 buffer_load_dwordx4 v22,s[24:27],s40 offen offset:2048 lds
 buffer_load_dwordx4 v23,s[24:27],s40 offen offset:3072 lds
 s_xor_b32 s46,s53,0
 s_add_u32 s46,s46,s44
 s_add_u32 m0,s41,84480
 s_add_u32 s40,s46,128
 buffer_load_dwordx4 v2,s[16:19],s40 offen lds
 s_add_u32 m0,s41,85536
 s_add_u32 s40,s46,16512
 buffer_load_dwordx4 v2,s[16:19],s40 offen lds
 s_add_u32 m0,s41,86592
 s_add_u32 s40,s46,65664
 buffer_load_dwordx4 v2,s[16:19],s40 offen lds
 s_add_u32 m0,s41,87648
 s_add_u32 s40,s46,82048
 buffer_load_dwordx4 v2,s[16:19],s40 offen lds
L_noissue:
 s_mov_b32 s20,s56
 s_mov_b32 s21,s57
 s_mov_b32 s22,0x400000
 s_mov_b32 s23,0x20000
 s_lshl_b32 s54,s34,4
 s_add_u32 s54,s54,s35
 s_lshl_b32 s40,s54,17
 s_add_u32 s60,s72,s40
 s_addc_u32 s61,s73,0
 s_mov_b32 s62,25296896
 s_mov_b32 s63,0x20000
 s_lshl_b32 s46,s37,14
 s_add_u32 s40,s40,s46
 s_add_u32 s28,s72,s40
 s_addc_u32 s29,s73,0
 s_mov_b32 s30,25182208
 s_mov_b32 s31,0x20000
 s_lshl_b32 s40,s54,10
 s_add_u32 s40,s40,33554432
 s_add_u32 s96,s72,s40
 s_addc_u32 s97,s73,0
 s_mov_b32 s98,1024
 s_mov_b32 s99,0x20000
 s_mul_i32 s40,s35,229376
 s_add_u32 s56,s68,s40
 s_addc_u32 s57,s69,0
 s_mov_b32 s58,229376
 s_mov_b32 s59,0x20000
 s_mov_b32 s64,s70
 s_mov_b32 s65,s71
 s_mov_b32 s66,256
 s_mov_b32 s67,0x20000
 s_mov_b32 s38,0x3e0293ee
 s_mov_b32 s4,0x0
 s_mov_b32 s100,0
 s_mov_b64 s[94:95],0
 s_mov_b32 s101,0x53800000
 s_cmp_eq_u32 s32,7
 s_cbranch_scc1 L_proj_s
 s_cmp_ge_u32 s32,4
 s_cbranch_scc1 L_proj
 s_cmp_lg_u32 s3,0
 s_cbranch_scc1 X_safe
 s_cmp_eq_u32 s32,3
 s_cbranch_scc1 L_attn_s
 s_branch L_attn
L_proj:
 s_lshl_b32 s45,s33,15
 s_lshl_b32 s40,s36,17
 s_add_u32 s45,s45,s40
 v_lshrrev_b32 v8,4,v1
 v_and_b32 v9,15,v1
 v_xor_b32 v8,v8,v9
 v_lshlrev_b32 v64,4,v8
 v_and_b32 v8,3,v1
 v_lshl_add_u32 v64,v8,10,v64
 v_bfe_u32 v8,v1,2,2
 v_lshl_add_u32 v64,v8,8,v64
 s_lshl_b32 s46,s33,13
 v_add_u32 v64,s46,v64
 v_xor_b32 v65,64,v64
 v_xor_b32 v66,128,v64
 v_xor_b32 v67,192,v64
 v_bfe_u32 v8,v1,3,2
 v_mul_u32_u24 v3,1056,v8
 v_lshrrev_b32 v8,5,v1
 v_lshl_add_u32 v3,v8,8,v3
 v_bfe_u32 v8,v1,2,1
 v_lshl_add_u32 v3,v8,7,v3
 v_and_b32 v8,3,v1
 v_lshl_add_u32 v3,v8,3,v3
 v_add_u32 v3,67584,v3
 v_add_u32 v68,135168,v64
 v_add_u32 v69,135168,v65
 v_add_u32 v70,135168,v66
 v_add_u32 v71,135168,v67
 v_and_b32 v4,15,v1
 s_lshl_b32 s40,s33,5
 v_add_lshl_u32 v4,v4,s40,4
 v_lshrrev_b32 v8,4,v1
 v_mul_u32_u24 v8,1792,v8
 v_add_u32 v4,v4,v8
 v_add_u32 v4,135168,v4
 s_mov_b32 s40,256
 s_cmp_eq_u32 s33,3
 s_cselect_b32 s40,65536,s40
 v_add_u32 v5,s40,v4
 v_and_b32 v6,15,v1
 s_lshl_b32 s40,s33,5
 v_add_lshl_u32 v6,v6,s40,4
 v_lshrrev_b32 v8,5,v1
 v_mul_u32_u24 v8,1792,v8
 v_add_u32 v6,v6,v8
 v_bfe_u32 v8,v1,4,1
 v_lshl_add_u32 v6,v8,3,v6
 v_add_u32 v6,135168,v6
 s_mov_b32 s40,256
 s_cmp_eq_u32 s33,3
 s_cselect_b32 s40,65536,s40
 v_add_u32 v7,s40,v6
 s_lshl_b32 s40,s33,12
 v_add_u32 v1,s40,v14
 s_barrier
 ds_read_b128 v[128:131],v64 offset:33792
 ds_read_b128 v[132:135],v64 offset:37888
 ds_read_b128 v[136:139],v65 offset:33792
 ds_read_b128 v[140:143],v65 offset:37888
 ds_read_b128 v[144:147],v66 offset:33792
 ds_read_b128 v[148:151],v66 offset:37888
 ds_read_b128 v[152:155],v67 offset:33792
 ds_read_b128 v[156:159],v67 offset:37888
 ds_read_b64_tr_b16 v[8:9],v3
 tr 10,3,512
 tr 12,3,32
 tr 14,3,544
 tr 16,3,64
 tr 18,3,576
 tr 20,3,96
 tr 22,3,608
 tr 72,3,4224
 tr 74,3,4736
 tr 76,3,4256
 tr 78,3,4768
 tr 80,3,4288
 tr 82,3,4800
 s_waitcnt lgkmcnt(10)
 mz 96,8,128
 tr 84,3,4320
 tr 86,3,4832
 mz 112,8,132
 mz 100,12,128
 tr 8,3,8448
 tr 10,3,8960
 mz 116,12,132
 s_waitcnt lgkmcnt(10)
 mz 104,16,128
 tr 12,3,8480
 tr 14,3,8992
 mz 120,16,132
 mz 108,20,128
 tr 16,3,8512
 tr 18,3,9024
 mz 124,20,132
 s_waitcnt lgkmcnt(10)
 mf 96,72,136,96
 tr 20,3,8544
 tr 22,3,9056
 mf 112,72,140,112
 mf 100,76,136,100
 tr 72,3,12672
 tr 74,3,13184
 mf 116,76,140,116
 s_waitcnt lgkmcnt(10)
 mf 104,80,136,104
 tr 76,3,12704
 tr 78,3,13216
 mf 120,80,140,120
 mf 108,84,136,108
 tr 80,3,12736
 tr 82,3,13248
 mf 124,84,140,124
 s_waitcnt lgkmcnt(10)
 mf 96,8,144,96
 tr 84,3,12768
 tr 86,3,13280
 mf 112,8,148,112
 mf 100,12,144,100
 mf 116,12,148,116
 s_waitcnt lgkmcnt(8)
 mf 104,16,144,104
 mf 120,16,148,120
 mf 108,20,144,108
 mf 124,20,148,124
 s_waitcnt lgkmcnt(0)
 s_barrier
 tr 8,3,16896
 tr 10,3,17408
 tr 12,3,16928
 tr 14,3,17440
 tr 16,3,16960
 tr 18,3,17472
 mf 96,72,152,96
 tr 20,3,16992
 tr 22,3,17504
 mf 112,72,156,112
 mf 100,76,152,100
 tr 72,3,21120
 tr 74,3,21632
 mf 116,76,156,116
 mf 104,80,152,104
 tr 76,3,21152
 tr 78,3,21664
 mf 120,80,156,120
 mf 108,84,152,108
 tr 80,3,21184
 tr 82,3,21696
 mf 124,84,156,124
 s_waitcnt lgkmcnt(10)
 mz 32,8,128
 tr 84,3,21216
 tr 86,3,21728
 mz 48,8,132
 mz 36,12,128
 tr 8,3,25344
 tr 10,3,25856
 mz 52,12,132
 s_waitcnt lgkmcnt(10)
 mz 40,16,128
 tr 12,3,25376
 tr 14,3,25888
 mz 56,16,132
 mz 44,20,128
 tr 16,3,25408
 tr 18,3,25920
 mz 60,20,132
 s_waitcnt lgkmcnt(10)
 mf 32,72,136,32
 tr 20,3,25440
 tr 22,3,25952
 mf 48,72,140,48
 mf 36,76,136,36
 tr 72,3,29568
 tr 74,3,30080
 mf 52,76,140,52
 s_waitcnt lgkmcnt(10)
 mf 40,80,136,40
 tr 76,3,29600
 tr 78,3,30112
 mf 56,80,140,56
 mf 44,84,136,44
 tr 80,3,29632
 tr 82,3,30144
 mf 60,84,140,60
 s_waitcnt lgkmcnt(10)
 mf 32,8,144,32
 tr 84,3,29664
 tr 86,3,30176
 mf 48,8,148,48
 mf 36,12,144,36
 mf 52,12,148,52
 s_waitcnt lgkmcnt(8)
 mf 40,16,144,40
 mf 56,16,148,56
 mf 44,20,144,44
 mf 60,20,148,60
 s_waitcnt vmcnt(0)
 s_waitcnt lgkmcnt(0)
 s_barrier
 ds_read_b128 v[160:163],v68
 ds_read_b128 v[164:167],v68 offset:4096
 ds_read_b128 v[168:171],v69
 ds_read_b128 v[172:175],v69 offset:4096
 ds_read_b128 v[176:179],v70
 ds_read_b128 v[180:183],v70 offset:4096
 ds_read_b128 v[184:187],v71
 ds_read_b128 v[188:191],v71 offset:4096
 tr 8,3,33792
 tr 10,3,34304
 tr 12,3,33824
 tr 14,3,34336
 tr 16,3,33856
 tr 18,3,34368
 mf 32,72,152,32
 tr 20,3,33888
 tr 22,3,34400
 mf 48,72,156,48
 mf 36,76,152,36
 tr 72,3,38016
 tr 74,3,38528
 mf 52,76,156,52
 mf 40,80,152,40
 tr 76,3,38048
 tr 78,3,38560
 mf 56,80,156,56
 mf 44,84,152,44
 tr 80,3,38080
 tr 82,3,38592
 mf 60,84,156,60
 s_waitcnt lgkmcnt(10)
 mf 96,8,160,96
 tr 84,3,38112
 tr 86,3,38624
 mf 112,8,164,112
 mf 100,12,160,100
 tr 8,3,42240
 tr 10,3,42752
 mf 116,12,164,116
 s_waitcnt lgkmcnt(10)
 mf 104,16,160,104
 tr 12,3,42272
 tr 14,3,42784
 mf 120,16,164,120
 mf 108,20,160,108
 tr 16,3,42304
 tr 18,3,42816
 mf 124,20,164,124
 s_waitcnt lgkmcnt(10)
 mf 96,72,168,96
 tr 20,3,42336
 tr 22,3,42848
 mf 112,72,172,112
 mf 100,76,168,100
 tr 72,3,46464
 tr 74,3,46976
 mf 116,76,172,116
 s_waitcnt lgkmcnt(10)
 mf 104,80,168,104
 tr 76,3,46496
 tr 78,3,47008
 mf 120,80,172,120
 mf 108,84,168,108
 tr 80,3,46528
 tr 82,3,47040
 mf 124,84,172,124
 s_waitcnt lgkmcnt(10)
 mf 96,8,176,96
 tr 84,3,46560
 tr 86,3,47072
 mf 112,8,180,112
 mf 100,12,176,100
 mf 116,12,180,116
 s_waitcnt lgkmcnt(8)
 mf 104,16,176,104
 mf 120,16,180,120
 mf 108,20,176,108
 mf 124,20,180,124
 s_waitcnt lgkmcnt(0)
 s_barrier
 tr 8,3,50688
 tr 10,3,51200
 tr 12,3,50720
 tr 14,3,51232
 tr 16,3,50752
 tr 18,3,51264
 mf 96,72,184,96
 tr 20,3,50784
 tr 22,3,51296
 mf 112,72,188,112
 mf 100,76,184,100
 tr 72,3,54912
 tr 74,3,55424
 mf 116,76,188,116
 mf 104,80,184,104
 tr 76,3,54944
 tr 78,3,55456
 mf 120,80,188,120
 mf 108,84,184,108
 tr 80,3,54976
 tr 82,3,55488
 mf 124,84,188,124
 s_waitcnt lgkmcnt(10)
 mf 32,8,160,32
 tr 84,3,55008
 tr 86,3,55520
 mf 48,8,164,48
 mf 36,12,160,36
 tr 8,3,59136
 tr 10,3,59648
 mf 52,12,164,52
 s_waitcnt lgkmcnt(10)
 mf 40,16,160,40
 tr 12,3,59168
 tr 14,3,59680
 mf 56,16,164,56
 mf 44,20,160,44
 tr 16,3,59200
 tr 18,3,59712
 mf 60,20,164,60
 s_waitcnt lgkmcnt(10)
 mf 32,72,168,32
 tr 20,3,59232
 tr 22,3,59744
 mf 48,72,172,48
 mf 36,76,168,36
 tr 72,3,63360
 tr 74,3,63872
 mf 52,76,172,52
 s_waitcnt lgkmcnt(10)
 mf 40,80,168,40
 tr 76,3,63392
 tr 78,3,63904
 mf 56,80,172,56
 mf 44,84,168,44
 tr 80,3,63424
 tr 82,3,63936
 mf 60,84,172,60
 s_waitcnt lgkmcnt(10)
 mf 32,8,176,32
 tr 84,3,63456
 tr 86,3,63968
 mf 48,8,180,48
 mf 36,12,176,36
 mf 52,12,180,52
 s_waitcnt lgkmcnt(8)
 mf 40,16,176,40
 mf 56,16,180,56
 mf 44,20,176,44
 mf 60,20,180,60
 s_waitcnt lgkmcnt(0)
 s_barrier
 ds_read_b128 v[192:195],v64 offset:33792
 ds_read_b128 v[196:199],v64 offset:37888
 ds_read_b128 v[200:203],v65 offset:33792
 ds_read_b128 v[204:207],v65 offset:37888
 ds_read_b128 v[208:211],v66 offset:33792
 ds_read_b128 v[212:215],v66 offset:37888
 ds_read_b128 v[216:219],v67 offset:33792
 ds_read_b128 v[220:223],v67 offset:37888
 ds_read_b64_tr_b16 v[8:9],v3
 tr 10,3,512
 tr 12,3,32
 tr 14,3,544
 tr 16,3,64
 tr 18,3,576
 mf 32,72,184,32
 tr 20,3,96
 tr 22,3,608
 mf 48,72,188,48
 mf 36,76,184,36
 tr 72,3,4224
 tr 74,3,4736
 mf 52,76,188,52
 mf 40,80,184,40
 tr 76,3,4256
 tr 78,3,4768
 mf 56,80,188,56
 mf 44,84,184,44
 tr 80,3,4288
 tr 82,3,4800
 mf 60,84,188,60
 s_waitcnt lgkmcnt(10)
 mf 96,8,192,96
 tr 84,3,4320
 tr 86,3,4832
 mf 112,8,196,112
 mf 100,12,192,100
 tr 8,3,8448
 tr 10,3,8960
 mf 116,12,196,116
 s_waitcnt lgkmcnt(10)
 mf 104,16,192,104
 tr 12,3,8480
 tr 14,3,8992
 mf 120,16,196,120
 mf 108,20,192,108
 tr 16,3,8512
 tr 18,3,9024
 mf 124,20,196,124
 s_waitcnt lgkmcnt(10)
 mf 96,72,200,96
 tr 20,3,8544
 tr 22,3,9056
 mf 112,72,204,112
 mf 100,76,200,100
 tr 72,3,12672
 tr 74,3,13184
 mf 116,76,204,116
 s_waitcnt lgkmcnt(10)
 mf 104,80,200,104
 tr 76,3,12704
 tr 78,3,13216
 mf 120,80,204,120
 mf 108,84,200,108
 tr 80,3,12736
 tr 82,3,13248
 mf 124,84,204,124
 s_waitcnt lgkmcnt(10)
 mf 96,8,208,96
 tr 84,3,12768
 tr 86,3,13280
 mf 112,8,212,112
 mf 100,12,208,100
 mf 116,12,212,116
 s_waitcnt lgkmcnt(8)
 mf 104,16,208,104
 mf 120,16,212,120
 mf 108,20,208,108
 mf 124,20,212,124
 s_waitcnt lgkmcnt(0)
 s_barrier
 ds_read_b128 v[224:227],v68
 ds_read_b128 v[228:231],v68 offset:4096
 ds_read_b128 v[232:235],v69
 ds_read_b128 v[236:239],v69 offset:4096
 ds_read_b128 v[240:243],v70
 ds_read_b128 v[244:247],v70 offset:4096
 ds_read_b128 v[248:251],v71
 ds_read_b128 v[252:255],v71 offset:4096
 tr 8,3,16896
 tr 10,3,17408
 tr 12,3,16928
 tr 14,3,17440
 tr 16,3,16960
 tr 18,3,17472
 mf 96,72,216,96
 tr 20,3,16992
 tr 22,3,17504
 s_xor_b32 s46,s53,0
 s_add_u32 s46,s46,s44
 s_add_u32 m0,s41,67584
 s_add_u32 s40,s46,256
 mf 112,72,220,112
 mf 100,76,216,100
 tr 72,3,21120
 tr 74,3,21632
 mf 116,76,220,116
 mf 104,80,216,104
 tr 76,3,21152
 tr 78,3,21664
 mf 120,80,220,120
 mf 108,84,216,108
 tr 80,3,21184
 tr 82,3,21696
 mf 124,84,220,124
 s_waitcnt lgkmcnt(10)
 mf 96,8,224,96
 tr 84,3,21216
 tr 86,3,21728
 mf 112,8,228,112
 mf 100,12,224,100
 tr 8,3,25344
 tr 10,3,25856
 mf 116,12,228,116
 s_waitcnt lgkmcnt(10)
 mf 104,16,224,104
 tr 12,3,25376
 tr 14,3,25888
 mf 120,16,228,120
 mf 108,20,224,108
 tr 16,3,25408
 tr 18,3,25920
 mf 124,20,228,124
 s_waitcnt lgkmcnt(10)
 mf 96,72,232,96
 tr 20,3,25440
 tr 22,3,25952
 mf 112,72,236,112
 mf 100,76,232,100
 tr 72,3,29568
 tr 74,3,30080
 mf 116,76,236,116
 s_waitcnt lgkmcnt(10)
 mf 104,80,232,104
 tr 76,3,29600
 tr 78,3,30112
 mf 120,80,236,120
 mf 108,84,232,108
 tr 80,3,29632
 tr 82,3,30144
 mf 124,84,236,124
 s_waitcnt lgkmcnt(10)
 mf 96,8,240,96
 tr 84,3,29664
 tr 86,3,30176
 buffer_load_dwordx4 v2,s[16:19],s40 offen lds
 mf 112,8,244,112
 s_add_u32 m0,s41,68640
 s_add_u32 s40,s46,16640
 mf 100,12,240,100
 buffer_load_dwordx4 v2,s[16:19],s40 offen lds
 mf 116,12,244,116
 s_add_u32 m0,s41,69696
 s_add_u32 s40,s46,65792
 s_waitcnt lgkmcnt(8)
 mf 104,16,240,104
 buffer_load_dwordx4 v2,s[16:19],s40 offen lds
 mf 120,16,244,120
 s_add_u32 m0,s41,70752
 s_add_u32 s40,s46,82176
 mf 108,20,240,108
 buffer_load_dwordx4 v2,s[16:19],s40 offen lds
 mf 124,20,244,124
 s_waitcnt lgkmcnt(0)
 s_barrier
 tr 8,3,33792
 tr 10,3,34304
 tr 12,3,33824
 tr 14,3,34336
 tr 16,3,33856
 tr 18,3,34368
 mf 96,72,248,96
 tr 20,3,33888
 tr 22,3,34400
 s_xor_b32 s46,s53,1048576
 s_add_u32 s46,s46,s44
 s_add_u32 m0,s41,84480
 s_add_u32 s40,s46,256
 buffer_load_dwordx4 v2,s[16:19],s40 offen lds
 mf 112,72,252,112
 s_add_u32 m0,s41,85536
 s_add_u32 s40,s46,16640
 buffer_load_dwordx4 v2,s[16:19],s40 offen lds
 mf 100,76,248,100
 tr 72,3,38016
 tr 74,3,38528
 s_add_u32 m0,s41,86592
 mf 116,76,252,116
 mf 104,80,248,104
 tr 76,3,38048
 tr 78,3,38560
 mf 120,80,252,120
 mf 108,84,248,108
 tr 80,3,38080
 tr 82,3,38592
 mf 124,84,252,124
 s_waitcnt lgkmcnt(10)
 mf 32,8,192,32
 tr 84,3,38112
 tr 86,3,38624
 mf 48,8,196,48
 v_mul_f32 v96,s38,v96
 v_mul_f32 v97,s38,v97
 v_mul_f32 v98,s38,v98
 mf 36,12,192,36
 tr 8,3,42240
 tr 10,3,42752
 v_mul_f32 v99,s38,v99
 v_mul_f32 v100,s38,v100
 v_mul_f32 v101,s38,v101
 v_mul_f32 v102,s38,v102
 mf 52,12,196,52
 v_mul_f32 v103,s38,v103
 cv 96,96,97
 cv 97,98,99
 s_waitcnt lgkmcnt(10)
 mf 40,16,192,40
 tr 12,3,42272
 tr 14,3,42784
 cv 98,100,101
 cv 99,102,103
 ds_write_b64 v6,v[96:97]
 mf 56,16,196,56
 ds_write_b64 v6,v[98:99] offset:3584
 mf 44,20,192,44
 tr 16,3,42304
 tr 18,3,42816
 v_mul_f32 v104,s38,v104
 v_mul_f32 v105,s38,v105
 v_mul_f32 v106,s38,v106
 mf 60,20,196,60
 v_mul_f32 v107,s38,v107
 v_mul_f32 v108,s38,v108
 v_mul_f32 v109,s38,v109
 s_waitcnt lgkmcnt(12)
 mf 32,72,200,32
 tr 20,3,42336
 tr 22,3,42848
 v_mul_f32 v110,s38,v110
 v_mul_f32 v111,s38,v111
 cv 104,104,105
 cv 105,106,107
 mf 48,72,204,48
 cv 106,108,109
 cv 107,110,111
 mf 36,76,200,36
 tr 72,3,46464
 tr 74,3,46976
 ds_write_b64 v6,v[104:105] offset:7168
 mf 52,76,204,52
 ds_write_b64 v6,v[106:107] offset:10752
 v_mul_f32 v112,s38,v112
 s_waitcnt lgkmcnt(14)
 mf 40,80,200,40
 tr 76,3,46496
 tr 78,3,47008
 v_mul_f32 v113,s38,v113
 v_mul_f32 v114,s38,v114
 v_mul_f32 v115,s38,v115
 v_mul_f32 v116,s38,v116
 mf 56,80,204,56
 v_mul_f32 v117,s38,v117
 v_mul_f32 v118,s38,v118
 v_mul_f32 v119,s38,v119
 cv 112,112,113
 mf 44,84,200,44
 tr 80,3,46528
 tr 82,3,47040
 cv 113,114,115
 cv 114,116,117
 cv 115,118,119
 mf 60,84,204,60
 ds_write_b64 v7,v[112:113]
 s_waitcnt lgkmcnt(15)
 mf 32,8,208,32
 tr 84,3,46560
 tr 86,3,47072
 ds_write_b64 v7,v[114:115] offset:3584
 v_mul_f32 v120,s38,v120
 mf 48,8,212,48
 v_mul_f32 v121,s38,v121
 v_mul_f32 v122,s38,v122
 v_mul_f32 v123,s38,v123
 v_mul_f32 v124,s38,v124
 mf 36,12,208,36
 v_mul_f32 v125,s38,v125
 v_mul_f32 v126,s38,v126
 v_mul_f32 v127,s38,v127
 cv 120,120,121
 mf 52,12,212,52
 cv 121,122,123
 cv 122,124,125
 cv 123,126,127
 s_waitcnt lgkmcnt(12)
 mf 40,16,208,40
 ds_write_b64 v7,v[120:121] offset:7168
 mf 56,16,212,56
 ds_write_b64 v7,v[122:123] offset:10752
 s_add_u32 s40,s46,65792
 mf 44,20,208,44
 buffer_load_dwordx4 v2,s[16:19],s40 offen lds
 s_add_u32 m0,s41,87648
 mf 60,20,212,60
 s_add_u32 s40,s46,82176
 buffer_load_dwordx4 v2,s[16:19],s40 offen lds
 s_waitcnt lgkmcnt(0)
 s_barrier
 tr 8,3,50688
 tr 10,3,51200
 tr 12,3,50720
 tr 14,3,51232
 tr 16,3,50752
 tr 18,3,51264
 mf 32,72,216,32
 tr 20,3,50784
 tr 22,3,51296
 s_xor_b32 s46,s53,2097152
 s_add_u32 s46,s46,s44
 s_add_u32 m0,s41,101376
 s_add_u32 s40,s46,256
 mf 48,72,220,48
 mf 36,76,216,36
 tr 72,3,54912
 tr 74,3,55424
 mf 52,76,220,52
 mf 40,80,216,40
 tr 76,3,54944
 tr 78,3,55456
 mf 56,80,220,56
 mf 44,84,216,44
 tr 80,3,54976
 tr 82,3,55488
 mf 60,84,220,60
 s_waitcnt lgkmcnt(10)
 mf 32,8,224,32
 tr 84,3,55008
 tr 86,3,55520
 mf 48,8,228,48
 mf 36,12,224,36
 tr 8,3,59136
 tr 10,3,59648
 mf 52,12,228,52
 s_waitcnt lgkmcnt(10)
 mf 40,16,224,40
 tr 12,3,59168
 tr 14,3,59680
 mf 56,16,228,56
 mf 44,20,224,44
 tr 16,3,59200
 tr 18,3,59712
 mf 60,20,228,60
 s_waitcnt lgkmcnt(10)
 mf 32,72,232,32
 tr 20,3,59232
 tr 22,3,59744
 mf 48,72,236,48
 mf 36,76,232,36
 tr 72,3,63360
 tr 74,3,63872
 mf 52,76,236,52
 s_waitcnt lgkmcnt(10)
 mf 40,80,232,40
 tr 76,3,63392
 tr 78,3,63904
 mf 56,80,236,56
 mf 44,84,232,44
 tr 80,3,63424
 tr 82,3,63936
 mf 60,84,236,60
 s_waitcnt lgkmcnt(10)
 mf 32,8,240,32
 tr 84,3,63456
 tr 86,3,63968
 mf 48,8,244,48
 mf 36,12,240,36
 mf 52,12,244,52
 s_waitcnt lgkmcnt(8)
 mf 40,16,240,40
 mf 56,16,244,56
 mf 44,20,240,44
 mf 60,20,244,60
 s_waitcnt lgkmcnt(4)
 mf 32,72,248,32
 buffer_load_dwordx4 v2,s[16:19],s40 offen lds
 mf 48,72,252,48
 s_add_u32 m0,s41,102432
 s_add_u32 s40,s46,16640
 mf 36,76,248,36
 buffer_load_dwordx4 v2,s[16:19],s40 offen lds
 mf 52,76,252,52
 s_add_u32 m0,s41,103488
 s_add_u32 s40,s46,65792
 s_waitcnt lgkmcnt(0)
 mf 40,80,248,40
 buffer_load_dwordx4 v2,s[16:19],s40 offen lds
 mf 56,80,252,56
 s_add_u32 m0,s41,104544
 s_add_u32 s40,s46,82176
 mf 44,84,248,44
 buffer_load_dwordx4 v2,s[16:19],s40 offen lds
 mf 60,84,252,60
 v_mul_f32 v32,s38,v32
 v_mul_f32 v33,s38,v33
 v_mul_f32 v34,s38,v34
 v_mul_f32 v35,s38,v35
 v_mul_f32 v36,s38,v36
 v_mul_f32 v37,s38,v37
 v_mul_f32 v38,s38,v38
 v_mul_f32 v39,s38,v39
 cv 32,32,33
 cv 33,34,35
 cv 34,36,37
 cv 35,38,39
 ds_write_b64 v6,v[32:33] offset:14336
 ds_write_b64 v6,v[34:35] offset:17920
 v_mul_f32 v40,s38,v40
 v_mul_f32 v41,s38,v41
 v_mul_f32 v42,s38,v42
 v_mul_f32 v43,s38,v43
 v_mul_f32 v44,s38,v44
 v_mul_f32 v45,s38,v45
 v_mul_f32 v46,s38,v46
 v_mul_f32 v47,s38,v47
 cv 40,40,41
 cv 41,42,43
 cv 42,44,45
 cv 43,46,47
 ds_write_b64 v6,v[40:41] offset:21504
 ds_write_b64 v6,v[42:43] offset:25088
 v_mul_f32 v48,s38,v48
 v_mul_f32 v49,s38,v49
 v_mul_f32 v50,s38,v50
 v_mul_f32 v51,s38,v51
 v_mul_f32 v52,s38,v52
 v_mul_f32 v53,s38,v53
 v_mul_f32 v54,s38,v54
 v_mul_f32 v55,s38,v55
 cv 48,48,49
 cv 49,50,51
 cv 50,52,53
 cv 51,54,55
 ds_write_b64 v7,v[48:49] offset:14336
 ds_write_b64 v7,v[50:51] offset:17920
 v_mul_f32 v56,s38,v56
 v_mul_f32 v57,s38,v57
 v_mul_f32 v58,s38,v58
 v_mul_f32 v59,s38,v59
 v_mul_f32 v60,s38,v60
 v_mul_f32 v61,s38,v61
 v_mul_f32 v62,s38,v62
 v_mul_f32 v63,s38,v63
 cv 56,56,57
 cv 57,58,59
 cv 58,60,61
 cv 59,62,63
 ds_write_b64 v7,v[56:57] offset:21504
 ds_write_b64 v7,v[58:59] offset:25088
 s_waitcnt vmcnt(8)
 s_waitcnt lgkmcnt(0)
 s_barrier
 ds_read_b64_tr_b16 v[16:17],v3
 tr 18,3,512
 tr 20,3,32
 tr 22,3,544
 tr 24,3,64
 tr 26,3,576
 tr 28,3,96
 tr 30,3,608
 tr 8,3,4224
 tr 10,3,4736
 s_waitcnt lgkmcnt(6)
 mz 96,16,128
 tr 12,3,4256
 tr 14,3,4768
 s_xor_b32 s46,s53,3145728
 s_add_u32 s46,s46,s44
 s_add_u32 m0,s41,118272
 s_add_u32 s40,s46,256
 mz 112,16,132
 mz 100,20,128
 tr 16,3,4288
 tr 18,3,4800
 mz 116,20,132
 s_waitcnt lgkmcnt(6)
 mz 104,24,128
 tr 20,3,4320
 tr 22,3,4832
 mz 120,24,132
 mz 108,28,128
 tr 24,3,8448
 tr 26,3,8960
 mz 124,28,132
 s_waitcnt lgkmcnt(6)
 mf 96,8,136,96
 tr 28,3,8480
 tr 30,3,8992
 mf 112,8,140,112
 mf 100,12,136,100
 tr 8,3,8512
 tr 10,3,9024
 mf 116,12,140,116
 s_waitcnt lgkmcnt(6)
 mf 104,16,136,104
 tr 12,3,8544
 tr 14,3,9056
 mf 120,16,140,120
 mf 108,20,136,108
 tr 16,3,12672
 tr 18,3,13184
 mf 124,20,140,124
 s_waitcnt lgkmcnt(6)
 mf 96,24,144,96
 tr 20,3,12704
 tr 22,3,13216
 mf 112,24,148,112
 mf 100,28,144,100
 tr 24,3,12736
 tr 26,3,13248
 buffer_load_dwordx4 v2,s[16:19],s40 offen lds
 mf 116,28,148,116
 s_add_u32 m0,s41,119328
 s_add_u32 s40,s46,16640
 s_waitcnt lgkmcnt(6)
 mf 104,8,144,104
 tr 28,3,12768
 tr 30,3,13280
 buffer_load_dwordx4 v2,s[16:19],s40 offen lds
 mf 120,8,148,120
 s_add_u32 m0,s41,120384
 s_add_u32 s40,s46,65792
 mf 108,12,144,108
 buffer_load_dwordx4 v2,s[16:19],s40 offen lds
 mf 124,12,148,124
 s_add_u32 m0,s41,121440
 s_add_u32 s40,s46,82176
 s_waitcnt lgkmcnt(4)
 mf 96,16,152,96
 buffer_load_dwordx4 v2,s[16:19],s40 offen lds
 mf 112,16,156,112
 s_waitcnt vmcnt(8)
 s_waitcnt lgkmcnt(0)
 s_barrier
 tr 8,3,16896
 tr 10,3,17408
 tr 12,3,16928
 tr 14,3,17440
 mf 100,20,152,100
 tr 16,3,16960
 tr 18,3,17472
 s_xor_b32 s46,s53,0
 s_add_u32 s46,s46,s44
 s_add_u32 m0,s41,67584
 s_add_u32 s40,s46,384
 mf 116,20,156,116
 mf 104,24,152,104
 tr 20,3,16992
 tr 22,3,17504
 mf 120,24,156,120
 mf 108,28,152,108
 tr 24,3,21120
 tr 26,3,21632
 mf 124,28,156,124
 s_waitcnt lgkmcnt(6)
 mf 96,8,160,96
 tr 28,3,21152
 tr 30,3,21664
 mf 112,8,164,112
 mf 100,12,160,100
 tr 8,3,21184
 tr 10,3,21696
 mf 116,12,164,116
 s_waitcnt lgkmcnt(6)
 mf 104,16,160,104
 tr 12,3,21216
 tr 14,3,21728
 mf 120,16,164,120
 mf 108,20,160,108
 buffer_load_dwordx4 v2,s[16:19],s40 offen lds
 mf 124,20,164,124
 s_add_u32 m0,s41,68640
 s_add_u32 s40,s46,16768
 s_waitcnt lgkmcnt(4)
 mf 96,24,168,96
 buffer_load_dwordx4 v2,s[16:19],s40 offen lds
 mf 112,24,172,112
 s_waitcnt vmcnt(6)
 s_waitcnt lgkmcnt(0)
 s_barrier
 tr 16,3,25344
 tr 18,3,25856
 tr 20,3,25376
 tr 22,3,25888
 mf 100,28,168,100
 tr 24,3,25408
 tr 26,3,25920
 s_xor_b32 s46,s53,0
 s_add_u32 s46,s46,s44
 s_add_u32 m0,s41,69696
 s_add_u32 s40,s46,65920
 mf 116,28,172,116
 mf 104,8,168,104
 tr 28,3,25440
 tr 30,3,25952
 mf 120,8,172,120
 mf 108,12,168,108
 tr 8,3,29568
 tr 10,3,30080
 mf 124,12,172,124
 s_waitcnt lgkmcnt(6)
 mf 96,16,176,96
 tr 12,3,29600
 tr 14,3,30112
 mf 112,16,180,112
 mf 100,20,176,100
 tr 16,3,29632
 tr 18,3,30144
 mf 116,20,180,116
 s_waitcnt lgkmcnt(6)
 mf 104,24,176,104
 tr 20,3,29664
 tr 22,3,30176
 mf 120,24,180,120
 mf 108,28,176,108
 tr 24,3,33792
 tr 26,3,34304
 mf 124,28,180,124
 s_waitcnt lgkmcnt(6)
 mf 96,8,184,96
 tr 28,3,33824
 tr 30,3,34336
 mf 112,8,188,112
 mf 100,12,184,100
 tr 8,3,33856
 tr 10,3,34368
 mf 116,12,188,116
 s_waitcnt lgkmcnt(6)
 mf 104,16,184,104
 tr 12,3,33888
 tr 14,3,34400
 mf 120,16,188,120
 mf 108,20,184,108
 buffer_load_dwordx4 v2,s[16:19],s40 offen lds
 mf 124,20,188,124
 s_add_u32 m0,s41,70752
 s_add_u32 s40,s46,82304
 s_waitcnt lgkmcnt(4)
 mf 96,24,192,96
 buffer_load_dwordx4 v2,s[16:19],s40 offen lds
 mf 112,24,196,112
 s_waitcnt lgkmcnt(0)
 s_barrier
 tr 16,3,38016
 tr 18,3,38528
 tr 20,3,38048
 tr 22,3,38560
 mf 100,28,192,100
 tr 24,3,38080
 tr 26,3,38592
 s_xor_b32 s46,s53,1048576
 s_add_u32 s46,s46,s44
 s_add_u32 m0,s41,84480
 s_add_u32 s40,s46,384
 mf 116,28,196,116
 mf 104,8,192,104
 tr 28,3,38112
 tr 30,3,38624
 mf 120,8,196,120
 mf 108,12,192,108
 tr 8,3,42240
 tr 10,3,42752
 mf 124,12,196,124
 s_waitcnt lgkmcnt(6)
 mf 96,16,200,96
 tr 12,3,42272
 tr 14,3,42784
 mf 112,16,204,112
 mf 100,20,200,100
 tr 16,3,42304
 tr 18,3,42816
 mf 116,20,204,116
 s_waitcnt lgkmcnt(6)
 mf 104,24,200,104
 tr 20,3,42336
 tr 22,3,42848
 mf 120,24,204,120
 mf 108,28,200,108
 buffer_load_dwordx4 v2,s[16:19],s40 offen lds
 mf 124,28,204,124
 s_add_u32 m0,s41,85536
 s_add_u32 s40,s46,16768
 s_waitcnt lgkmcnt(4)
 mf 96,8,208,96
 buffer_load_dwordx4 v2,s[16:19],s40 offen lds
 mf 112,8,212,112
 s_waitcnt vmcnt(6)
 s_waitcnt lgkmcnt(0)
 s_barrier
 tr 24,3,46464
 tr 26,3,46976
 tr 28,3,46496
 tr 30,3,47008
 mf 100,12,208,100
 tr 8,3,46528
 tr 10,3,47040
 s_xor_b32 s46,s53,1048576
 s_add_u32 s46,s46,s44
 s_add_u32 m0,s41,86592
 s_add_u32 s40,s46,65920
 mf 116,12,212,116
 mf 104,16,208,104
 tr 12,3,46560
 tr 14,3,47072
 mf 120,16,212,120
 mf 108,20,208,108
 tr 16,3,50688
 tr 18,3,51200
 mf 124,20,212,124
 s_waitcnt lgkmcnt(6)
 mf 96,24,216,96
 tr 20,3,50720
 tr 22,3,51232
 mf 112,24,220,112
 mf 100,28,216,100
 tr 24,3,50752
 tr 26,3,51264
 mf 116,28,220,116
 s_waitcnt lgkmcnt(6)
 mf 104,8,216,104
 tr 28,3,50784
 tr 30,3,51296
 mf 120,8,220,120
 mf 108,12,216,108
 tr 8,3,54912
 tr 10,3,55424
 mf 124,12,220,124
 s_waitcnt lgkmcnt(6)
 mf 96,16,224,96
 tr 12,3,54944
 tr 14,3,55456
 mf 112,16,228,112
 mf 100,20,224,100
 tr 16,3,54976
 tr 18,3,55488
 mf 116,20,228,116
 s_waitcnt lgkmcnt(6)
 mf 104,24,224,104
 tr 20,3,55008
 tr 22,3,55520
 mf 120,24,228,120
 mf 108,28,224,108
 buffer_load_dwordx4 v2,s[16:19],s40 offen lds
 mf 124,28,228,124
 s_add_u32 m0,s41,87648
 s_add_u32 s40,s46,82304
 s_waitcnt lgkmcnt(4)
 mf 96,8,232,96
 buffer_load_dwordx4 v2,s[16:19],s40 offen lds
 mf 112,8,236,112
 s_waitcnt lgkmcnt(0)
 s_barrier
 tr 24,3,59136
 tr 26,3,59648
 tr 28,3,59168
 tr 30,3,59680
 mf 100,12,232,100
 tr 8,3,59200
 tr 10,3,59712
 s_xor_b32 s46,s53,2097152
 s_add_u32 s46,s46,s44
 s_add_u32 m0,s41,101376
 s_add_u32 s40,s46,384
 mf 116,12,236,116
 mf 104,16,232,104
 tr 12,3,59232
 tr 14,3,59744
 mf 120,16,236,120
 mf 108,20,232,108
 tr 16,3,63360
 tr 18,3,63872
 mf 124,20,236,124
 s_waitcnt lgkmcnt(6)
 mf 96,24,240,96
 tr 20,3,63392
 tr 22,3,63904
 mf 112,24,244,112
 mf 100,28,240,100
 tr 24,3,63424
 tr 26,3,63936
 mf 116,28,244,116
 s_waitcnt lgkmcnt(6)
 mf 104,8,240,104
 tr 28,3,63456
 tr 30,3,63968
 mf 120,8,244,120
 mf 108,12,240,108
 buffer_load_dwordx4 v2,s[16:19],s40 offen lds
 mf 124,12,244,124
 s_add_u32 m0,s41,102432
 s_add_u32 s40,s46,16768
 s_waitcnt lgkmcnt(4)
 mf 96,16,248,96
 buffer_load_dwordx4 v2,s[16:19],s40 offen lds
 mf 112,16,252,112
 s_waitcnt vmcnt(6)
 s_waitcnt lgkmcnt(0)
 s_barrier
 ds_read_b64_tr_b16 v[8:9],v3
 tr 10,3,512
 tr 12,3,32
 tr 14,3,544
 mf 100,20,248,100
 tr 16,3,64
 tr 18,3,576
 s_xor_b32 s46,s53,2097152
 s_add_u32 s46,s46,s44
 s_add_u32 m0,s41,103488
 s_add_u32 s40,s46,65920
 buffer_load_dwordx4 v2,s[16:19],s40 offen lds
 s_add_u32 m0,s41,104544
 s_add_u32 s40,s46,82304
 buffer_load_dwordx4 v2,s[16:19],s40 offen lds
 s_xor_b32 s46,s53,3145728
 mf 116,20,252,116
 mf 104,24,248,104
 tr 20,3,96
 tr 22,3,608
 mf 120,24,252,120
 mf 108,28,248,108
 mf 124,28,252,124
 v_mul_f32 v96,s38,v96
 v_mul_f32 v97,s38,v97
 v_mul_f32 v98,s38,v98
 v_mul_f32 v99,s38,v99
 v_mul_f32 v100,s38,v100
 v_mul_f32 v101,s38,v101
 v_mul_f32 v102,s38,v102
 v_mul_f32 v103,s38,v103
 cv 96,96,97
 cv 97,98,99
 cv 98,100,101
 cv 99,102,103
 ds_write_b64 v6,v[96:97]
 ds_write_b64 v6,v[98:99] offset:3584
 v_mul_f32 v104,s38,v104
 v_mul_f32 v105,s38,v105
 v_mul_f32 v106,s38,v106
 v_mul_f32 v107,s38,v107
 v_mul_f32 v108,s38,v108
 v_mul_f32 v109,s38,v109
 v_mul_f32 v110,s38,v110
 v_mul_f32 v111,s38,v111
 cv 104,104,105
 cv 105,106,107
 cv 106,108,109
 cv 107,110,111
 ds_write_b64 v6,v[104:105] offset:7168
 ds_write_b64 v6,v[106:107] offset:10752
 v_mul_f32 v112,s38,v112
 v_mul_f32 v113,s38,v113
 v_mul_f32 v114,s38,v114
 v_mul_f32 v115,s38,v115
 v_mul_f32 v116,s38,v116
 v_mul_f32 v117,s38,v117
 v_mul_f32 v118,s38,v118
 v_mul_f32 v119,s38,v119
 cv 112,112,113
 cv 113,114,115
 cv 114,116,117
 cv 115,118,119
 ds_write_b64 v7,v[112:113]
 ds_write_b64 v7,v[114:115] offset:3584
 v_mul_f32 v120,s38,v120
 v_mul_f32 v121,s38,v121
 v_mul_f32 v122,s38,v122
 v_mul_f32 v123,s38,v123
 v_mul_f32 v124,s38,v124
 v_mul_f32 v125,s38,v125
 v_mul_f32 v126,s38,v126
 v_mul_f32 v127,s38,v127
 cv 120,120,121
 cv 121,122,123
 cv 122,124,125
 cv 123,126,127
 ds_write_b64 v7,v[120:121] offset:7168
 ds_write_b64 v7,v[122:123] offset:10752
 s_waitcnt lgkmcnt(12)
 mz 96,8,128
 s_add_u32 s46,s46,s44
 s_add_u32 m0,s41,118272
 s_add_u32 s40,s46,384
 mz 112,8,132
 buffer_load_dwordx4 v2,s[16:19],s40 offen lds
 s_waitcnt lgkmcnt(0)
 s_barrier
 tr 24,3,4224
 tr 26,3,4736
 tr 28,3,4256
 tr 30,3,4768
 mz 100,12,128
 tr 8,3,4288
 tr 10,3,4800
 s_xor_b32 s46,s53,3145728
 s_add_u32 s46,s46,s44
 s_add_u32 m0,s41,119328
 s_add_u32 s40,s46,16768
 mz 116,12,132
 mz 104,16,128
 tr 12,3,4320
 tr 14,3,4832
 mz 120,16,132
 mz 108,20,128
 tr 16,3,8448
 tr 18,3,8960
 mz 124,20,132
 s_waitcnt lgkmcnt(6)
 mf 96,24,136,96
 tr 20,3,8480
 tr 22,3,8992
 mf 112,24,140,112
 mf 100,28,136,100
 tr 24,3,8512
 tr 26,3,9024
 mf 116,28,140,116
 s_waitcnt lgkmcnt(6)
 mf 104,8,136,104
 tr 28,3,8544
 tr 30,3,9056
 mf 120,8,140,120
 mf 108,12,136,108
 buffer_load_dwordx4 v2,s[16:19],s40 offen lds
 mf 124,12,140,124
 s_add_u32 m0,s41,120384
 s_add_u32 s40,s46,65920
 s_waitcnt lgkmcnt(4)
 mf 96,16,144,96
 buffer_load_dwordx4 v2,s[16:19],s40 offen lds
 mf 112,16,148,112
 s_waitcnt vmcnt(7)
 s_waitcnt lgkmcnt(0)
 s_barrier
 tr 8,3,12672
 tr 10,3,13184
 tr 12,3,12704
 tr 14,3,13216
 mf 100,20,144,100
 tr 16,3,12736
 tr 18,3,13248
 s_xor_b32 s46,s53,3145728
 s_add_u32 s46,s46,s44
 s_add_u32 m0,s41,121440
 s_add_u32 s40,s46,82304
 mf 116,20,148,116
 mf 104,24,144,104
 tr 20,3,12768
 tr 22,3,13280
 mf 120,24,148,120
 mf 108,28,144,108
 tr 24,3,16896
 tr 26,3,17408
 mf 124,28,148,124
 s_waitcnt lgkmcnt(6)
 mf 96,8,152,96
 tr 28,3,16928
 tr 30,3,17440
 mf 112,8,156,112
 mf 100,12,152,100
 tr 8,3,16960
 tr 10,3,17472
 mf 116,12,156,116
 s_waitcnt lgkmcnt(6)
 mf 104,16,152,104
 tr 12,3,16992
 tr 14,3,17504
 mf 120,16,156,120
 mf 108,20,152,108
 tr 16,3,21120
 tr 18,3,21632
 mf 124,20,156,124
 s_waitcnt lgkmcnt(6)
 mf 96,24,160,96
 tr 20,3,21152
 tr 22,3,21664
 mf 112,24,164,112
 mf 100,28,160,100
 tr 24,3,21184
 tr 26,3,21696
 mf 116,28,164,116
 s_waitcnt lgkmcnt(6)
 mf 104,8,160,104
 tr 28,3,21216
 tr 30,3,21728
 mf 120,8,164,120
 mf 108,12,160,108
 mf 124,12,164,124
 s_waitcnt lgkmcnt(4)
 mf 96,16,168,96
 buffer_load_dwordx4 v2,s[16:19],s40 offen lds
 mf 112,16,172,112
 s_waitcnt lgkmcnt(0)
 s_barrier
 tr 8,3,25344
 tr 10,3,25856
 tr 12,3,25376
 tr 14,3,25888
 mf 100,20,168,100
 tr 16,3,25408
 tr 18,3,25920
 s_xor_b32 s46,s53,0
 s_add_u32 s46,s46,s44
 s_add_u32 m0,s41,67584
 s_add_u32 s40,s46,512
 mf 116,20,172,116
 mf 104,24,168,104
 tr 20,3,25440
 tr 22,3,25952
 mf 120,24,172,120
 mf 108,28,168,108
 tr 24,3,29568
 tr 26,3,30080
 mf 124,28,172,124
 s_waitcnt lgkmcnt(6)
 mf 96,8,176,96
 tr 28,3,29600
 tr 30,3,30112
 mf 112,8,180,112
 mf 100,12,176,100
 tr 8,3,29632
 tr 10,3,30144
 mf 116,12,180,116
 s_waitcnt lgkmcnt(6)
 mf 104,16,176,104
 tr 12,3,29664
 tr 14,3,30176
 mf 120,16,180,120
 mf 108,20,176,108
 buffer_load_dwordx4 v2,s[16:19],s40 offen lds
 mf 124,20,180,124
 s_add_u32 m0,s41,68640
 s_add_u32 s40,s46,16896
 s_waitcnt lgkmcnt(4)
 mf 96,24,184,96
 buffer_load_dwordx4 v2,s[16:19],s40 offen lds
 mf 112,24,188,112
 s_waitcnt vmcnt(6)
 s_waitcnt lgkmcnt(0)
 s_barrier
 tr 16,3,33792
 tr 18,3,34304
 tr 20,3,33824
 tr 22,3,34336
 mf 100,28,184,100
 tr 24,3,33856
 tr 26,3,34368
 s_xor_b32 s46,s53,0
 s_add_u32 s46,s46,s44
 s_add_u32 m0,s41,69696
 s_add_u32 s40,s46,66048
 mf 116,28,188,116
 mf 104,8,184,104
 tr 28,3,33888
 tr 30,3,34400
 mf 120,8,188,120
 mf 108,12,184,108
 tr 8,3,38016
 tr 10,3,38528
 mf 124,12,188,124
 s_waitcnt lgkmcnt(6)
 mf 96,16,192,96
 tr 12,3,38048
 tr 14,3,38560
 mf 112,16,196,112
 mf 100,20,192,100
 tr 16,3,38080
 tr 18,3,38592
 mf 116,20,196,116
 s_waitcnt lgkmcnt(6)
 mf 104,24,192,104
 tr 20,3,38112
 tr 22,3,38624
 mf 120,24,196,120
 mf 108,28,192,108
 tr 24,3,42240
 tr 26,3,42752
 mf 124,28,196,124
 s_waitcnt lgkmcnt(6)
 mf 96,8,200,96
 tr 28,3,42272
 tr 30,3,42784
 mf 112,8,204,112
 mf 100,12,200,100
 tr 8,3,42304
 tr 10,3,42816
 mf 116,12,204,116
 s_waitcnt lgkmcnt(6)
 mf 104,16,200,104
 tr 12,3,42336
 tr 14,3,42848
 buffer_load_dwordx4 v2,s[16:19],s40 offen lds
 mf 120,16,204,120
 s_add_u32 m0,s41,70752
 s_add_u32 s40,s46,82432
 mf 108,20,200,108
 buffer_load_dwordx4 v2,s[16:19],s40 offen lds
 mf 124,20,204,124
 s_xor_b32 s46,s53,1048576
 s_add_u32 s46,s46,s44
 s_add_u32 m0,s41,84480
 s_add_u32 s40,s46,512
 s_waitcnt lgkmcnt(4)
 mf 96,24,208,96
 buffer_load_dwordx4 v2,s[16:19],s40 offen lds
 mf 112,24,212,112
 s_waitcnt vmcnt(5)
 s_waitcnt lgkmcnt(0)
 s_barrier
 tr 16,3,46464
 tr 18,3,46976
 tr 20,3,46496
 tr 22,3,47008
 mf 100,28,208,100
 tr 24,3,46528
 tr 26,3,47040
 s_xor_b32 s46,s53,1048576
 s_add_u32 s46,s46,s44
 s_add_u32 m0,s41,85536
 s_add_u32 s40,s46,16896
 mf 116,28,212,116
 mf 104,8,208,104
 tr 28,3,46560
 tr 30,3,47072
 mf 120,8,212,120
 mf 108,12,208,108
 tr 8,3,50688
 tr 10,3,51200
 mf 124,12,212,124
 s_waitcnt lgkmcnt(6)
 mf 96,16,216,96
 tr 12,3,50720
 tr 14,3,51232
 mf 112,16,220,112
 mf 100,20,216,100
 tr 16,3,50752
 tr 18,3,51264
 mf 116,20,220,116
 s_waitcnt lgkmcnt(6)
 mf 104,24,216,104
 tr 20,3,50784
 tr 22,3,51296
 mf 120,24,220,120
 mf 108,28,216,108
 buffer_load_dwordx4 v2,s[16:19],s40 offen lds
 mf 124,28,220,124
 s_add_u32 m0,s41,86592
 s_add_u32 s40,s46,66048
 s_waitcnt lgkmcnt(4)
 mf 96,8,224,96
 buffer_load_dwordx4 v2,s[16:19],s40 offen lds
 mf 112,8,228,112
 s_waitcnt lgkmcnt(0)
 s_barrier
 tr 24,3,54912
 tr 26,3,55424
 tr 28,3,54944
 tr 30,3,55456
 mf 100,12,224,100
 tr 8,3,54976
 tr 10,3,55488
 s_xor_b32 s46,s53,1048576
 s_add_u32 s46,s46,s44
 s_add_u32 m0,s41,87648
 s_add_u32 s40,s46,82432
 mf 116,12,228,116
 mf 104,16,224,104
 tr 12,3,55008
 tr 14,3,55520
 mf 120,16,228,120
 mf 108,20,224,108
 tr 16,3,59136
 tr 18,3,59648
 mf 124,20,228,124
 s_waitcnt lgkmcnt(6)
 mf 96,24,232,96
 tr 20,3,59168
 tr 22,3,59680
 mf 112,24,236,112
 mf 100,28,232,100
 tr 24,3,59200
 tr 26,3,59712
 mf 116,28,236,116
 s_waitcnt lgkmcnt(6)
 mf 104,8,232,104
 tr 28,3,59232
 tr 30,3,59744
 mf 120,8,236,120
 mf 108,12,232,108
 tr 8,3,63360
 tr 10,3,63872
 mf 124,12,236,124
 s_waitcnt lgkmcnt(6)
 mf 96,16,240,96
 tr 12,3,63392
 tr 14,3,63904
 mf 112,16,244,112
 mf 100,20,240,100
 tr 16,3,63424
 tr 18,3,63936
 mf 116,20,244,116
 s_waitcnt lgkmcnt(6)
 mf 104,24,240,104
 tr 20,3,63456
 tr 22,3,63968
 buffer_load_dwordx4 v2,s[16:19],s40 offen lds
 mf 120,24,244,120
 s_xor_b32 s46,s53,2097152
 s_add_u32 s46,s46,s44
 s_add_u32 m0,s41,101376
 s_add_u32 s40,s46,512
 mf 108,28,240,108
 buffer_load_dwordx4 v2,s[16:19],s40 offen lds
 mf 124,28,244,124
 s_add_u32 m0,s41,102432
 s_add_u32 s40,s46,16896
 s_waitcnt lgkmcnt(4)
 mf 96,8,248,96
 buffer_load_dwordx4 v2,s[16:19],s40 offen lds
 mf 112,8,252,112
 s_waitcnt vmcnt(6)
 s_waitcnt lgkmcnt(0)
 s_barrier
 ds_read_b64_tr_b16 v[24:25],v3
 tr 26,3,512
 tr 28,3,32
 tr 30,3,544
 mf 100,12,248,100
 tr 8,3,64
 tr 10,3,576
 s_xor_b32 s46,s53,2097152
 s_add_u32 s46,s46,s44
 s_add_u32 m0,s41,103488
 s_add_u32 s40,s46,66048
 buffer_load_dwordx4 v2,s[16:19],s40 offen lds
 s_add_u32 m0,s41,104544
 s_add_u32 s40,s46,82432
 buffer_load_dwordx4 v2,s[16:19],s40 offen lds
 s_xor_b32 s46,s53,3145728
 mf 116,12,252,116
 mf 104,16,248,104
 tr 12,3,96
 tr 14,3,608
 mf 120,16,252,120
 mf 108,20,248,108
 mf 124,20,252,124
 v_mul_f32 v96,s38,v96
 v_mul_f32 v97,s38,v97
 v_mul_f32 v98,s38,v98
 v_mul_f32 v99,s38,v99
 v_mul_f32 v100,s38,v100
 v_mul_f32 v101,s38,v101
 v_mul_f32 v102,s38,v102
 v_mul_f32 v103,s38,v103
 cv 96,96,97
 cv 97,98,99
 cv 98,100,101
 cv 99,102,103
 ds_write_b64 v6,v[96:97] offset:14336
 ds_write_b64 v6,v[98:99] offset:17920
 v_mul_f32 v104,s38,v104
 v_mul_f32 v105,s38,v105
 v_mul_f32 v106,s38,v106
 v_mul_f32 v107,s38,v107
 v_mul_f32 v108,s38,v108
 v_mul_f32 v109,s38,v109
 v_mul_f32 v110,s38,v110
 v_mul_f32 v111,s38,v111
 cv 104,104,105
 cv 105,106,107
 cv 106,108,109
 cv 107,110,111
 ds_write_b64 v6,v[104:105] offset:21504
 ds_write_b64 v6,v[106:107] offset:25088
 v_mul_f32 v112,s38,v112
 v_mul_f32 v113,s38,v113
 v_mul_f32 v114,s38,v114
 v_mul_f32 v115,s38,v115
 v_mul_f32 v116,s38,v116
 v_mul_f32 v117,s38,v117
 v_mul_f32 v118,s38,v118
 v_mul_f32 v119,s38,v119
 cv 112,112,113
 cv 113,114,115
 cv 114,116,117
 cv 115,118,119
 ds_write_b64 v7,v[112:113] offset:14336
 ds_write_b64 v7,v[114:115] offset:17920
 v_mul_f32 v120,s38,v120
 v_mul_f32 v121,s38,v121
 v_mul_f32 v122,s38,v122
 v_mul_f32 v123,s38,v123
 v_mul_f32 v124,s38,v124
 v_mul_f32 v125,s38,v125
 v_mul_f32 v126,s38,v126
 v_mul_f32 v127,s38,v127
 cv 120,120,121
 cv 121,122,123
 cv 122,124,125
 cv 123,126,127
 ds_write_b64 v7,v[120:121] offset:21504
 ds_write_b64 v7,v[122:123] offset:25088
 s_waitcnt lgkmcnt(12)
 mz 96,24,128
 s_add_u32 s46,s46,s44
 s_add_u32 m0,s41,118272
 s_add_u32 s40,s46,512
 mz 112,24,132
 buffer_load_dwordx4 v2,s[16:19],s40 offen lds
 s_waitcnt lgkmcnt(0)
 s_barrier
 tr 16,3,4224
 tr 18,3,4736
 tr 20,3,4256
 tr 22,3,4768
 mz 100,28,128
 tr 24,3,4288
 tr 26,3,4800
 s_xor_b32 s46,s53,3145728
 s_add_u32 s46,s46,s44
 s_add_u32 m0,s41,119328
 s_add_u32 s40,s46,16896
 mz 116,28,132
 mz 104,8,128
 tr 28,3,4320
 tr 30,3,4832
 mz 120,8,132
 mz 108,12,128
 tr 8,3,8448
 tr 10,3,8960
 mz 124,12,132
 s_waitcnt lgkmcnt(6)
 mf 96,16,136,96
 tr 12,3,8480
 tr 14,3,8992
 mf 112,16,140,112
 mf 100,20,136,100
 tr 16,3,8512
 tr 18,3,9024
 mf 116,20,140,116
 s_waitcnt lgkmcnt(6)
 mf 104,24,136,104
 tr 20,3,8544
 tr 22,3,9056
 mf 120,24,140,120
 mf 108,28,136,108
 buffer_load_dwordx4 v2,s[16:19],s40 offen lds
 mf 124,28,140,124
 s_add_u32 m0,s41,120384
 s_add_u32 s40,s46,66048
 s_waitcnt lgkmcnt(4)
 mf 96,8,144,96
 buffer_load_dwordx4 v2,s[16:19],s40 offen lds
 mf 112,8,148,112
 s_waitcnt vmcnt(7)
 s_waitcnt lgkmcnt(0)
 s_barrier
 tr 24,3,12672
 tr 26,3,13184
 tr 28,3,12704
 tr 30,3,13216
 mf 100,12,144,100
 tr 8,3,12736
 tr 10,3,13248
 s_xor_b32 s46,s53,3145728
 s_add_u32 s46,s46,s44
 s_add_u32 m0,s41,121440
 s_add_u32 s40,s46,82432
 mf 116,12,148,116
 mf 104,16,144,104
 tr 12,3,12768
 tr 14,3,13280
 mf 120,16,148,120
 mf 108,20,144,108
 tr 16,3,16896
 tr 18,3,17408
 mf 124,20,148,124
 s_waitcnt lgkmcnt(6)
 mf 96,24,152,96
 tr 20,3,16928
 tr 22,3,17440
 mf 112,24,156,112
 mf 100,28,152,100
 tr 24,3,16960
 tr 26,3,17472
 mf 116,28,156,116
 s_waitcnt lgkmcnt(6)
 mf 104,8,152,104
 tr 28,3,16992
 tr 30,3,17504
 mf 120,8,156,120
 mf 108,12,152,108
 mf 124,12,156,124
 s_waitcnt lgkmcnt(4)
 mf 96,16,160,96
 buffer_load_dwordx4 v2,s[16:19],s40 offen lds
 mf 112,16,164,112
 s_waitcnt lgkmcnt(0)
 s_barrier
 tr 8,3,21120
 tr 10,3,21632
 tr 12,3,21152
 tr 14,3,21664
 mf 100,20,160,100
 tr 16,3,21184
 tr 18,3,21696
 s_xor_b32 s46,s53,0
 s_add_u32 s46,s46,s44
 s_add_u32 m0,s41,67584
 s_add_u32 s40,s46,640
 mf 116,20,164,116
 mf 104,24,160,104
 tr 20,3,21216
 tr 22,3,21728
 mf 120,24,164,120
 mf 108,28,160,108
 tr 24,3,25344
 tr 26,3,25856
 mf 124,28,164,124
 s_waitcnt lgkmcnt(6)
 mf 96,8,168,96
 tr 28,3,25376
 tr 30,3,25888
 mf 112,8,172,112
 mf 100,12,168,100
 tr 8,3,25408
 tr 10,3,25920
 mf 116,12,172,116
 s_waitcnt lgkmcnt(6)
 mf 104,16,168,104
 tr 12,3,25440
 tr 14,3,25952
 mf 120,16,172,120
 mf 108,20,168,108
 tr 16,3,29568
 tr 18,3,30080
 mf 124,20,172,124
 s_waitcnt lgkmcnt(6)
 mf 96,24,176,96
 tr 20,3,29600
 tr 22,3,30112
 mf 112,24,180,112
 mf 100,28,176,100
 tr 24,3,29632
 tr 26,3,30144
 mf 116,28,180,116
 s_waitcnt lgkmcnt(6)
 mf 104,8,176,104
 tr 28,3,29664
 tr 30,3,30176
 buffer_load_dwordx4 v2,s[16:19],s40 offen lds
 mf 120,8,180,120
 s_add_u32 m0,s41,68640
 s_add_u32 s40,s46,17024
 mf 108,12,176,108
 buffer_load_dwordx4 v2,s[16:19],s40 offen lds
 mf 124,12,180,124
 s_add_u32 m0,s41,69696
 s_add_u32 s40,s46,66176
 s_waitcnt lgkmcnt(4)
 mf 96,16,184,96
 buffer_load_dwordx4 v2,s[16:19],s40 offen lds
 mf 112,16,188,112
 s_waitcnt vmcnt(7)
 s_waitcnt lgkmcnt(0)
 s_barrier
 tr 8,3,33792
 tr 10,3,34304
 tr 12,3,33824
 tr 14,3,34336
 mf 100,20,184,100
 tr 16,3,33856
 tr 18,3,34368
 s_xor_b32 s46,s53,0
 s_add_u32 s46,s46,s44
 s_add_u32 m0,s41,70752
 s_add_u32 s40,s46,82560
 mf 116,20,188,116
 mf 104,24,184,104
 tr 20,3,33888
 tr 22,3,34400
 mf 120,24,188,120
 mf 108,28,184,108
 tr 24,3,38016
 tr 26,3,38528
 mf 124,28,188,124
 s_waitcnt lgkmcnt(6)
 mf 96,8,192,96
 tr 28,3,38048
 tr 30,3,38560
 mf 112,8,196,112
 mf 100,12,192,100
 tr 8,3,38080
 tr 10,3,38592
 mf 116,12,196,116
 s_waitcnt lgkmcnt(6)
 mf 104,16,192,104
 tr 12,3,38112
 tr 14,3,38624
 mf 120,16,196,120
 mf 108,20,192,108
 tr 16,3,42240
 tr 18,3,42752
 mf 124,20,196,124
 s_waitcnt lgkmcnt(6)
 mf 96,24,200,96
 tr 20,3,42272
 tr 22,3,42784
 mf 112,24,204,112
 mf 100,28,200,100
 tr 24,3,42304
 tr 26,3,42816
 mf 116,28,204,116
 s_waitcnt lgkmcnt(6)
 mf 104,8,200,104
 tr 28,3,42336
 tr 30,3,42848
 mf 120,8,204,120
 mf 108,12,200,108
 tr 8,3,46464
 tr 10,3,46976
 mf 124,12,204,124
 s_waitcnt lgkmcnt(6)
 mf 96,16,208,96
 tr 12,3,46496
 tr 14,3,47008
 mf 112,16,212,112
 mf 100,20,208,100
 tr 16,3,46528
 tr 18,3,47040
 buffer_load_dwordx4 v2,s[16:19],s40 offen lds
 mf 116,20,212,116
 s_xor_b32 s46,s53,1048576
 s_add_u32 s46,s46,s44
 s_add_u32 m0,s41,84480
 s_add_u32 s40,s46,640
 s_waitcnt lgkmcnt(6)
 mf 104,24,208,104
 tr 20,3,46560
 tr 22,3,47072
 buffer_load_dwordx4 v2,s[16:19],s40 offen lds
 mf 120,24,212,120
 s_add_u32 m0,s41,85536
 s_add_u32 s40,s46,17024
 mf 108,28,208,108
 buffer_load_dwordx4 v2,s[16:19],s40 offen lds
 mf 124,28,212,124
 s_add_u32 m0,s41,86592
 s_add_u32 s40,s46,66176
 s_waitcnt lgkmcnt(4)
 mf 96,8,216,96
 buffer_load_dwordx4 v2,s[16:19],s40 offen lds
 mf 112,8,220,112
 s_waitcnt vmcnt(7)
 s_waitcnt lgkmcnt(0)
 s_barrier
 tr 24,3,50688
 tr 26,3,51200
 tr 28,3,50720
 tr 30,3,51232
 mf 100,12,216,100
 tr 8,3,50752
 tr 10,3,51264
 s_xor_b32 s46,s53,1048576
 s_add_u32 s46,s46,s44
 s_add_u32 m0,s41,87648
 s_add_u32 s40,s46,82560
 mf 116,12,220,116
 mf 104,16,216,104
 tr 12,3,50784
 tr 14,3,51296
 buffer_load_dwordx4 v2,s[16:19],s40 offen lds
 mf 120,16,220,120
 s_xor_b32 s46,s53,2097152
 s_add_u32 s46,s46,s44
 s_add_u32 m0,s41,101376
 s_add_u32 s40,s46,640
 mf 108,20,216,108
 tr 16,3,54912
 tr 18,3,55424
 buffer_load_dwordx4 v2,s[16:19],s40 offen lds
 mf 124,20,220,124
 s_add_u32 m0,s41,102432
 s_add_u32 s40,s46,17024
 s_waitcnt lgkmcnt(6)
 mf 96,24,224,96
 tr 20,3,54944
 tr 22,3,55456
 buffer_load_dwordx4 v2,s[16:19],s40 offen lds
 mf 112,24,228,112
 ds_read_b128 v[32:35],v4
 mf 100,28,224,100
 tr 24,3,54976
 tr 26,3,55488
 ds_read_b128 v[36:39],v5
 mf 116,28,228,116
 ds_read_b128 v[40:43],v4 offset:7168
 s_waitcnt lgkmcnt(9)
 mf 104,8,224,104
 tr 28,3,55008
 tr 30,3,55520
 ds_read_b128 v[44:47],v5 offset:7168
 mf 120,8,228,120
 ds_read_b128 v[48:51],v4 offset:14336
 mf 108,12,224,108
 ds_read_b128 v[52:55],v5 offset:14336
 mf 124,12,228,124
 ds_read_b128 v[56:59],v4 offset:21504
 s_waitcnt lgkmcnt(11)
 mf 96,16,232,96
 ds_read_b128 v[60:63],v5 offset:21504
 mf 112,16,236,112
 s_waitcnt lgkmcnt(0)
 s_barrier
 tr 8,3,59136
 tr 10,3,59648
 tr 12,3,59168
 tr 14,3,59680
 mf 100,20,232,100
 tr 16,3,59200
 tr 18,3,59712
 s_xor_b32 s46,s53,2097152
 s_add_u32 s46,s46,s44
 s_add_u32 m0,s41,103488
 s_add_u32 s40,s46,66176
 mf 116,20,236,116
 mf 104,24,232,104
 tr 20,3,59232
 tr 22,3,59744
 mf 120,24,236,120
 mf 108,28,232,108
 tr 24,3,63360
 tr 26,3,63872
 mf 124,28,236,124
 s_waitcnt lgkmcnt(6)
 mf 96,8,240,96
 tr 28,3,63392
 tr 30,3,63904
 mf 112,8,244,112
 mf 100,12,240,100
 tr 8,3,63424
 tr 10,3,63936
 mf 116,12,244,116
 s_waitcnt lgkmcnt(6)
 mf 104,16,240,104
 tr 12,3,63456
 tr 14,3,63968
 mf 120,16,244,120
 mf 108,20,240,108
 buffer_load_dwordx4 v2,s[16:19],s40 offen lds
 mf 124,20,244,124
 s_add_u32 m0,s41,104544
 s_add_u32 s40,s46,82560
 s_waitcnt lgkmcnt(4)
 mf 96,24,248,96
 buffer_load_dwordx4 v2,s[16:19],s40 offen lds
 mf 112,24,252,112
 s_waitcnt lgkmcnt(0)
 s_barrier
 mf 100,28,248,100
 s_xor_b32 s46,s53,3145728
 s_add_u32 s46,s46,s44
 s_add_u32 m0,s41,118272
 s_add_u32 s40,s46,640
 buffer_load_dwordx4 v2,s[16:19],s40 offen lds
 s_add_u32 m0,s41,119328
 s_add_u32 s40,s46,17024
 buffer_load_dwordx4 v2,s[16:19],s40 offen lds
 mf 116,28,252,116
 mf 104,8,248,104
 mf 120,8,252,120
 mf 108,12,248,108
 mf 124,12,252,124
 v_mul_f32 v96,s38,v96
 v_mul_f32 v97,s38,v97
 v_mul_f32 v98,s38,v98
 v_mul_f32 v99,s38,v99
 v_mul_f32 v100,s38,v100
 v_mul_f32 v101,s38,v101
 v_mul_f32 v102,s38,v102
 v_mul_f32 v103,s38,v103
 cv 96,96,97
 cv 97,98,99
 cv 98,100,101
 cv 99,102,103
 ds_write_b64 v6,v[96:97]
 ds_write_b64 v6,v[98:99] offset:3584
 v_mul_f32 v104,s38,v104
 v_mul_f32 v105,s38,v105
 v_mul_f32 v106,s38,v106
 v_mul_f32 v107,s38,v107
 v_mul_f32 v108,s38,v108
 v_mul_f32 v109,s38,v109
 v_mul_f32 v110,s38,v110
 v_mul_f32 v111,s38,v111
 cv 104,104,105
 cv 105,106,107
 cv 106,108,109
 cv 107,110,111
 ds_write_b64 v6,v[104:105] offset:7168
 ds_write_b64 v6,v[106:107] offset:10752
 v_mul_f32 v112,s38,v112
 v_mul_f32 v113,s38,v113
 v_mul_f32 v114,s38,v114
 v_mul_f32 v115,s38,v115
 v_mul_f32 v116,s38,v116
 v_mul_f32 v117,s38,v117
 v_mul_f32 v118,s38,v118
 v_mul_f32 v119,s38,v119
 cv 112,112,113
 cv 113,114,115
 cv 114,116,117
 cv 115,118,119
 ds_write_b64 v7,v[112:113]
 ds_write_b64 v7,v[114:115] offset:3584
 v_mul_f32 v120,s38,v120
 v_mul_f32 v121,s38,v121
 v_mul_f32 v122,s38,v122
 v_mul_f32 v123,s38,v123
 v_mul_f32 v124,s38,v124
 v_mul_f32 v125,s38,v125
 v_mul_f32 v126,s38,v126
 v_mul_f32 v127,s38,v127
 cv 120,120,121
 cv 121,122,123
 cv 122,124,125
 cv 123,126,127
 ds_write_b64 v7,v[120:121] offset:7168
 ds_write_b64 v7,v[122:123] offset:10752
 s_waitcnt vmcnt(10)
 s_waitcnt lgkmcnt(0)
 s_barrier
 ds_read_b64_tr_b16 v[16:17],v3
 tr 18,3,512
 tr 20,3,32
 tr 22,3,544
 tr 24,3,64
 tr 26,3,576
 tr 28,3,96
 tr 30,3,608
 tr 8,3,4224
 tr 10,3,4736
 s_waitcnt lgkmcnt(6)
 mz 96,16,128
 tr 12,3,4256
 tr 14,3,4768
 s_xor_b32 s46,s53,3145728
 s_add_u32 s46,s46,s44
 s_add_u32 m0,s41,120384
 s_add_u32 s40,s46,66176
 mz 112,16,132
 mz 100,20,128
 tr 16,3,4288
 tr 18,3,4800
 mz 116,20,132
 s_waitcnt lgkmcnt(6)
 mz 104,24,128
 tr 20,3,4320
 tr 22,3,4832
 mz 120,24,132
 mz 108,28,128
 buffer_load_dwordx4 v2,s[16:19],s40 offen lds
 mz 124,28,132
 s_add_u32 m0,s41,121440
 s_add_u32 s40,s46,82560
 s_waitcnt lgkmcnt(4)
 mf 96,8,136,96
 buffer_load_dwordx4 v2,s[16:19],s40 offen lds
 mf 112,8,140,112
 s_waitcnt lgkmcnt(0)
 s_barrier
 tr 24,3,8448
 tr 26,3,8960
 tr 28,3,8480
 tr 30,3,8992
 mf 100,12,136,100
 tr 8,3,8512
 tr 10,3,9024
 mf 116,12,140,116
 mf 104,16,136,104
 tr 12,3,8544
 tr 14,3,9056
 mf 120,16,140,120
 mf 108,20,136,108
 tr 16,3,12672
 tr 18,3,13184
 mf 124,20,140,124
 s_waitcnt lgkmcnt(6)
 mf 96,24,144,96
 tr 20,3,12704
 tr 22,3,13216
 mf 112,24,148,112
 mf 100,28,144,100
 tr 24,3,12736
 tr 26,3,13248
 mf 116,28,148,116
 s_waitcnt lgkmcnt(6)
 mf 104,8,144,104
 tr 28,3,12768
 tr 30,3,13280
 mf 120,8,148,120
 mf 108,12,144,108
 mf 124,12,148,124
 s_waitcnt lgkmcnt(4)
 mf 96,16,152,96
 mf 112,16,156,112
 s_waitcnt vmcnt(8)
 s_waitcnt lgkmcnt(0)
 s_barrier
 tr 8,3,16896
 tr 10,3,17408
 tr 12,3,16928
 tr 14,3,17440
 mf 100,20,152,100
 tr 16,3,16960
 tr 18,3,17472
 s_xor_b32 s46,s53,0
 s_add_u32 s46,s46,s44
 s_add_u32 m0,s41,67584
 s_add_u32 s40,s46,768
 mf 116,20,156,116
 mf 104,24,152,104
 tr 20,3,16992
 tr 22,3,17504
 mf 120,24,156,120
 mf 108,28,152,108
 tr 24,3,21120
 tr 26,3,21632
 mf 124,28,156,124
 s_waitcnt lgkmcnt(6)
 mf 96,8,160,96
 tr 28,3,21152
 tr 30,3,21664
 mf 112,8,164,112
 mf 100,12,160,100
 tr 8,3,21184
 tr 10,3,21696
 mf 116,12,164,116
 s_waitcnt lgkmcnt(6)
 mf 104,16,160,104
 tr 12,3,21216
 tr 14,3,21728
 mf 120,16,164,120
 mf 108,20,160,108
 buffer_load_dwordx4 v2,s[16:19],s40 offen lds
 mf 124,20,164,124
 s_add_u32 m0,s41,68640
 s_add_u32 s40,s46,17152
 s_waitcnt lgkmcnt(4)
 mf 96,24,168,96
 buffer_load_dwordx4 v2,s[16:19],s40 offen lds
 mf 112,24,172,112
 s_waitcnt lgkmcnt(0)
 s_barrier
 tr 16,3,25344
 tr 18,3,25856
 tr 20,3,25376
 tr 22,3,25888
 mf 100,28,168,100
 tr 24,3,25408
 tr 26,3,25920
 s_xor_b32 s46,s53,0
 s_add_u32 s46,s46,s44
 s_add_u32 m0,s41,69696
 s_add_u32 s40,s46,66304
 mf 116,28,172,116
 mf 104,8,168,104
 tr 28,3,25440
 tr 30,3,25952
 mf 120,8,172,120
 mf 108,12,168,108
 tr 8,3,29568
 tr 10,3,30080
 mf 124,12,172,124
 s_waitcnt lgkmcnt(6)
 mf 96,16,176,96
 tr 12,3,29600
 tr 14,3,30112
 mf 112,16,180,112
 mf 100,20,176,100
 tr 16,3,29632
 tr 18,3,30144
 mf 116,20,180,116
 s_waitcnt lgkmcnt(6)
 mf 104,24,176,104
 tr 20,3,29664
 tr 22,3,30176
 mf 120,24,180,120
 mf 108,28,176,108
 buffer_load_dwordx4 v2,s[16:19],s40 offen lds
 mf 124,28,180,124
 s_add_u32 m0,s41,70752
 s_add_u32 s40,s46,82688
 s_waitcnt lgkmcnt(4)
 mf 96,8,184,96
 buffer_load_dwordx4 v2,s[16:19],s40 offen lds
 mf 112,8,188,112
 s_waitcnt vmcnt(8)
 s_waitcnt lgkmcnt(0)
 s_barrier
 tr 24,3,33792
 tr 26,3,34304
 tr 28,3,33824
 tr 30,3,34336
 mf 100,12,184,100
 tr 8,3,33856
 tr 10,3,34368
 s_xor_b32 s46,s53,1048576
 s_add_u32 s46,s46,s44
 s_add_u32 m0,s41,84480
 s_add_u32 s40,s46,768
 mf 116,12,188,116
 mf 104,16,184,104
 tr 12,3,33888
 tr 14,3,34400
 mf 120,16,188,120
 mf 108,20,184,108
 tr 16,3,38016
 tr 18,3,38528
 mf 124,20,188,124
 s_waitcnt lgkmcnt(6)
 mf 96,24,192,96
 tr 20,3,38048
 tr 22,3,38560
 mf 112,24,196,112
 mf 100,28,192,100
 tr 24,3,38080
 tr 26,3,38592
 mf 116,28,196,116
 s_waitcnt lgkmcnt(6)
 mf 104,8,192,104
 tr 28,3,38112
 tr 30,3,38624
 mf 120,8,196,120
 mf 108,12,192,108
 buffer_load_dwordx4 v2,s[16:19],s40 offen lds
 mf 124,12,196,124
 s_add_u32 m0,s41,85536
 s_add_u32 s40,s46,17152
 s_waitcnt lgkmcnt(4)
 mf 96,16,200,96
 buffer_load_dwordx4 v2,s[16:19],s40 offen lds
 mf 112,16,204,112
 s_waitcnt lgkmcnt(0)
 s_barrier
 tr 8,3,42240
 tr 10,3,42752
 tr 12,3,42272
 tr 14,3,42784
 mf 100,20,200,100
 tr 16,3,42304
 tr 18,3,42816
 s_xor_b32 s46,s53,1048576
 s_add_u32 s46,s46,s44
 s_add_u32 m0,s41,86592
 s_add_u32 s40,s46,66304
 mf 116,20,204,116
 mf 104,24,200,104
 tr 20,3,42336
 tr 22,3,42848
 mf 120,24,204,120
 mf 108,28,200,108
 tr 24,3,46464
 tr 26,3,46976
 mf 124,28,204,124
 s_waitcnt lgkmcnt(6)
 mf 96,8,208,96
 tr 28,3,46496
 tr 30,3,47008
 mf 112,8,212,112
 mf 100,12,208,100
 tr 8,3,46528
 tr 10,3,47040
 mf 116,12,212,116
 s_waitcnt lgkmcnt(6)
 mf 104,16,208,104
 tr 12,3,46560
 tr 14,3,47072
 mf 120,16,212,120
 mf 108,20,208,108
 buffer_load_dwordx4 v2,s[16:19],s40 offen lds
 mf 124,20,212,124
 s_add_u32 m0,s41,87648
 s_add_u32 s40,s46,82688
 s_waitcnt lgkmcnt(4)
 mf 96,24,216,96
 buffer_load_dwordx4 v2,s[16:19],s40 offen lds
 mf 112,24,220,112
 s_waitcnt vmcnt(8)
 s_waitcnt lgkmcnt(0)
 s_barrier
 tr 16,3,50688
 tr 18,3,51200
 tr 20,3,50720
 tr 22,3,51232
 mf 100,28,216,100
 tr 24,3,50752
 tr 26,3,51264
 s_xor_b32 s46,s53,2097152
 s_add_u32 s46,s46,s44
 s_add_u32 m0,s41,101376
 s_add_u32 s40,s46,768
 mf 116,28,220,116
 mf 104,8,216,104
 tr 28,3,50784
 tr 30,3,51296
 mf 120,8,220,120
 mf 108,12,216,108
 tr 8,3,54912
 tr 10,3,55424
 mf 124,12,220,124
 s_waitcnt lgkmcnt(6)
 mf 96,16,224,96
 tr 12,3,54944
 tr 14,3,55456
 mf 112,16,228,112
 mf 100,20,224,100
 tr 16,3,54976
 tr 18,3,55488
 mf 116,20,228,116
 s_waitcnt lgkmcnt(6)
 mf 104,24,224,104
 tr 20,3,55008
 tr 22,3,55520
 mf 120,24,228,120
 mf 108,28,224,108
 buffer_load_dwordx4 v2,s[16:19],s40 offen lds
 mf 124,28,228,124
 s_add_u32 m0,s41,102432
 s_add_u32 s40,s46,17152
 s_waitcnt lgkmcnt(4)
 mf 96,8,232,96
 buffer_load_dwordx4 v2,s[16:19],s40 offen lds
 mf 112,8,236,112
 s_waitcnt lgkmcnt(0)
 s_barrier
 tr 24,3,59136
 tr 26,3,59648
 tr 28,3,59168
 tr 30,3,59680
 mf 100,12,232,100
 tr 8,3,59200
 tr 10,3,59712
 s_xor_b32 s46,s53,2097152
 s_add_u32 s46,s46,s44
 s_add_u32 m0,s41,103488
 s_add_u32 s40,s46,66304
 mf 116,12,236,116
 mf 104,16,232,104
 tr 12,3,59232
 tr 14,3,59744
 mf 120,16,236,120
 mf 108,20,232,108
 tr 16,3,63360
 tr 18,3,63872
 mf 124,20,236,124
 s_waitcnt lgkmcnt(6)
 mf 96,24,240,96
 tr 20,3,63392
 tr 22,3,63904
 mf 112,24,244,112
 mf 100,28,240,100
 tr 24,3,63424
 tr 26,3,63936
 mf 116,28,244,116
 s_waitcnt lgkmcnt(6)
 mf 104,8,240,104
 tr 28,3,63456
 tr 30,3,63968
 mf 120,8,244,120
 mf 108,12,240,108
 buffer_load_dwordx4 v2,s[16:19],s40 offen lds
 mf 124,12,244,124
 s_add_u32 m0,s41,104544
 s_add_u32 s40,s46,82688
 s_waitcnt lgkmcnt(4)
 mf 96,16,248,96
 buffer_load_dwordx4 v2,s[16:19],s40 offen lds
 mf 112,16,252,112
 s_waitcnt vmcnt(8)
 s_waitcnt lgkmcnt(0)
 s_barrier
 ds_read_b64_tr_b16 v[8:9],v3
 tr 10,3,512
 tr 12,3,32
 tr 14,3,544
 mf 100,20,248,100
 tr 16,3,64
 tr 18,3,576
 s_xor_b32 s46,s53,3145728
 s_add_u32 s46,s46,s44
 s_add_u32 m0,s41,118272
 s_add_u32 s40,s46,768
 buffer_load_dwordx4 v2,s[16:19],s40 offen lds
 s_add_u32 m0,s41,119328
 s_add_u32 s40,s46,17152
 buffer_load_dwordx4 v2,s[16:19],s40 offen lds
 mf 116,20,252,116
 mf 104,24,248,104
 tr 20,3,96
 tr 22,3,608
 mf 120,24,252,120
 mf 108,28,248,108
 mf 124,28,252,124
 v_mul_f32 v96,s38,v96
 v_mul_f32 v97,s38,v97
 v_mul_f32 v98,s38,v98
 v_mul_f32 v99,s38,v99
 v_mul_f32 v100,s38,v100
 v_mul_f32 v101,s38,v101
 v_mul_f32 v102,s38,v102
 v_mul_f32 v103,s38,v103
 cv 96,96,97
 cv 97,98,99
 cv 98,100,101
 cv 99,102,103
 ds_write_b64 v6,v[96:97] offset:14336
 ds_write_b64 v6,v[98:99] offset:17920
 v_mul_f32 v104,s38,v104
 v_mul_f32 v105,s38,v105
 v_mul_f32 v106,s38,v106
 v_mul_f32 v107,s38,v107
 v_mul_f32 v108,s38,v108
 v_mul_f32 v109,s38,v109
 v_mul_f32 v110,s38,v110
 v_mul_f32 v111,s38,v111
 cv 104,104,105
 cv 105,106,107
 cv 106,108,109
 cv 107,110,111
 ds_write_b64 v6,v[104:105] offset:21504
 ds_write_b64 v6,v[106:107] offset:25088
 v_mul_f32 v112,s38,v112
 v_mul_f32 v113,s38,v113
 v_mul_f32 v114,s38,v114
 v_mul_f32 v115,s38,v115
 v_mul_f32 v116,s38,v116
 v_mul_f32 v117,s38,v117
 v_mul_f32 v118,s38,v118
 v_mul_f32 v119,s38,v119
 cv 112,112,113
 cv 113,114,115
 cv 114,116,117
 cv 115,118,119
 ds_write_b64 v7,v[112:113] offset:14336
 ds_write_b64 v7,v[114:115] offset:17920
 v_mul_f32 v120,s38,v120
 v_mul_f32 v121,s38,v121
 v_mul_f32 v122,s38,v122
 v_mul_f32 v123,s38,v123
 v_mul_f32 v124,s38,v124
 v_mul_f32 v125,s38,v125
 v_mul_f32 v126,s38,v126
 v_mul_f32 v127,s38,v127
 cv 120,120,121
 cv 121,122,123
 cv 122,124,125
 cv 123,126,127
 ds_write_b64 v7,v[120:121] offset:21504
 ds_write_b64 v7,v[122:123] offset:25088
 s_waitcnt lgkmcnt(12)
 mz 96,8,128
 mz 112,8,132
 s_waitcnt lgkmcnt(0)
 s_barrier
 tr 24,3,4224
 tr 26,3,4736
 tr 28,3,4256
 tr 30,3,4768
 mz 100,12,128
 tr 8,3,4288
 tr 10,3,4800
 s_xor_b32 s46,s53,3145728
 s_add_u32 s46,s46,s44
 s_add_u32 m0,s41,120384
 s_add_u32 s40,s46,66304
 mz 116,12,132
 mz 104,16,128
 tr 12,3,4320
 tr 14,3,4832
 mz 120,16,132
 mz 108,20,128
 tr 16,3,8448
 tr 18,3,8960
 mz 124,20,132
 s_waitcnt lgkmcnt(6)
 mf 96,24,136,96
 tr 20,3,8480
 tr 22,3,8992
 mf 112,24,140,112
 mf 100,28,136,100
 tr 24,3,8512
 tr 26,3,9024
 mf 116,28,140,116
 s_waitcnt lgkmcnt(6)
 mf 104,8,136,104
 tr 28,3,8544
 tr 30,3,9056
 mf 120,8,140,120
 mf 108,12,136,108
 buffer_load_dwordx4 v2,s[16:19],s40 offen lds
 mf 124,12,140,124
 s_add_u32 m0,s41,121440
 s_add_u32 s40,s46,82688
 s_waitcnt lgkmcnt(4)
 mf 96,16,144,96
 buffer_load_dwordx4 v2,s[16:19],s40 offen lds
 mf 112,16,148,112
 s_waitcnt vmcnt(8)
 s_waitcnt lgkmcnt(0)
 s_barrier
 tr 8,3,12672
 tr 10,3,13184
 tr 12,3,12704
 tr 14,3,13216
 mf 100,20,144,100
 tr 16,3,12736
 tr 18,3,13248
 mf 116,20,148,116
 mf 104,24,144,104
 tr 20,3,12768
 tr 22,3,13280
 mf 120,24,148,120
 mf 108,28,144,108
 tr 24,3,16896
 tr 26,3,17408
 mf 124,28,148,124
 s_waitcnt lgkmcnt(6)
 mf 96,8,152,96
 tr 28,3,16928
 tr 30,3,17440
 mf 112,8,156,112
 mf 100,12,152,100
 tr 8,3,16960
 tr 10,3,17472
 mf 116,12,156,116
 s_waitcnt lgkmcnt(6)
 mf 104,16,152,104
 tr 12,3,16992
 tr 14,3,17504
 mf 120,16,156,120
 mf 108,20,152,108
 mf 124,20,156,124
 s_waitcnt lgkmcnt(4)
 mf 96,24,160,96
 mf 112,24,164,112
 s_waitcnt lgkmcnt(0)
 s_barrier
 tr 16,3,21120
 tr 18,3,21632
 tr 20,3,21152
 tr 22,3,21664
 mf 100,28,160,100
 tr 24,3,21184
 tr 26,3,21696
 s_xor_b32 s46,s53,0
 s_add_u32 s46,s46,s44
 s_add_u32 m0,s41,67584
 s_add_u32 s40,s46,896
 mf 116,28,164,116
 mf 104,8,160,104
 tr 28,3,21216
 tr 30,3,21728
 mf 120,8,164,120
 mf 108,12,160,108
 tr 8,3,25344
 tr 10,3,25856
 mf 124,12,164,124
 s_waitcnt lgkmcnt(6)
 mf 96,16,168,96
 tr 12,3,25376
 tr 14,3,25888
 mf 112,16,172,112
 mf 100,20,168,100
 tr 16,3,25408
 tr 18,3,25920
 mf 116,20,172,116
 s_waitcnt lgkmcnt(6)
 mf 104,24,168,104
 tr 20,3,25440
 tr 22,3,25952
 mf 120,24,172,120
 mf 108,28,168,108
 tr 24,3,29568
 tr 26,3,30080
 mf 124,28,172,124
 s_waitcnt lgkmcnt(6)
 mf 96,8,176,96
 tr 28,3,29600
 tr 30,3,30112
 mf 112,8,180,112
 mf 100,12,176,100
 tr 8,3,29632
 tr 10,3,30144
 mf 116,12,180,116
 s_waitcnt lgkmcnt(6)
 mf 104,16,176,104
 tr 12,3,29664
 tr 14,3,30176
 buffer_load_dwordx4 v2,s[16:19],s40 offen lds
 mf 120,16,180,120
 s_add_u32 m0,s41,68640
 s_add_u32 s40,s46,17280
 mf 108,20,176,108
 buffer_load_dwordx4 v2,s[16:19],s40 offen lds
 mf 124,20,180,124
 s_add_u32 m0,s41,69696
 s_add_u32 s40,s46,66432
 s_waitcnt lgkmcnt(4)
 mf 96,24,184,96
 buffer_load_dwordx4 v2,s[16:19],s40 offen lds
 mf 112,24,188,112
 s_waitcnt vmcnt(7)
 s_waitcnt lgkmcnt(0)
 s_barrier
 tr 16,3,33792
 tr 18,3,34304
 tr 20,3,33824
 tr 22,3,34336
 mf 100,28,184,100
 tr 24,3,33856
 tr 26,3,34368
 s_xor_b32 s46,s53,0
 s_add_u32 s46,s46,s44
 s_add_u32 m0,s41,70752
 s_add_u32 s40,s46,82816
 mf 116,28,188,116
 mf 104,8,184,104
 tr 28,3,33888
 tr 30,3,34400
 mf 120,8,188,120
 mf 108,12,184,108
 tr 8,3,38016
 tr 10,3,38528
 mf 124,12,188,124
 s_waitcnt lgkmcnt(6)
 mf 96,16,192,96
 tr 12,3,38048
 tr 14,3,38560
 mf 112,16,196,112
 mf 100,20,192,100
 tr 16,3,38080
 tr 18,3,38592
 mf 116,20,196,116
 s_waitcnt lgkmcnt(6)
 mf 104,24,192,104
 tr 20,3,38112
 tr 22,3,38624
 mf 120,24,196,120
 mf 108,28,192,108
 tr 24,3,42240
 tr 26,3,42752
 mf 124,28,196,124
 s_waitcnt lgkmcnt(6)
 mf 96,8,200,96
 tr 28,3,42272
 tr 30,3,42784
 mf 112,8,204,112
 mf 100,12,200,100
 tr 8,3,42304
 tr 10,3,42816
 mf 116,12,204,116
 s_waitcnt lgkmcnt(6)
 mf 104,16,200,104
 tr 12,3,42336
 tr 14,3,42848
 mf 120,16,204,120
 mf 108,20,200,108
 tr 16,3,46464
 tr 18,3,46976
 mf 124,20,204,124
 s_waitcnt lgkmcnt(6)
 mf 96,24,208,96
 tr 20,3,46496
 tr 22,3,47008
 mf 112,24,212,112
 mf 100,28,208,100
 tr 24,3,46528
 tr 26,3,47040
 buffer_load_dwordx4 v2,s[16:19],s40 offen lds
 mf 116,28,212,116
 s_xor_b32 s46,s53,1048576
 s_add_u32 s46,s46,s44
 s_add_u32 m0,s41,84480
 s_add_u32 s40,s46,896
 s_waitcnt lgkmcnt(6)
 mf 104,8,208,104
 tr 28,3,46560
 tr 30,3,47072
 buffer_load_dwordx4 v2,s[16:19],s40 offen lds
 mf 120,8,212,120
 s_add_u32 m0,s41,85536
 s_add_u32 s40,s46,17280
 mf 108,12,208,108
 buffer_load_dwordx4 v2,s[16:19],s40 offen lds
 mf 124,12,212,124
 s_add_u32 m0,s41,86592
 s_add_u32 s40,s46,66432
 s_waitcnt lgkmcnt(4)
 mf 96,16,216,96
 buffer_load_dwordx4 v2,s[16:19],s40 offen lds
 mf 112,16,220,112
 s_waitcnt vmcnt(7)
 s_waitcnt lgkmcnt(0)
 s_barrier
 tr 8,3,50688
 tr 10,3,51200
 tr 12,3,50720
 tr 14,3,51232
 mf 100,20,216,100
 tr 16,3,50752
 tr 18,3,51264
 s_xor_b32 s46,s53,1048576
 s_add_u32 s46,s46,s44
 s_add_u32 m0,s41,87648
 s_add_u32 s40,s46,82816
 mf 116,20,220,116
 mf 104,24,216,104
 tr 20,3,50784
 tr 22,3,51296
 buffer_load_dwordx4 v2,s[16:19],s40 offen lds
 mf 120,24,220,120
 s_xor_b32 s46,s53,2097152
 s_add_u32 s46,s46,s44
 s_add_u32 m0,s41,101376
 s_add_u32 s40,s46,896
 mf 108,28,216,108
 tr 24,3,54912
 tr 26,3,55424
 buffer_load_dwordx4 v2,s[16:19],s40 offen lds
 mf 124,28,220,124
 s_add_u32 m0,s41,102432
 s_add_u32 s40,s46,17280
 s_waitcnt lgkmcnt(6)
 mf 96,8,224,96
 tr 28,3,54944
 tr 30,3,55456
 buffer_load_dwordx4 v2,s[16:19],s40 offen lds
 mf 112,8,228,112
 ds_read_b128 v[64:67],v4
 mf 100,12,224,100
 tr 8,3,54976
 tr 10,3,55488
 ds_read_b128 v[68:71],v5
 mf 116,12,228,116
 ds_read_b128 v[72:75],v4 offset:7168
 s_waitcnt lgkmcnt(9)
 mf 104,16,224,104
 tr 12,3,55008
 tr 14,3,55520
 ds_read_b128 v[76:79],v5 offset:7168
 mf 120,16,228,120
 ds_read_b128 v[80:83],v4 offset:14336
 mf 108,20,224,108
 ds_read_b128 v[84:87],v5 offset:14336
 mf 124,20,228,124
 ds_read_b128 v[88:91],v4 offset:21504
 s_waitcnt lgkmcnt(11)
 mf 96,24,232,96
 ds_read_b128 v[92:95],v5 offset:21504
 mf 112,24,236,112
 s_waitcnt lgkmcnt(0)
 s_barrier
 tr 16,3,59136
 tr 18,3,59648
 tr 20,3,59168
 tr 22,3,59680
 mf 100,28,232,100
 tr 24,3,59200
 tr 26,3,59712
 s_xor_b32 s46,s53,2097152
 s_add_u32 s46,s46,s44
 s_add_u32 m0,s41,103488
 s_add_u32 s40,s46,66432
 mf 116,28,236,116
 mf 104,8,232,104
 tr 28,3,59232
 tr 30,3,59744
 mf 120,8,236,120
 mf 108,12,232,108
 tr 8,3,63360
 tr 10,3,63872
 mf 124,12,236,124
 s_waitcnt lgkmcnt(6)
 mf 96,16,240,96
 tr 12,3,63392
 tr 14,3,63904
 mf 112,16,244,112
 mf 100,20,240,100
 tr 16,3,63424
 tr 18,3,63936
 mf 116,20,244,116
 s_waitcnt lgkmcnt(6)
 mf 104,24,240,104
 tr 20,3,63456
 tr 22,3,63968
 mf 120,24,244,120
 mf 108,28,240,108
 buffer_load_dwordx4 v2,s[16:19],s40 offen lds
 mf 124,28,244,124
 s_add_u32 m0,s41,104544
 s_add_u32 s40,s46,82816
 s_waitcnt lgkmcnt(4)
 mf 96,8,248,96
 buffer_load_dwordx4 v2,s[16:19],s40 offen lds
 mf 112,8,252,112
 s_waitcnt lgkmcnt(0)
 s_barrier
 mf 100,12,248,100
 s_xor_b32 s46,s53,3145728
 s_add_u32 s46,s46,s44
 s_add_u32 m0,s41,118272
 s_add_u32 s40,s46,896
 buffer_load_dwordx4 v2,s[16:19],s40 offen lds
 s_add_u32 m0,s41,119328
 s_add_u32 s40,s46,17280
 buffer_load_dwordx4 v2,s[16:19],s40 offen lds
 mf 116,12,252,116
 mf 104,16,248,104
 mf 120,16,252,120
 mf 108,20,248,108
 mf 124,20,252,124
 v_mul_f32 v96,s38,v96
 v_mul_f32 v97,s38,v97
 v_mul_f32 v98,s38,v98
 v_mul_f32 v99,s38,v99
 v_mul_f32 v100,s38,v100
 v_mul_f32 v101,s38,v101
 v_mul_f32 v102,s38,v102
 v_mul_f32 v103,s38,v103
 cv 96,96,97
 cv 97,98,99
 cv 98,100,101
 cv 99,102,103
 ds_write_b64 v6,v[96:97]
 ds_write_b64 v6,v[98:99] offset:3584
 v_mul_f32 v104,s38,v104
 v_mul_f32 v105,s38,v105
 v_mul_f32 v106,s38,v106
 v_mul_f32 v107,s38,v107
 v_mul_f32 v108,s38,v108
 v_mul_f32 v109,s38,v109
 v_mul_f32 v110,s38,v110
 v_mul_f32 v111,s38,v111
 cv 104,104,105
 cv 105,106,107
 cv 106,108,109
 cv 107,110,111
 ds_write_b64 v6,v[104:105] offset:7168
 ds_write_b64 v6,v[106:107] offset:10752
 v_mul_f32 v112,s38,v112
 v_mul_f32 v113,s38,v113
 v_mul_f32 v114,s38,v114
 v_mul_f32 v115,s38,v115
 v_mul_f32 v116,s38,v116
 v_mul_f32 v117,s38,v117
 v_mul_f32 v118,s38,v118
 v_mul_f32 v119,s38,v119
 cv 112,112,113
 cv 113,114,115
 cv 114,116,117
 cv 115,118,119
 ds_write_b64 v7,v[112:113]
 ds_write_b64 v7,v[114:115] offset:3584
 v_mul_f32 v120,s38,v120
 v_mul_f32 v121,s38,v121
 v_mul_f32 v122,s38,v122
 v_mul_f32 v123,s38,v123
 v_mul_f32 v124,s38,v124
 v_mul_f32 v125,s38,v125
 v_mul_f32 v126,s38,v126
 v_mul_f32 v127,s38,v127
 cv 120,120,121
 cv 121,122,123
 cv 122,124,125
 cv 123,126,127
 ds_write_b64 v7,v[120:121] offset:7168
 ds_write_b64 v7,v[122:123] offset:10752
 s_waitcnt vmcnt(10)
 s_waitcnt lgkmcnt(0)
 s_barrier
 ds_read_b64_tr_b16 v[24:25],v3
 tr 26,3,512
 tr 28,3,32
 tr 30,3,544
 tr 8,3,64
 tr 10,3,576
 tr 12,3,96
 tr 14,3,608
 tr 16,3,4224
 tr 18,3,4736
 s_waitcnt lgkmcnt(6)
 mz 96,24,128
 tr 20,3,4256
 tr 22,3,4768
 s_xor_b32 s46,s53,3145728
 s_add_u32 s46,s46,s44
 s_add_u32 m0,s41,120384
 s_add_u32 s40,s46,66432
 mz 112,24,132
 mz 100,28,128
 tr 24,3,4288
 tr 26,3,4800
 mz 116,28,132
 s_waitcnt lgkmcnt(6)
 mz 104,8,128
 tr 28,3,4320
 tr 30,3,4832
 mz 120,8,132
 mz 108,12,128
 buffer_load_dwordx4 v2,s[16:19],s40 offen lds
 mz 124,12,132
 s_add_u32 m0,s41,121440
 s_add_u32 s40,s46,82816
 s_waitcnt lgkmcnt(4)
 mf 96,16,136,96
 buffer_load_dwordx4 v2,s[16:19],s40 offen lds
 mf 112,16,140,112
 s_waitcnt lgkmcnt(0)
 s_barrier
 tr 8,3,8448
 tr 10,3,8960
 tr 12,3,8480
 tr 14,3,8992
 mf 100,20,136,100
 tr 16,3,8512
 tr 18,3,9024
 mf 116,20,140,116
 mf 104,24,136,104
 tr 20,3,8544
 tr 22,3,9056
 mf 120,24,140,120
 mf 108,28,136,108
 tr 24,3,12672
 tr 26,3,13184
 mf 124,28,140,124
 s_waitcnt lgkmcnt(6)
 mf 96,8,144,96
 tr 28,3,12704
 tr 30,3,13216
 mf 112,8,148,112
 mf 100,12,144,100
 tr 8,3,12736
 tr 10,3,13248
 mf 116,12,148,116
 s_waitcnt lgkmcnt(6)
 mf 104,16,144,104
 tr 12,3,12768
 tr 14,3,13280
 mf 120,16,148,120
 mf 108,20,144,108
 mf 124,20,148,124
 s_waitcnt lgkmcnt(4)
 mf 96,24,152,96
 mf 112,24,156,112
 s_waitcnt vmcnt(8)
 s_waitcnt lgkmcnt(0)
 s_barrier
 tr 16,3,16896
 tr 18,3,17408
 tr 20,3,16928
 tr 22,3,17440
 mf 100,28,152,100
 tr 24,3,16960
 tr 26,3,17472
 v_and_b32 v2,0x70,v1
 mf 116,28,156,116
 v_bfe_u32 v0,v1,7,1
 mf 104,8,152,104
 tr 28,3,16992
 tr 30,3,17504
 v_lshl_add_u32 v2,v0,10,v2
 mf 120,8,156,120
 v_bfe_u32 v0,v1,8,2
 mf 108,12,152,108
 tr 8,3,21120
 tr 10,3,21632
 v_lshl_add_u32 v2,v0,13,v2
 mf 124,12,156,124
 s_add_u32 s46,s37,1
 s_and_b32 s46,s46,7
 s_lshl_b32 s46,s46,7
 s_add_u32 s46,s46,s45
 s_add_u32 m0,s41,67584
 s_add_u32 s40,s46,0
 s_waitcnt lgkmcnt(6)
 mf 96,16,160,96
 tr 12,3,21152
 tr 14,3,21664
 mf 112,16,164,112
 mf 100,20,160,100
 tr 16,3,21184
 tr 18,3,21696
 mf 116,20,164,116
 s_waitcnt lgkmcnt(6)
 mf 104,24,160,104
 tr 20,3,21216
 tr 22,3,21728
 mf 120,24,164,120
 mf 108,28,160,108
 buffer_load_dwordx4 v2,s[20:23],s40 offen lds
 mf 124,28,164,124
 s_add_u32 m0,s41,68640
 s_add_u32 s40,s46,2048
 s_waitcnt lgkmcnt(4)
 mf 96,8,168,96
 buffer_load_dwordx4 v2,s[20:23],s40 offen lds
 mf 112,8,172,112
 s_waitcnt lgkmcnt(0)
 s_barrier
 tr 24,3,25344
 tr 26,3,25856
 tr 28,3,25376
 tr 30,3,25888
 mf 100,12,168,100
 tr 8,3,25408
 tr 10,3,25920
 s_add_u32 s46,s37,1
 s_and_b32 s46,s46,7
 s_lshl_b32 s46,s46,7
 s_add_u32 s46,s46,s45
 s_add_u32 m0,s41,69696
 s_add_u32 s40,s46,4096
 mf 116,12,172,116
 mf 104,16,168,104
 tr 12,3,25440
 tr 14,3,25952
 mf 120,16,172,120
 mf 108,20,168,108
 tr 16,3,29568
 tr 18,3,30080
 mf 124,20,172,124
 s_waitcnt lgkmcnt(6)
 mf 96,24,176,96
 tr 20,3,29600
 tr 22,3,30112
 mf 112,24,180,112
 mf 100,28,176,100
 tr 24,3,29632
 tr 26,3,30144
 mf 116,28,180,116
 s_waitcnt lgkmcnt(6)
 mf 104,8,176,104
 tr 28,3,29664
 tr 30,3,30176
 mf 120,8,180,120
 mf 108,12,176,108
 buffer_load_dwordx4 v2,s[20:23],s40 offen lds
 mf 124,12,180,124
 s_add_u32 m0,s41,70752
 s_add_u32 s40,s46,6144
 s_waitcnt lgkmcnt(4)
 mf 96,16,184,96
 buffer_load_dwordx4 v2,s[20:23],s40 offen lds
 mf 112,16,188,112
 s_waitcnt vmcnt(8)
 s_waitcnt lgkmcnt(0)
 s_barrier
 tr 8,3,33792
 tr 10,3,34304
 tr 12,3,33824
 tr 14,3,34336
 mf 100,20,184,100
 tr 16,3,33856
 tr 18,3,34368
 s_add_u32 s46,s37,2
 s_and_b32 s46,s46,7
 s_lshl_b32 s46,s46,7
 s_add_u32 s46,s46,s45
 s_add_u32 m0,s41,84480
 s_add_u32 s40,s46,0
 mf 116,20,188,116
 mf 104,24,184,104
 tr 20,3,33888
 tr 22,3,34400
 mf 120,24,188,120
 mf 108,28,184,108
 tr 24,3,38016
 tr 26,3,38528
 mf 124,28,188,124
 s_waitcnt lgkmcnt(6)
 mf 96,8,192,96
 tr 28,3,38048
 tr 30,3,38560
 mf 112,8,196,112
 mf 100,12,192,100
 tr 8,3,38080
 tr 10,3,38592
 mf 116,12,196,116
 s_waitcnt lgkmcnt(6)
 mf 104,16,192,104
 tr 12,3,38112
 tr 14,3,38624
 mf 120,16,196,120
 mf 108,20,192,108
 buffer_load_dwordx4 v2,s[20:23],s40 offen lds
 mf 124,20,196,124
 s_add_u32 m0,s41,85536
 s_add_u32 s40,s46,2048
 s_waitcnt lgkmcnt(4)
 mf 96,24,200,96
 buffer_load_dwordx4 v2,s[20:23],s40 offen lds
 mf 112,24,204,112
 s_waitcnt lgkmcnt(0)
 s_barrier
 tr 16,3,42240
 tr 18,3,42752
 tr 20,3,42272
 tr 22,3,42784
 mf 100,28,200,100
 tr 24,3,42304
 tr 26,3,42816
 s_add_u32 s46,s37,2
 s_and_b32 s46,s46,7
 s_lshl_b32 s46,s46,7
 s_add_u32 s46,s46,s45
 s_add_u32 m0,s41,86592
 s_add_u32 s40,s46,4096
 mf 116,28,204,116
 mf 104,8,200,104
 tr 28,3,42336
 tr 30,3,42848
 mf 120,8,204,120
 mf 108,12,200,108
 tr 8,3,46464
 tr 10,3,46976
 mf 124,12,204,124
 s_waitcnt lgkmcnt(6)
 mf 96,16,208,96
 tr 12,3,46496
 tr 14,3,47008
 mf 112,16,212,112
 mf 100,20,208,100
 tr 16,3,46528
 tr 18,3,47040
 mf 116,20,212,116
 s_waitcnt lgkmcnt(6)
 mf 104,24,208,104
 tr 20,3,46560
 tr 22,3,47072
 mf 120,24,212,120
 mf 108,28,208,108
 buffer_load_dwordx4 v2,s[20:23],s40 offen lds
 mf 124,28,212,124
 s_add_u32 m0,s41,87648
 s_add_u32 s40,s46,6144
 s_waitcnt lgkmcnt(4)
 mf 96,8,216,96
 buffer_load_dwordx4 v2,s[20:23],s40 offen lds
 mf 112,8,220,112
 s_waitcnt vmcnt(8)
 s_waitcnt lgkmcnt(0)
 s_barrier
 tr 24,3,50688
 tr 26,3,51200
 tr 28,3,50720
 tr 30,3,51232
 mf 100,12,216,100
 tr 8,3,50752
 tr 10,3,51264
 s_add_u32 s46,s37,3
 s_and_b32 s46,s46,7
 s_lshl_b32 s46,s46,7
 s_add_u32 s46,s46,s45
 s_add_u32 m0,s41,101376
 s_add_u32 s40,s46,0
 mf 116,12,220,116
 mf 104,16,216,104
 tr 12,3,50784
 tr 14,3,51296
 mf 120,16,220,120
 mf 108,20,216,108
 tr 16,3,54912
 tr 18,3,55424
 mf 124,20,220,124
 s_waitcnt lgkmcnt(6)
 mf 96,24,224,96
 tr 20,3,54944
 tr 22,3,55456
 mf 112,24,228,112
 mf 100,28,224,100
 tr 24,3,54976
 tr 26,3,55488
 mf 116,28,228,116
 s_waitcnt lgkmcnt(6)
 mf 104,8,224,104
 tr 28,3,55008
 tr 30,3,55520
 mf 120,8,228,120
 mf 108,12,224,108
 buffer_load_dwordx4 v2,s[20:23],s40 offen lds
 mf 124,12,228,124
 s_add_u32 m0,s41,102432
 s_add_u32 s40,s46,2048
 s_waitcnt lgkmcnt(4)
 mf 96,16,232,96
 buffer_load_dwordx4 v2,s[20:23],s40 offen lds
 mf 112,16,236,112
 s_waitcnt lgkmcnt(0)
 s_barrier
 tr 8,3,59136
 tr 10,3,59648
 tr 12,3,59168
 tr 14,3,59680
 mf 100,20,232,100
 tr 16,3,59200
 tr 18,3,59712
 s_add_u32 s46,s37,3
 s_and_b32 s46,s46,7
 s_lshl_b32 s46,s46,7
 s_add_u32 s46,s46,s45
 s_add_u32 m0,s41,103488
 s_add_u32 s40,s46,4096
 mf 116,20,236,116
 mf 104,24,232,104
 tr 20,3,59232
 tr 22,3,59744
 mf 120,24,236,120
 mf 108,28,232,108
 tr 24,3,63360
 tr 26,3,63872
 mf 124,28,236,124
 s_waitcnt lgkmcnt(6)
 mf 96,8,240,96
 tr 28,3,63392
 tr 30,3,63904
 mf 112,8,244,112
 mf 100,12,240,100
 tr 8,3,63424
 tr 10,3,63936
 mf 116,12,244,116
 s_waitcnt lgkmcnt(6)
 mf 104,16,240,104
 tr 12,3,63456
 tr 14,3,63968
 mf 120,16,244,120
 mf 108,20,240,108
 buffer_load_dwordx4 v2,s[20:23],s40 offen lds
 mf 124,20,244,124
 s_add_u32 m0,s41,104544
 s_add_u32 s40,s46,6144
 s_waitcnt lgkmcnt(4)
 mf 96,24,248,96
 buffer_load_dwordx4 v2,s[20:23],s40 offen lds
 mf 112,24,252,112
 s_waitcnt vmcnt(8)
 s_waitcnt lgkmcnt(0)
 s_barrier
 ds_read_b64_tr_b16 v[16:17],v3
 tr 18,3,512
 tr 20,3,32
 tr 22,3,544
 mf 100,28,248,100
 tr 24,3,64
 tr 26,3,576
 s_add_u32 s46,s37,4
 s_and_b32 s46,s46,7
 s_lshl_b32 s46,s46,7
 s_add_u32 s46,s46,s45
 s_add_u32 m0,s41,118272
 s_add_u32 s40,s46,0
 buffer_load_dwordx4 v2,s[20:23],s40 offen lds
 s_add_u32 m0,s41,119328
 s_add_u32 s40,s46,2048
 mf 116,28,252,116
 mf 104,8,248,104
 tr 28,3,96
 tr 30,3,608
 mf 120,8,252,120
 mf 108,12,248,108
 tr 8,3,4224
 tr 10,3,4736
 mf 124,12,252,124
 s_waitcnt lgkmcnt(6)
 mz 128,16,32
 tr 12,3,4256
 tr 14,3,4768
 mz 144,16,36
 v_mul_f32 v96,s38,v96
 v_mul_f32 v97,s38,v97
 v_mul_f32 v98,s38,v98
 v_mul_f32 v99,s38,v99
 v_mul_f32 v100,s38,v100
 v_mul_f32 v101,s38,v101
 v_mul_f32 v102,s38,v102
 v_mul_f32 v103,s38,v103
 mz 132,20,32
 tr 16,3,4288
 tr 18,3,4800
 cv 96,96,97
 cv 97,98,99
 cv 98,100,101
 cv 99,102,103
 ds_write_b64 v6,v[96:97] offset:14336
 ds_write_b64 v6,v[98:99] offset:17920
 mz 148,20,36
 v_mul_f32 v104,s38,v104
 v_mul_f32 v105,s38,v105
 v_mul_f32 v106,s38,v106
 v_mul_f32 v107,s38,v107
 v_mul_f32 v108,s38,v108
 v_mul_f32 v109,s38,v109
 v_mul_f32 v110,s38,v110
 v_mul_f32 v111,s38,v111
 s_waitcnt lgkmcnt(8)
 mz 136,24,32
 tr 20,3,4320
 tr 22,3,4832
 cv 104,104,105
 cv 105,106,107
 cv 106,108,109
 cv 107,110,111
 ds_write_b64 v6,v[104:105] offset:21504
 mz 152,24,36
 ds_write_b64 v6,v[106:107] offset:25088
 v_mul_f32 v112,s38,v112
 v_mul_f32 v113,s38,v113
 v_mul_f32 v114,s38,v114
 v_mul_f32 v115,s38,v115
 v_mul_f32 v116,s38,v116
 v_mul_f32 v117,s38,v117
 mz 140,28,32
 v_mul_f32 v118,s38,v118
 v_mul_f32 v119,s38,v119
 cv 112,112,113
 cv 113,114,115
 cv 114,116,117
 cv 115,118,119
 ds_write_b64 v7,v[112:113] offset:14336
 mz 156,28,36
 ds_write_b64 v7,v[114:115] offset:17920
 v_mul_f32 v120,s38,v120
 v_mul_f32 v121,s38,v121
 v_mul_f32 v122,s38,v122
 v_mul_f32 v123,s38,v123
 v_mul_f32 v124,s38,v124
 s_waitcnt lgkmcnt(10)
 mf 128,8,40,128
 v_mul_f32 v125,s38,v125
 v_mul_f32 v126,s38,v126
 v_mul_f32 v127,s38,v127
 cv 120,120,121
 cv 121,122,123
 cv 122,124,125
 cv 123,126,127
 ds_write_b64 v7,v[120:121] offset:21504
 mf 144,8,44,144
 ds_write_b64 v7,v[122:123] offset:25088
 buffer_load_dwordx4 v2,s[20:23],s40 offen lds
 s_waitcnt lgkmcnt(0)
 s_barrier
 tr 24,3,8448
 tr 26,3,8960
 tr 28,3,8480
 tr 30,3,8992
 mf 132,12,40,132
 tr 8,3,8512
 tr 10,3,9024
 s_add_u32 s46,s37,4
 s_and_b32 s46,s46,7
 s_lshl_b32 s46,s46,7
 s_add_u32 s46,s46,s45
 s_add_u32 m0,s41,120384
 s_add_u32 s40,s46,4096
 mf 148,12,44,148
 mf 136,16,40,136
 tr 12,3,8544
 tr 14,3,9056
 mf 152,16,44,152
 mf 140,20,40,140
 tr 16,3,12672
 tr 18,3,13184
 mf 156,20,44,156
 s_waitcnt lgkmcnt(6)
 mf 128,24,48,128
 tr 20,3,12704
 tr 22,3,13216
 mf 144,24,52,144
 mf 132,28,48,132
 tr 24,3,12736
 tr 26,3,13248
 mf 148,28,52,148
 s_waitcnt lgkmcnt(6)
 mf 136,8,48,136
 tr 28,3,12768
 tr 30,3,13280
 mf 152,8,52,152
 mf 140,12,48,140
 buffer_load_dwordx4 v2,s[20:23],s40 offen lds
 mf 156,12,52,156
 s_add_u32 m0,s41,121440
 s_add_u32 s40,s46,6144
 s_waitcnt lgkmcnt(4)
 mf 128,16,56,128
 buffer_load_dwordx4 v2,s[20:23],s40 offen lds
 mf 144,16,60,144
 v_mbcnt_lo_u32_b32 v0,-1,0
 v_mbcnt_hi_u32_b32 v0,-1,v0
 s_lshl_b32 s47,s37,2
 s_add_u32 s47,s47,s33
 s_lshl_b32 s47,s47,2
 v_cmp_eq_u32 vcc,0,v0
 v_mov_b32 v0,s47
 v_mov_b32 v7,0x40000000
 v_cndmask_b32 v7,v7,v0,vcc
 s_mov_b32 s40,0
 s_cmp_eq_u32 s33,3
 s_cselect_b32 s40,0x40000000,s40
 v_add_u32 v6,s40,v1
 s_waitcnt vmcnt(8)
 s_waitcnt lgkmcnt(0)
 s_barrier
 tr 8,3,16896
 tr 10,3,17408
 tr 12,3,16928
 tr 14,3,17440
 mf 132,20,56,132
 tr 16,3,16960
 tr 18,3,17472
 s_add_u32 s46,s37,5
 s_and_b32 s46,s46,7
 s_lshl_b32 s46,s46,7
 s_add_u32 s46,s46,s45
 s_add_u32 m0,s41,67584
 s_add_u32 s40,s46,0
 mf 148,20,60,148
 mf 136,24,56,136
 tr 20,3,16992
 tr 22,3,17504
 mf 152,24,60,152
 mf 140,28,56,140
 tr 24,3,21120
 tr 26,3,21632
 mf 156,28,60,156
 s_waitcnt lgkmcnt(6)
 mz 160,8,32
 tr 28,3,21152
 tr 30,3,21664
 mz 176,8,36
 mz 164,12,32
 tr 8,3,21184
 tr 10,3,21696
 mz 180,12,36
 s_waitcnt lgkmcnt(6)
 mz 168,16,32
 tr 12,3,21216
 tr 14,3,21728
 mz 184,16,36
 mz 172,20,32
 tr 16,3,25344
 tr 18,3,25856
 mz 188,20,36
 s_waitcnt lgkmcnt(6)
 mf 160,24,40,160
 tr 20,3,25376
 tr 22,3,25888
 mf 176,24,44,176
 mf 164,28,40,164
 tr 24,3,25408
 tr 26,3,25920
 mf 180,28,44,180
 s_waitcnt lgkmcnt(6)
 mf 168,8,40,168
 tr 28,3,25440
 tr 30,3,25952
 buffer_load_dwordx4 v2,s[20:23],s40 offen lds
 mf 184,8,44,184
 s_add_u32 m0,s41,68640
 s_add_u32 s40,s46,2048
 mf 172,12,40,172
 buffer_load_dwordx4 v2,s[20:23],s40 offen lds
 mf 188,12,44,188
 s_add_u32 m0,s41,69696
 s_add_u32 s40,s46,4096
 s_waitcnt lgkmcnt(4)
 mf 160,16,48,160
 buffer_load_dwordx4 v2,s[20:23],s40 offen lds
 mf 176,16,52,176
 s_waitcnt vmcnt(7)
 s_waitcnt lgkmcnt(0)
 s_barrier
 tr 8,3,29568
 tr 10,3,30080
 tr 12,3,29600
 tr 14,3,30112
 mf 164,20,48,164
 tr 16,3,29632
 tr 18,3,30144
 s_add_u32 s46,s37,5
 s_and_b32 s46,s46,7
 s_lshl_b32 s46,s46,7
 s_add_u32 s46,s46,s45
 s_add_u32 m0,s41,70752
 s_add_u32 s40,s46,6144
 mf 180,20,52,180
 mf 168,24,48,168
 tr 20,3,29664
 tr 22,3,30176
 mf 184,24,52,184
 mf 172,28,48,172
 tr 24,3,33792
 tr 26,3,34304
 mf 188,28,52,188
 s_waitcnt lgkmcnt(6)
 mf 160,8,56,160
 tr 28,3,33824
 tr 30,3,34336
 mf 176,8,60,176
 mf 164,12,56,164
 tr 8,3,33856
 tr 10,3,34368
 mf 180,12,60,180
 s_waitcnt lgkmcnt(6)
 mf 168,16,56,168
 tr 12,3,33888
 tr 14,3,34400
 mf 184,16,60,184
 mf 172,20,56,172
 tr 16,3,38016
 tr 18,3,38528
 mf 188,20,60,188
 s_waitcnt lgkmcnt(6)
 mz 192,24,32
 tr 20,3,38048
 tr 22,3,38560
 mz 208,24,36
 mz 196,28,32
 tr 24,3,38080
 tr 26,3,38592
 mz 212,28,36
 s_waitcnt lgkmcnt(6)
 mz 200,8,32
 tr 28,3,38112
 tr 30,3,38624
 mz 216,8,36
 mz 204,12,32
 mz 220,12,36
 s_waitcnt lgkmcnt(4)
 mf 192,16,40,192
 buffer_load_dwordx4 v2,s[20:23],s40 offen lds
 mf 208,16,44,208
 v_mbcnt_lo_u32_b32 v0,-1,0
 v_mbcnt_hi_u32_b32 v0,-1,v0
 s_lshl_b32 s40,s33,2
 v_min_u32 v0,7,v0
 v_lshlrev_b32 v0,4,v0
 v_add_u32 v0,s40,v0
 s_lshl_b32 s39,s37,7
 s_waitcnt vmcnt(4)
 s_waitcnt lgkmcnt(0)
 s_barrier
 tr 8,3,42240
 tr 10,3,42752
 tr 12,3,42272
 tr 14,3,42784
 mf 196,20,40,196
 tr 16,3,42304
 tr 18,3,42816
 s_add_u32 s46,s37,1
 s_and_b32 s46,s46,7
 s_lshl_b32 s46,s46,7
 s_add_u32 s46,s46,s45
 s_add_u32 m0,s41,84480
 s_add_u32 s40,s46,131072
 mf 212,20,44,212
 mf 200,24,40,200
 tr 20,3,42336
 tr 22,3,42848
 mf 216,24,44,216
 mf 204,28,40,204
 tr 24,3,46464
 tr 26,3,46976
 mf 220,28,44,220
 s_waitcnt lgkmcnt(6)
 mf 192,8,48,192
 tr 28,3,46496
 tr 30,3,47008
 mf 208,8,52,208
 mf 196,12,48,196
 tr 8,3,46528
 tr 10,3,47040
 mf 212,12,52,212
 s_waitcnt lgkmcnt(6)
 mf 200,16,48,200
 tr 12,3,46560
 tr 14,3,47072
 mf 216,16,52,216
 mf 204,20,48,204
 tr 16,3,50688
 tr 18,3,51200
 mf 220,20,52,220
 s_waitcnt lgkmcnt(6)
 mf 192,24,56,192
 tr 20,3,50720
 tr 22,3,51232
 mf 208,24,60,208
 mf 196,28,56,196
 tr 24,3,50752
 tr 26,3,51264
 mf 212,28,60,212
 s_waitcnt lgkmcnt(6)
 mf 200,8,56,200
 tr 28,3,50784
 tr 30,3,51296
 mf 216,8,60,216
 mf 204,12,56,204
 tr 8,3,54912
 tr 10,3,55424
 mf 220,12,60,220
 s_waitcnt lgkmcnt(6)
 mz 224,16,32
 tr 12,3,54944
 tr 14,3,55456
 mz 240,16,36
 mz 228,20,32
 tr 16,3,54976
 tr 18,3,55488
 buffer_load_dwordx4 v2,s[20:23],s40 offen lds
 mz 244,20,36
 s_add_u32 m0,s41,85536
 s_add_u32 s40,s46,133120
 s_waitcnt lgkmcnt(6)
 mz 232,24,32
 tr 20,3,55008
 tr 22,3,55520
 buffer_load_dwordx4 v2,s[20:23],s40 offen lds
 mz 248,24,36
 s_add_u32 m0,s41,86592
 s_add_u32 s40,s46,135168
 mz 236,28,32
 buffer_load_dwordx4 v2,s[20:23],s40 offen lds
 mz 252,28,36
 s_add_u32 m0,s41,87648
 s_add_u32 s40,s46,137216
 s_waitcnt lgkmcnt(4)
 mf 224,8,40,224
 buffer_load_dwordx4 v2,s[20:23],s40 offen lds
 mf 240,8,44,240
 s_waitcnt vmcnt(4)
 s_waitcnt lgkmcnt(0)
 s_barrier
 tr 24,3,59136
 tr 26,3,59648
 tr 28,3,59168
 tr 30,3,59680
 mf 228,12,40,228
 tr 8,3,59200
 tr 10,3,59712
 s_add_u32 s46,s37,2
 s_and_b32 s46,s46,7
 s_lshl_b32 s46,s46,7
 s_add_u32 s46,s46,s45
 s_add_u32 m0,s41,101376
 s_add_u32 s40,s46,131072
 mf 244,12,44,244
 mf 232,16,40,232
 tr 12,3,59232
 tr 14,3,59744
 mf 248,16,44,248
 mf 236,20,40,236
 tr 16,3,63360
 tr 18,3,63872
 mf 252,20,44,252
 s_waitcnt lgkmcnt(6)
 mf 224,24,48,224
 tr 20,3,63392
 tr 22,3,63904
 mf 240,24,52,240
 mf 228,28,48,228
 tr 24,3,63424
 tr 26,3,63936
 mf 244,28,52,244
 s_waitcnt lgkmcnt(6)
 mf 232,8,48,232
 tr 28,3,63456
 tr 30,3,63968
 mf 248,8,52,248
 mf 236,12,48,236
 ds_read_b64_tr_b16 v[8:9],v3
 tr 10,3,512
 mf 252,12,52,252
 s_waitcnt lgkmcnt(6)
 mf 224,16,56,224
 tr 12,3,32
 tr 14,3,544
 mf 240,16,60,240
 mf 228,20,56,228
 tr 16,3,64
 tr 18,3,576
 mf 244,20,60,244
 s_waitcnt lgkmcnt(6)
 mf 232,24,56,232
 tr 20,3,96
 tr 22,3,608
 buffer_load_dwordx4 v2,s[20:23],s40 offen lds
 mf 248,24,60,248
 s_add_u32 m0,s41,102432
 s_add_u32 s40,s46,133120
 mf 236,28,56,236
 buffer_load_dwordx4 v2,s[20:23],s40 offen lds
 mf 252,28,60,252
 s_add_u32 m0,s41,103488
 s_add_u32 s40,s46,135168
 s_waitcnt lgkmcnt(4)
 mz 96,8,32
 buffer_load_dwordx4 v2,s[20:23],s40 offen lds
 mz 112,8,36
 s_waitcnt lgkmcnt(0)
 s_barrier
 tr 24,3,4224
 tr 26,3,4736
 tr 28,3,4256
 tr 30,3,4768
 mz 100,12,32
 tr 8,3,4288
 tr 10,3,4800
 s_add_u32 s46,s37,2
 s_and_b32 s46,s46,7
 s_lshl_b32 s46,s46,7
 s_add_u32 s46,s46,s45
 s_add_u32 m0,s41,104544
 s_add_u32 s40,s46,137216
 mz 116,12,36
 mz 104,16,32
 tr 12,3,4320
 tr 14,3,4832
 mz 120,16,36
 mz 108,20,32
 tr 16,3,8448
 tr 18,3,8960
 mz 124,20,36
 s_waitcnt lgkmcnt(6)
 mf 96,24,40,96
 tr 20,3,8480
 tr 22,3,8992
 mf 112,24,44,112
 mf 100,28,40,100
 tr 24,3,8512
 tr 26,3,9024
 mf 116,28,44,116
 s_waitcnt lgkmcnt(6)
 mf 104,8,40,104
 tr 28,3,8544
 tr 30,3,9056
 mf 120,8,44,120
 mf 108,12,40,108
 tr 8,3,12672
 tr 10,3,13184
 mf 124,12,44,124
 s_waitcnt lgkmcnt(6)
 mf 96,16,48,96
 tr 12,3,12704
 tr 14,3,13216
 mf 112,16,52,112
 mf 100,20,48,100
 tr 16,3,12736
 tr 18,3,13248
 mf 116,20,52,116
 s_waitcnt lgkmcnt(6)
 mf 104,24,48,104
 tr 20,3,12768
 tr 22,3,13280
 buffer_load_dwordx4 v2,s[20:23],s40 offen lds
 mf 120,24,52,120
 s_add_u32 s46,s37,3
 s_and_b32 s46,s46,7
 s_lshl_b32 s46,s46,7
 s_add_u32 s46,s46,s45
 s_add_u32 m0,s41,118272
 s_add_u32 s40,s46,131072
 mf 108,28,48,108
 buffer_load_dwordx4 v2,s[20:23],s40 offen lds
 mf 124,28,52,124
 s_add_u32 m0,s41,119328
 s_add_u32 s40,s46,133120
 s_waitcnt lgkmcnt(4)
 mf 96,8,56,96
 buffer_load_dwordx4 v2,s[20:23],s40 offen lds
 mf 112,8,60,112
 s_waitcnt vmcnt(6)
 s_waitcnt lgkmcnt(0)
 s_barrier
 tr 24,3,16896
 tr 26,3,17408
 tr 28,3,16928
 tr 30,3,17440
 mf 100,12,56,100
 tr 8,3,16960
 tr 10,3,17472
 s_add_u32 s46,s37,3
 s_and_b32 s46,s46,7
 s_lshl_b32 s46,s46,7
 s_add_u32 s46,s46,s45
 s_add_u32 m0,s41,120384
 s_add_u32 s40,s46,135168
 mf 116,12,60,116
 mf 104,16,56,104
 tr 12,3,16992
 tr 14,3,17504
 buffer_load_dwordx4 v2,s[20:23],s40 offen lds
 mf 120,16,60,120
 s_add_u32 m0,s41,121440
 s_add_u32 s40,s46,137216
 mf 108,20,56,108
 tr 16,3,21120
 tr 18,3,21632
 buffer_load_dwordx4 v2,s[20:23],s40 offen lds
 mf 124,20,60,124
 s_add_u32 s46,s37,4
 s_and_b32 s46,s46,7
 s_lshl_b32 s46,s46,7
 s_add_u32 s46,s46,s45
 s_add_u32 m0,s41,67584
 s_add_u32 s40,s46,131072
 s_waitcnt lgkmcnt(6)
 mf 128,24,64,128
 tr 20,3,21152
 tr 22,3,21664
 buffer_load_dwordx4 v2,s[20:23],s40 offen lds
 mf 144,24,68,144
 ds_read_b128 v[32:35],v4
 mf 132,28,64,132
 tr 24,3,21184
 tr 26,3,21696
 ds_read_b128 v[36:39],v5
 mf 148,28,68,148
 ds_read_b128 v[40:43],v4 offset:7168
 s_waitcnt lgkmcnt(9)
 mf 136,8,64,136
 tr 28,3,21216
 tr 30,3,21728
 ds_read_b128 v[44:47],v5 offset:7168
 mf 152,8,68,152
 ds_read_b128 v[48:51],v4 offset:14336
 mf 140,12,64,140
 ds_read_b128 v[52:55],v5 offset:14336
 mf 156,12,68,156
 ds_read_b128 v[56:59],v4 offset:21504
 s_waitcnt lgkmcnt(11)
 mf 128,16,72,128
 ds_read_b128 v[60:63],v5 offset:21504
 mf 144,16,76,144
 s_waitcnt vmcnt(5)
 s_waitcnt lgkmcnt(0)
 s_barrier
 tr 8,3,25344
 tr 10,3,25856
 tr 12,3,25376
 tr 14,3,25888
 mf 132,20,72,132
 tr 16,3,25408
 tr 18,3,25920
 s_add_u32 s46,s37,4
 s_and_b32 s46,s46,7
 s_lshl_b32 s46,s46,7
 s_add_u32 s46,s46,s45
 s_add_u32 m0,s41,68640
 s_add_u32 s40,s46,133120
 mf 148,20,76,148
 mf 136,24,72,136
 tr 20,3,25440
 tr 22,3,25952
 mf 152,24,76,152
 mf 140,28,72,140
 tr 24,3,29568
 tr 26,3,30080
 mf 156,28,76,156
 s_waitcnt lgkmcnt(6)
 mf 128,8,80,128
 tr 28,3,29600
 tr 30,3,30112
 mf 144,8,84,144
 mf 132,12,80,132
 tr 8,3,29632
 tr 10,3,30144
 mf 148,12,84,148
 s_waitcnt lgkmcnt(6)
 mf 136,16,80,136
 tr 12,3,29664
 tr 14,3,30176
 mf 152,16,84,152
 mf 140,20,80,140
 tr 16,3,33792
 tr 18,3,34304
 mf 156,20,84,156
 s_waitcnt lgkmcnt(6)
 mf 128,24,88,128
 tr 20,3,33824
 tr 22,3,34336
 mf 144,24,92,144
 mf 132,28,88,132
 tr 24,3,33856
 tr 26,3,34368
 mf 148,28,92,148
 s_waitcnt lgkmcnt(6)
 mf 136,8,88,136
 tr 28,3,33888
 tr 30,3,34400
 buffer_load_dwordx4 v2,s[20:23],s40 offen lds
 mf 152,8,92,152
 s_add_u32 m0,s41,69696
 s_add_u32 s40,s46,135168
 mf 140,12,88,140
 buffer_load_dwordx4 v2,s[20:23],s40 offen lds
 mf 156,12,92,156
 s_add_u32 m0,s41,70752
 s_add_u32 s40,s46,137216
 s_waitcnt lgkmcnt(4)
 mf 160,16,64,160
 buffer_load_dwordx4 v2,s[20:23],s40 offen lds
 mf 176,16,68,176
 s_waitcnt lgkmcnt(0)
 s_barrier
 tr 8,3,38016
 tr 10,3,38528
 tr 12,3,38048
 tr 14,3,38560
 mf 164,20,64,164
 tr 16,3,38080
 tr 18,3,38592
 s_add_u32 s46,s37,5
 s_and_b32 s46,s46,7
 s_lshl_b32 s46,s46,7
 s_add_u32 s46,s46,s45
 s_add_u32 m0,s41,84480
 s_add_u32 s40,s46,131072
 mf 180,20,68,180
 mf 168,24,64,168
 tr 20,3,38112
 tr 22,3,38624
 mf 184,24,68,184
 mf 172,28,64,172
 tr 24,3,42240
 tr 26,3,42752
 mf 188,28,68,188
 s_waitcnt lgkmcnt(6)
 mf 160,8,72,160
 tr 28,3,42272
 tr 30,3,42784
 mf 176,8,76,176
 mf 164,12,72,164
 tr 8,3,42304
 tr 10,3,42816
 mf 180,12,76,180
 s_waitcnt lgkmcnt(6)
 mf 168,16,72,168
 tr 12,3,42336
 tr 14,3,42848
 mf 184,16,76,184
 mf 172,20,72,172
 tr 16,3,46464
 tr 18,3,46976
 mf 188,20,76,188
 s_waitcnt lgkmcnt(6)
 mf 160,24,80,160
 tr 20,3,46496
 tr 22,3,47008
 mf 176,24,84,176
 mf 164,28,80,164
 tr 24,3,46528
 tr 26,3,47040
 mf 180,28,84,180
 s_waitcnt lgkmcnt(6)
 mf 168,8,80,168
 tr 28,3,46560
 tr 30,3,47072
 buffer_load_dwordx4 v2,s[20:23],s40 offen lds
 mf 184,8,84,184
 s_add_u32 m0,s41,85536
 s_add_u32 s40,s46,133120
 mf 172,12,80,172
 buffer_load_dwordx4 v2,s[20:23],s40 offen lds
 mf 188,12,84,188
 s_add_u32 m0,s41,86592
 s_add_u32 s40,s46,135168
 s_waitcnt lgkmcnt(4)
 mf 160,16,88,160
 buffer_load_dwordx4 v2,s[20:23],s40 offen lds
 mf 176,16,92,176
 s_waitcnt vmcnt(7)
 s_waitcnt lgkmcnt(0)
 s_barrier
 tr 8,3,50688
 tr 10,3,51200
 tr 12,3,50720
 tr 14,3,51232
 mf 164,20,88,164
 tr 16,3,50752
 tr 18,3,51264
 s_add_u32 s46,s37,5
 s_and_b32 s46,s46,7
 s_lshl_b32 s46,s46,7
 s_add_u32 s46,s46,s45
 s_add_u32 m0,s41,87648
 s_add_u32 s40,s46,137216
 mf 180,20,92,180
 mf 168,24,88,168
 tr 20,3,50784
 tr 22,3,51296
 mf 184,24,92,184
 mf 172,28,88,172
 tr 24,3,54912
 tr 26,3,55424
 mf 188,28,92,188
 s_waitcnt lgkmcnt(6)
 mf 192,8,64,192
 tr 28,3,54944
 tr 30,3,55456
 mf 208,8,68,208
 mf 196,12,64,196
 tr 8,3,54976
 tr 10,3,55488
 mf 212,12,68,212
 s_waitcnt lgkmcnt(6)
 mf 200,16,64,200
 tr 12,3,55008
 tr 14,3,55520
 mf 216,16,68,216
 mf 204,20,64,204
 tr 16,3,59136
 tr 18,3,59648
 mf 220,20,68,220
 s_waitcnt lgkmcnt(6)
 mf 192,24,72,192
 tr 20,3,59168
 tr 22,3,59680
 mf 208,24,76,208
 mf 196,28,72,196
 tr 24,3,59200
 tr 26,3,59712
 mf 212,28,76,212
 s_waitcnt lgkmcnt(6)
 mf 200,8,72,200
 tr 28,3,59232
 tr 30,3,59744
 buffer_load_dwordx4 v2,s[20:23],s40 offen lds
 mf 216,8,76,216
 s_add_u32 s46,s37,1
 s_and_b32 s46,s46,7
 s_lshl_b32 s46,s46,7
 s_add_u32 s46,s46,s45
 s_add_u32 m0,s41,101376
 s_add_u32 s40,s46,262144
 mf 204,12,72,204
 buffer_load_dwordx4 v2,s[20:23],s40 offen lds
 mf 220,12,76,220
 s_add_u32 m0,s41,102432
 s_add_u32 s40,s46,264192
 s_waitcnt lgkmcnt(4)
 mf 192,16,80,192
 buffer_load_dwordx4 v2,s[20:23],s40 offen lds
 mf 208,16,84,208
 s_waitcnt vmcnt(6)
 s_waitcnt lgkmcnt(0)
 s_barrier
 tr 8,3,63360
 tr 10,3,63872
 tr 12,3,63392
 tr 14,3,63904
 mf 196,20,80,196
 tr 16,3,63424
 tr 18,3,63936
 s_add_u32 s46,s37,1
 s_and_b32 s46,s46,7
 s_lshl_b32 s46,s46,7
 s_add_u32 s46,s46,s45
 s_add_u32 m0,s41,103488
 s_add_u32 s40,s46,266240
 mf 212,20,84,212
 mf 200,24,80,200
 tr 20,3,63456
 tr 22,3,63968
 mf 216,24,84,216
 mf 204,28,80,204
 ds_read_b64_tr_b16 v[24:25],v3
 tr 26,3,512
 mf 220,28,84,220
 s_waitcnt lgkmcnt(6)
 mf 192,8,88,192
 tr 28,3,32
 tr 30,3,544
 mf 208,8,92,208
 mf 196,12,88,196
 tr 8,3,64
 tr 10,3,576
 mf 212,12,92,212
 s_waitcnt lgkmcnt(6)
 mf 200,16,88,200
 tr 12,3,96
 tr 14,3,608
 mf 216,16,92,216
 mf 204,20,88,204
 tr 16,3,4224
 tr 18,3,4736
 mf 220,20,92,220
 s_waitcnt lgkmcnt(6)
 mf 224,24,64,224
 tr 20,3,4256
 tr 22,3,4768
 mf 240,24,68,240
 mf 228,28,64,228
 tr 24,3,4288
 tr 26,3,4800
 mf 244,28,68,244
 s_waitcnt lgkmcnt(6)
 mf 232,8,64,232
 tr 28,3,4320
 tr 30,3,4832
 mf 248,8,68,248
 mf 236,12,64,236
 buffer_load_dwordx4 v2,s[20:23],s40 offen lds
 mf 252,12,68,252
 s_add_u32 m0,s41,104544
 s_add_u32 s40,s46,268288
 s_waitcnt lgkmcnt(4)
 mf 224,16,72,224
 buffer_load_dwordx4 v2,s[20:23],s40 offen lds
 mf 240,16,76,240
 s_waitcnt vmcnt(4)
 s_waitcnt lgkmcnt(0)
 s_barrier
 tr 8,3,8448
 tr 10,3,8960
 tr 12,3,8480
 tr 14,3,8992
 mf 228,20,72,228
 tr 16,3,8512
 tr 18,3,9024
 s_add_u32 s46,s37,2
 s_and_b32 s46,s46,7
 s_lshl_b32 s46,s46,7
 s_add_u32 s46,s46,s45
 s_add_u32 m0,s41,118272
 s_add_u32 s40,s46,262144
 mf 244,20,76,244
 mf 232,24,72,232
 tr 20,3,8544
 tr 22,3,9056
 mf 248,24,76,248
 mf 236,28,72,236
 tr 24,3,12672
 tr 26,3,13184
 mf 252,28,76,252
 s_waitcnt lgkmcnt(6)
 mf 224,8,80,224
 tr 28,3,12704
 tr 30,3,13216
 buffer_load_dwordx4 v2,s[20:23],s40 offen lds
 mf 240,8,84,240
 s_add_u32 m0,s41,119328
 s_add_u32 s40,s46,264192
 mf 228,12,80,228
 tr 8,3,12736
 tr 10,3,13248
 buffer_load_dwordx4 v2,s[20:23],s40 offen lds
 mf 244,12,84,244
 s_add_u32 m0,s41,120384
 s_add_u32 s40,s46,266240
 s_waitcnt lgkmcnt(6)
 mf 232,16,80,232
 tr 12,3,12768
 tr 14,3,13280
 buffer_load_dwordx4 v2,s[20:23],s40 offen lds
 mf 248,16,84,248
 ds_write_b128 v4,v[64:67]
 mf 236,20,80,236
 tr 16,3,16896
 tr 18,3,17408
 ds_write_b128 v5,v[68:71]
 mf 252,20,84,252
 ds_write_b128 v4,v[72:75] offset:7168
 s_waitcnt lgkmcnt(9)
 mf 224,24,88,224
 tr 20,3,16928
 tr 22,3,17440
 ds_write_b128 v5,v[76:79] offset:7168
 mf 240,24,92,240
 mf 228,28,88,228
 tr 24,3,16960
 tr 26,3,17472
 ds_write_b128 v4,v[80:83] offset:14336
 mf 244,28,92,244
 s_waitcnt lgkmcnt(11)
 mf 232,8,88,232
 tr 28,3,16992
 tr 30,3,17504
 ds_write_b128 v5,v[84:87] offset:14336
 mf 248,8,92,248
 mf 236,12,88,236
 ds_write_b128 v4,v[88:91] offset:21504
 mf 252,12,92,252
 s_waitcnt lgkmcnt(8)
 mf 96,16,64,96
 ds_write_b128 v5,v[92:95] offset:21504
 mf 112,16,68,112
 s_waitcnt lgkmcnt(0)
 s_barrier
 tr 8,3,21120
 tr 10,3,21632
 tr 12,3,21152
 tr 14,3,21664
 mf 100,20,64,100
 tr 16,3,21184
 tr 18,3,21696
 s_add_u32 s46,s37,2
 s_and_b32 s46,s46,7
 s_lshl_b32 s46,s46,7
 s_add_u32 s46,s46,s45
 s_add_u32 m0,s41,121440
 s_add_u32 s40,s46,268288
 mf 116,20,68,116
 mf 104,24,64,104
 tr 20,3,21216
 tr 22,3,21728
 mf 120,24,68,120
 mf 108,28,64,108
 tr 24,3,25344
 tr 26,3,25856
 mf 124,28,68,124
 s_waitcnt lgkmcnt(6)
 mf 96,8,72,96
 tr 28,3,25376
 tr 30,3,25888
 mf 112,8,76,112
 mf 100,12,72,100
 tr 8,3,25408
 tr 10,3,25920
 mf 116,12,76,116
 s_waitcnt lgkmcnt(6)
 mf 104,16,72,104
 tr 12,3,25440
 tr 14,3,25952
 mf 120,16,76,120
 mf 108,20,72,108
 tr 16,3,29568
 tr 18,3,30080
 mf 124,20,76,124
 s_waitcnt lgkmcnt(6)
 mf 96,24,80,96
 tr 20,3,29600
 tr 22,3,30112
 mf 112,24,84,112
 mf 100,28,80,100
 tr 24,3,29632
 tr 26,3,30144
 mf 116,28,84,116
 s_waitcnt lgkmcnt(6)
 mf 104,8,80,104
 tr 28,3,29664
 tr 30,3,30176
 buffer_load_dwordx4 v2,s[20:23],s40 offen lds
 mf 120,8,84,120
 s_add_u32 s46,s37,3
 s_and_b32 s46,s46,7
 s_lshl_b32 s46,s46,7
 s_add_u32 s46,s46,s45
 s_add_u32 m0,s41,67584
 s_add_u32 s40,s46,262144
 mf 108,12,80,108
 buffer_load_dwordx4 v2,s[20:23],s40 offen lds
 mf 124,12,84,124
 s_add_u32 m0,s41,68640
 s_add_u32 s40,s46,264192
 s_waitcnt lgkmcnt(4)
 mf 96,16,88,96
 buffer_load_dwordx4 v2,s[20:23],s40 offen lds
 mf 112,16,92,112
 s_waitcnt vmcnt(6)
 s_waitcnt lgkmcnt(0)
 s_barrier
 tr 8,3,33792
 tr 10,3,34304
 tr 12,3,33824
 tr 14,3,34336
 mf 100,20,88,100
 tr 16,3,33856
 tr 18,3,34368
 s_add_u32 s46,s37,3
 s_and_b32 s46,s46,7
 s_lshl_b32 s46,s46,7
 s_add_u32 s46,s46,s45
 s_add_u32 m0,s41,69696
 s_add_u32 s40,s46,266240
 mf 116,20,92,116
 mf 104,24,88,104
 tr 20,3,33888
 tr 22,3,34400
 mf 120,24,92,120
 mf 108,28,88,108
 tr 24,3,38016
 tr 26,3,38528
 mf 124,28,92,124
 s_waitcnt lgkmcnt(6)
 mf 128,8,32,128
 tr 28,3,38048
 tr 30,3,38560
 mf 144,8,36,144
 mf 132,12,32,132
 tr 8,3,38080
 tr 10,3,38592
 mf 148,12,36,148
 s_waitcnt lgkmcnt(6)
 mf 136,16,32,136
 tr 12,3,38112
 tr 14,3,38624
 mf 152,16,36,152
 mf 140,20,32,140
 tr 16,3,42240
 tr 18,3,42752
 mf 156,20,36,156
 s_waitcnt lgkmcnt(6)
 mf 128,24,40,128
 tr 20,3,42272
 tr 22,3,42784
 mf 144,24,44,144
 mf 132,28,40,132
 tr 24,3,42304
 tr 26,3,42816
 mf 148,28,44,148
 s_waitcnt lgkmcnt(6)
 mf 136,8,40,136
 tr 28,3,42336
 tr 30,3,42848
 buffer_load_dwordx4 v2,s[20:23],s40 offen lds
 mf 152,8,44,152
 s_add_u32 m0,s41,70752
 s_add_u32 s40,s46,268288
 mf 140,12,40,140
 buffer_load_dwordx4 v2,s[20:23],s40 offen lds
 mf 156,12,44,156
 s_add_u32 s46,s37,4
 s_and_b32 s46,s46,7
 s_lshl_b32 s46,s46,7
 s_add_u32 s46,s46,s45
 s_add_u32 m0,s41,84480
 s_add_u32 s40,s46,262144
 s_waitcnt lgkmcnt(4)
 mf 128,16,48,128
 buffer_load_dwordx4 v2,s[20:23],s40 offen lds
 mf 144,16,52,144
 s_waitcnt vmcnt(5)
 s_waitcnt lgkmcnt(0)
 s_barrier
 tr 8,3,46464
 tr 10,3,46976
 tr 12,3,46496
 tr 14,3,47008
 mf 132,20,48,132
 tr 16,3,46528
 tr 18,3,47040
 s_add_u32 s46,s37,6
 s_and_b32 s46,s46,7
 s_lshl_b32 s46,s46,7
 s_add_u32 s46,s46,s45
 s_add_u32 m0,s41,16896
 s_add_u32 s40,s46,131072
 mf 148,20,52,148
 mf 136,24,48,136
 tr 20,3,46560
 tr 22,3,47072
 mf 152,24,52,152
 mf 140,28,48,140
 tr 24,3,50688
 tr 26,3,51200
 mf 156,28,52,156
 s_waitcnt lgkmcnt(6)
 mf 128,8,56,128
 tr 28,3,50720
 tr 30,3,51232
 mf 144,8,60,144
 mf 132,12,56,132
 tr 8,3,50752
 tr 10,3,51264
 mf 148,12,60,148
 s_waitcnt lgkmcnt(6)
 mf 136,16,56,136
 tr 12,3,50784
 tr 14,3,51296
 buffer_load_dwordx4 v2,s[20:23],s40 offen lds
 mf 152,16,60,152
 s_add_u32 m0,s41,17952
 s_add_u32 s40,s46,133120
 mf 140,20,56,140
 tr 16,3,54912
 tr 18,3,55424
 buffer_load_dwordx4 v2,s[20:23],s40 offen lds
 mf 156,20,60,156
 s_add_u32 m0,s41,19008
 s_add_u32 s40,s46,135168
 s_waitcnt lgkmcnt(6)
 mf 160,24,32,160
 tr 20,3,54944
 tr 22,3,55456
 buffer_load_dwordx4 v2,s[20:23],s40 offen lds
 mf 176,24,36,176
 s_add_u32 m0,s41,20064
 s_add_u32 s40,s46,137216
 mf 164,28,32,164
 tr 24,3,54976
 tr 26,3,55488
 buffer_load_dwordx4 v2,s[20:23],s40 offen lds
 mf 180,28,36,180
 s_add_u32 s46,s37,4
 s_and_b32 s46,s46,7
 s_lshl_b32 s46,s46,7
 s_add_u32 s46,s46,s45
 s_add_u32 m0,s41,85536
 s_add_u32 s40,s46,264192
 s_waitcnt lgkmcnt(6)
 mf 168,8,32,168
 tr 28,3,55008
 tr 30,3,55520
 buffer_load_dwordx4 v2,s[20:23],s40 offen lds
 mf 184,8,36,184
 s_add_u32 m0,s41,86592
 s_add_u32 s40,s46,266240
 mf 172,12,32,172
 buffer_load_dwordx4 v2,s[20:23],s40 offen lds
 mf 188,12,36,188
 s_add_u32 m0,s41,87648
 s_add_u32 s40,s46,268288
 s_waitcnt lgkmcnt(4)
 mf 160,16,40,160
 buffer_load_dwordx4 v2,s[20:23],s40 offen lds
 mf 176,16,44,176
 s_waitcnt vmcnt(8)
 s_waitcnt lgkmcnt(0)
 s_barrier
 tr 8,3,59136
 tr 10,3,59648
 tr 12,3,59168
 tr 14,3,59680
 mf 164,20,40,164
 tr 16,3,59200
 tr 18,3,59712
 s_add_u32 s46,s37,5
 s_and_b32 s46,s46,7
 s_lshl_b32 s46,s46,7
 s_add_u32 s46,s46,s45
 s_add_u32 m0,s41,101376
 s_add_u32 s40,s46,262144
 mf 180,20,44,180
 mf 168,24,40,168
 tr 20,3,59232
 tr 22,3,59744
 mf 184,24,44,184
 mf 172,28,40,172
 tr 24,3,63360
 tr 26,3,63872
 mf 188,28,44,188
 s_waitcnt lgkmcnt(6)
 mf 160,8,48,160
 tr 28,3,63392
 tr 30,3,63904
 mf 176,8,52,176
 mf 164,12,48,164
 tr 8,3,63424
 tr 10,3,63936
 mf 180,12,52,180
 s_waitcnt lgkmcnt(6)
 mf 168,16,48,168
 tr 12,3,63456
 tr 14,3,63968
 mf 184,16,52,184
 mf 172,20,48,172
 ds_read_b64_tr_b16 v[16:17],v3
 tr 18,3,512
 mf 188,20,52,188
 s_waitcnt lgkmcnt(6)
 mf 160,24,56,160
 tr 20,3,32
 tr 22,3,544
 mf 176,24,60,176
 mf 164,28,56,164
 tr 24,3,64
 tr 26,3,576
 mf 180,28,60,180
 s_waitcnt lgkmcnt(6)
 mf 168,8,56,168
 tr 28,3,96
 tr 30,3,608
 buffer_load_dwordx4 v2,s[20:23],s40 offen lds
 mf 184,8,60,184
 s_add_u32 m0,s41,102432
 s_add_u32 s40,s46,264192
 mf 172,12,56,172
 buffer_load_dwordx4 v2,s[20:23],s40 offen lds
 mf 188,12,60,188
 s_add_u32 m0,s41,103488
 s_add_u32 s40,s46,266240
 s_waitcnt lgkmcnt(4)
 mf 192,16,32,192
 buffer_load_dwordx4 v2,s[20:23],s40 offen lds
 mf 208,16,36,208
 s_waitcnt vmcnt(3)
 s_waitcnt lgkmcnt(0)
 s_barrier
 tr 8,3,4224
 tr 10,3,4736
 tr 12,3,4256
 tr 14,3,4768
 mf 196,20,32,196
 tr 16,3,4288
 tr 18,3,4800
 s_add_u32 s46,s37,6
 s_and_b32 s46,s46,7
 s_lshl_b32 s46,s46,7
 s_add_u32 s46,s46,s45
 s_add_u32 m0,s41,0
 s_add_u32 s40,s46,0
 mf 212,20,36,212
 mf 200,24,32,200
 tr 20,3,4320
 tr 22,3,4832
 mf 216,24,36,216
 mf 204,28,32,204
 tr 24,3,8448
 tr 26,3,8960
 mf 220,28,36,220
 s_waitcnt lgkmcnt(6)
 mf 192,8,40,192
 tr 28,3,8480
 tr 30,3,8992
 mf 208,8,44,208
 mf 196,12,40,196
 tr 8,3,8512
 tr 10,3,9024
 mf 212,12,44,212
 s_waitcnt lgkmcnt(6)
 mf 200,16,40,200
 tr 12,3,8544
 tr 14,3,9056
 mf 216,16,44,216
 mf 204,20,40,204
 tr 16,3,12672
 tr 18,3,13184
 mf 220,20,44,220
 s_waitcnt lgkmcnt(6)
 mf 192,24,48,192
 tr 20,3,12704
 tr 22,3,13216
 mf 208,24,52,208
 mf 196,28,48,196
 tr 24,3,12736
 tr 26,3,13248
 buffer_load_dwordx4 v2,s[20:23],s40 offen lds
 mf 212,28,52,212
 s_add_u32 m0,s41,1056
 s_add_u32 s40,s46,2048
 s_waitcnt lgkmcnt(6)
 mf 200,8,48,200
 tr 28,3,12768
 tr 30,3,13280
 buffer_load_dwordx4 v2,s[20:23],s40 offen lds
 mf 216,8,52,216
 s_add_u32 m0,s41,2112
 s_add_u32 s40,s46,4096
 mf 204,12,48,204
 tr 8,3,16896
 tr 10,3,17408
 buffer_load_dwordx4 v2,s[20:23],s40 offen lds
 mf 220,12,52,220
 s_add_u32 m0,s41,3168
 s_add_u32 s40,s46,6144
 s_waitcnt lgkmcnt(6)
 mf 192,16,56,192
 tr 12,3,16928
 tr 14,3,17440
 buffer_load_dwordx4 v2,s[20:23],s40 offen lds
 mf 208,16,60,208
 s_add_u32 s46,s37,5
 s_and_b32 s46,s46,7
 s_lshl_b32 s46,s46,7
 s_add_u32 s46,s46,s45
 s_add_u32 m0,s41,104544
 s_add_u32 s40,s46,268288
 mf 196,20,56,196
 tr 16,3,16960
 tr 18,3,17472
 buffer_load_dwordx4 v2,s[20:23],s40 offen lds
 mf 212,20,60,212
 s_add_u32 s46,s37,1
 s_and_b32 s46,s46,7
 s_lshl_b32 s46,s46,7
 s_add_u32 s46,s46,s45
 s_add_u32 m0,s41,118272
 s_add_u32 s40,s46,393216
 s_waitcnt lgkmcnt(6)
 mf 200,24,56,200
 tr 20,3,16992
 tr 22,3,17504
 buffer_load_dwordx4 v2,s[20:23],s40 offen lds
 mf 216,24,60,216
 s_add_u32 m0,s41,119328
 s_add_u32 s40,s46,395264
 mf 204,28,56,204
 buffer_load_dwordx4 v2,s[20:23],s40 offen lds
 mf 220,28,60,220
 s_add_u32 m0,s41,120384
 s_add_u32 s40,s46,397312
 s_waitcnt lgkmcnt(4)
 mf 224,8,32,224
 buffer_load_dwordx4 v2,s[20:23],s40 offen lds
 mf 240,8,36,240
 s_waitcnt vmcnt(3)
 s_waitcnt lgkmcnt(0)
 s_barrier
 tr 24,3,21120
 tr 26,3,21632
 tr 28,3,21152
 tr 30,3,21664
 mf 228,12,32,228
 tr 8,3,21184
 tr 10,3,21696
 s_add_u32 s46,s37,6
 s_and_b32 s46,s46,7
 s_lshl_b32 s46,s46,7
 s_add_u32 s46,s46,s45
 s_add_u32 m0,s41,33792
 s_add_u32 s40,s46,262144
 mf 244,12,36,244
 mf 232,16,32,232
 tr 12,3,21216
 tr 14,3,21728
 mf 248,16,36,248
 mf 236,20,32,236
 tr 16,3,25344
 tr 18,3,25856
 buffer_load_dwordx4 v2,s[20:23],s40 offen lds
 mf 252,20,36,252
 s_add_u32 m0,s41,34848
 s_add_u32 s40,s46,264192
 s_waitcnt lgkmcnt(6)
 mf 224,24,40,224
 tr 20,3,25376
 tr 22,3,25888
 buffer_load_dwordx4 v2,s[20:23],s40 offen lds
 mf 240,24,44,240
 s_add_u32 m0,s41,35904
 s_add_u32 s40,s46,266240
 mf 228,28,40,228
 tr 24,3,25408
 tr 26,3,25920
 buffer_load_dwordx4 v2,s[20:23],s40 offen lds
 mf 244,28,44,244
 s_add_u32 m0,s41,36960
 s_add_u32 s40,s46,268288
 s_waitcnt lgkmcnt(6)
 mf 232,8,40,232
 tr 28,3,25440
 tr 30,3,25952
 buffer_load_dwordx4 v2,s[20:23],s40 offen lds
 mf 248,8,44,248
 s_add_u32 s46,s37,1
 s_and_b32 s46,s46,7
 s_lshl_b32 s46,s46,7
 s_add_u32 s46,s46,s45
 s_add_u32 m0,s41,121440
 s_add_u32 s40,s46,399360
 mf 236,12,40,236
 tr 8,3,29568
 tr 10,3,30080
 buffer_load_dwordx4 v2,s[20:23],s40 offen lds
 mf 252,12,44,252
 s_add_u32 s46,s37,2
 s_and_b32 s46,s46,7
 s_lshl_b32 s46,s46,7
 s_add_u32 s46,s46,s45
 s_add_u32 m0,s41,67584
 s_add_u32 s40,s46,393216
 s_waitcnt lgkmcnt(6)
 mf 224,16,48,224
 tr 12,3,29600
 tr 14,3,30112
 buffer_load_dwordx4 v2,s[20:23],s40 offen lds
 mf 240,16,52,240
 s_add_u32 m0,s41,68640
 s_add_u32 s40,s46,395264
 mf 228,20,48,228
 tr 16,3,29632
 tr 18,3,30144
 buffer_load_dwordx4 v2,s[20:23],s40 offen lds
 mf 244,20,52,244
 s_add_u32 m0,s41,69696
 s_add_u32 s40,s46,397312
 s_waitcnt lgkmcnt(6)
 mf 232,24,48,232
 tr 20,3,29664
 tr 22,3,30176
 buffer_load_dwordx4 v2,s[20:23],s40 offen lds
 mf 248,24,52,248
 ds_write_b128 v4,v[32:35]
 mf 236,28,48,236
 tr 24,3,33792
 tr 26,3,34304
 ds_write_b128 v5,v[36:39]
 mf 252,28,52,252
 ds_write_b128 v4,v[40:43] offset:7168
 s_waitcnt lgkmcnt(9)
 mf 224,8,56,224
 tr 28,3,33824
 tr 30,3,34336
 ds_write_b128 v5,v[44:47] offset:7168
 mf 240,8,60,240
 mf 228,12,56,228
 tr 8,3,33856
 tr 10,3,34368
 ds_write_b128 v4,v[48:51] offset:14336
 mf 244,12,60,244
 s_waitcnt lgkmcnt(11)
 mf 232,16,56,232
 tr 12,3,33888
 tr 14,3,34400
 ds_write_b128 v5,v[52:55] offset:14336
 mf 248,16,60,248
 mf 236,20,56,236
 ds_write_b128 v4,v[56:59] offset:21504
 mf 252,20,60,252
 s_waitcnt lgkmcnt(8)
 mf 96,24,32,96
 ds_write_b128 v5,v[60:63] offset:21504
 mf 112,24,36,112
 s_waitcnt lgkmcnt(0)
 s_barrier
 tr 16,3,38016
 tr 18,3,38528
 tr 20,3,38048
 tr 22,3,38560
 mf 100,28,32,100
 tr 24,3,38080
 tr 26,3,38592
 s_add_u32 s46,s37,6
 s_and_b32 s46,s46,7
 s_lshl_b32 s46,s46,7
 s_add_u32 s46,s46,s45
 s_add_u32 m0,s41,50688
 s_add_u32 s40,s46,393216
 mf 116,28,36,116
 mf 104,8,32,104
 tr 28,3,38112
 tr 30,3,38624
 mf 120,8,36,120
 mf 108,12,32,108
 tr 8,3,42240
 tr 10,3,42752
 mf 124,12,36,124
 s_waitcnt lgkmcnt(6)
 mf 96,16,40,96
 tr 12,3,42272
 tr 14,3,42784
 mf 112,16,44,112
 mf 100,20,40,100
 tr 16,3,42304
 tr 18,3,42816
 mf 116,20,44,116
 s_waitcnt lgkmcnt(6)
 mf 104,24,40,104
 tr 20,3,42336
 tr 22,3,42848
 buffer_load_dwordx4 v2,s[20:23],s40 offen lds
 mf 120,24,44,120
 s_add_u32 m0,s41,51744
 s_add_u32 s40,s46,395264
 mf 108,28,40,108
 tr 24,3,46464
 tr 26,3,46976
 buffer_load_dwordx4 v2,s[20:23],s40 offen lds
 mf 124,28,44,124
 s_add_u32 m0,s41,52800
 s_add_u32 s40,s46,397312
 s_waitcnt lgkmcnt(6)
 mf 96,8,48,96
 tr 28,3,46496
 tr 30,3,47008
 buffer_load_dwordx4 v2,s[20:23],s40 offen lds
 mf 112,8,52,112
 s_add_u32 m0,s41,53856
 s_add_u32 s40,s46,399360
 mf 100,12,48,100
 tr 8,3,46528
 tr 10,3,47040
 buffer_load_dwordx4 v2,s[20:23],s40 offen lds
 mf 116,12,52,116
 s_add_u32 s46,s37,2
 s_and_b32 s46,s46,7
 s_lshl_b32 s46,s46,7
 s_add_u32 s46,s46,s45
 s_add_u32 m0,s41,70752
 s_add_u32 s40,s46,399360
 s_waitcnt lgkmcnt(6)
 mf 104,16,48,104
 tr 12,3,46560
 tr 14,3,47072
 buffer_load_dwordx4 v2,s[20:23],s40 offen lds
 mf 120,16,52,120
 s_add_u32 s46,s37,3
 s_and_b32 s46,s46,7
 s_lshl_b32 s46,s46,7
 s_add_u32 s46,s46,s45
 s_add_u32 m0,s41,84480
 s_add_u32 s40,s46,393216
 mf 108,20,48,108
 buffer_load_dwordx4 v2,s[20:23],s40 offen lds
 mf 124,20,52,124
 s_add_u32 m0,s41,85536
 s_add_u32 s40,s46,395264
 s_waitcnt lgkmcnt(4)
 mf 96,24,56,96
 buffer_load_dwordx4 v2,s[20:23],s40 offen lds
 mf 112,24,60,112
 s_setprio 1
 s_waitcnt vmcnt(10)
 s_waitcnt lgkmcnt(0)
 s_barrier
 ds_read_b128 v[64:67],v4
 ds_read_b128 v[68:71],v5
 ds_read_b128 v[72:75],v4 offset:7168
 ds_read_b128 v[76:79],v5 offset:7168
 ds_read_b128 v[80:83],v4 offset:14336
 ds_read_b128 v[84:87],v5 offset:14336
 ds_read_b128 v[88:91],v4 offset:21504
 ds_read_b128 v[92:95],v5 offset:21504
 tr 16,3,50688
 tr 18,3,51200
 tr 20,3,50720
 tr 22,3,51232
 mf 100,28,56,100
 tr 24,3,50752
 tr 26,3,51264
 s_add_u32 s46,s37,3
 s_and_b32 s46,s46,7
 s_lshl_b32 s46,s46,7
 s_add_u32 s46,s46,s45
 s_add_u32 m0,s41,86592
 s_add_u32 s40,s46,397312
 mf 116,28,60,116
 mf 104,8,56,104
 tr 28,3,50784
 tr 30,3,51296
 mf 120,8,60,120
 mf 108,12,56,108
 tr 8,3,54912
 tr 10,3,55424
 mf 124,12,60,124
 s_waitcnt lgkmcnt(6)
 mf 128,16,64,128
 tr 12,3,54944
 tr 14,3,55456
 mf 144,16,68,144
 mf 132,20,64,132
 tr 16,3,54976
 tr 18,3,55488
 mf 148,20,68,148
 s_waitcnt lgkmcnt(6)
 mf 136,24,64,136
 tr 20,3,55008
 tr 22,3,55520
 mf 152,24,68,152
 mf 140,28,64,140
 tr 24,3,59136
 tr 26,3,59648
 mf 156,28,68,156
 s_waitcnt lgkmcnt(6)
 mf 128,8,72,128
 tr 28,3,59168
 tr 30,3,59680
 mf 144,8,76,144
 mf 132,12,72,132
 tr 8,3,59200
 tr 10,3,59712
 mf 148,12,76,148
 s_waitcnt lgkmcnt(6)
 mf 136,16,72,136
 tr 12,3,59232
 tr 14,3,59744
 mf 152,16,76,152
 mf 140,20,72,140
 tr 16,3,63360
 tr 18,3,63872
 mf 156,20,76,156
 s_waitcnt lgkmcnt(6)
 mf 128,24,80,128
 tr 20,3,63392
 tr 22,3,63904
 mf 144,24,84,144
 mf 132,28,80,132
 tr 24,3,63424
 tr 26,3,63936
 mf 148,28,84,148
 buffer_load_dwordx4 v2,s[20:23],s40 offen lds
 s_waitcnt lgkmcnt(6)
 mf 136,8,80,136
 tr 28,3,63456
 tr 30,3,63968
 s_add_u32 m0,s41,87648
 s_add_u32 s40,s46,399360
 mf 152,8,84,152
 buffer_load_dwordx4 v2,s[20:23],s40 offen lds
 mf 140,12,80,140
 s_add_u32 s46,s37,4
 s_and_b32 s46,s46,7
 s_lshl_b32 s46,s46,7
 s_add_u32 s46,s46,s45
 s_add_u32 m0,s41,101376
 s_add_u32 s40,s46,393216
 mf 156,12,84,156
 buffer_load_dwordx4 v2,s[20:23],s40 offen lds
 s_waitcnt lgkmcnt(4)
 mf 128,16,88,128
 s_add_u32 m0,s41,102432
 s_add_u32 s40,s46,395264
 mf 144,16,92,144
 buffer_load_dwordx4 v2,s[20:23],s40 offen lds
 mf 132,20,88,132
 s_add_u32 m0,s41,103488
 s_add_u32 s40,s46,397312
 mf 148,20,92,148
 buffer_load_dwordx4 v2,s[20:23],s40 offen lds
 s_waitcnt lgkmcnt(0)
 mf 136,24,88,136
 s_add_u32 m0,s41,104544
 s_add_u32 s40,s46,399360
 mf 152,24,92,152
 buffer_load_dwordx4 v2,s[20:23],s40 offen lds
 mf 140,28,88,140
 v_mov_b32 v32,16880
 mf 156,28,92,156
 ds_read_b32 v32,v32
 s_waitcnt lgkmcnt(0)
 v_readfirstlane_b32 s40,v32
 s_nop 0
 s_cmp_lg_u32 s40,0
 s_cbranch_scc1 X_restart
 s_mov_b32 s47,0
 cv 128,128,129
 cv 129,130,131
 cv 130,132,133
 cv 131,134,135
 buffer_store_dwordx4 v[128:131],v1,s[28:31],s47 offen sc1
 cv 136,136,137
 cv 137,138,139
 cv 138,140,141
 cv 139,142,143
 buffer_store_dwordx4 v[136:139],v1,s[28:31],s47 offen offset:1024 sc1
 cv 144,144,145
 cv 145,146,147
 cv 146,148,149
 cv 147,150,151
 buffer_store_dwordx4 v[144:147],v6,s[28:31],s47 offen offset:2048 sc1
 cv 152,152,153
 cv 153,154,155
 cv 154,156,157
 cv 155,158,159
 buffer_store_dwordx4 v[152:155],v6,s[28:31],s47 offen offset:3072 sc1
 s_waitcnt vmcnt(12)
 s_barrier
 ds_read_b64_tr_b16 v[8:9],v3
 tr 10,3,512
 tr 12,3,32
 tr 14,3,544
 tr 16,3,64
 tr 18,3,576
 tr 20,3,96
 tr 22,3,608
 tr 24,3,4224
 tr 26,3,4736
 s_waitcnt lgkmcnt(6)
 mf 160,8,64,160
 tr 28,3,4256
 tr 30,3,4768
 s_add_u32 s46,s37,7
 s_and_b32 s46,s46,7
 s_lshl_b32 s46,s46,7
 s_add_u32 s46,s46,s45
 s_add_u32 m0,s41,0
 s_add_u32 s40,s46,0
 mf 176,8,68,176
 mf 164,12,64,164
 tr 8,3,4288
 tr 10,3,4800
 mf 180,12,68,180
 s_waitcnt lgkmcnt(6)
 mf 168,16,64,168
 tr 12,3,4320
 tr 14,3,4832
 mf 184,16,68,184
 mf 172,20,64,172
 tr 16,3,8448
 tr 18,3,8960
 mf 188,20,68,188
 s_waitcnt lgkmcnt(6)
 mf 160,24,72,160
 tr 20,3,8480
 tr 22,3,8992
 mf 176,24,76,176
 mf 164,28,72,164
 tr 24,3,8512
 tr 26,3,9024
 mf 180,28,76,180
 s_waitcnt lgkmcnt(6)
 mf 168,8,72,168
 tr 28,3,8544
 tr 30,3,9056
 mf 184,8,76,184
 mf 172,12,72,172
 tr 8,3,12672
 tr 10,3,13184
 mf 188,12,76,188
 s_waitcnt lgkmcnt(6)
 mf 160,16,80,160
 tr 12,3,12704
 tr 14,3,13216
 buffer_load_dwordx4 v2,s[20:23],s40 offen lds
 mf 176,16,84,176
 s_add_u32 m0,s41,1056
 s_add_u32 s40,s46,2048
 mf 164,20,80,164
 tr 16,3,12736
 tr 18,3,13248
 buffer_load_dwordx4 v2,s[20:23],s40 offen lds
 mf 180,20,84,180
 s_add_u32 m0,s41,2112
 s_add_u32 s40,s46,4096
 s_waitcnt lgkmcnt(6)
 mf 168,24,80,168
 tr 20,3,12768
 tr 22,3,13280
 buffer_load_dwordx4 v2,s[20:23],s40 offen lds
 mf 184,24,84,184
 s_add_u32 m0,s41,3168
 s_add_u32 s40,s46,6144
 mf 172,28,80,172
 buffer_load_dwordx4 v2,s[20:23],s40 offen lds
 mf 188,28,84,188
 s_add_u32 s46,s37,5
 s_and_b32 s46,s46,7
 s_lshl_b32 s46,s46,7
 s_add_u32 s46,s46,s45
 s_add_u32 m0,s41,118272
 s_add_u32 s40,s46,393216
 s_waitcnt lgkmcnt(4)
 mf 160,8,88,160
 buffer_load_dwordx4 v2,s[20:23],s40 offen lds
 mf 176,8,92,176
 s_add_u32 m0,s41,119328
 s_add_u32 s40,s46,395264
 mf 164,12,88,164
 buffer_load_dwordx4 v2,s[20:23],s40 offen lds
 mf 180,12,92,180
 s_add_u32 m0,s41,120384
 s_add_u32 s40,s46,397312
 s_waitcnt lgkmcnt(0)
 mf 168,16,88,168
 buffer_load_dwordx4 v2,s[20:23],s40 offen lds
 mf 184,16,92,184
 s_add_u32 m0,s41,121440
 s_add_u32 s40,s46,399360
 mf 172,20,88,172
 buffer_load_dwordx4 v2,s[20:23],s40 offen lds
 mf 188,20,92,188
 s_mov_b32 s47,4194304
 cv 160,160,161
 cv 161,162,163
 cv 162,164,165
 cv 163,166,167
 buffer_store_dwordx4 v[160:163],v1,s[28:31],s47 offen sc1
 cv 168,168,169
 cv 169,170,171
 cv 170,172,173
 cv 171,174,175
 buffer_store_dwordx4 v[168:171],v1,s[28:31],s47 offen offset:1024 sc1
 cv 176,176,177
 cv 177,178,179
 cv 178,180,181
 cv 179,182,183
 buffer_store_dwordx4 v[176:179],v6,s[28:31],s47 offen offset:2048 sc1
 cv 184,184,185
 cv 185,186,187
 cv 186,188,189
 cv 187,190,191
 buffer_store_dwordx4 v[184:187],v6,s[28:31],s47 offen offset:3072 sc1
 s_waitcnt vmcnt(20)
 s_barrier
 tr 24,3,16896
 tr 26,3,17408
 tr 28,3,16928
 tr 30,3,17440
 tr 8,3,16960
 tr 10,3,17472
 tr 12,3,16992
 tr 14,3,17504
 tr 16,3,21120
 tr 18,3,21632
 s_waitcnt lgkmcnt(6)
 mf 192,24,64,192
 tr 20,3,21152
 tr 22,3,21664
 s_add_u32 s46,s37,7
 s_and_b32 s46,s46,7
 s_lshl_b32 s46,s46,7
 s_add_u32 s46,s46,s45
 s_add_u32 m0,s41,16896
 s_add_u32 s40,s46,131072
 mf 208,24,68,208
 mf 196,28,64,196
 tr 24,3,21184
 tr 26,3,21696
 mf 212,28,68,212
 s_waitcnt lgkmcnt(6)
 mf 200,8,64,200
 tr 28,3,21216
 tr 30,3,21728
 mf 216,8,68,216
 mf 204,12,64,204
 tr 8,3,25344
 tr 10,3,25856
 mf 220,12,68,220
 s_waitcnt lgkmcnt(6)
 mf 192,16,72,192
 tr 12,3,25376
 tr 14,3,25888
 mf 208,16,76,208
 mf 196,20,72,196
 tr 16,3,25408
 tr 18,3,25920
 mf 212,20,76,212
 s_waitcnt lgkmcnt(6)
 mf 200,24,72,200
 tr 20,3,25440
 tr 22,3,25952
 mf 216,24,76,216
 mf 204,28,72,204
 tr 24,3,29568
 tr 26,3,30080
 mf 220,28,76,220
 s_waitcnt lgkmcnt(6)
 mf 192,8,80,192
 tr 28,3,29600
 tr 30,3,30112
 buffer_load_dwordx4 v2,s[20:23],s40 offen lds
 mf 208,8,84,208
 s_add_u32 m0,s41,17952
 s_add_u32 s40,s46,133120
 mf 196,12,80,196
 tr 8,3,29632
 tr 10,3,30144
 buffer_load_dwordx4 v2,s[20:23],s40 offen lds
 mf 212,12,84,212
 s_add_u32 m0,s41,19008
 s_add_u32 s40,s46,135168
 s_waitcnt lgkmcnt(6)
 mf 200,16,80,200
 tr 12,3,29664
 tr 14,3,30176
 buffer_load_dwordx4 v2,s[20:23],s40 offen lds
 mf 216,16,84,216
 s_add_u32 m0,s41,20064
 s_add_u32 s40,s46,137216
 mf 204,20,80,204
 buffer_load_dwordx4 v2,s[20:23],s40 offen lds
 mf 220,20,84,220
 s_add_u32 s46,s37,8
 s_and_b32 s46,s46,7
 s_lshl_b32 s46,s46,7
 s_add_u32 s46,s46,s45
 s_add_u32 m0,s41,67584
 s_add_u32 s40,s46,0
 s_waitcnt lgkmcnt(4)
 mf 192,24,88,192
 buffer_load_dwordx4 v2,s[20:23],s40 offen lds
 mf 208,24,92,208
 s_add_u32 m0,s41,68640
 s_add_u32 s40,s46,2048
 mf 196,28,88,196
 buffer_load_dwordx4 v2,s[20:23],s40 offen lds
 mf 212,28,92,212
 s_add_u32 m0,s41,69696
 s_add_u32 s40,s46,4096
 s_waitcnt lgkmcnt(0)
 mf 200,8,88,200
 buffer_load_dwordx4 v2,s[20:23],s40 offen lds
 mf 216,8,92,216
 s_add_u32 m0,s41,70752
 s_add_u32 s40,s46,6144
 mf 204,12,88,204
 buffer_load_dwordx4 v2,s[20:23],s40 offen lds
 mf 220,12,92,220
 s_waitcnt vmcnt(20)
 s_add_u32 s47,s37,1
 s_and_b32 s47,s47,7
 s_lshl_b32 s47,s47,7
 buffer_store_dword v4,v7,s[96:99],s47 offen sc1
 s_mov_b32 s47,8388608
 cv 192,192,193
 cv 193,194,195
 cv 194,196,197
 cv 195,198,199
 buffer_store_dwordx4 v[192:195],v1,s[28:31],s47 offen sc1
 cv 200,200,201
 cv 201,202,203
 cv 202,204,205
 cv 203,206,207
 buffer_store_dwordx4 v[200:203],v1,s[28:31],s47 offen offset:1024 sc1
 cv 208,208,209
 cv 209,210,211
 cv 210,212,213
 cv 211,214,215
 buffer_store_dwordx4 v[208:211],v6,s[28:31],s47 offen offset:2048 sc1
 cv 216,216,217
 cv 217,218,219
 cv 218,220,221
 cv 219,222,223
 buffer_store_dwordx4 v[216:219],v6,s[28:31],s47 offen offset:3072 sc1
 s_barrier
 tr 16,3,33792
 tr 18,3,34304
 tr 20,3,33824
 tr 22,3,34336
 tr 24,3,33856
 tr 26,3,34368
 tr 28,3,33888
 tr 30,3,34400
 tr 8,3,38016
 tr 10,3,38528
 s_waitcnt lgkmcnt(6)
 mf 224,16,64,224
 tr 12,3,38048
 tr 14,3,38560
 s_add_u32 s46,s37,7
 s_and_b32 s46,s46,7
 s_lshl_b32 s46,s46,7
 s_add_u32 s46,s46,s45
 s_add_u32 m0,s41,33792
 s_add_u32 s40,s46,262144
 buffer_load_dwordx4 v2,s[20:23],s40 offen lds
 mf 240,16,68,240
 s_add_u32 m0,s41,34848
 s_add_u32 s40,s46,264192
 buffer_load_dwordx4 v2,s[20:23],s40 offen lds
 mf 228,20,64,228
 tr 16,3,38080
 tr 18,3,38592
 s_add_u32 m0,s41,35904
 s_add_u32 s40,s46,266240
 mf 244,20,68,244
 buffer_load_dwordx4 v2,s[20:23],s40 offen lds
 s_waitcnt lgkmcnt(6)
 mf 232,24,64,232
 tr 20,3,38112
 tr 22,3,38624
 s_add_u32 m0,s41,36960
 s_add_u32 s40,s46,268288
 mf 248,24,68,248
 buffer_load_dwordx4 v2,s[20:23],s40 offen lds
 mf 236,28,64,236
 tr 24,3,42240
 tr 26,3,42752
 s_add_u32 s46,s37,8
 s_and_b32 s46,s46,7
 s_lshl_b32 s46,s46,7
 s_add_u32 s46,s46,s45
 s_add_u32 m0,s41,84480
 s_add_u32 s40,s46,131072
 mf 252,28,68,252
 buffer_load_dwordx4 v2,s[20:23],s40 offen lds
 s_waitcnt lgkmcnt(6)
 mf 224,8,72,224
 tr 28,3,42272
 tr 30,3,42784
 s_add_u32 m0,s41,85536
 s_add_u32 s40,s46,133120
 mf 240,8,76,240
 buffer_load_dwordx4 v2,s[20:23],s40 offen lds
 mf 228,12,72,228
 tr 8,3,42304
 tr 10,3,42816
 s_add_u32 m0,s41,86592
 s_add_u32 s40,s46,135168
 mf 244,12,76,244
 buffer_load_dwordx4 v2,s[20:23],s40 offen lds
 s_waitcnt lgkmcnt(6)
 mf 232,16,72,232
 tr 12,3,42336
 tr 14,3,42848
 s_add_u32 m0,s41,87648
 s_add_u32 s40,s46,137216
 mf 248,16,76,248
 buffer_load_dwordx4 v2,s[20:23],s40 offen lds
 mf 236,20,72,236
 tr 16,3,46464
 tr 18,3,46976
 v_mbcnt_lo_u32_b32 v152,-1,0
 v_mbcnt_hi_u32_b32 v152,-1,v152
 mf 252,20,76,252
 v_bfe_u32 v154,v152,2,1
 v_lshrrev_b32 v155,5,v152
 s_waitcnt lgkmcnt(6)
 mf 224,24,80,224
 tr 20,3,46496
 tr 22,3,47008
 v_xor_b32 v154,v154,v155
 v_lshlrev_b32 v154,4,v154
 mf 240,24,84,240
 v_bfe_u32 v155,v152,3,2
 v_lshl_add_u32 v154,v155,1,v154
 mf 228,28,80,228
 tr 24,3,46528
 tr 26,3,47040
 v_bfe_u32 v155,v152,1,1
 v_add_u32 v154,v154,v155
 mf 244,28,84,244
 v_and_b32 v155,1,v152
 v_lshlrev_b32 v155,4,v155
 s_waitcnt lgkmcnt(6)
 mf 232,8,80,232
 tr 28,3,46560
 tr 30,3,47072
 v_mov_b32 v156,0x3f80
 v_lshlrev_b32 v155,v155,v156
 mf 248,8,84,248
 v_cmp_eq_u32 vcc,0,v154
 s_nop 1
 v_cndmask_b32 v144,0,v155,vcc
 mf 236,12,80,236
 v_cmp_eq_u32 vcc,1,v154
 s_nop 1
 v_cndmask_b32 v145,0,v155,vcc
 mf 252,12,84,252
 v_cmp_eq_u32 vcc,2,v154
 s_nop 1
 v_cndmask_b32 v146,0,v155,vcc
 s_waitcnt lgkmcnt(4)
 mf 224,16,88,224
 v_cmp_eq_u32 vcc,3,v154
 s_nop 1
 v_cndmask_b32 v147,0,v155,vcc
 mf 240,16,92,240
 v_cmp_eq_u32 vcc,4,v154
 s_nop 1
 v_cndmask_b32 v148,0,v155,vcc
 mf 228,20,88,228
 v_cmp_eq_u32 vcc,5,v154
 s_nop 1
 v_cndmask_b32 v149,0,v155,vcc
 mf 244,20,92,244
 v_cmp_eq_u32 vcc,6,v154
 s_nop 1
 v_cndmask_b32 v150,0,v155,vcc
 s_waitcnt lgkmcnt(0)
 mf 232,24,88,232
 v_cmp_eq_u32 vcc,7,v154
 s_nop 1
 v_cndmask_b32 v151,0,v155,vcc
 mf 248,24,92,248
 v_and_b32 v158,15,v152
 s_lshl_b32 s47,s33,5
 v_add_lshl_u32 v158,v158,s47,4
 mf 236,28,88,236
 v_and_b32 v155,48,v152
 v_lshl_add_u32 v158,v158,7,v155
 mf 252,28,92,252
 v_add_u32 v159,32768,v158
 s_waitcnt vmcnt(21)
 s_add_u32 s47,s37,2
 s_and_b32 s47,s47,7
 s_lshl_b32 s47,s47,7
 buffer_store_dword v4,v7,s[96:99],s47 offen sc1
 s_mov_b32 s47,12582912
 cv 224,224,225
 cv 225,226,227
 cv 226,228,229
 cv 227,230,231
 buffer_store_dwordx4 v[224:227],v1,s[28:31],s47 offen sc1
 cv 232,232,233
 cv 233,234,235
 cv 234,236,237
 cv 235,238,239
 buffer_store_dwordx4 v[232:235],v1,s[28:31],s47 offen offset:1024 sc1
 cv 240,240,241
 cv 241,242,243
 cv 242,244,245
 cv 243,246,247
 buffer_store_dwordx4 v[240:243],v6,s[28:31],s47 offen offset:2048 sc1
 cv 248,248,249
 cv 249,250,251
 cv 250,252,253
 cv 251,254,255
 buffer_store_dwordx4 v[248:251],v6,s[28:31],s47 offen offset:3072 sc1
 s_barrier
 tr 8,3,50688
 tr 10,3,51200
 tr 12,3,50720
 tr 14,3,51232
 tr 16,3,50752
 tr 18,3,51264
 tr 20,3,50784
 tr 22,3,51296
 tr 24,3,54912
 tr 26,3,55424
 s_waitcnt lgkmcnt(6)
 mf 96,8,64,96
 tr 28,3,54944
 tr 30,3,55456
 s_add_u32 s46,s37,7
 s_and_b32 s46,s46,7
 s_lshl_b32 s46,s46,7
 s_add_u32 s46,s46,s45
 s_add_u32 m0,s41,50688
 s_add_u32 s40,s46,393216
 mf 112,8,68,112
 mf 100,12,64,100
 tr 8,3,54976
 tr 10,3,55488
 mf 116,12,68,116
 s_waitcnt lgkmcnt(6)
 mf 104,16,64,104
 tr 12,3,55008
 tr 14,3,55520
 mf 120,16,68,120
 mf 108,20,64,108
 tr 16,3,59136
 tr 18,3,59648
 mf 124,20,68,124
 s_waitcnt lgkmcnt(6)
 mf 96,24,72,96
 tr 20,3,59168
 tr 22,3,59680
 mf 112,24,76,112
 mf 100,28,72,100
 tr 24,3,59200
 tr 26,3,59712
 mf 116,28,76,116
 s_waitcnt lgkmcnt(6)
 mf 104,8,72,104
 tr 28,3,59232
 tr 30,3,59744
 mf 120,8,76,120
 mf 108,12,72,108
 tr 8,3,63360
 tr 10,3,63872
 mf 124,12,76,124
 s_waitcnt lgkmcnt(6)
 mf 96,16,80,96
 tr 12,3,63392
 tr 14,3,63904
 buffer_load_dwordx4 v2,s[20:23],s40 offen lds
 mf 112,16,84,112
 s_add_u32 m0,s41,51744
 s_add_u32 s40,s46,395264
 mf 100,20,80,100
 tr 16,3,63424
 tr 18,3,63936
 buffer_load_dwordx4 v2,s[20:23],s40 offen lds
 mf 116,20,84,116
 s_add_u32 m0,s41,52800
 s_add_u32 s40,s46,397312
 s_waitcnt lgkmcnt(6)
 mf 104,24,80,104
 tr 20,3,63456
 tr 22,3,63968
 buffer_load_dwordx4 v2,s[20:23],s40 offen lds
 mf 120,24,84,120
 s_add_u32 m0,s41,53856
 s_add_u32 s40,s46,399360
 mf 108,28,80,108
 buffer_load_dwordx4 v2,s[20:23],s40 offen lds
 mf 124,28,84,124
 s_add_u32 s46,s37,8
 s_and_b32 s46,s46,7
 s_lshl_b32 s46,s46,7
 s_add_u32 s46,s46,s45
 s_add_u32 m0,s41,101376
 s_add_u32 s40,s46,262144
 s_waitcnt lgkmcnt(4)
 mf 96,8,88,96
 buffer_load_dwordx4 v2,s[20:23],s40 offen lds
 mf 112,8,92,112
 s_add_u32 m0,s41,102432
 s_add_u32 s40,s46,264192
 mf 100,12,88,100
 buffer_load_dwordx4 v2,s[20:23],s40 offen lds
 mf 116,12,92,116
 s_add_u32 m0,s41,103488
 s_add_u32 s40,s46,266240
 s_waitcnt lgkmcnt(0)
 mf 104,16,88,104
 buffer_load_dwordx4 v2,s[20:23],s40 offen lds
 mf 120,16,92,120
 s_add_u32 m0,s41,104544
 s_add_u32 s40,s46,268288
 mf 108,20,88,108
 buffer_load_dwordx4 v2,s[20:23],s40 offen lds
 mf 124,20,92,124
 s_waitcnt vmcnt(21)
 s_add_u32 s47,s37,3
 s_and_b32 s47,s47,7
 s_lshl_b32 s47,s47,7
 buffer_store_dword v4,v7,s[96:99],s47 offen sc1
 s_mov_b32 s47,16777216
 cv 96,96,97
 cv 97,98,99
 cv 98,100,101
 cv 99,102,103
 buffer_store_dwordx4 v[96:99],v1,s[28:31],s47 offen sc1
 cv 104,104,105
 cv 105,106,107
 cv 106,108,109
 cv 107,110,111
 buffer_store_dwordx4 v[104:107],v1,s[28:31],s47 offen offset:1024 sc1
 cv 112,112,113
 cv 113,114,115
 cv 114,116,117
 cv 115,118,119
 buffer_store_dwordx4 v[112:115],v6,s[28:31],s47 offen offset:2048 sc1
 cv 120,120,121
 cv 121,122,123
 cv 122,124,125
 cv 123,126,127
 buffer_store_dwordx4 v[120:123],v6,s[28:31],s47 offen offset:3072 sc1
 buffer_load_dword v153,v0,s[96:99],s39 offen sc1
 s_waitcnt vmcnt(10)
 s_barrier
 s_add_u32 s46,s37,8
 s_and_b32 s46,s46,7
 s_lshl_b32 s46,s46,7
 s_add_u32 s46,s46,s45
 s_add_u32 m0,s41,0
 s_add_u32 s40,s46,393216
 buffer_load_dwordx4 v2,s[20:23],s40 offen lds
 s_add_u32 m0,s41,1056
 s_add_u32 s40,s46,395264
 buffer_load_dwordx4 v2,s[20:23],s40 offen lds
 s_add_u32 m0,s41,2112
 s_add_u32 s40,s46,397312
 buffer_load_dwordx4 v2,s[20:23],s40 offen lds
 s_add_u32 m0,s41,3168
 s_add_u32 s40,s46,399360
 buffer_load_dwordx4 v2,s[20:23],s40 offen lds
 ds_read_b128 v[64:67],v4
 ds_read_b128 v[68:71],v4 offset:7168
 ds_read_b128 v[72:75],v5
 ds_read_b128 v[76:79],v5 offset:7168
 s_mov_b32 s47,20971520
 s_waitcnt lgkmcnt(3)
 buffer_store_dwordx4 v[64:67],v1,s[28:31],s47 offen sc1
 s_waitcnt lgkmcnt(2)
 buffer_store_dwordx4 v[68:71],v1,s[28:31],s47 offen offset:1024 sc1
 s_waitcnt lgkmcnt(1)
 buffer_store_dwordx4 v[72:75],v6,s[28:31],s47 offen offset:2048 sc1
 s_waitcnt lgkmcnt(0)
 buffer_store_dwordx4 v[76:79],v6,s[28:31],s47 offen offset:3072 sc1
 s_waitcnt vmcnt(8)
 v_cmp_ne_u32 vcc,0,v153
 s_nop 3
 s_mov_b32 s55,vcc_lo
 s_sub_u32 s46,s37,1
 s_and_b32 s46,s46,7
L_chk0:
 s_bitcmp1_b32 s55,s46
 s_cbranch_scc1 L_go0
 buffer_load_dword v153,v0,s[96:99],s39 offen sc1
 s_waitcnt vmcnt(0)
 v_cmp_ne_u32 vcc,0,v153
 s_add_u32 s100,s100,1
 s_nop 2
 s_mov_b32 s55,vcc_lo
 s_cmp_lt_u32 s100,0x40000
 s_cbranch_scc1 L_chk0
L_go0:
 s_lshl_b32 s46,s46,14
 s_add_u32 s46,s46,0
 buffer_load_dwordx4 v[128:131],v1,s[60:63],s46 offen sc1
 buffer_load_dwordx4 v[132:135],v1,s[60:63],s46 offen offset:1024 sc1
 buffer_load_dwordx4 v[136:139],v6,s[60:63],s46 offen offset:2048 sc1
 buffer_load_dwordx4 v[140:143],v6,s[60:63],s46 offen offset:3072 sc1
 s_sub_u32 s46,s37,2
 s_and_b32 s46,s46,7
L_chk1:
 s_bitcmp1_b32 s55,s46
 s_cbranch_scc1 L_go1
 buffer_load_dword v153,v0,s[96:99],s39 offen sc1
 s_waitcnt vmcnt(0)
 v_cmp_ne_u32 vcc,0,v153
 s_add_u32 s100,s100,1
 s_nop 2
 s_mov_b32 s55,vcc_lo
 s_cmp_lt_u32 s100,0x40000
 s_cbranch_scc1 L_chk1
L_go1:
 s_lshl_b32 s46,s46,14
 s_add_u32 s46,s46,4194304
 buffer_load_dwordx4 v[160:163],v1,s[60:63],s46 offen sc1
 buffer_load_dwordx4 v[164:167],v1,s[60:63],s46 offen offset:1024 sc1
 buffer_load_dwordx4 v[168:171],v6,s[60:63],s46 offen offset:2048 sc1
 buffer_load_dwordx4 v[172:175],v6,s[60:63],s46 offen offset:3072 sc1
 s_add_u32 s47,s37,4
 s_and_b32 s47,s47,7
 s_lshl_b32 s47,s47,7
 buffer_store_dword v4,v7,s[96:99],s47 offen sc1
 s_add_u32 s47,s37,5
 s_and_b32 s47,s47,7
 s_lshl_b32 s47,s47,7
 buffer_store_dword v4,v7,s[96:99],s47 offen sc1
 s_waitcnt vmcnt(10)
 s_add_u32 s47,s37,6
 s_and_b32 s47,s47,7
 s_lshl_b32 s47,s47,7
 buffer_store_dword v4,v7,s[96:99],s47 offen sc1
 buffer_load_dword v153,v0,s[96:99],s39 offen sc1
 s_barrier
 ds_read_b128 v[80:83],v4 offset:14336
 ds_read_b128 v[84:87],v4 offset:21504
 ds_read_b128 v[88:91],v5 offset:14336
 ds_read_b128 v[92:95],v5 offset:21504
 s_mov_b32 s47,25165824
 s_waitcnt lgkmcnt(3)
 buffer_store_dwordx4 v[80:83],v1,s[28:31],s47 offen sc1
 s_waitcnt lgkmcnt(2)
 buffer_store_dwordx4 v[84:87],v1,s[28:31],s47 offen offset:1024 sc1
 s_waitcnt lgkmcnt(1)
 buffer_store_dwordx4 v[88:91],v6,s[28:31],s47 offen offset:2048 sc1
 s_waitcnt lgkmcnt(0)
 buffer_store_dwordx4 v[92:95],v6,s[28:31],s47 offen offset:3072 sc1
 s_waitcnt vmcnt(4)
 v_cmp_ne_u32 vcc,0,v153
 s_nop 3
 s_mov_b32 s55,vcc_lo
 s_waitcnt vmcnt(0)
 s_add_u32 s47,s37,7
 s_and_b32 s47,s47,7
 s_lshl_b32 s47,s47,7
 buffer_store_dword v4,v7,s[96:99],s47 offen sc1
 s_sub_u32 s46,s37,3
 s_and_b32 s46,s46,7
L_chk2:
 s_bitcmp1_b32 s55,s46
 s_cbranch_scc1 L_go2
 buffer_load_dword v153,v0,s[96:99],s39 offen sc1
 s_waitcnt vmcnt(0)
 v_cmp_ne_u32 vcc,0,v153
 s_add_u32 s100,s100,1
 s_nop 2
 s_mov_b32 s55,vcc_lo
 s_cmp_lt_u32 s100,0x40000
 s_cbranch_scc1 L_chk2
L_go2:
 s_lshl_b32 s46,s46,14
 s_add_u32 s46,s46,8388608
 buffer_load_dwordx4 v[176:179],v1,s[60:63],s46 offen sc1
 buffer_load_dwordx4 v[180:183],v1,s[60:63],s46 offen offset:1024 sc1
 buffer_load_dwordx4 v[184:187],v6,s[60:63],s46 offen offset:2048 sc1
 buffer_load_dwordx4 v[188:191],v6,s[60:63],s46 offen offset:3072 sc1
 s_sub_u32 s46,s37,4
 s_and_b32 s46,s46,7
L_chk3:
 s_bitcmp1_b32 s55,s46
 s_cbranch_scc1 L_go3
 buffer_load_dword v153,v0,s[96:99],s39 offen sc1
 s_waitcnt vmcnt(0)
 v_cmp_ne_u32 vcc,0,v153
 s_add_u32 s100,s100,1
 s_nop 2
 s_mov_b32 s55,vcc_lo
 s_cmp_lt_u32 s100,0x40000
 s_cbranch_scc1 L_chk3
L_go3:
 s_lshl_b32 s46,s46,14
 s_add_u32 s46,s46,12582912
 buffer_load_dwordx4 v[192:195],v1,s[60:63],s46 offen sc1
 buffer_load_dwordx4 v[196:199],v1,s[60:63],s46 offen offset:1024 sc1
 buffer_load_dwordx4 v[200:203],v6,s[60:63],s46 offen offset:2048 sc1
 buffer_load_dwordx4 v[204:207],v6,s[60:63],s46 offen offset:3072 sc1
 s_sub_u32 s46,s37,5
 s_and_b32 s46,s46,7
L_chk4:
 s_bitcmp1_b32 s55,s46
 s_cbranch_scc1 L_go4
 buffer_load_dword v153,v0,s[96:99],s39 offen sc1
 s_waitcnt vmcnt(0)
 v_cmp_ne_u32 vcc,0,v153
 s_add_u32 s100,s100,1
 s_nop 2
 s_mov_b32 s55,vcc_lo
 s_cmp_lt_u32 s100,0x40000
 s_cbranch_scc1 L_chk4
L_go4:
 s_lshl_b32 s46,s46,14
 s_add_u32 s46,s46,16777216
 buffer_load_dwordx4 v[208:211],v1,s[60:63],s46 offen sc1
 buffer_load_dwordx4 v[212:215],v1,s[60:63],s46 offen offset:1024 sc1
 buffer_load_dwordx4 v[216:219],v6,s[60:63],s46 offen offset:2048 sc1
 buffer_load_dwordx4 v[220:223],v6,s[60:63],s46 offen offset:3072 sc1
 s_sub_u32 s46,s37,6
 s_and_b32 s46,s46,7
L_chk5:
 s_bitcmp1_b32 s55,s46
 s_cbranch_scc1 L_go5
 buffer_load_dword v153,v0,s[96:99],s39 offen sc1
 s_waitcnt vmcnt(0)
 v_cmp_ne_u32 vcc,0,v153
 s_add_u32 s100,s100,1
 s_nop 2
 s_mov_b32 s55,vcc_lo
 s_cmp_lt_u32 s100,0x40000
 s_cbranch_scc1 L_chk5
L_go5:
 s_lshl_b32 s46,s46,14
 s_add_u32 s46,s46,20971520
 buffer_load_dwordx4 v[224:227],v1,s[60:63],s46 offen sc1
 buffer_load_dwordx4 v[228:231],v1,s[60:63],s46 offen offset:1024 sc1
 buffer_load_dwordx4 v[232:235],v6,s[60:63],s46 offen offset:2048 sc1
 buffer_load_dwordx4 v[236:239],v6,s[60:63],s46 offen offset:3072 sc1
 mz 32,144,128
 mz 36,148,128
 mz 40,144,132
 mz 44,148,132
 mz 48,144,136
 mz 52,148,136
 mz 56,144,140
 mz 60,148,140
 mf 32,144,160,32
 mf 36,148,160,36
 mf 40,144,164,40
 mf 44,148,164,44
 mf 48,144,168,48
 mf 52,148,168,52
 mf 56,144,172,56
 mf 60,148,172,60
 s_waitcnt vmcnt(12)
 mf 32,144,176,32
 mf 36,148,176,36
 mf 40,144,180,40
 mf 44,148,180,44
 mf 48,144,184,48
 mf 52,148,184,52
 mf 56,144,188,56
 mf 60,148,188,60
 s_waitcnt vmcnt(8)
 mf 32,144,192,32
 mf 36,148,192,36
 mf 40,144,196,40
 mf 44,148,196,44
 mf 48,144,200,48
 mf 52,148,200,52
 mf 56,144,204,56
 mf 60,148,204,60
 s_sub_u32 s46,s37,7
 s_and_b32 s46,s46,7
L_chk6:
 s_bitcmp1_b32 s55,s46
 s_cbranch_scc1 L_go6
 buffer_load_dword v153,v0,s[96:99],s39 offen sc1
 s_waitcnt vmcnt(0)
 v_cmp_ne_u32 vcc,0,v153
 s_add_u32 s100,s100,1
 s_nop 2
 s_mov_b32 s55,vcc_lo
 s_cmp_lt_u32 s100,0x40000
 s_cbranch_scc1 L_chk6
L_go6:
 s_lshl_b32 s46,s46,14
 s_add_u32 s46,s46,25165824
 buffer_load_dwordx4 v[240:243],v1,s[60:63],s46 offen sc1
 buffer_load_dwordx4 v[244:247],v1,s[60:63],s46 offen offset:1024 sc1
 buffer_load_dwordx4 v[248:251],v6,s[60:63],s46 offen offset:2048 sc1
 buffer_load_dwordx4 v[252:255],v6,s[60:63],s46 offen offset:3072 sc1
 s_waitcnt vmcnt(8)
 mf 32,144,208,32
 mf 36,148,208,36
 mf 40,144,212,40
 mf 44,148,212,44
 mf 48,144,216,48
 mf 52,148,216,52
 mf 56,144,220,56
 mf 60,148,220,60
 s_waitcnt vmcnt(4)
 mf 32,144,224,32
 mf 36,148,224,36
 mf 40,144,228,40
 mf 44,148,228,44
 mf 48,144,232,48
 mf 52,148,232,52
 mf 56,144,236,56
 mf 60,148,236,60
 s_barrier
 ds_read_b128 v[96:99],v4
 ds_read_b128 v[100:103],v4 offset:7168
 ds_read_b128 v[104:107],v5
 ds_read_b128 v[108:111],v5 offset:7168
 s_waitcnt vmcnt(0)
 mf 32,144,240,32
 mf 36,148,240,36
 mf 40,144,244,40
 mf 44,148,244,44
 mf 48,144,248,48
 mf 52,148,248,52
 mf 56,144,252,56
 mf 60,148,252,60
 s_waitcnt lgkmcnt(3)
 mf 32,144,96,32
 mf 36,148,96,36
 s_waitcnt lgkmcnt(2)
 mf 40,144,100,40
 mf 44,148,100,44
 s_waitcnt lgkmcnt(1)
 mf 48,144,104,48
 mf 52,148,104,52
 s_waitcnt lgkmcnt(0)
 mf 56,144,108,56
 mf 60,148,108,60
 s_lshl_b32 s40,s34,10
 s_add_u32 s40,s40,s39
 cv 32,32,33
 cv 33,34,35
 cv 34,36,37
 cv 35,38,39
 buffer_store_dwordx4 v[32:35],v158,s[56:59],s40 offen nt
 cv 40,40,41
 cv 41,42,43
 cv 42,44,45
 cv 43,46,47
 buffer_store_dwordx4 v[40:43],v158,s[56:59],s40 offen offset:64 nt
 cv 48,48,49
 cv 49,50,51
 cv 50,52,53
 cv 51,54,55
 buffer_store_dwordx4 v[48:51],v159,s[56:59],s40 offen nt
 cv 56,56,57
 cv 57,58,59
 cv 58,60,61
 cv 59,62,63
 buffer_store_dwordx4 v[56:59],v159,s[56:59],s40 offen offset:64 nt
 s_endpgm
L_attn:
 s_and_b32 s40,s33,1
 s_mul_i32 s40,s40,4096
 s_lshr_b32 s46,s33,1
 s_mul_i32 s46,s46,8192
 s_add_u32 s40,s40,s46
 v_add_u32 v14,s40,v14
 s_waitcnt vmcnt(4)
 s_barrier
 s_xor_b32 s40,s52,256
 s_add_u32 m0,s42,135168
 s_nop 0
 buffer_load_dwordx4 v20,s[24:27],s40 offen lds
 buffer_load_dwordx4 v21,s[24:27],s40 offen offset:1024 lds
 buffer_load_dwordx4 v22,s[24:27],s40 offen offset:2048 lds
 buffer_load_dwordx4 v23,s[24:27],s40 offen offset:3072 lds
 s_xor_b32 s40,s52,16640
 s_add_u32 m0,s42,139264
 s_nop 0
 buffer_load_dwordx4 v20,s[24:27],s40 offen lds
 buffer_load_dwordx4 v21,s[24:27],s40 offen offset:1024 lds
 buffer_load_dwordx4 v22,s[24:27],s40 offen offset:2048 lds
 buffer_load_dwordx4 v23,s[24:27],s40 offen offset:3072 lds
 s_xor_b32 s46,s53,1048576
 s_add_u32 s46,s46,s44
 s_add_u32 m0,s41,101376
 s_add_u32 s40,s46,0
 buffer_load_dwordx4 v2,s[16:19],s40 offen lds
 s_add_u32 m0,s41,102432
 s_add_u32 s40,s46,16384
 buffer_load_dwordx4 v2,s[16:19],s40 offen lds
 s_add_u32 m0,s41,103488
 s_add_u32 s40,s46,65536
 buffer_load_dwordx4 v2,s[16:19],s40 offen lds
 s_add_u32 m0,s41,104544
 s_add_u32 s40,s46,81920
 buffer_load_dwordx4 v2,s[16:19],s40 offen lds
 s_waitcnt vmcnt(12)
 s_barrier
 s_xor_b32 s46,s53,1048576
 s_add_u32 s46,s46,s44
 s_add_u32 m0,s41,118272
 s_add_u32 s40,s46,128
 buffer_load_dwordx4 v2,s[16:19],s40 offen lds
 s_add_u32 m0,s41,119328
 s_add_u32 s40,s46,16512
 buffer_load_dwordx4 v2,s[16:19],s40 offen lds
 s_add_u32 m0,s41,120384
 s_add_u32 s40,s46,65664
 buffer_load_dwordx4 v2,s[16:19],s40 offen lds
 s_add_u32 m0,s41,121440
 s_add_u32 s40,s46,82048
 buffer_load_dwordx4 v2,s[16:19],s40 offen lds
 s_xor_b32 s46,s53,2097152
 s_add_u32 s46,s46,s44
 s_add_u32 m0,s41,67584
 s_add_u32 s40,s46,0
 buffer_load_dwordx4 v2,s[16:19],s40 offen lds
 s_add_u32 m0,s41,68640
 s_add_u32 s40,s46,16384
 buffer_load_dwordx4 v2,s[16:19],s40 offen lds
 s_add_u32 m0,s41,69696
 s_add_u32 s40,s46,65536
 buffer_load_dwordx4 v2,s[16:19],s40 offen lds
 s_add_u32 m0,s41,70752
 s_add_u32 s40,s46,81920
 buffer_load_dwordx4 v2,s[16:19],s40 offen lds
 s_waitcnt vmcnt(8)
 s_barrier
 s_xor_b32 s40,s52,512
 s_add_u32 m0,s42,33792
 s_nop 0
 buffer_load_dwordx4 v20,s[24:27],s40 offen lds
 buffer_load_dwordx4 v21,s[24:27],s40 offen offset:1024 lds
 buffer_load_dwordx4 v22,s[24:27],s40 offen offset:2048 lds
 buffer_load_dwordx4 v23,s[24:27],s40 offen offset:3072 lds
 s_xor_b32 s40,s52,16896
 s_add_u32 m0,s42,37888
 s_nop 0
 buffer_load_dwordx4 v20,s[24:27],s40 offen lds
 buffer_load_dwordx4 v21,s[24:27],s40 offen offset:1024 lds
 buffer_load_dwordx4 v22,s[24:27],s40 offen offset:2048 lds
 buffer_load_dwordx4 v23,s[24:27],s40 offen offset:3072 lds
 s_xor_b32 s46,s53,3145728
 s_add_u32 s46,s46,s44
 s_add_u32 m0,s41,84480
 s_add_u32 s40,s46,0
 buffer_load_dwordx4 v2,s[16:19],s40 offen lds
 s_add_u32 m0,s41,85536
 s_add_u32 s40,s46,16384
 buffer_load_dwordx4 v2,s[16:19],s40 offen lds
 s_add_u32 m0,s41,86592
 s_add_u32 s40,s46,65536
 buffer_load_dwordx4 v2,s[16:19],s40 offen lds
 s_add_u32 m0,s41,87648
 s_add_u32 s40,s46,81920
 buffer_load_dwordx4 v2,s[16:19],s40 offen lds
 s_waitcnt vmcnt(16)
 s_barrier
 s_xor_b32 s40,s52,768
 s_add_u32 m0,s42,135168
 s_nop 0
 buffer_load_dwordx4 v20,s[24:27],s40 offen lds
 buffer_load_dwordx4 v21,s[24:27],s40 offen offset:1024 lds
 buffer_load_dwordx4 v22,s[24:27],s40 offen offset:2048 lds
 buffer_load_dwordx4 v23,s[24:27],s40 offen offset:3072 lds
 s_xor_b32 s40,s52,17152
 s_add_u32 m0,s42,139264
 s_nop 0
 buffer_load_dwordx4 v20,s[24:27],s40 offen lds
 buffer_load_dwordx4 v21,s[24:27],s40 offen offset:1024 lds
 buffer_load_dwordx4 v22,s[24:27],s40 offen offset:2048 lds
 buffer_load_dwordx4 v23,s[24:27],s40 offen offset:3072 lds
 s_xor_b32 s46,s53,2097152
 s_add_u32 s46,s46,s44
 s_add_u32 m0,s41,101376
 s_add_u32 s40,s46,128
 buffer_load_dwordx4 v2,s[16:19],s40 offen lds
 s_add_u32 m0,s41,102432
 s_add_u32 s40,s46,16512
 buffer_load_dwordx4 v2,s[16:19],s40 offen lds
 s_add_u32 m0,s41,103488
 s_add_u32 s40,s46,65664
 buffer_load_dwordx4 v2,s[16:19],s40 offen lds
 s_add_u32 m0,s41,104544
 s_add_u32 s40,s46,82048
 buffer_load_dwordx4 v2,s[16:19],s40 offen lds
 s_mov_b32 s40,0
 s_add_u32 m0,s41,16896
 s_nop 0
 buffer_load_dwordx4 v14,s[8:11],s40 offen nt lds
 s_mov_b32 s40,1024
 s_add_u32 m0,s41,17952
 s_nop 0
 buffer_load_dwordx4 v14,s[8:11],s40 offen nt lds
 s_mov_b32 s40,2048
 s_add_u32 m0,s41,19008
 s_nop 0
 buffer_load_dwordx4 v14,s[8:11],s40 offen nt lds
 s_mov_b32 s40,3072
 s_add_u32 m0,s41,20064
 s_nop 0
 buffer_load_dwordx4 v14,s[8:11],s40 offen nt lds
 s_waitcnt vmcnt(20)
 s_barrier
 s_xor_b32 s46,s53,3145728
 s_add_u32 s46,s46,s44
 s_add_u32 m0,s41,118272
 s_add_u32 s40,s46,128
 buffer_load_dwordx4 v2,s[16:19],s40 offen lds
 s_add_u32 m0,s41,119328
 s_add_u32 s40,s46,16512
 buffer_load_dwordx4 v2,s[16:19],s40 offen lds
 s_add_u32 m0,s41,120384
 s_add_u32 s40,s46,65664
 buffer_load_dwordx4 v2,s[16:19],s40 offen lds
 s_add_u32 m0,s41,121440
 s_add_u32 s40,s46,82048
 buffer_load_dwordx4 v2,s[16:19],s40 offen lds
 s_waitcnt vmcnt(12)
 s_barrier
 v_lshlrev_b32 v10,2,v0
 v_mov_b32 v11,0x40000000
 v_cmp_gt_u32 vcc,32,v0
 s_nop 1
 v_cndmask_b32 v10,v11,v10,vcc
 v_mov_b32 v12,0
 s_lshl_b32 s40,s37,7
 buffer_store_dword v12,v10,s[96:99],s40 offen sc1
 v_mov_b32 v240,0
 v_mov_b32 v241,0
 v_mov_b32 v242,0
 v_mov_b32 v243,0
 v_mov_b32 v244,0
 v_mov_b32 v245,0
 v_mov_b32 v246,0
 v_mov_b32 v247,0
 s_waitcnt vmcnt(9)
 s_barrier
 s_mov_b32 s40,16384
 s_add_u32 m0,s41,0
 s_nop 0
 buffer_load_dwordx4 v14,s[8:11],s40 offen nt lds
 s_mov_b32 s40,17408
 s_add_u32 m0,s41,1056
 s_nop 0
 buffer_load_dwordx4 v14,s[8:11],s40 offen nt lds
 s_mov_b32 s40,18432
 s_add_u32 m0,s41,2112
 s_nop 0
 buffer_load_dwordx4 v14,s[8:11],s40 offen nt lds
 s_mov_b32 s40,19456
 s_add_u32 m0,s41,3168
 s_nop 0
 buffer_load_dwordx4 v14,s[8:11],s40 offen nt lds
 v_and_b32 v10,15,v1
 v_mul_u32_u24 v2,1056,v10
 v_and_b32 v10,48,v1
 v_add_u32 v2,v2,v10
 v_lshrrev_b32 v10,2,v1
 v_mul_u32_u24 v3,1056,v10
 v_and_b32 v10,3,v1
 v_lshl_add_u32 v3,v10,3,v3
 v_cmp_eq_u32 vcc,0,v10
 v_mov_b32 v11,0x3f803f80
 s_nop 0
 v_cndmask_b32 v6,0,v11,vcc
 v_cndmask_b32 v7,0,v11,vcc
 v_cndmask_b32 v8,0,v11,vcc
 v_cndmask_b32 v9,0,v11,vcc
 v_and_b32 v4,15,v1
 s_lshl_b32 s40,s33,5
 v_add_lshl_u32 v4,v4,s40,4
 v_lshrrev_b32 v10,4,v1
 v_mul_u32_u24 v10,1792,v10
 v_add_u32 v4,v4,v10
 v_add_u32 v4,135168,v4
 s_mov_b32 s40,256
 s_cmp_eq_u32 s33,3
 s_cselect_b32 s40,65536,s40
 v_add_u32 v5,s40,v4
 s_waitcnt vmcnt(5)
 s_barrier
 v_mov_b32 v10,16880
 v_mov_b32 v11,0
 ds_write_b32 v10,v11
 s_setprio 1
 s_waitcnt vmcnt(4)
 s_waitcnt lgkmcnt(0)
 s_barrier
 ds_read_b128 v[48:51],v4
 ds_read_b128 v[52:55],v5
 ds_read_b128 v[56:59],v4 offset:7168
 ds_read_b128 v[60:63],v5 offset:7168
 ds_read_b128 v[64:67],v4 offset:14336
 ds_read_b128 v[68:71],v5 offset:14336
 ds_read_b128 v[72:75],v4 offset:21504
 ds_read_b128 v[76:79],v5 offset:21504
 v_mov_b32 v11,0x40000000
 v_cmp_eq_u32 vcc,0,v0
 s_nop 1
 v_cndmask_b32 v12,v11,v0,vcc
 v_mov_b32 v11,1
 s_lshl_b32 s40,s54,2
 buffer_atomic_add v11,v12,s[64:67],s40 offen sc1
 ds_read_b128 v[16:19],v2 offset:16896
 ds_read_b128 v[20:23],v2 offset:16960
 ds_read_b128 v[24:27],v2 offset:17024
 ds_read_b128 v[28:31],v2 offset:17088
 ds_read_b128 v[32:35],v2 offset:17152
 ds_read_b128 v[36:39],v2 offset:17216
 ds_read_b128 v[40:43],v2 offset:17280
 s_waitcnt lgkmcnt(5)
 mz 80,16,48
 ds_read_b128 v[44:47],v2 offset:17344
 mz 96,16,52
 mf 80,20,56,80
 ds_read_b128 v[16:19],v2 offset:17408
 mf 96,20,60,96
 s_waitcnt lgkmcnt(5)
 mf 80,24,64,80
 ds_read_b128 v[20:23],v2 offset:17472
 mf 96,24,68,96
 mf 80,28,72,80
 ds_read_b128 v[24:27],v2 offset:17536
 mf 96,28,76,96
 s_waitcnt lgkmcnt(5)
 mz 84,32,48
 ds_read_b128 v[28:31],v2 offset:17600
 mz 100,32,52
 mf 84,36,56,84
 ds_read_b128 v[32:35],v2 offset:17664
 mf 100,36,60,100
 s_waitcnt lgkmcnt(5)
 mf 84,40,64,84
 ds_read_b128 v[36:39],v2 offset:17728
 mf 100,40,68,100
 mf 84,44,72,84
 ds_read_b128 v[40:43],v2 offset:17792
 mf 100,44,76,100
 s_waitcnt lgkmcnt(5)
 mz 88,16,48
 ds_read_b128 v[44:47],v2 offset:17856
 mz 104,16,52
 mf 88,20,56,88
 mf 104,20,60,104
 s_waitcnt lgkmcnt(4)
 mf 88,24,64,88
 mf 104,24,68,104
 mf 88,28,72,88
 mf 104,28,76,104
 s_waitcnt lgkmcnt(2)
 mz 92,32,48
 mz 108,32,52
 mf 92,36,56,92
 mf 108,36,60,108
 s_waitcnt lgkmcnt(0)
 mf 92,40,64,92
 mf 108,40,68,108
 mf 92,44,72,92
 mf 108,44,76,108
 s_waitcnt vmcnt(1)
 s_mov_b32 s39,0
 s_barrier
 ds_read_b128 v[16:19],v2
 ds_read_b128 v[20:23],v2 offset:64
 ds_read_b128 v[24:27],v2 offset:128
 ds_read_b128 v[28:31],v2 offset:192
 ds_read_b128 v[32:35],v2 offset:256
 ds_read_b128 v[36:39],v2 offset:320
 ds_read_b128 v[40:43],v2 offset:384
 s_waitcnt lgkmcnt(5)
 mz 112,16,48
 ds_read_b128 v[44:47],v2 offset:448
 mz 128,16,52
 mf 112,20,56,112
 ds_read_b128 v[16:19],v2 offset:512
 mf 128,20,60,128
 s_waitcnt lgkmcnt(5)
 mf 112,24,64,112
 ds_read_b128 v[20:23],v2 offset:576
 v_exp_f32 v80,v80
 mf 128,24,68,128
 mf 112,28,72,112
 ds_read_b128 v[24:27],v2 offset:640
 v_exp_f32 v81,v81
 mf 128,28,76,128
 s_waitcnt lgkmcnt(5)
 mz 116,32,48
 ds_read_b128 v[28:31],v2 offset:704
 v_exp_f32 v82,v82
 mz 132,32,52
 mf 116,36,56,116
 ds_read_b128 v[32:35],v2 offset:768
 v_exp_f32 v83,v83
 mf 132,36,60,132
 s_waitcnt lgkmcnt(5)
 mf 116,40,64,116
 ds_read_b128 v[36:39],v2 offset:832
 v_exp_f32 v84,v84
 mf 132,40,68,132
 mf 116,44,72,116
 ds_read_b128 v[40:43],v2 offset:896
 v_exp_f32 v85,v85
 mf 132,44,76,132
 s_waitcnt lgkmcnt(5)
 mz 120,16,48
 ds_read_b128 v[44:47],v2 offset:960
 v_exp_f32 v86,v86
 mz 136,16,52
 mf 120,20,56,120
 v_exp_f32 v87,v87
 mf 136,20,60,136
 cv 80,80,81
 s_waitcnt lgkmcnt(4)
 mf 120,24,64,120
 cv 81,82,83
 mf 136,24,68,136
 cv 82,84,85
 mf 120,28,72,120
 cv 83,86,87
 mf 136,28,76,136
 s_waitcnt lgkmcnt(0)
 s_branch L_aloop1
L_aloop:
 s_barrier
 ds_read_b128 v[16:19],v2
 ds_read_b128 v[20:23],v2 offset:64
 ds_read_b128 v[24:27],v2 offset:128
 mf 160,32,120,160
 ds_read_b128 v[28:31],v2 offset:192
 v_exp_f32 v80,v80
 v_exp_f32 v81,v81
 mf 192,32,136,192
 v_exp_f32 v82,v82
 v_exp_f32 v83,v83
 mf 164,36,120,164
 ds_read_b128 v[32:35],v2 offset:256
 v_exp_f32 v84,v84
 v_exp_f32 v85,v85
 mf 196,36,136,196
 v_exp_f32 v86,v86
 v_exp_f32 v87,v87
 cv 80,80,81
 mf 168,40,120,168
 ds_read_b128 v[36:39],v2 offset:320
 cv 81,82,83
 cv 82,84,85
 cv 83,86,87
 mf 200,40,136,200
 mf 172,44,120,172
 ds_read_b128 v[40:43],v2 offset:384
 mf 204,44,136,204
 v_rcp_f32 v10,v248
 v_rcp_f32 v12,v252
 v_max_f32 v11,v10,v248
 s_waitcnt lgkmcnt(5)
 mz 112,16,48
 ds_read_b128 v[44:47],v2 offset:448
 v_max3_f32 v11,v11,v12,v252
 v_cmp_nge_f32 vcc,s101,v11
 s_nop 0
 s_or_b64 s[94:95],s[94:95],vcc
 v_mul_f32 v144,v10,v144
 v_mul_f32 v145,v10,v145
 v_mul_f32 v146,v10,v146
 mz 128,16,52
 v_mul_f32 v147,v10,v147
 v_mul_f32 v148,v10,v148
 v_mul_f32 v149,v10,v149
 v_mul_f32 v150,v10,v150
 v_mul_f32 v151,v10,v151
 mf 112,20,56,112
 ds_read_b128 v[16:19],v2 offset:512
 cv 144,144,145
 cv 145,146,147
 cv 146,148,149
 cv 147,150,151
 mf 128,20,60,128
 ds_write_b128 v4,v[144:147]
 v_mul_f32 v176,v12,v176
 v_mul_f32 v177,v12,v177
 s_waitcnt lgkmcnt(6)
 mf 112,24,64,112
 ds_read_b128 v[20:23],v2 offset:576
 v_mul_f32 v178,v12,v178
 v_mul_f32 v179,v12,v179
 v_mul_f32 v180,v12,v180
 v_mul_f32 v181,v12,v181
 v_mul_f32 v182,v12,v182
 mf 128,24,68,128
 v_mul_f32 v183,v12,v183
 cv 176,176,177
 cv 177,178,179
 cv 178,180,181
 cv 179,182,183
 mf 112,28,72,112
 ds_read_b128 v[24:27],v2 offset:640
 ds_write_b128 v5,v[176:179]
 v_mul_f32 v152,v10,v152
 v_mul_f32 v153,v10,v153
 mf 128,28,76,128
 v_mul_f32 v154,v10,v154
 v_mul_f32 v155,v10,v155
 v_mul_f32 v156,v10,v156
 v_mul_f32 v157,v10,v157
 v_mul_f32 v158,v10,v158
 s_waitcnt lgkmcnt(7)
 mz 116,32,48
 ds_read_b128 v[28:31],v2 offset:704
 v_mul_f32 v159,v10,v159
 cv 152,152,153
 cv 153,154,155
 cv 154,156,157
 cv 155,158,159
 mz 132,32,52
 ds_write_b128 v4,v[152:155] offset:7168
 v_mul_f32 v184,v12,v184
 v_mul_f32 v185,v12,v185
 mf 116,36,56,116
 ds_read_b128 v[32:35],v2 offset:768
 v_mul_f32 v186,v12,v186
 v_mul_f32 v187,v12,v187
 v_mul_f32 v188,v12,v188
 v_mul_f32 v189,v12,v189
 v_mul_f32 v190,v12,v190
 mf 132,36,60,132
 v_mul_f32 v191,v12,v191
 cv 184,184,185
 cv 185,186,187
 cv 186,188,189
 cv 187,190,191
 s_waitcnt lgkmcnt(8)
 mf 116,40,64,116
 ds_read_b128 v[36:39],v2 offset:832
 ds_write_b128 v5,v[184:187] offset:7168
 v_mul_f32 v160,v10,v160
 v_mul_f32 v161,v10,v161
 mf 132,40,68,132
 v_mul_f32 v162,v10,v162
 v_mul_f32 v163,v10,v163
 v_mul_f32 v164,v10,v164
 v_mul_f32 v165,v10,v165
 v_mul_f32 v166,v10,v166
 mf 116,44,72,116
 ds_read_b128 v[40:43],v2 offset:896
 v_mul_f32 v167,v10,v167
 cv 160,160,161
 cv 161,162,163
 cv 162,164,165
 cv 163,166,167
 mf 132,44,76,132
 ds_write_b128 v4,v[160:163] offset:14336
 v_mul_f32 v192,v12,v192
 v_mul_f32 v193,v12,v193
 s_waitcnt lgkmcnt(9)
 mz 120,16,48
 ds_read_b128 v[44:47],v2 offset:960
 v_mul_f32 v194,v12,v194
 v_mul_f32 v195,v12,v195
 v_mul_f32 v196,v12,v196
 v_mul_f32 v197,v12,v197
 v_mul_f32 v198,v12,v198
 mz 136,16,52
 v_mul_f32 v199,v12,v199
 cv 192,192,193
 cv 193,194,195
 cv 194,196,197
 cv 195,198,199
 mf 120,20,56,120
 ds_write_b128 v5,v[192:195] offset:14336
 v_mul_f32 v168,v10,v168
 v_mul_f32 v169,v10,v169
 v_mul_f32 v170,v10,v170
 mf 136,20,60,136
 v_mul_f32 v171,v10,v171
 v_mul_f32 v172,v10,v172
 v_mul_f32 v173,v10,v173
 v_mul_f32 v174,v10,v174
 v_mul_f32 v175,v10,v175
 s_waitcnt lgkmcnt(8)
 mf 120,24,64,120
 cv 168,168,169
 cv 169,170,171
 cv 170,172,173
 cv 171,174,175
 ds_write_b128 v4,v[168:171] offset:21504
 mf 136,24,68,136
 v_mul_f32 v200,v12,v200
 v_mul_f32 v201,v12,v201
 v_mul_f32 v202,v12,v202
 v_mul_f32 v203,v12,v203
 v_mul_f32 v204,v12,v204
 mf 120,28,72,120
 v_mul_f32 v205,v12,v205
 v_mul_f32 v206,v12,v206
 v_mul_f32 v207,v12,v207
 cv 200,200,201
 cv 201,202,203
 mf 136,28,76,136
 cv 202,204,205
 cv 203,206,207
 ds_write_b128 v5,v[200:203] offset:21504
 s_waitcnt lgkmcnt(0)
L_aloop1:
 s_barrier
 tr 16,3,33792
 tr 18,3,34048
 tr 20,3,33824
 tr 22,3,34080
 tr 24,3,33856
 tr 26,3,34112
 mz 124,32,48
 tr 28,3,33888
 tr 30,3,34144
 v_exp_f32 v96,v96
 mz 140,32,52
 v_exp_f32 v97,v97
 mf 124,36,56,124
 tr 32,3,33920
 tr 34,3,34176
 v_exp_f32 v98,v98
 mf 140,36,60,140
 v_exp_f32 v99,v99
 mf 124,40,64,124
 tr 36,3,33952
 tr 38,3,34208
 v_exp_f32 v100,v100
 v_exp_f32 v101,v101
 mf 140,40,68,140
 v_exp_f32 v102,v102
 mf 124,44,72,124
 tr 40,3,33984
 tr 42,3,34240
 v_exp_f32 v103,v103
 cv 96,96,97
 mf 140,44,76,140
 cv 97,98,99
 cv 98,100,101
 cv 99,102,103
 s_waitcnt lgkmcnt(10)
 mz 144,16,80
 tr 44,3,34016
 tr 46,3,34272
 v_exp_f32 v88,v88
 mz 176,16,96
 v_exp_f32 v89,v89
 mz 248,6,80
 v_exp_f32 v90,v90
 mz 148,20,80
 tr 16,3,34304
 tr 18,3,34560
 v_exp_f32 v91,v91
 mz 180,20,96
 v_exp_f32 v92,v92
 mz 252,6,96
 v_exp_f32 v93,v93
 s_waitcnt lgkmcnt(10)
 mz 152,24,80
 tr 20,3,34336
 tr 22,3,34592
 v_exp_f32 v94,v94
 mz 184,24,96
 v_exp_f32 v95,v95
 mz 156,28,80
 tr 24,3,34368
 tr 26,3,34624
 cv 88,88,89
 cv 89,90,91
 mz 188,28,96
 cv 90,92,93
 cv 91,94,95
 s_waitcnt lgkmcnt(10)
 mz 160,32,80
 tr 28,3,34400
 tr 30,3,34656
 v_exp_f32 v104,v104
 mz 192,32,96
 v_exp_f32 v105,v105
 mz 164,36,80
 tr 32,3,34432
 tr 34,3,34688
 v_exp_f32 v106,v106
 mz 196,36,96
 v_exp_f32 v107,v107
 s_waitcnt lgkmcnt(10)
 mz 168,40,80
 tr 36,3,34464
 tr 38,3,34720
 v_exp_f32 v108,v108
 v_exp_f32 v109,v109
 mz 200,40,96
 v_exp_f32 v110,v110
 mz 172,44,80
 tr 40,3,34496
 tr 42,3,34752
 v_exp_f32 v111,v111
 cv 104,104,105
 mz 204,44,96
 cv 105,106,107
 cv 106,108,109
 cv 107,110,111
 s_waitcnt lgkmcnt(10)
 mf 144,16,88,144
 tr 44,3,34528
 tr 46,3,34784
 mf 176,16,104,176
 mf 248,6,88,248
 mf 148,20,88,148
 mf 180,20,104,180
 mf 252,6,104,252
 s_waitcnt lgkmcnt(8)
 mf 152,24,88,152
 mf 184,24,104,184
 mf 156,28,88,156
 mf 188,28,104,188
 s_cmp_lg_u32 s39,1
 s_waitcnt lgkmcnt(0)
 s_cbranch_scc1 L_nokeep
 ds_read_b128 v[208:211],v4
 ds_read_b128 v[212:215],v5
 ds_read_b128 v[216:219],v4 offset:7168
 ds_read_b128 v[220:223],v5 offset:7168
 ds_read_b128 v[224:227],v4 offset:14336
 ds_read_b128 v[228:231],v5 offset:14336
 ds_read_b128 v[232:235],v4 offset:21504
 ds_read_b128 v[236:239],v5 offset:21504
 s_waitcnt lgkmcnt(0)
L_nokeep:
 s_barrier
 ds_read_b128 v[16:19],v2 offset:16896
 ds_read_b128 v[20:23],v2 offset:16960
 ds_read_b128 v[24:27],v2 offset:17024
 mf 160,32,88,160
 ds_read_b128 v[28:31],v2 offset:17088
 v_exp_f32 v112,v112
 mf 192,32,104,192
 v_exp_f32 v113,v113
 mf 164,36,88,164
 ds_read_b128 v[32:35],v2 offset:17152
 v_exp_f32 v114,v114
 mf 196,36,104,196
 v_exp_f32 v115,v115
 mf 168,40,88,168
 ds_read_b128 v[36:39],v2 offset:17216
 v_exp_f32 v116,v116
 mf 200,40,104,200
 v_exp_f32 v117,v117
 mf 172,44,88,172
 ds_read_b128 v[40:43],v2 offset:17280
 v_exp_f32 v118,v118
 mf 204,44,104,204
 v_exp_f32 v119,v119
 s_waitcnt lgkmcnt(5)
 mz 80,16,48
 ds_read_b128 v[44:47],v2 offset:17344
 cv 112,112,113
 cv 113,114,115
 mz 96,16,52
 cv 114,116,117
 cv 115,118,119
 mf 80,20,56,80
 ds_read_b128 v[16:19],v2 offset:17408
 v_exp_f32 v128,v128
 mf 96,20,60,96
 v_exp_f32 v129,v129
 s_waitcnt lgkmcnt(5)
 mf 80,24,64,80
 ds_read_b128 v[20:23],v2 offset:17472
 v_exp_f32 v130,v130
 mf 96,24,68,96
 v_exp_f32 v131,v131
 mf 80,28,72,80
 ds_read_b128 v[24:27],v2 offset:17536
 v_exp_f32 v132,v132
 mf 96,28,76,96
 v_exp_f32 v133,v133
 s_waitcnt lgkmcnt(5)
 mz 84,32,48
 ds_read_b128 v[28:31],v2 offset:17600
 v_exp_f32 v134,v134
 mz 100,32,52
 v_exp_f32 v135,v135
 mf 84,36,56,84
 ds_read_b128 v[32:35],v2 offset:17664
 cv 128,128,129
 cv 129,130,131
 mf 100,36,60,100
 cv 130,132,133
 cv 131,134,135
 s_waitcnt lgkmcnt(5)
 mf 84,40,64,84
 ds_read_b128 v[36:39],v2 offset:17728
 v_exp_f32 v120,v120
 mf 100,40,68,100
 v_exp_f32 v121,v121
 mf 84,44,72,84
 ds_read_b128 v[40:43],v2 offset:17792
 v_exp_f32 v122,v122
 mf 100,44,76,100
 v_exp_f32 v123,v123
 s_waitcnt lgkmcnt(5)
 mz 88,16,48
 ds_read_b128 v[44:47],v2 offset:17856
 v_exp_f32 v124,v124
 mz 104,16,52
 v_exp_f32 v125,v125
 mf 88,20,56,88
 v_exp_f32 v126,v126
 mf 104,20,60,104
 v_exp_f32 v127,v127
 s_waitcnt lgkmcnt(4)
 mf 88,24,64,88
 cv 120,120,121
 mf 104,24,68,104
 cv 121,122,123
 mf 88,28,72,88
 cv 122,124,125
 mf 104,28,76,104
 cv 123,126,127
 s_waitcnt lgkmcnt(0)
 s_barrier
 tr 16,3,50688
 tr 18,3,50944
 tr 20,3,50720
 tr 22,3,50976
 tr 24,3,50752
 tr 26,3,51008
 mz 92,32,48
 tr 28,3,50784
 tr 30,3,51040
 mz 108,32,52
 mf 92,36,56,92
 tr 32,3,50816
 tr 34,3,51072
 mf 108,36,60,108
 mf 92,40,64,92
 tr 36,3,50848
 tr 38,3,51104
 mf 108,40,68,108
 mf 92,44,72,92
 tr 40,3,50880
 tr 42,3,51136
 v_exp_f32 v136,v136
 mf 108,44,76,108
 s_waitcnt lgkmcnt(10)
 mf 144,16,112,144
 tr 44,3,50912
 tr 46,3,51168
 v_exp_f32 v137,v137
 mf 176,16,128,176
 mf 248,6,112,248
 v_exp_f32 v138,v138
 mf 148,20,112,148
 tr 16,3,51200
 tr 18,3,51456
 mf 180,20,128,180
 v_exp_f32 v139,v139
 mf 252,6,128,252
 s_waitcnt lgkmcnt(10)
 mf 152,24,112,152
 tr 20,3,51232
 tr 22,3,51488
 v_exp_f32 v140,v140
 mf 184,24,128,184
 mf 156,28,112,156
 tr 24,3,51264
 tr 26,3,51520
 v_exp_f32 v141,v141
 mf 188,28,128,188
 s_waitcnt lgkmcnt(10)
 mf 160,32,112,160
 tr 28,3,51296
 tr 30,3,51552
 v_exp_f32 v142,v142
 mf 192,32,128,192
 mf 164,36,112,164
 tr 32,3,51328
 tr 34,3,51584
 v_exp_f32 v143,v143
 mf 196,36,128,196
 cv 136,136,137
 s_waitcnt lgkmcnt(10)
 mf 168,40,112,168
 tr 36,3,51360
 tr 38,3,51616
 cv 137,138,139
 mf 200,40,128,200
 cv 138,140,141
 mf 172,44,112,172
 tr 40,3,51392
 tr 42,3,51648
 cv 139,142,143
 mf 204,44,128,204
 s_waitcnt lgkmcnt(10)
 mf 144,16,120,144
 tr 44,3,51424
 tr 46,3,51680
 mf 176,16,136,176
 mf 248,6,120,248
 mf 148,20,120,148
 mf 180,20,136,180
 mf 252,6,136,252
 s_waitcnt lgkmcnt(8)
 mf 152,24,120,152
 mf 184,24,136,184
 mf 156,28,120,156
 mf 188,28,136,188
 s_waitcnt lgkmcnt(0)
 s_barrier
 ds_read_b128 v[16:19],v2
 ds_read_b128 v[20:23],v2 offset:64
 ds_read_b128 v[24:27],v2 offset:128
 mf 160,32,120,160
 ds_read_b128 v[28:31],v2 offset:192
 v_exp_f32 v80,v80
 mf 192,32,136,192
 v_exp_f32 v81,v81
 mf 164,36,120,164
 ds_read_b128 v[32:35],v2 offset:256
 v_exp_f32 v82,v82
 mf 196,36,136,196
 v_exp_f32 v83,v83
 mf 168,40,120,168
 ds_read_b128 v[36:39],v2 offset:320
 v_exp_f32 v84,v84
 mf 200,40,136,200
 v_exp_f32 v85,v85
 mf 172,44,120,172
 ds_read_b128 v[40:43],v2 offset:384
 v_exp_f32 v86,v86
 mf 204,44,136,204
 v_exp_f32 v87,v87
 s_waitcnt lgkmcnt(5)
 mz 112,16,48
 ds_read_b128 v[44:47],v2 offset:448
 cv 80,80,81
 cv 81,82,83
 mz 128,16,52
 cv 82,84,85
 cv 83,86,87
 mf 112,20,56,112
 ds_read_b128 v[16:19],v2 offset:512
 v_exp_f32 v96,v96
 mf 128,20,60,128
 v_exp_f32 v97,v97
 s_waitcnt lgkmcnt(5)
 mf 112,24,64,112
 ds_read_b128 v[20:23],v2 offset:576
 v_exp_f32 v98,v98
 mf 128,24,68,128
 v_exp_f32 v99,v99
 mf 112,28,72,112
 ds_read_b128 v[24:27],v2 offset:640
 v_exp_f32 v100,v100
 mf 128,28,76,128
 v_exp_f32 v101,v101
 s_waitcnt lgkmcnt(5)
 mz 116,32,48
 ds_read_b128 v[28:31],v2 offset:704
 v_exp_f32 v102,v102
 mz 132,32,52
 v_exp_f32 v103,v103
 mf 116,36,56,116
 ds_read_b128 v[32:35],v2 offset:768
 cv 96,96,97
 cv 97,98,99
 mf 132,36,60,132
 cv 98,100,101
 cv 99,102,103
 s_waitcnt lgkmcnt(5)
 mf 116,40,64,116
 ds_read_b128 v[36:39],v2 offset:832
 v_exp_f32 v88,v88
 mf 132,40,68,132
 v_exp_f32 v89,v89
 mf 116,44,72,116
 ds_read_b128 v[40:43],v2 offset:896
 v_exp_f32 v90,v90
 mf 132,44,76,132
 v_exp_f32 v91,v91
 s_waitcnt lgkmcnt(5)
 mz 120,16,48
 ds_read_b128 v[44:47],v2 offset:960
 v_exp_f32 v92,v92
 mz 136,16,52
 v_exp_f32 v93,v93
 mf 120,20,56,120
 v_exp_f32 v94,v94
 mf 136,20,60,136
 v_exp_f32 v95,v95
 s_waitcnt lgkmcnt(4)
 mf 120,24,64,120
 cv 88,88,89
 mf 136,24,68,136
 cv 89,90,91
 mf 120,28,72,120
 cv 90,92,93
 mf 136,28,76,136
 cv 91,94,95
 s_waitcnt lgkmcnt(0)
 s_barrier
 tr 16,3,33792
 tr 18,3,34048
 tr 20,3,33824
 tr 22,3,34080
 tr 24,3,33856
 tr 26,3,34112
 mz 124,32,48
 tr 28,3,33888
 tr 30,3,34144
 mz 140,32,52
 mf 124,36,56,124
 tr 32,3,33920
 tr 34,3,34176
 mf 140,36,60,140
 mf 124,40,64,124
 tr 36,3,33952
 tr 38,3,34208
 mf 140,40,68,140
 mf 124,44,72,124
 tr 40,3,33984
 tr 42,3,34240
 v_exp_f32 v104,v104
 mf 140,44,76,140
 s_waitcnt lgkmcnt(10)
 mf 144,16,80,144
 tr 44,3,34016
 tr 46,3,34272
 v_exp_f32 v105,v105
 mf 176,16,96,176
 mf 248,6,80,248
 v_exp_f32 v106,v106
 mf 148,20,80,148
 tr 16,3,34304
 tr 18,3,34560
 mf 180,20,96,180
 v_exp_f32 v107,v107
 mf 252,6,96,252
 s_waitcnt lgkmcnt(10)
 mf 152,24,80,152
 tr 20,3,34336
 tr 22,3,34592
 v_exp_f32 v108,v108
 mf 184,24,96,184
 mf 156,28,80,156
 tr 24,3,34368
 tr 26,3,34624
 v_exp_f32 v109,v109
 mf 188,28,96,188
 s_waitcnt lgkmcnt(10)
 mf 160,32,80,160
 tr 28,3,34400
 tr 30,3,34656
 v_exp_f32 v110,v110
 mf 192,32,96,192
 mf 164,36,80,164
 tr 32,3,34432
 tr 34,3,34688
 v_exp_f32 v111,v111
 mf 196,36,96,196
 cv 104,104,105
 s_waitcnt lgkmcnt(10)
 mf 168,40,80,168
 tr 36,3,34464
 tr 38,3,34720
 cv 105,106,107
 mf 200,40,96,200
 cv 106,108,109
 mf 172,44,80,172
 tr 40,3,34496
 tr 42,3,34752
 cv 107,110,111
 mf 204,44,96,204
 s_waitcnt lgkmcnt(10)
 mf 144,16,88,144
 tr 44,3,34528
 tr 46,3,34784
 mf 176,16,104,176
 mf 248,6,88,248
 mf 148,20,88,148
 mf 180,20,104,180
 mf 252,6,104,252
 s_waitcnt lgkmcnt(8)
 mf 152,24,88,152
 mf 184,24,104,184
 mf 156,28,88,156
 mf 188,28,104,188
 s_waitcnt lgkmcnt(0)
 s_barrier
 ds_read_b128 v[16:19],v2 offset:16896
 ds_read_b128 v[20:23],v2 offset:16960
 ds_read_b128 v[24:27],v2 offset:17024
 mf 160,32,88,160
 ds_read_b128 v[28:31],v2 offset:17088
 v_exp_f32 v112,v112
 mf 192,32,104,192
 v_exp_f32 v113,v113
 mf 164,36,88,164
 ds_read_b128 v[32:35],v2 offset:17152
 v_exp_f32 v114,v114
 mf 196,36,104,196
 v_exp_f32 v115,v115
 mf 168,40,88,168
 ds_read_b128 v[36:39],v2 offset:17216
 v_exp_f32 v116,v116
 mf 200,40,104,200
 v_exp_f32 v117,v117
 mf 172,44,88,172
 ds_read_b128 v[40:43],v2 offset:17280
 v_exp_f32 v118,v118
 mf 204,44,104,204
 v_exp_f32 v119,v119
 s_waitcnt lgkmcnt(5)
 mz 80,16,48
 ds_read_b128 v[44:47],v2 offset:17344
 cv 112,112,113
 cv 113,114,115
 mz 96,16,52
 cv 114,116,117
 cv 115,118,119
 mf 80,20,56,80
 ds_read_b128 v[16:19],v2 offset:17408
 v_exp_f32 v128,v128
 mf 96,20,60,96
 v_exp_f32 v129,v129
 s_waitcnt lgkmcnt(5)
 mf 80,24,64,80
 ds_read_b128 v[20:23],v2 offset:17472
 v_exp_f32 v130,v130
 mf 96,24,68,96
 v_exp_f32 v131,v131
 mf 80,28,72,80
 ds_read_b128 v[24:27],v2 offset:17536
 v_exp_f32 v132,v132
 mf 96,28,76,96
 v_exp_f32 v133,v133
 s_waitcnt lgkmcnt(5)
 mz 84,32,48
 ds_read_b128 v[28:31],v2 offset:17600
 v_exp_f32 v134,v134
 mz 100,32,52
 v_exp_f32 v135,v135
 mf 84,36,56,84
 ds_read_b128 v[32:35],v2 offset:17664
 cv 128,128,129
 cv 129,130,131
 mf 100,36,60,100
 cv 130,132,133
 cv 131,134,135
 s_waitcnt lgkmcnt(5)
 mf 84,40,64,84
 ds_read_b128 v[36:39],v2 offset:17728
 v_exp_f32 v120,v120
 mf 100,40,68,100
 v_exp_f32 v121,v121
 mf 84,44,72,84
 ds_read_b128 v[40:43],v2 offset:17792
 v_exp_f32 v122,v122
 mf 100,44,76,100
 v_exp_f32 v123,v123
 s_waitcnt lgkmcnt(5)
 mz 88,16,48
 ds_read_b128 v[44:47],v2 offset:17856
 v_exp_f32 v124,v124
 mz 104,16,52
 v_exp_f32 v125,v125
 mf 88,20,56,88
 v_exp_f32 v126,v126
 mf 104,20,60,104
 v_exp_f32 v127,v127
 s_waitcnt lgkmcnt(4)
 mf 88,24,64,88
 cv 120,120,121
 mf 104,24,68,104
 cv 121,122,123
 mf 88,28,72,88
 cv 122,124,125
 mf 104,28,76,104
 cv 123,126,127
 s_waitcnt lgkmcnt(0)
 s_barrier
 tr 16,3,50688
 tr 18,3,50944
 tr 20,3,50720
 tr 22,3,50976
 tr 24,3,50752
 tr 26,3,51008
 mz 92,32,48
 tr 28,3,50784
 tr 30,3,51040
 mz 108,32,52
 mf 92,36,56,92
 tr 32,3,50816
 tr 34,3,51072
 mf 108,36,60,108
 mf 92,40,64,92
 tr 36,3,50848
 tr 38,3,51104
 mf 108,40,68,108
 mf 92,44,72,92
 tr 40,3,50880
 tr 42,3,51136
 v_exp_f32 v136,v136
 mf 108,44,76,108
 s_waitcnt lgkmcnt(10)
 mf 144,16,112,144
 tr 44,3,50912
 tr 46,3,51168
 v_exp_f32 v137,v137
 mf 176,16,128,176
 mf 248,6,112,248
 v_exp_f32 v138,v138
 mf 148,20,112,148
 tr 16,3,51200
 tr 18,3,51456
 mf 180,20,128,180
 v_exp_f32 v139,v139
 mf 252,6,128,252
 s_waitcnt lgkmcnt(10)
 mf 152,24,112,152
 tr 20,3,51232
 tr 22,3,51488
 v_exp_f32 v140,v140
 mf 184,24,128,184
 mf 156,28,112,156
 tr 24,3,51264
 tr 26,3,51520
 v_exp_f32 v141,v141
 mf 188,28,128,188
 s_waitcnt lgkmcnt(10)
 mf 160,32,112,160
 tr 28,3,51296
 tr 30,3,51552
 v_exp_f32 v142,v142
 mf 192,32,128,192
 mf 164,36,112,164
 tr 32,3,51328
 tr 34,3,51584
 v_exp_f32 v143,v143
 mf 196,36,128,196
 cv 136,136,137
 s_waitcnt lgkmcnt(10)
 mf 168,40,112,168
 tr 36,3,51360
 tr 38,3,51616
 cv 137,138,139
 mf 200,40,128,200
 cv 138,140,141
 mf 172,44,112,172
 tr 40,3,51392
 tr 42,3,51648
 cv 139,142,143
 mf 204,44,128,204
 s_waitcnt lgkmcnt(10)
 mf 144,16,120,144
 tr 44,3,51424
 tr 46,3,51680
 mf 176,16,136,176
 mf 248,6,120,248
 mf 148,20,120,148
 mf 180,20,136,180
 mf 252,6,136,252
 s_waitcnt lgkmcnt(8)
 mf 152,24,120,152
 mf 184,24,136,184
 mf 156,28,120,156
 mf 188,28,136,188
 s_waitcnt lgkmcnt(0)
 s_barrier
 ds_read_b128 v[16:19],v2
 ds_read_b128 v[20:23],v2 offset:64
 ds_read_b128 v[24:27],v2 offset:128
 mf 160,32,120,160
 ds_read_b128 v[28:31],v2 offset:192
 v_exp_f32 v80,v80
 mf 192,32,136,192
 v_exp_f32 v81,v81
 mf 164,36,120,164
 ds_read_b128 v[32:35],v2 offset:256
 v_exp_f32 v82,v82
 mf 196,36,136,196
 v_exp_f32 v83,v83
 mf 168,40,120,168
 ds_read_b128 v[36:39],v2 offset:320
 v_exp_f32 v84,v84
 mf 200,40,136,200
 v_exp_f32 v85,v85
 mf 172,44,120,172
 ds_read_b128 v[40:43],v2 offset:384
 v_exp_f32 v86,v86
 mf 204,44,136,204
 v_exp_f32 v87,v87
 s_waitcnt lgkmcnt(5)
 mz 112,16,48
 ds_read_b128 v[44:47],v2 offset:448
 cv 80,80,81
 cv 81,82,83
 mz 128,16,52
 cv 82,84,85
 cv 83,86,87
 mf 112,20,56,112
 ds_read_b128 v[16:19],v2 offset:512
 v_exp_f32 v96,v96
 mf 128,20,60,128
 v_exp_f32 v97,v97
 s_waitcnt lgkmcnt(5)
 mf 112,24,64,112
 ds_read_b128 v[20:23],v2 offset:576
 v_exp_f32 v98,v98
 mf 128,24,68,128
 v_exp_f32 v99,v99
 mf 112,28,72,112
 ds_read_b128 v[24:27],v2 offset:640
 v_exp_f32 v100,v100
 mf 128,28,76,128
 v_exp_f32 v101,v101
 s_waitcnt lgkmcnt(5)
 mz 116,32,48
 ds_read_b128 v[28:31],v2 offset:704
 v_exp_f32 v102,v102
 mz 132,32,52
 v_exp_f32 v103,v103
 mf 116,36,56,116
 ds_read_b128 v[32:35],v2 offset:768
 cv 96,96,97
 cv 97,98,99
 mf 132,36,60,132
 cv 98,100,101
 cv 99,102,103
 s_waitcnt lgkmcnt(5)
 mf 116,40,64,116
 ds_read_b128 v[36:39],v2 offset:832
 v_exp_f32 v88,v88
 mf 132,40,68,132
 v_exp_f32 v89,v89
 mf 116,44,72,116
 ds_read_b128 v[40:43],v2 offset:896
 v_exp_f32 v90,v90
 mf 132,44,76,132
 v_exp_f32 v91,v91
 s_waitcnt lgkmcnt(5)
 mz 120,16,48
 ds_read_b128 v[44:47],v2 offset:960
 v_exp_f32 v92,v92
 mz 136,16,52
 v_exp_f32 v93,v93
 mf 120,20,56,120
 v_exp_f32 v94,v94
 mf 136,20,60,136
 v_exp_f32 v95,v95
 s_waitcnt lgkmcnt(4)
 mf 120,24,64,120
 cv 88,88,89
 mf 136,24,68,136
 cv 89,90,91
 mf 120,28,72,120
 cv 90,92,93
 mf 136,28,76,136
 cv 91,94,95
 s_waitcnt lgkmcnt(0)
 s_barrier
 tr 16,3,33792
 tr 18,3,34048
 tr 20,3,33824
 tr 22,3,34080
 tr 24,3,33856
 tr 26,3,34112
 mz 124,32,48
 tr 28,3,33888
 tr 30,3,34144
 mz 140,32,52
 mf 124,36,56,124
 tr 32,3,33920
 tr 34,3,34176
 mf 140,36,60,140
 mf 124,40,64,124
 tr 36,3,33952
 tr 38,3,34208
 mf 140,40,68,140
 mf 124,44,72,124
 tr 40,3,33984
 tr 42,3,34240
 v_exp_f32 v104,v104
 mf 140,44,76,140
 s_waitcnt lgkmcnt(10)
 mf 144,16,80,144
 tr 44,3,34016
 tr 46,3,34272
 v_exp_f32 v105,v105
 mf 176,16,96,176
 mf 248,6,80,248
 v_exp_f32 v106,v106
 mf 148,20,80,148
 tr 16,3,34304
 tr 18,3,34560
 mf 180,20,96,180
 v_exp_f32 v107,v107
 mf 252,6,96,252
 s_waitcnt lgkmcnt(10)
 mf 152,24,80,152
 tr 20,3,34336
 tr 22,3,34592
 v_exp_f32 v108,v108
 mf 184,24,96,184
 mf 156,28,80,156
 tr 24,3,34368
 tr 26,3,34624
 v_exp_f32 v109,v109
 mf 188,28,96,188
 s_waitcnt lgkmcnt(10)
 mf 160,32,80,160
 tr 28,3,34400
 tr 30,3,34656
 v_exp_f32 v110,v110
 mf 192,32,96,192
 mf 164,36,80,164
 tr 32,3,34432
 tr 34,3,34688
 v_exp_f32 v111,v111
 mf 196,36,96,196
 cv 104,104,105
 s_waitcnt lgkmcnt(10)
 mf 168,40,80,168
 tr 36,3,34464
 tr 38,3,34720
 cv 105,106,107
 mf 200,40,96,200
 cv 106,108,109
 mf 172,44,80,172
 tr 40,3,34496
 tr 42,3,34752
 cv 107,110,111
 mf 204,44,96,204
 s_waitcnt lgkmcnt(10)
 mf 144,16,88,144
 tr 44,3,34528
 tr 46,3,34784
 mf 176,16,104,176
 mf 248,6,88,248
 mf 148,20,88,148
 mf 180,20,104,180
 mf 252,6,104,252
 s_waitcnt lgkmcnt(8)
 mf 152,24,88,152
 mf 184,24,104,184
 mf 156,28,88,156
 mf 188,28,104,188
 s_waitcnt lgkmcnt(0)
 s_barrier
 ds_read_b128 v[16:19],v2 offset:16896
 ds_read_b128 v[20:23],v2 offset:16960
 ds_read_b128 v[24:27],v2 offset:17024
 mf 160,32,88,160
 ds_read_b128 v[28:31],v2 offset:17088
 v_exp_f32 v112,v112
 mf 192,32,104,192
 v_exp_f32 v113,v113
 mf 164,36,88,164
 ds_read_b128 v[32:35],v2 offset:17152
 v_exp_f32 v114,v114
 mf 196,36,104,196
 v_exp_f32 v115,v115
 mf 168,40,88,168
 ds_read_b128 v[36:39],v2 offset:17216
 v_exp_f32 v116,v116
 mf 200,40,104,200
 v_exp_f32 v117,v117
 mf 172,44,88,172
 ds_read_b128 v[40:43],v2 offset:17280
 v_exp_f32 v118,v118
 mf 204,44,104,204
 v_exp_f32 v119,v119
 s_waitcnt lgkmcnt(5)
 mz 80,16,48
 ds_read_b128 v[44:47],v2 offset:17344
 cv 112,112,113
 cv 113,114,115
 mz 96,16,52
 cv 114,116,117
 cv 115,118,119
 mf 80,20,56,80
 ds_read_b128 v[16:19],v2 offset:17408
 v_exp_f32 v128,v128
 mf 96,20,60,96
 v_exp_f32 v129,v129
 s_waitcnt lgkmcnt(5)
 mf 80,24,64,80
 ds_read_b128 v[20:23],v2 offset:17472
 v_exp_f32 v130,v130
 mf 96,24,68,96
 v_exp_f32 v131,v131
 mf 80,28,72,80
 ds_read_b128 v[24:27],v2 offset:17536
 v_exp_f32 v132,v132
 mf 96,28,76,96
 v_exp_f32 v133,v133
 s_waitcnt lgkmcnt(5)
 mz 84,32,48
 ds_read_b128 v[28:31],v2 offset:17600
 v_exp_f32 v134,v134
 mz 100,32,52
 v_exp_f32 v135,v135
 mf 84,36,56,84
 ds_read_b128 v[32:35],v2 offset:17664
 cv 128,128,129
 cv 129,130,131
 mf 100,36,60,100
 cv 130,132,133
 cv 131,134,135
 s_waitcnt lgkmcnt(5)
 mf 84,40,64,84
 ds_read_b128 v[36:39],v2 offset:17728
 v_exp_f32 v120,v120
 mf 100,40,68,100
 v_exp_f32 v121,v121
 mf 84,44,72,84
 ds_read_b128 v[40:43],v2 offset:17792
 v_exp_f32 v122,v122
 mf 100,44,76,100
 v_exp_f32 v123,v123
 s_waitcnt lgkmcnt(5)
 mz 88,16,48
 ds_read_b128 v[44:47],v2 offset:17856
 v_exp_f32 v124,v124
 mz 104,16,52
 v_exp_f32 v125,v125
 mf 88,20,56,88
 v_exp_f32 v126,v126
 mf 104,20,60,104
 v_exp_f32 v127,v127
 s_waitcnt lgkmcnt(4)
 mf 88,24,64,88
 cv 120,120,121
 mf 104,24,68,104
 cv 121,122,123
 mf 88,28,72,88
 cv 122,124,125
 mf 104,28,76,104
 cv 123,126,127
 s_waitcnt lgkmcnt(0)
 s_barrier
 tr 16,3,50688
 tr 18,3,50944
 tr 20,3,50720
 tr 22,3,50976
 tr 24,3,50752
 tr 26,3,51008
 mz 92,32,48
 tr 28,3,50784
 tr 30,3,51040
 mz 108,32,52
 mf 92,36,56,92
 tr 32,3,50816
 tr 34,3,51072
 mf 108,36,60,108
 mf 92,40,64,92
 tr 36,3,50848
 tr 38,3,51104
 mf 108,40,68,108
 mf 92,44,72,92
 tr 40,3,50880
 tr 42,3,51136
 v_exp_f32 v136,v136
 mf 108,44,76,108
 s_waitcnt lgkmcnt(10)
 mf 144,16,112,144
 tr 44,3,50912
 tr 46,3,51168
 v_exp_f32 v137,v137
 mf 176,16,128,176
 mf 248,6,112,248
 v_exp_f32 v138,v138
 mf 148,20,112,148
 tr 16,3,51200
 tr 18,3,51456
 mf 180,20,128,180
 v_exp_f32 v139,v139
 mf 252,6,128,252
 s_waitcnt lgkmcnt(10)
 mf 152,24,112,152
 tr 20,3,51232
 tr 22,3,51488
 v_exp_f32 v140,v140
 mf 184,24,128,184
 mf 156,28,112,156
 tr 24,3,51264
 tr 26,3,51520
 v_exp_f32 v141,v141
 mf 188,28,128,188
 s_waitcnt lgkmcnt(10)
 mf 160,32,112,160
 tr 28,3,51296
 tr 30,3,51552
 v_exp_f32 v142,v142
 mf 192,32,128,192
 mf 164,36,112,164
 tr 32,3,51328
 tr 34,3,51584
 v_exp_f32 v143,v143
 mf 196,36,128,196
 cv 136,136,137
 s_waitcnt lgkmcnt(10)
 mf 168,40,112,168
 tr 36,3,51360
 tr 38,3,51616
 cv 137,138,139
 mf 200,40,128,200
 cv 138,140,141
 mf 172,44,112,172
 tr 40,3,51392
 tr 42,3,51648
 cv 139,142,143
 mf 204,44,128,204
 s_waitcnt lgkmcnt(10)
 mf 144,16,120,144
 tr 44,3,51424
 tr 46,3,51680
 mf 176,16,136,176
 mf 248,6,120,248
 mf 148,20,120,148
 mf 180,20,136,180
 mf 252,6,136,252
 s_waitcnt lgkmcnt(8)
 mf 152,24,120,152
 mf 184,24,136,184
 mf 156,28,120,156
 mf 188,28,136,188
 s_waitcnt lgkmcnt(0)
 s_barrier
 ds_read_b128 v[16:19],v2
 ds_read_b128 v[20:23],v2 offset:64
 ds_read_b128 v[24:27],v2 offset:128
 mf 160,32,120,160
 ds_read_b128 v[28:31],v2 offset:192
 v_exp_f32 v80,v80
 mf 192,32,136,192
 v_exp_f32 v81,v81
 mf 164,36,120,164
 ds_read_b128 v[32:35],v2 offset:256
 v_exp_f32 v82,v82
 mf 196,36,136,196
 v_exp_f32 v83,v83
 mf 168,40,120,168
 ds_read_b128 v[36:39],v2 offset:320
 v_exp_f32 v84,v84
 mf 200,40,136,200
 v_exp_f32 v85,v85
 mf 172,44,120,172
 ds_read_b128 v[40:43],v2 offset:384
 v_exp_f32 v86,v86
 mf 204,44,136,204
 v_exp_f32 v87,v87
 s_waitcnt lgkmcnt(5)
 mz 112,16,48
 ds_read_b128 v[44:47],v2 offset:448
 cv 80,80,81
 cv 81,82,83
 mz 128,16,52
 cv 82,84,85
 cv 83,86,87
 mf 112,20,56,112
 ds_read_b128 v[16:19],v2 offset:512
 v_exp_f32 v96,v96
 mf 128,20,60,128
 v_exp_f32 v97,v97
 s_waitcnt lgkmcnt(5)
 mf 112,24,64,112
 ds_read_b128 v[20:23],v2 offset:576
 v_exp_f32 v98,v98
 mf 128,24,68,128
 v_exp_f32 v99,v99
 mf 112,28,72,112
 ds_read_b128 v[24:27],v2 offset:640
 v_exp_f32 v100,v100
 mf 128,28,76,128
 v_exp_f32 v101,v101
 s_waitcnt lgkmcnt(5)
 mz 116,32,48
 ds_read_b128 v[28:31],v2 offset:704
 v_exp_f32 v102,v102
 mz 132,32,52
 v_exp_f32 v103,v103
 mf 116,36,56,116
 ds_read_b128 v[32:35],v2 offset:768
 cv 96,96,97
 cv 97,98,99
 mf 132,36,60,132
 cv 98,100,101
 cv 99,102,103
 s_waitcnt lgkmcnt(5)
 mf 116,40,64,116
 ds_read_b128 v[36:39],v2 offset:832
 v_exp_f32 v88,v88
 mf 132,40,68,132
 v_exp_f32 v89,v89
 mf 116,44,72,116
 ds_read_b128 v[40:43],v2 offset:896
 v_exp_f32 v90,v90
 mf 132,44,76,132
 v_exp_f32 v91,v91
 s_waitcnt lgkmcnt(5)
 mz 120,16,48
 ds_read_b128 v[44:47],v2 offset:960
 v_exp_f32 v92,v92
 mz 136,16,52
 v_exp_f32 v93,v93
 mf 120,20,56,120
 v_exp_f32 v94,v94
 mf 136,20,60,136
 v_exp_f32 v95,v95
 s_waitcnt lgkmcnt(4)
 mf 120,24,64,120
 cv 88,88,89
 mf 136,24,68,136
 cv 89,90,91
 mf 120,28,72,120
 cv 90,92,93
 mf 136,28,76,136
 cv 91,94,95
 s_waitcnt lgkmcnt(0)
 s_barrier
 tr 16,3,33792
 tr 18,3,34048
 tr 20,3,33824
 tr 22,3,34080
 tr 24,3,33856
 tr 26,3,34112
 mz 124,32,48
 tr 28,3,33888
 tr 30,3,34144
 v_exp_f32 v104,v104
 mz 140,32,52
 mf 124,36,56,124
 tr 32,3,33920
 tr 34,3,34176
 v_exp_f32 v105,v105
 mf 140,36,60,140
 mf 124,40,64,124
 tr 36,3,33952
 tr 38,3,34208
 v_exp_f32 v106,v106
 mf 140,40,68,140
 mf 124,44,72,124
 tr 40,3,33984
 tr 42,3,34240
 v_exp_f32 v107,v107
 mf 140,44,76,140
 s_waitcnt lgkmcnt(10)
 mf 144,16,80,144
 tr 44,3,34016
 tr 46,3,34272
 v_exp_f32 v108,v108
 mf 176,16,96,176
 mf 248,6,80,248
 v_exp_f32 v109,v109
 mf 148,20,80,148
 tr 16,3,34304
 tr 18,3,34560
 mf 180,20,96,180
 v_exp_f32 v110,v110
 mf 252,6,96,252
 s_waitcnt lgkmcnt(10)
 mf 152,24,80,152
 tr 20,3,34336
 tr 22,3,34592
 v_exp_f32 v111,v111
 mf 184,24,96,184
 cv 104,104,105
 mf 156,28,80,156
 tr 24,3,34368
 tr 26,3,34624
 cv 105,106,107
 mf 188,28,96,188
 cv 106,108,109
 s_waitcnt lgkmcnt(10)
 mf 160,32,80,160
 tr 28,3,34400
 tr 30,3,34656
 cv 107,110,111
 mf 192,32,96,192
 mf 164,36,80,164
 tr 32,3,34432
 tr 34,3,34688
 ds_read_b128 v[48:51],v4
 mf 196,36,96,196
 s_waitcnt lgkmcnt(11)
 mf 168,40,80,168
 tr 36,3,34464
 tr 38,3,34720
 ds_read_b128 v[52:55],v5
 mf 200,40,96,200
 mf 172,44,80,172
 tr 40,3,34496
 tr 42,3,34752
 ds_read_b128 v[56:59],v4 offset:7168
 mf 204,44,96,204
 s_waitcnt lgkmcnt(13)
 mf 144,16,88,144
 tr 44,3,34528
 tr 46,3,34784
 ds_read_b128 v[60:63],v5 offset:7168
 mf 176,16,104,176
 mf 248,6,88,248
 ds_read_b128 v[64:67],v4 offset:14336
 mf 148,20,88,148
 mf 180,20,104,180
 ds_read_b128 v[68:71],v5 offset:14336
 mf 252,6,104,252
 s_waitcnt lgkmcnt(14)
 mf 152,24,88,152
 ds_read_b128 v[72:75],v4 offset:21504
 mf 184,24,104,184
 mf 156,28,88,156
 ds_read_b128 v[76:79],v5 offset:21504
 mf 188,28,104,188
 s_cmp_eq_u32 s39,3
 s_waitcnt lgkmcnt(0)
 s_cbranch_scc1 L_alast
 s_barrier
 ds_read_b128 v[16:19],v2 offset:16896
 ds_read_b128 v[20:23],v2 offset:16960
 ds_read_b128 v[24:27],v2 offset:17024
 mf 160,32,88,160
 ds_read_b128 v[28:31],v2 offset:17088
 v_exp_f32 v112,v112
 mf 192,32,104,192
 v_exp_f32 v113,v113
 mf 164,36,88,164
 ds_read_b128 v[32:35],v2 offset:17152
 v_exp_f32 v114,v114
 mf 196,36,104,196
 v_exp_f32 v115,v115
 mf 168,40,88,168
 ds_read_b128 v[36:39],v2 offset:17216
 v_exp_f32 v116,v116
 mf 200,40,104,200
 v_exp_f32 v117,v117
 mf 172,44,88,172
 ds_read_b128 v[40:43],v2 offset:17280
 v_exp_f32 v118,v118
 mf 204,44,104,204
 v_exp_f32 v119,v119
 s_waitcnt lgkmcnt(5)
 mz 80,16,48
 ds_read_b128 v[44:47],v2 offset:17344
 cv 112,112,113
 cv 113,114,115
 mz 96,16,52
 cv 114,116,117
 cv 115,118,119
 mf 80,20,56,80
 ds_read_b128 v[16:19],v2 offset:17408
 v_exp_f32 v128,v128
 mf 96,20,60,96
 v_exp_f32 v129,v129
 s_waitcnt lgkmcnt(5)
 mf 80,24,64,80
 ds_read_b128 v[20:23],v2 offset:17472
 v_exp_f32 v130,v130
 mf 96,24,68,96
 v_exp_f32 v131,v131
 mf 80,28,72,80
 ds_read_b128 v[24:27],v2 offset:17536
 v_exp_f32 v132,v132
 mf 96,28,76,96
 v_exp_f32 v133,v133
 s_waitcnt lgkmcnt(5)
 mz 84,32,48
 ds_read_b128 v[28:31],v2 offset:17600
 v_exp_f32 v134,v134
 mz 100,32,52
 v_exp_f32 v135,v135
 mf 84,36,56,84
 ds_read_b128 v[32:35],v2 offset:17664
 cv 128,128,129
 cv 129,130,131
 mf 100,36,60,100
 cv 130,132,133
 cv 131,134,135
 s_waitcnt lgkmcnt(5)
 mf 84,40,64,84
 ds_read_b128 v[36:39],v2 offset:17728
 v_exp_f32 v120,v120
 mf 100,40,68,100
 v_exp_f32 v121,v121
 mf 84,44,72,84
 ds_read_b128 v[40:43],v2 offset:17792
 v_exp_f32 v122,v122
 mf 100,44,76,100
 v_exp_f32 v123,v123
 s_waitcnt lgkmcnt(5)
 mz 88,16,48
 ds_read_b128 v[44:47],v2 offset:17856
 v_exp_f32 v124,v124
 mz 104,16,52
 v_exp_f32 v125,v125
 mf 88,20,56,88
 v_exp_f32 v126,v126
 mf 104,20,60,104
 v_exp_f32 v127,v127
 s_waitcnt lgkmcnt(4)
 mf 88,24,64,88
 cv 120,120,121
 mf 104,24,68,104
 cv 121,122,123
 mf 88,28,72,88
 cv 122,124,125
 mf 104,28,76,104
 cv 123,126,127
 s_waitcnt lgkmcnt(0)
 s_barrier
 tr 16,3,50688
 tr 18,3,50944
 tr 20,3,50720
 tr 22,3,50976
 tr 24,3,50752
 tr 26,3,51008
 mz 92,32,48
 tr 28,3,50784
 tr 30,3,51040
 mz 108,32,52
 mf 92,36,56,92
 tr 32,3,50816
 tr 34,3,51072
 mf 108,36,60,108
 mf 92,40,64,92
 tr 36,3,50848
 tr 38,3,51104
 mf 108,40,68,108
 mf 92,44,72,92
 tr 40,3,50880
 tr 42,3,51136
 v_exp_f32 v136,v136
 mf 108,44,76,108
 s_waitcnt lgkmcnt(10)
 mf 144,16,112,144
 tr 44,3,50912
 tr 46,3,51168
 v_exp_f32 v137,v137
 mf 176,16,128,176
 mf 248,6,112,248
 v_exp_f32 v138,v138
 mf 148,20,112,148
 tr 16,3,51200
 tr 18,3,51456
 mf 180,20,128,180
 v_exp_f32 v139,v139
 mf 252,6,128,252
 s_waitcnt lgkmcnt(10)
 mf 152,24,112,152
 tr 20,3,51232
 tr 22,3,51488
 v_exp_f32 v140,v140
 mf 184,24,128,184
 mf 156,28,112,156
 tr 24,3,51264
 tr 26,3,51520
 v_exp_f32 v141,v141
 mf 188,28,128,188
 s_waitcnt lgkmcnt(10)
 mf 160,32,112,160
 tr 28,3,51296
 tr 30,3,51552
 v_exp_f32 v142,v142
 mf 192,32,128,192
 mf 164,36,112,164
 tr 32,3,51328
 tr 34,3,51584
 v_exp_f32 v143,v143
 mf 196,36,128,196
 cv 136,136,137
 s_waitcnt lgkmcnt(10)
 mf 168,40,112,168
 tr 36,3,51360
 tr 38,3,51616
 cv 137,138,139
 mf 200,40,128,200
 cv 138,140,141
 mf 172,44,112,172
 tr 40,3,51392
 tr 42,3,51648
 cv 139,142,143
 mf 204,44,128,204
 s_waitcnt lgkmcnt(10)
 mf 144,16,120,144
 tr 44,3,51424
 tr 46,3,51680
 mf 176,16,136,176
 mf 248,6,120,248
 mf 148,20,120,148
 mf 180,20,136,180
 mf 252,6,136,252
 s_waitcnt lgkmcnt(8)
 mf 152,24,120,152
 mf 184,24,136,184
 mf 156,28,120,156
 mf 188,28,136,188
 s_add_u32 s39,s39,1
 s_waitcnt lgkmcnt(0)
 s_branch L_aloop
L_alast:
 s_barrier
 tr 16,3,50688
 tr 18,3,50944
 tr 20,3,50720
 tr 22,3,50976
 tr 24,3,50752
 tr 26,3,51008
 mf 160,32,88,160
 tr 28,3,50784
 tr 30,3,51040
 v_exp_f32 v112,v112
 v_exp_f32 v113,v113
 v_exp_f32 v114,v114
 mf 192,32,104,192
 v_exp_f32 v115,v115
 v_exp_f32 v116,v116
 mf 164,36,88,164
 tr 32,3,50816
 tr 34,3,51072
 v_exp_f32 v117,v117
 v_exp_f32 v118,v118
 v_exp_f32 v119,v119
 mf 196,36,104,196
 cv 112,112,113
 cv 113,114,115
 cv 114,116,117
 cv 115,118,119
 mf 168,40,88,168
 tr 36,3,50848
 tr 38,3,51104
 v_exp_f32 v128,v128
 v_exp_f32 v129,v129
 v_exp_f32 v130,v130
 mf 200,40,104,200
 v_exp_f32 v131,v131
 v_exp_f32 v132,v132
 mf 172,44,88,172
 tr 40,3,50880
 tr 42,3,51136
 v_exp_f32 v133,v133
 v_exp_f32 v134,v134
 v_exp_f32 v135,v135
 mf 204,44,104,204
 cv 128,128,129
 cv 129,130,131
 cv 130,132,133
 cv 131,134,135
 s_waitcnt lgkmcnt(10)
 mf 144,16,112,144
 tr 44,3,50912
 tr 46,3,51168
 v_exp_f32 v120,v120
 mf 176,16,128,176
 v_exp_f32 v121,v121
 mf 248,6,112,248
 v_exp_f32 v122,v122
 mf 148,20,112,148
 tr 16,3,51200
 tr 18,3,51456
 v_exp_f32 v123,v123
 mf 180,20,128,180
 v_exp_f32 v124,v124
 mf 252,6,128,252
 v_exp_f32 v125,v125
 s_waitcnt lgkmcnt(10)
 mf 152,24,112,152
 tr 20,3,51232
 tr 22,3,51488
 v_exp_f32 v126,v126
 mf 184,24,128,184
 v_exp_f32 v127,v127
 mf 156,28,112,156
 tr 24,3,51264
 tr 26,3,51520
 cv 120,120,121
 cv 121,122,123
 mf 188,28,128,188
 cv 122,124,125
 cv 123,126,127
 s_waitcnt lgkmcnt(10)
 mf 160,32,112,160
 tr 28,3,51296
 tr 30,3,51552
 v_exp_f32 v136,v136
 mf 192,32,128,192
 v_exp_f32 v137,v137
 mf 164,36,112,164
 tr 32,3,51328
 tr 34,3,51584
 v_exp_f32 v138,v138
 mf 196,36,128,196
 v_exp_f32 v139,v139
 s_waitcnt lgkmcnt(10)
 mf 168,40,112,168
 tr 36,3,51360
 tr 38,3,51616
 v_exp_f32 v140,v140
 v_exp_f32 v141,v141
 mf 200,40,128,200
 v_exp_f32 v142,v142
 mf 172,44,112,172
 tr 40,3,51392
 tr 42,3,51648
 v_exp_f32 v143,v143
 cv 136,136,137
 mf 204,44,128,204
 cv 137,138,139
 cv 138,140,141
 cv 139,142,143
 s_waitcnt lgkmcnt(10)
 mf 144,16,120,144
 tr 44,3,51424
 tr 46,3,51680
 mf 176,16,136,176
 mf 248,6,120,248
 mf 148,20,120,148
 mf 180,20,136,180
 mf 252,6,136,252
 s_waitcnt lgkmcnt(8)
 mf 152,24,120,152
 mf 184,24,136,184
 mf 156,28,120,156
 mf 188,28,136,188
 s_lshl_b32 s42,s54,2
 v_mov_b32 v9,0
 buffer_load_dword v9,v9,s[64:67],s42 offen sc1
 s_waitcnt lgkmcnt(0)
 s_barrier
 mf 160,32,120,160
 ds_read_b128 v[80:83],v4
 ds_read_b128 v[84:87],v5
 ds_read_b128 v[88:91],v4 offset:7168
 ds_read_b128 v[92:95],v5 offset:7168
 ds_read_b128 v[96:99],v4 offset:14336
 ds_read_b128 v[100:103],v5 offset:14336
 ds_read_b128 v[104:107],v4 offset:21504
 ds_read_b128 v[108:111],v5 offset:21504
 v_mbcnt_lo_u32_b32 v13,-1,0
 v_mbcnt_hi_u32_b32 v13,-1,v13
 v_bfe_u32 v11,v13,3,2
 mf 192,32,136,192
 v_mul_u32_u24 v2,1056,v11
 v_lshrrev_b32 v11,5,v13
 v_lshl_add_u32 v2,v11,8,v2
 v_bfe_u32 v11,v13,2,1
 v_lshl_add_u32 v2,v11,7,v2
 v_and_b32 v11,3,v13
 v_lshl_add_u32 v2,v11,3,v2
 mf 164,36,120,164
 mf 196,36,136,196
 mf 168,40,120,168
 mf 200,40,136,200
 mf 172,44,120,172
 mf 204,44,136,204
 v_rcp_f32 v10,v248
 v_rcp_f32 v12,v252
 v_max_f32 v11,v10,v248
 v_max3_f32 v11,v11,v12,v252
 v_cmp_nge_f32 vcc,s101,v11
 s_nop 0
 s_or_b64 s[94:95],s[94:95],vcc
 v_mul_f32 v144,v10,v144
 v_mul_f32 v145,v10,v145
 v_mul_f32 v146,v10,v146
 v_mul_f32 v147,v10,v147
 v_mul_f32 v148,v10,v148
 v_mul_f32 v149,v10,v149
 v_mul_f32 v150,v10,v150
 v_mul_f32 v151,v10,v151
 cv 144,144,145
 cv 145,146,147
 cv 146,148,149
 cv 147,150,151
 ds_write_b128 v4,v[144:147]
 v_mul_f32 v176,v12,v176
 v_mul_f32 v177,v12,v177
 v_mul_f32 v178,v12,v178
 v_mul_f32 v179,v12,v179
 v_mul_f32 v180,v12,v180
 v_mul_f32 v181,v12,v181
 v_mul_f32 v182,v12,v182
 v_mul_f32 v183,v12,v183
 cv 176,176,177
 cv 177,178,179
 cv 178,180,181
 cv 179,182,183
 ds_write_b128 v5,v[176:179]
 v_mul_f32 v152,v10,v152
 v_mul_f32 v153,v10,v153
 v_mul_f32 v154,v10,v154
 v_mul_f32 v155,v10,v155
 v_mul_f32 v156,v10,v156
 v_mul_f32 v157,v10,v157
 v_mul_f32 v158,v10,v158
 v_mul_f32 v159,v10,v159
 cv 152,152,153
 cv 153,154,155
 cv 154,156,157
 cv 155,158,159
 ds_write_b128 v4,v[152:155] offset:7168
 v_mul_f32 v184,v12,v184
 v_mul_f32 v185,v12,v185
 v_mul_f32 v186,v12,v186
 v_mul_f32 v187,v12,v187
 v_mul_f32 v188,v12,v188
 v_mul_f32 v189,v12,v189
 v_mul_f32 v190,v12,v190
 v_mul_f32 v191,v12,v191
 cv 184,184,185
 cv 185,186,187
 cv 186,188,189
 cv 187,190,191
 ds_write_b128 v5,v[184:187] offset:7168
 v_mul_f32 v160,v10,v160
 v_mul_f32 v161,v10,v161
 v_mul_f32 v162,v10,v162
 v_mul_f32 v163,v10,v163
 v_mul_f32 v164,v10,v164
 v_mul_f32 v165,v10,v165
 v_mul_f32 v166,v10,v166
 v_mul_f32 v167,v10,v167
 cv 160,160,161
 cv 161,162,163
 cv 162,164,165
 cv 163,166,167
 ds_write_b128 v4,v[160:163] offset:14336
 v_mul_f32 v192,v12,v192
 v_mul_f32 v193,v12,v193
 v_mul_f32 v194,v12,v194
 v_mul_f32 v195,v12,v195
 v_mul_f32 v196,v12,v196
 v_mul_f32 v197,v12,v197
 v_mul_f32 v198,v12,v198
 v_mul_f32 v199,v12,v199
 cv 192,192,193
 cv 193,194,195
 cv 194,196,197
 cv 195,198,199
 ds_write_b128 v5,v[192:195] offset:14336
 v_mul_f32 v168,v10,v168
 v_mul_f32 v169,v10,v169
 v_mul_f32 v170,v10,v170
 v_mul_f32 v171,v10,v171
 v_mul_f32 v172,v10,v172
 v_mul_f32 v173,v10,v173
 v_mul_f32 v174,v10,v174
 v_mul_f32 v175,v10,v175
 cv 168,168,169
 cv 169,170,171
 cv 170,172,173
 cv 171,174,175
 ds_write_b128 v4,v[168:171] offset:21504
 v_mul_f32 v200,v12,v200
 v_mul_f32 v201,v12,v201
 v_mul_f32 v202,v12,v202
 v_mul_f32 v203,v12,v203
 v_mul_f32 v204,v12,v204
 v_mul_f32 v205,v12,v205
 v_mul_f32 v206,v12,v206
 v_mul_f32 v207,v12,v207
 cv 200,200,201
 cv 201,202,203
 cv 202,204,205
 cv 203,206,207
 ds_write_b128 v5,v[200:203] offset:21504
 s_cmp_eq_u64 s[94:95],0
 s_waitcnt lgkmcnt(0)
 s_cbranch_scc1 L_good
 v_mov_b32 v10,16880
 ds_write_b32 v10,v10
 s_waitcnt lgkmcnt(0)
L_good:
 s_setprio 0
 s_barrier
 ds_read_b64_tr_b16 v[16:17],v2
 tr 18,2,512
 tr 20,2,32
 tr 22,2,544
 tr 24,2,64
 tr 26,2,576
 tr 28,2,96
 tr 30,2,608
 tr 148,2,4224
 tr 150,2,4736
 tr 156,2,4256
 tr 158,2,4768
 tr 164,2,4288
 tr 166,2,4800
 s_waitcnt lgkmcnt(10)
 mz 112,16,208
 tr 172,2,4320
 tr 174,2,4832
 mz 128,16,212
 mz 116,20,208
 tr 16,2,8448
 tr 18,2,8960
 mz 132,20,212
 s_waitcnt lgkmcnt(10)
 mz 120,24,208
 tr 20,2,8480
 tr 22,2,8992
 mz 136,24,212
 mz 124,28,208
 tr 24,2,8512
 tr 26,2,9024
 mz 140,28,212
 s_waitcnt lgkmcnt(10)
 mf 112,148,216,112
 tr 28,2,8544
 tr 30,2,9056
 mf 128,148,220,128
 mf 116,156,216,116
 tr 148,2,12672
 tr 150,2,13184
 mf 132,156,220,132
 s_waitcnt lgkmcnt(10)
 mf 120,164,216,120
 tr 156,2,12704
 tr 158,2,13216
 mf 136,164,220,136
 mf 124,172,216,124
 tr 164,2,12736
 tr 166,2,13248
 mf 140,172,220,140
 s_waitcnt lgkmcnt(10)
 mf 112,16,224,112
 tr 172,2,12768
 tr 174,2,13280
 mf 128,16,228,128
 mf 116,20,224,116
 v_mov_b32 v10,16880
 mf 132,20,228,132
 s_waitcnt lgkmcnt(8)
 mf 120,24,224,120
 mf 136,24,228,136
 mf 124,28,224,124
 ds_read_b32 v10,v10
 mf 140,28,228,140
 s_waitcnt lgkmcnt(0)
 v_readfirstlane_b32 s40,v10
 s_nop 0
 s_cmp_lg_u32 s40,0
 s_cbranch_scc1 X_restart
 s_waitcnt vmcnt(0)
L_rdy:
 v_readfirstlane_b32 s55,v9
 s_add_u32 s100,s100,1
 s_cmp_gt_u32 s100,0x40000
 s_cbranch_scc1 L_rdyok
 s_cmp_ge_u32 s55,8
 s_cbranch_scc1 L_rdyok
 v_mov_b32 v9,0
 buffer_load_dword v9,v9,s[64:67],s42 offen sc1
 s_waitcnt vmcnt(0)
 s_branch L_rdy
L_rdyok:
 s_barrier
 tr 16,2,16896
 tr 18,2,17408
 tr 20,2,16928
 tr 22,2,17440
 tr 24,2,16960
 tr 26,2,17472
 mf 112,148,232,112
 tr 28,2,16992
 tr 30,2,17504
 mf 128,148,236,128
 mf 116,156,232,116
 tr 148,2,21120
 tr 150,2,21632
 mf 132,156,236,132
 mf 120,164,232,120
 tr 156,2,21152
 tr 158,2,21664
 mf 136,164,236,136
 mf 124,172,232,124
 tr 164,2,21184
 tr 166,2,21696
 mf 140,172,236,140
 s_waitcnt lgkmcnt(10)
 mf 112,16,48,112
 tr 172,2,21216
 tr 174,2,21728
 mf 128,16,52,128
 mf 116,20,48,116
 tr 16,2,25344
 tr 18,2,25856
 mf 132,20,52,132
 s_waitcnt lgkmcnt(10)
 mf 120,24,48,120
 tr 20,2,25376
 tr 22,2,25888
 v_mbcnt_lo_u32_b32 v10,-1,0
 mf 136,24,52,136
 mf 124,28,48,124
 tr 24,2,25408
 tr 26,2,25920
 v_mbcnt_hi_u32_b32 v10,-1,v10
 mf 140,28,52,140
 s_lshl_b32 s47,s37,2
 s_add_u32 s47,s47,s33
 s_lshl_b32 s47,s47,2
 s_waitcnt lgkmcnt(10)
 mf 112,148,56,112
 tr 28,2,25440
 tr 30,2,25952
 v_cmp_eq_u32 vcc,0,v10
 mf 128,148,60,128
 mf 116,156,56,116
 tr 148,2,29568
 tr 150,2,30080
 v_mov_b32 v10,s47
 mf 132,156,60,132
 s_waitcnt lgkmcnt(10)
 mf 120,164,56,120
 tr 156,2,29600
 tr 158,2,30112
 v_mov_b32 v7,0x40000000
 mf 136,164,60,136
 mf 124,172,56,124
 tr 164,2,29632
 tr 166,2,30144
 v_cndmask_b32 v7,v7,v10,vcc
 mf 140,172,60,140
 s_lshl_b32 s40,s33,12
 s_waitcnt lgkmcnt(10)
 mf 112,16,64,112
 tr 172,2,29664
 tr 174,2,30176
 v_lshlrev_b32 v3,4,v13
 mf 128,16,68,128
 mf 116,20,64,116
 v_add_u32 v3,s40,v3
 mf 132,20,68,132
 s_mov_b32 s40,0
 s_cmp_eq_u32 s33,3
 s_cselect_b32 s40,0x40000000,s40
 s_waitcnt lgkmcnt(8)
 mf 120,24,64,120
 v_add_u32 v6,s40,v3
 mf 136,24,68,136
 mf 124,28,64,124
 v_add_u32 v8,67584,v2
 mf 140,28,68,140
 s_waitcnt lgkmcnt(0)
 s_barrier
 tr 16,2,33792
 tr 18,2,34304
 tr 20,2,33824
 tr 22,2,34336
 tr 24,2,33856
 tr 26,2,34368
 mf 112,148,72,112
 tr 28,2,33888
 tr 30,2,34400
 mf 128,148,76,128
 mf 116,156,72,116
 tr 148,2,38016
 tr 150,2,38528
 mf 132,156,76,132
 mf 120,164,72,120
 tr 156,2,38048
 tr 158,2,38560
 mf 136,164,76,136
 mf 124,172,72,124
 tr 164,2,38080
 tr 166,2,38592
 mf 140,172,76,140
 s_waitcnt lgkmcnt(10)
 mf 112,16,80,112
 tr 172,2,38112
 tr 174,2,38624
 mf 128,16,84,128
 mf 116,20,80,116
 tr 16,2,42240
 tr 18,2,42752
 mf 132,20,84,132
 s_waitcnt lgkmcnt(10)
 mf 120,24,80,120
 tr 20,2,42272
 tr 22,2,42784
 mf 136,24,84,136
 mf 124,28,80,124
 tr 24,2,42304
 tr 26,2,42816
 mf 140,28,84,140
 s_waitcnt lgkmcnt(10)
 mf 112,148,88,112
 tr 28,2,42336
 tr 30,2,42848
 mf 128,148,92,128
 mf 116,156,88,116
 tr 148,2,46464
 tr 150,2,46976
 mf 132,156,92,132
 s_waitcnt lgkmcnt(10)
 mf 120,164,88,120
 tr 156,2,46496
 tr 158,2,47008
 mf 136,164,92,136
 mf 124,172,88,124
 tr 164,2,46528
 tr 166,2,47040
 mf 140,172,92,140
 s_waitcnt lgkmcnt(10)
 mf 112,16,96,112
 tr 172,2,46560
 tr 174,2,47072
 mf 128,16,100,128
 mf 116,20,96,116
 mf 132,20,100,132
 s_waitcnt lgkmcnt(8)
 mf 120,24,96,120
 mf 136,24,100,136
 mf 124,28,96,124
 mf 140,28,100,140
 s_waitcnt lgkmcnt(0)
 s_barrier
 tr 16,2,50688
 tr 18,2,51200
 tr 20,2,50720
 tr 22,2,51232
 tr 24,2,50752
 tr 26,2,51264
 mf 112,148,104,112
 tr 28,2,50784
 tr 30,2,51296
 mf 128,148,108,128
 mf 116,156,104,116
 tr 148,2,54912
 tr 150,2,55424
 mf 132,156,108,132
 mf 120,164,104,120
 tr 156,2,54944
 tr 158,2,55456
 mf 136,164,108,136
 mf 124,172,104,124
 tr 164,2,54976
 tr 166,2,55488
 mf 140,172,108,140
 s_waitcnt lgkmcnt(10)
 mf 112,16,144,112
 tr 172,2,55008
 tr 174,2,55520
 mf 128,16,176,128
 mf 116,20,144,116
 tr 16,2,59136
 tr 18,2,59648
 mf 132,20,176,132
 s_waitcnt lgkmcnt(10)
 mf 120,24,144,120
 tr 20,2,59168
 tr 22,2,59680
 mf 136,24,176,136
 mf 124,28,144,124
 tr 24,2,59200
 tr 26,2,59712
 mf 140,28,176,140
 s_waitcnt lgkmcnt(10)
 mf 112,148,152,112
 tr 28,2,59232
 tr 30,2,59744
 mf 128,148,184,128
 mf 116,156,152,116
 tr 148,2,63360
 tr 150,2,63872
 mf 132,156,184,132
 s_waitcnt lgkmcnt(10)
 mf 120,164,152,120
 tr 156,2,63392
 tr 158,2,63904
 mf 136,164,184,136
 mf 124,172,152,124
 tr 164,2,63424
 tr 166,2,63936
 mf 140,172,184,140
 s_waitcnt lgkmcnt(10)
 mf 112,16,160,112
 tr 172,2,63456
 tr 174,2,63968
 mf 128,16,192,128
 mf 116,20,160,116
 mf 132,20,192,132
 s_waitcnt lgkmcnt(8)
 mf 120,24,160,120
 mf 136,24,192,136
 mf 124,28,160,124
 mf 140,28,192,140
 s_waitcnt lgkmcnt(0)
 s_barrier
 ds_read_b64_tr_b16 v[16:17],v2
 tr 18,2,512
 tr 20,2,32
 tr 22,2,544
 tr 24,2,64
 tr 26,2,576
 mf 112,148,168,112
 tr 28,2,96
 tr 30,2,608
 mf 128,148,200,128
 mf 116,156,168,116
 tr 148,2,4224
 tr 150,2,4736
 mf 132,156,200,132
 mf 120,164,168,120
 tr 156,2,4256
 tr 158,2,4768
 mf 136,164,200,136
 mf 124,172,168,124
 tr 164,2,4288
 tr 166,2,4800
 mf 140,172,200,140
 s_waitcnt lgkmcnt(10)
 mz 32,16,208
 tr 172,2,4320
 tr 174,2,4832
 mz 240,16,212
 cv 112,112,113
 cv 113,114,115
 mz 36,20,208
 tr 16,2,8448
 tr 18,2,8960
 cv 114,116,117
 cv 115,118,119
 mz 244,20,212
 ds_write_b128 v4,v[112:115]
 s_waitcnt lgkmcnt(11)
 mz 40,24,208
 tr 20,2,8480
 tr 22,2,8992
 cv 120,120,121
 cv 121,122,123
 mz 248,24,212
 cv 122,124,125
 cv 123,126,127
 mz 44,28,208
 tr 24,2,8512
 tr 26,2,9024
 ds_write_b128 v4,v[120:123] offset:7168
 mz 252,28,212
 cv 128,128,129
 cv 129,130,131
 s_waitcnt lgkmcnt(12)
 mf 32,148,216,32
 tr 28,2,8544
 tr 30,2,9056
 cv 130,132,133
 cv 131,134,135
 mf 240,148,220,240
 mf 36,156,216,36
 tr 148,2,12672
 tr 150,2,13184
 ds_write_b128 v5,v[128:131]
 mf 244,156,220,244
 cv 136,136,137
 s_waitcnt lgkmcnt(13)
 mf 40,164,216,40
 tr 156,2,12704
 tr 158,2,13216
 cv 137,138,139
 cv 138,140,141
 mf 248,164,220,248
 cv 139,142,143
 mf 44,172,216,44
 tr 164,2,12736
 tr 166,2,13248
 ds_write_b128 v5,v[136:139] offset:7168
 mf 252,172,220,252
 s_waitcnt lgkmcnt(13)
 mf 32,16,224,32
 tr 172,2,12768
 tr 174,2,13280
 mf 240,16,228,240
 mf 36,20,224,36
 mf 244,20,228,244
 s_waitcnt lgkmcnt(10)
 mf 40,24,224,40
 mf 248,24,228,248
 mf 44,28,224,44
 mf 252,28,228,252
 s_waitcnt lgkmcnt(0)
 s_barrier
 tr 16,2,16896
 tr 18,2,17408
 tr 20,2,16928
 tr 22,2,17440
 tr 24,2,16960
 tr 26,2,17472
 mf 32,148,232,32
 tr 28,2,16992
 tr 30,2,17504
 mf 240,148,236,240
 mf 36,156,232,36
 tr 148,2,21120
 tr 150,2,21632
 mf 244,156,236,244
 mf 40,164,232,40
 tr 156,2,21152
 tr 158,2,21664
 mf 248,164,236,248
 mf 44,172,232,44
 tr 164,2,21184
 tr 166,2,21696
 mf 252,172,236,252
 s_waitcnt lgkmcnt(10)
 mf 32,16,48,32
 tr 172,2,21216
 tr 174,2,21728
 mf 240,16,52,240
 mf 36,20,48,36
 tr 16,2,25344
 tr 18,2,25856
 mf 244,20,52,244
 s_waitcnt lgkmcnt(10)
 mf 40,24,48,40
 tr 20,2,25376
 tr 22,2,25888
 mf 248,24,52,248
 mf 44,28,48,44
 tr 24,2,25408
 tr 26,2,25920
 mf 252,28,52,252
 s_waitcnt lgkmcnt(10)
 mf 32,148,56,32
 tr 28,2,25440
 tr 30,2,25952
 mf 240,148,60,240
 mf 36,156,56,36
 tr 148,2,29568
 tr 150,2,30080
 mf 244,156,60,244
 s_waitcnt lgkmcnt(10)
 mf 40,164,56,40
 tr 156,2,29600
 tr 158,2,30112
 mf 248,164,60,248
 mf 44,172,56,44
 tr 164,2,29632
 tr 166,2,30144
 mf 252,172,60,252
 s_waitcnt lgkmcnt(10)
 mf 32,16,64,32
 tr 172,2,29664
 tr 174,2,30176
 mf 240,16,68,240
 mf 36,20,64,36
 mf 244,20,68,244
 s_waitcnt lgkmcnt(8)
 mf 40,24,64,40
 mf 248,24,68,248
 mf 44,28,64,44
 mf 252,28,68,252
 tr 16,2,33792
 tr 18,2,34304
 tr 20,2,33824
 tr 22,2,34336
 tr 24,2,33856
 tr 26,2,34368
 s_waitcnt lgkmcnt(10)
 mf 32,148,72,32
 tr 28,2,33888
 tr 30,2,34400
 mf 240,148,76,240
 mf 36,156,72,36
 tr 148,2,38016
 tr 150,2,38528
 mf 244,156,76,244
 s_waitcnt lgkmcnt(10)
 mf 40,164,72,40
 tr 156,2,38048
 tr 158,2,38560
 mf 248,164,76,248
 mf 44,172,72,44
 tr 164,2,38080
 tr 166,2,38592
 mf 252,172,76,252
 s_waitcnt lgkmcnt(10)
 mf 32,16,80,32
 tr 172,2,38112
 tr 174,2,38624
 mf 240,16,84,240
 mf 36,20,80,36
 tr 16,2,42240
 tr 18,2,42752
 mf 244,20,84,244
 s_waitcnt lgkmcnt(10)
 mf 40,24,80,40
 tr 20,2,42272
 tr 22,2,42784
 mf 248,24,84,248
 mf 44,28,80,44
 tr 24,2,42304
 tr 26,2,42816
 mf 252,28,84,252
 s_waitcnt lgkmcnt(10)
 mf 32,148,88,32
 tr 28,2,42336
 tr 30,2,42848
 mf 240,148,92,240
 mf 36,156,88,36
 tr 148,2,46464
 tr 150,2,46976
 mf 244,156,92,244
 s_waitcnt lgkmcnt(10)
 mf 40,164,88,40
 tr 156,2,46496
 tr 158,2,47008
 mf 248,164,92,248
 mf 44,172,88,44
 tr 164,2,46528
 tr 166,2,47040
 mf 252,172,92,252
 s_waitcnt lgkmcnt(10)
 mf 32,16,96,32
 tr 172,2,46560
 tr 174,2,47072
 mf 240,16,100,240
 mf 36,20,96,36
 mf 244,20,100,244
 s_waitcnt lgkmcnt(8)
 mf 40,24,96,40
 mf 248,24,100,248
 mf 44,28,96,44
 mf 252,28,100,252
 tr 16,2,50688
 tr 18,2,51200
 tr 20,2,50720
 tr 22,2,51232
 tr 24,2,50752
 tr 26,2,51264
 s_waitcnt lgkmcnt(10)
 mf 32,148,104,32
 tr 28,2,50784
 tr 30,2,51296
 mf 240,148,108,240
 mf 36,156,104,36
 tr 148,2,54912
 tr 150,2,55424
 mf 244,156,108,244
 s_waitcnt lgkmcnt(10)
 mf 40,164,104,40
 tr 156,2,54944
 tr 158,2,55456
 mf 248,164,108,248
 mf 44,172,104,44
 tr 164,2,54976
 tr 166,2,55488
 mf 252,172,108,252
 s_waitcnt lgkmcnt(10)
 mf 32,16,144,32
 tr 172,2,55008
 tr 174,2,55520
 mf 240,16,176,240
 mf 36,20,144,36
 tr 16,2,59136
 tr 18,2,59648
 mf 244,20,176,244
 s_waitcnt lgkmcnt(10)
 mf 40,24,144,40
 tr 20,2,59168
 tr 22,2,59680
 mf 248,24,176,248
 mf 44,28,144,44
 tr 24,2,59200
 tr 26,2,59712
 mf 252,28,176,252
 s_waitcnt lgkmcnt(10)
 mf 32,148,152,32
 tr 28,2,59232
 tr 30,2,59744
 mf 240,148,184,240
 mf 36,156,152,36
 tr 148,2,63360
 tr 150,2,63872
 mf 244,156,184,244
 s_waitcnt lgkmcnt(10)
 mf 40,164,152,40
 tr 156,2,63392
 tr 158,2,63904
 mf 248,164,184,248
 mf 44,172,152,44
 tr 164,2,63424
 tr 166,2,63936
 mf 252,172,184,252
 s_waitcnt lgkmcnt(10)
 mf 32,16,160,32
 tr 172,2,63456
 tr 174,2,63968
 mf 240,16,192,240
 mf 36,20,160,36
 mf 244,20,192,244
 s_waitcnt lgkmcnt(8)
 mf 40,24,160,40
 mf 248,24,192,248
 mf 44,28,160,44
 mf 252,28,192,252
 s_waitcnt lgkmcnt(4)
 mf 32,148,168,32
 mf 240,148,200,240
 mf 36,156,168,36
 mf 244,156,200,244
 s_waitcnt lgkmcnt(0)
 mf 40,164,168,40
 mf 248,164,200,248
 mf 44,172,168,44
 mf 252,172,200,252
 cv 32,32,33
 cv 33,34,35
 cv 34,36,37
 cv 35,38,39
 ds_write_b128 v4,v[32:35] offset:14336
 cv 40,40,41
 cv 41,42,43
 cv 42,44,45
 cv 43,46,47
 ds_write_b128 v4,v[40:43] offset:21504
 cv 240,240,241
 cv 241,242,243
 cv 242,244,245
 cv 243,246,247
 ds_write_b128 v5,v[240:243] offset:14336
 cv 248,248,249
 cv 249,250,251
 cv 250,252,253
 cv 251,254,255
 ds_write_b128 v5,v[248:251] offset:21504
 s_waitcnt lgkmcnt(0)
 s_barrier
 ds_read_b64_tr_b16 v[16:17],v8
 tr 18,8,512
 tr 20,8,32
 tr 22,8,544
 tr 24,8,64
 tr 26,8,576
 tr 28,8,96
 tr 30,8,608
 tr 148,8,4224
 tr 150,8,4736
 tr 156,8,4256
 tr 158,8,4768
 tr 164,8,4288
 tr 166,8,4800
 s_waitcnt lgkmcnt(10)
 mz 112,16,208
 tr 172,8,4320
 tr 174,8,4832
 mz 128,16,212
 mz 116,20,208
 tr 16,8,8448
 tr 18,8,8960
 mz 132,20,212
 s_waitcnt lgkmcnt(10)
 mz 120,24,208
 tr 20,8,8480
 tr 22,8,8992
 mz 136,24,212
 mz 124,28,208
 tr 24,8,8512
 tr 26,8,9024
 mz 140,28,212
 s_waitcnt lgkmcnt(10)
 mf 112,148,216,112
 tr 28,8,8544
 tr 30,8,9056
 mf 128,148,220,128
 mf 116,156,216,116
 tr 148,8,12672
 tr 150,8,13184
 mf 132,156,220,132
 s_waitcnt lgkmcnt(10)
 mf 120,164,216,120
 tr 156,8,12704
 tr 158,8,13216
 mf 136,164,220,136
 mf 124,172,216,124
 tr 164,8,12736
 tr 166,8,13248
 mf 140,172,220,140
 s_waitcnt lgkmcnt(10)
 mf 112,16,224,112
 tr 172,8,12768
 tr 174,8,13280
 mf 128,16,228,128
 mf 116,20,224,116
 mf 132,20,228,132
 s_waitcnt lgkmcnt(8)
 mf 120,24,224,120
 mf 136,24,228,136
 mf 124,28,224,124
 mf 140,28,228,140
 tr 16,8,16896
 tr 18,8,17408
 tr 20,8,16928
 tr 22,8,17440
 tr 24,8,16960
 tr 26,8,17472
 s_waitcnt lgkmcnt(10)
 mf 112,148,232,112
 tr 28,8,16992
 tr 30,8,17504
 mf 128,148,236,128
 mf 116,156,232,116
 tr 148,8,21120
 tr 150,8,21632
 mf 132,156,236,132
 s_waitcnt lgkmcnt(10)
 mf 120,164,232,120
 tr 156,8,21152
 tr 158,8,21664
 mf 136,164,236,136
 mf 124,172,232,124
 tr 164,8,21184
 tr 166,8,21696
 mf 140,172,236,140
 s_waitcnt lgkmcnt(10)
 mf 112,16,48,112
 tr 172,8,21216
 tr 174,8,21728
 mf 128,16,52,128
 mf 116,20,48,116
 tr 16,8,25344
 tr 18,8,25856
 mf 132,20,52,132
 s_waitcnt lgkmcnt(10)
 mf 120,24,48,120
 tr 20,8,25376
 tr 22,8,25888
 mf 136,24,52,136
 mf 124,28,48,124
 tr 24,8,25408
 tr 26,8,25920
 mf 140,28,52,140
 s_waitcnt lgkmcnt(10)
 mf 112,148,56,112
 tr 28,8,25440
 tr 30,8,25952
 mf 128,148,60,128
 mf 116,156,56,116
 tr 148,8,29568
 tr 150,8,30080
 mf 132,156,60,132
 s_waitcnt lgkmcnt(10)
 mf 120,164,56,120
 tr 156,8,29600
 tr 158,8,30112
 mf 136,164,60,136
 mf 124,172,56,124
 tr 164,8,29632
 tr 166,8,30144
 mf 140,172,60,140
 s_waitcnt lgkmcnt(10)
 mf 112,16,64,112
 tr 172,8,29664
 tr 174,8,30176
 mf 128,16,68,128
 mf 116,20,64,116
 mf 132,20,68,132
 s_waitcnt lgkmcnt(8)
 mf 120,24,64,120
 mf 136,24,68,136
 mf 124,28,64,124
 mf 140,28,68,140
 tr 16,8,33792
 tr 18,8,34304
 tr 20,8,33824
 tr 22,8,34336
 tr 24,8,33856
 tr 26,8,34368
 s_waitcnt lgkmcnt(10)
 mf 112,148,72,112
 tr 28,8,33888
 tr 30,8,34400
 mf 128,148,76,128
 mf 116,156,72,116
 tr 148,8,38016
 tr 150,8,38528
 mf 132,156,76,132
 s_waitcnt lgkmcnt(10)
 mf 120,164,72,120
 tr 156,8,38048
 tr 158,8,38560
 mf 136,164,76,136
 mf 124,172,72,124
 tr 164,8,38080
 tr 166,8,38592
 mf 140,172,76,140
 s_waitcnt lgkmcnt(10)
 mf 112,16,80,112
 tr 172,8,38112
 tr 174,8,38624
 mf 128,16,84,128
 mf 116,20,80,116
 tr 16,8,42240
 tr 18,8,42752
 mf 132,20,84,132
 s_waitcnt lgkmcnt(10)
 mf 120,24,80,120
 tr 20,8,42272
 tr 22,8,42784
 mf 136,24,84,136
 mf 124,28,80,124
 tr 24,8,42304
 tr 26,8,42816
 mf 140,28,84,140
 s_waitcnt lgkmcnt(10)
 mf 112,148,88,112
 tr 28,8,42336
 tr 30,8,42848
 mf 128,148,92,128
 mf 116,156,88,116
 tr 148,8,46464
 tr 150,8,46976
 mf 132,156,92,132
 s_waitcnt lgkmcnt(10)
 mf 120,164,88,120
 tr 156,8,46496
 tr 158,8,47008
 mf 136,164,92,136
 mf 124,172,88,124
 tr 164,8,46528
 tr 166,8,47040
 mf 140,172,92,140
 s_waitcnt lgkmcnt(10)
 mf 112,16,96,112
 tr 172,8,46560
 tr 174,8,47072
 mf 128,16,100,128
 mf 116,20,96,116
 mf 132,20,100,132
 s_waitcnt lgkmcnt(8)
 mf 120,24,96,120
 mf 136,24,100,136
 mf 124,28,96,124
 mf 140,28,100,140
 ds_read_b64_tr_b16 v[16:17],v2
 tr 18,2,512
 tr 20,2,32
 tr 22,2,544
 tr 24,2,64
 tr 26,2,576
 s_waitcnt lgkmcnt(10)
 mf 112,148,104,112
 tr 28,2,96
 tr 30,2,608
 mf 128,148,108,128
 mf 116,156,104,116
 tr 148,2,4224
 tr 150,2,4736
 mf 132,156,108,132
 s_waitcnt lgkmcnt(10)
 mf 120,164,104,120
 tr 156,2,4256
 tr 158,2,4768
 mf 136,164,108,136
 mf 124,172,104,124
 tr 164,2,4288
 tr 166,2,4800
 mf 140,172,108,140
 s_waitcnt lgkmcnt(10)
 mf 112,16,144,112
 tr 172,2,4320
 tr 174,2,4832
 mf 128,16,176,128
 mf 116,20,144,116
 tr 16,2,8448
 tr 18,2,8960
 mf 132,20,176,132
 s_waitcnt lgkmcnt(10)
 mf 120,24,144,120
 tr 20,2,8480
 tr 22,2,8992
 mf 136,24,176,136
 mf 124,28,144,124
 tr 24,2,8512
 tr 26,2,9024
 mf 140,28,176,140
 s_waitcnt lgkmcnt(10)
 mf 112,148,152,112
 tr 28,2,8544
 tr 30,2,9056
 mf 128,148,184,128
 mf 116,156,152,116
 tr 148,2,12672
 tr 150,2,13184
 mf 132,156,184,132
 s_waitcnt lgkmcnt(10)
 mf 120,164,152,120
 tr 156,2,12704
 tr 158,2,13216
 mf 136,164,184,136
 mf 124,172,152,124
 tr 164,2,12736
 tr 166,2,13248
 mf 140,172,184,140
 s_waitcnt lgkmcnt(10)
 mf 112,16,160,112
 tr 172,2,12768
 tr 174,2,13280
 mf 128,16,192,128
 mf 116,20,160,116
 mf 132,20,192,132
 s_waitcnt lgkmcnt(8)
 mf 120,24,160,120
 mf 136,24,192,136
 mf 124,28,160,124
 mf 140,28,192,140
 s_waitcnt lgkmcnt(4)
 mf 112,148,168,112
 mf 128,148,200,128
 mf 116,156,168,116
 mf 132,156,200,132
 s_waitcnt lgkmcnt(0)
 mf 120,164,168,120
 mf 136,164,200,136
 mf 124,172,168,124
 mf 140,172,200,140
 cv 112,112,113
 cv 113,114,115
 cv 114,116,117
 cv 115,118,119
 ds_write_b128 v4,v[112:115]
 cv 120,120,121
 cv 121,122,123
 cv 122,124,125
 cv 123,126,127
 ds_write_b128 v4,v[120:123] offset:7168
 cv 128,128,129
 cv 129,130,131
 cv 130,132,133
 cv 131,134,135
 ds_write_b128 v5,v[128:131]
 cv 136,136,137
 cv 137,138,139
 cv 138,140,141
 cv 139,142,143
 ds_write_b128 v5,v[136:139] offset:7168
 s_waitcnt lgkmcnt(0)
 s_barrier
 s_endpgm
L_attn_s:
 s_and_b32 s40,s33,1
 s_mul_i32 s40,s40,4096
 s_lshr_b32 s46,s33,1
 s_mul_i32 s46,s46,8192
 s_add_u32 s40,s40,s46
 v_add_u32 v14,s40,v14
 s_waitcnt vmcnt(4)
 s_barrier
 s_xor_b32 s40,s52,256
 s_add_u32 m0,s42,135168
 s_nop 0
 buffer_load_dwordx4 v20,s[24:27],s40 offen lds
 buffer_load_dwordx4 v21,s[24:27],s40 offen offset:1024 lds
 buffer_load_dwordx4 v22,s[24:27],s40 offen offset:2048 lds
 buffer_load_dwordx4 v23,s[24:27],s40 offen offset:3072 lds
 s_xor_b32 s46,s53,1048576
 s_add_u32 s46,s46,s44
 s_add_u32 m0,s41,101376
 s_add_u32 s40,s46,0
 buffer_load_dwordx4 v2,s[16:19],s40 offen lds
 s_add_u32 m0,s41,102432
 s_add_u32 s40,s46,16384
 buffer_load_dwordx4 v2,s[16:19],s40 offen lds
 s_add_u32 m0,s41,103488
 s_add_u32 s40,s46,65536
 buffer_load_dwordx4 v2,s[16:19],s40 offen lds
 s_add_u32 m0,s41,104544
 s_add_u32 s40,s46,81920
 buffer_load_dwordx4 v2,s[16:19],s40 offen lds
 s_waitcnt vmcnt(8)
 s_barrier
 s_xor_b32 s46,s53,1048576
 s_add_u32 s46,s46,s44
 s_add_u32 m0,s41,118272
 s_add_u32 s40,s46,128
 buffer_load_dwordx4 v2,s[16:19],s40 offen lds
 s_add_u32 m0,s41,119328
 s_add_u32 s40,s46,16512
 buffer_load_dwordx4 v2,s[16:19],s40 offen lds
 s_add_u32 m0,s41,120384
 s_add_u32 s40,s46,65664
 buffer_load_dwordx4 v2,s[16:19],s40 offen lds
 s_add_u32 m0,s41,121440
 s_add_u32 s40,s46,82048
 buffer_load_dwordx4 v2,s[16:19],s40 offen lds
 s_xor_b32 s46,s53,2097152
 s_add_u32 s46,s46,s44
 s_add_u32 m0,s41,67584
 s_add_u32 s40,s46,0
 buffer_load_dwordx4 v2,s[16:19],s40 offen lds
 s_add_u32 m0,s41,68640
 s_add_u32 s40,s46,16384
 buffer_load_dwordx4 v2,s[16:19],s40 offen lds
 s_add_u32 m0,s41,69696
 s_add_u32 s40,s46,65536
 buffer_load_dwordx4 v2,s[16:19],s40 offen lds
 s_add_u32 m0,s41,70752
 s_add_u32 s40,s46,81920
 buffer_load_dwordx4 v2,s[16:19],s40 offen lds
 s_waitcnt vmcnt(8)
 s_barrier
 s_xor_b32 s40,s52,512
 s_add_u32 m0,s42,33792
 s_nop 0
 buffer_load_dwordx4 v20,s[24:27],s40 offen lds
 buffer_load_dwordx4 v21,s[24:27],s40 offen offset:1024 lds
 buffer_load_dwordx4 v22,s[24:27],s40 offen offset:2048 lds
 buffer_load_dwordx4 v23,s[24:27],s40 offen offset:3072 lds
 s_xor_b32 s46,s53,3145728
 s_add_u32 s46,s46,s44
 s_add_u32 m0,s41,84480
 s_add_u32 s40,s46,0
 buffer_load_dwordx4 v2,s[16:19],s40 offen lds
 s_add_u32 m0,s41,85536
 s_add_u32 s40,s46,16384
 buffer_load_dwordx4 v2,s[16:19],s40 offen lds
 s_add_u32 m0,s41,86592
 s_add_u32 s40,s46,65536
 buffer_load_dwordx4 v2,s[16:19],s40 offen lds
 s_add_u32 m0,s41,87648
 s_add_u32 s40,s46,81920
 buffer_load_dwordx4 v2,s[16:19],s40 offen lds
 s_waitcnt vmcnt(12)
 s_barrier
 s_xor_b32 s40,s52,768
 s_add_u32 m0,s42,135168
 s_nop 0
 buffer_load_dwordx4 v20,s[24:27],s40 offen lds
 buffer_load_dwordx4 v21,s[24:27],s40 offen offset:1024 lds
 buffer_load_dwordx4 v22,s[24:27],s40 offen offset:2048 lds
 buffer_load_dwordx4 v23,s[24:27],s40 offen offset:3072 lds
 s_xor_b32 s46,s53,2097152
 s_add_u32 s46,s46,s44
 s_add_u32 m0,s41,101376
 s_add_u32 s40,s46,128
 buffer_load_dwordx4 v2,s[16:19],s40 offen lds
 s_add_u32 m0,s41,102432
 s_add_u32 s40,s46,16512
 buffer_load_dwordx4 v2,s[16:19],s40 offen lds
 s_add_u32 m0,s41,103488
 s_add_u32 s40,s46,65664
 buffer_load_dwordx4 v2,s[16:19],s40 offen lds
 s_add_u32 m0,s41,104544
 s_add_u32 s40,s46,82048
 buffer_load_dwordx4 v2,s[16:19],s40 offen lds
 s_mov_b32 s40,0
 s_add_u32 m0,s41,16896
 s_nop 0
 buffer_load_dwordx4 v14,s[8:11],s40 offen nt lds
 s_mov_b32 s40,1024
 s_add_u32 m0,s41,17952
 s_nop 0
 buffer_load_dwordx4 v14,s[8:11],s40 offen nt lds
 s_mov_b32 s40,2048
 s_add_u32 m0,s41,19008
 s_nop 0
 buffer_load_dwordx4 v14,s[8:11],s40 offen nt lds
 s_mov_b32 s40,3072
 s_add_u32 m0,s41,20064
 s_nop 0
 buffer_load_dwordx4 v14,s[8:11],s40 offen nt lds
 s_waitcnt vmcnt(16)
 s_barrier
 s_xor_b32 s46,s53,3145728
 s_add_u32 s46,s46,s44
 s_add_u32 m0,s41,118272
 s_add_u32 s40,s46,128
 buffer_load_dwordx4 v2,s[16:19],s40 offen lds
 s_add_u32 m0,s41,119328
 s_add_u32 s40,s46,16512
 buffer_load_dwordx4 v2,s[16:19],s40 offen lds
 s_add_u32 m0,s41,120384
 s_add_u32 s40,s46,65664
 buffer_load_dwordx4 v2,s[16:19],s40 offen lds
 s_add_u32 m0,s41,121440
 s_add_u32 s40,s46,82048
 buffer_load_dwordx4 v2,s[16:19],s40 offen lds
 s_waitcnt vmcnt(12)
 s_barrier
 v_lshlrev_b32 v10,2,v0
 v_mov_b32 v11,0x40000000
 v_cmp_gt_u32 vcc,32,v0
 s_nop 1
 v_cndmask_b32 v10,v11,v10,vcc
 v_mov_b32 v12,0
 s_lshl_b32 s40,s37,7
 buffer_store_dword v12,v10,s[96:99],s40 offen sc1
 v_mov_b32 v240,0
 v_mov_b32 v241,0
 v_mov_b32 v242,0
 v_mov_b32 v243,0
 v_mov_b32 v244,0
 v_mov_b32 v245,0
 v_mov_b32 v246,0
 v_mov_b32 v247,0
 s_waitcnt vmcnt(9)
 s_barrier
 s_mov_b32 s40,16384
 s_add_u32 m0,s41,0
 s_nop 0
 buffer_load_dwordx4 v14,s[8:11],s40 offen nt lds
 s_mov_b32 s40,17408
 s_add_u32 m0,s41,1056
 s_nop 0
 buffer_load_dwordx4 v14,s[8:11],s40 offen nt lds
 s_mov_b32 s40,18432
 s_add_u32 m0,s41,2112
 s_nop 0
 buffer_load_dwordx4 v14,s[8:11],s40 offen nt lds
 s_mov_b32 s40,19456
 s_add_u32 m0,s41,3168
 s_nop 0
 buffer_load_dwordx4 v14,s[8:11],s40 offen nt lds
 v_and_b32 v10,15,v1
 v_mul_u32_u24 v2,1056,v10
 v_and_b32 v10,48,v1
 v_add_u32 v2,v2,v10
 v_lshrrev_b32 v10,2,v1
 v_mul_u32_u24 v3,1056,v10
 v_and_b32 v10,3,v1
 v_lshl_add_u32 v3,v10,3,v3
 v_cmp_eq_u32 vcc,0,v10
 v_mov_b32 v11,0x3f803f80
 s_nop 0
 v_cndmask_b32 v6,0,v11,vcc
 v_cndmask_b32 v7,0,v11,vcc
 v_cndmask_b32 v8,0,v11,vcc
 v_cndmask_b32 v9,0,v11,vcc
 v_and_b32 v4,15,v1
 s_lshl_b32 s40,s33,5
 v_add_lshl_u32 v4,v4,s40,4
 v_lshrrev_b32 v10,4,v1
 v_mul_u32_u24 v10,1792,v10
 v_add_u32 v4,v4,v10
 v_add_u32 v4,135168,v4
 s_mov_b32 s40,256
 s_cmp_eq_u32 s33,3
 s_cselect_b32 s40,65536,s40
 v_add_u32 v5,s40,v4
 s_waitcnt vmcnt(5)
 s_barrier
 v_mov_b32 v10,16880
 v_mov_b32 v11,0
 ds_write_b32 v10,v11
 s_setprio 1
 s_waitcnt vmcnt(4)
 s_waitcnt lgkmcnt(0)
 s_barrier
 ds_read_b128 v[48:51],v4
 ds_read_b128 v[56:59],v4 offset:7168
 ds_read_b128 v[64:67],v4 offset:14336
 ds_read_b128 v[72:75],v4 offset:21504
 v_mov_b32 v11,0x40000000
 v_cmp_eq_u32 vcc,0,v0
 s_nop 1
 v_cndmask_b32 v12,v11,v0,vcc
 v_mov_b32 v11,1
 s_lshl_b32 s40,s54,2
 buffer_atomic_add v11,v12,s[64:67],s40 offen sc1
 ds_read_b128 v[16:19],v2 offset:16896
 ds_read_b128 v[20:23],v2 offset:16960
 ds_read_b128 v[24:27],v2 offset:17024
 ds_read_b128 v[28:31],v2 offset:17088
 ds_read_b128 v[32:35],v2 offset:17152
 ds_read_b128 v[36:39],v2 offset:17216
 ds_read_b128 v[40:43],v2 offset:17280
 s_waitcnt lgkmcnt(5)
 mz 80,16,48
 ds_read_b128 v[44:47],v2 offset:17344
 mf 80,20,56,80
 ds_read_b128 v[16:19],v2 offset:17408
 s_waitcnt lgkmcnt(5)
 mf 80,24,64,80
 ds_read_b128 v[20:23],v2 offset:17472
 mf 80,28,72,80
 ds_read_b128 v[24:27],v2 offset:17536
 s_waitcnt lgkmcnt(5)
 mz 84,32,48
 ds_read_b128 v[28:31],v2 offset:17600
 mf 84,36,56,84
 ds_read_b128 v[32:35],v2 offset:17664
 s_waitcnt lgkmcnt(5)
 mf 84,40,64,84
 ds_read_b128 v[36:39],v2 offset:17728
 mf 84,44,72,84
 ds_read_b128 v[40:43],v2 offset:17792
 s_waitcnt lgkmcnt(5)
 mz 88,16,48
 ds_read_b128 v[44:47],v2 offset:17856
 mf 88,20,56,88
 s_waitcnt lgkmcnt(4)
 mf 88,24,64,88
 mf 88,28,72,88
 s_waitcnt lgkmcnt(2)
 mz 92,32,48
 mf 92,36,56,92
 s_waitcnt lgkmcnt(0)
 mf 92,40,64,92
 mf 92,44,72,92
 s_waitcnt vmcnt(1)
 s_mov_b32 s39,0
 s_barrier
 ds_read_b128 v[16:19],v2
 ds_read_b128 v[20:23],v2 offset:64
 ds_read_b128 v[24:27],v2 offset:128
 ds_read_b128 v[28:31],v2 offset:192
 ds_read_b128 v[32:35],v2 offset:256
 ds_read_b128 v[36:39],v2 offset:320
 ds_read_b128 v[40:43],v2 offset:384
 s_waitcnt lgkmcnt(5)
 mz 112,16,48
 ds_read_b128 v[44:47],v2 offset:448
 v_exp_f32 v80,v80
 mf 112,20,56,112
 ds_read_b128 v[16:19],v2 offset:512
 v_exp_f32 v81,v81
 s_waitcnt lgkmcnt(5)
 mf 112,24,64,112
 ds_read_b128 v[20:23],v2 offset:576
 v_exp_f32 v82,v82
 mf 112,28,72,112
 ds_read_b128 v[24:27],v2 offset:640
 v_exp_f32 v83,v83
 s_waitcnt lgkmcnt(5)
 mz 116,32,48
 ds_read_b128 v[28:31],v2 offset:704
 v_exp_f32 v84,v84
 mf 116,36,56,116
 ds_read_b128 v[32:35],v2 offset:768
 v_exp_f32 v85,v85
 s_waitcnt lgkmcnt(5)
 mf 116,40,64,116
 ds_read_b128 v[36:39],v2 offset:832
 v_exp_f32 v86,v86
 mf 116,44,72,116
 ds_read_b128 v[40:43],v2 offset:896
 v_exp_f32 v87,v87
 s_waitcnt lgkmcnt(5)
 mz 120,16,48
 ds_read_b128 v[44:47],v2 offset:960
 cv 80,80,81
 mf 120,20,56,120
 cv 81,82,83
 s_waitcnt lgkmcnt(4)
 mf 120,24,64,120
 cv 82,84,85
 mf 120,28,72,120
 cv 83,86,87
 s_waitcnt lgkmcnt(0)
 s_branch L_aloop1_s
L_aloop_s:
 s_barrier
 ds_read_b128 v[16:19],v2
 ds_read_b128 v[20:23],v2 offset:64
 ds_read_b128 v[24:27],v2 offset:128
 mf 160,32,120,160
 ds_read_b128 v[28:31],v2 offset:192
 v_exp_f32 v80,v80
 v_exp_f32 v81,v81
 v_exp_f32 v82,v82
 mf 164,36,120,164
 ds_read_b128 v[32:35],v2 offset:256
 v_exp_f32 v83,v83
 v_exp_f32 v84,v84
 v_exp_f32 v85,v85
 mf 168,40,120,168
 ds_read_b128 v[36:39],v2 offset:320
 v_exp_f32 v86,v86
 v_exp_f32 v87,v87
 cv 80,80,81
 mf 172,44,120,172
 ds_read_b128 v[40:43],v2 offset:384
 cv 81,82,83
 cv 82,84,85
 cv 83,86,87
 v_rcp_f32 v10,v248
 s_waitcnt lgkmcnt(5)
 mz 112,16,48
 ds_read_b128 v[44:47],v2 offset:448
 v_max_f32 v11,v10,v248
 v_cmp_nge_f32 vcc,s101,v11
 s_nop 0
 s_or_b64 s[94:95],s[94:95],vcc
 v_mul_f32 v144,v10,v144
 v_mul_f32 v145,v10,v145
 v_mul_f32 v146,v10,v146
 mf 112,20,56,112
 ds_read_b128 v[16:19],v2 offset:512
 v_mul_f32 v147,v10,v147
 v_mul_f32 v148,v10,v148
 v_mul_f32 v149,v10,v149
 v_mul_f32 v150,v10,v150
 v_mul_f32 v151,v10,v151
 s_waitcnt lgkmcnt(5)
 mf 112,24,64,112
 ds_read_b128 v[20:23],v2 offset:576
 cv 144,144,145
 cv 145,146,147
 cv 146,148,149
 cv 147,150,151
 mf 112,28,72,112
 ds_read_b128 v[24:27],v2 offset:640
 ds_write_b128 v4,v[144:147]
 v_mul_f32 v152,v10,v152
 v_mul_f32 v153,v10,v153
 s_waitcnt lgkmcnt(6)
 mz 116,32,48
 ds_read_b128 v[28:31],v2 offset:704
 v_mul_f32 v154,v10,v154
 v_mul_f32 v155,v10,v155
 v_mul_f32 v156,v10,v156
 v_mul_f32 v157,v10,v157
 v_mul_f32 v158,v10,v158
 mf 116,36,56,116
 ds_read_b128 v[32:35],v2 offset:768
 v_mul_f32 v159,v10,v159
 cv 152,152,153
 cv 153,154,155
 cv 154,156,157
 cv 155,158,159
 s_waitcnt lgkmcnt(6)
 mf 116,40,64,116
 ds_read_b128 v[36:39],v2 offset:832
 ds_write_b128 v4,v[152:155] offset:7168
 v_mul_f32 v160,v10,v160
 v_mul_f32 v161,v10,v161
 v_mul_f32 v162,v10,v162
 mf 116,44,72,116
 ds_read_b128 v[40:43],v2 offset:896
 v_mul_f32 v163,v10,v163
 v_mul_f32 v164,v10,v164
 v_mul_f32 v165,v10,v165
 v_mul_f32 v166,v10,v166
 v_mul_f32 v167,v10,v167
 s_waitcnt lgkmcnt(7)
 mz 120,16,48
 ds_read_b128 v[44:47],v2 offset:960
 cv 160,160,161
 cv 161,162,163
 cv 162,164,165
 cv 163,166,167
 ds_write_b128 v4,v[160:163] offset:14336
 mf 120,20,56,120
 v_mul_f32 v168,v10,v168
 v_mul_f32 v169,v10,v169
 v_mul_f32 v170,v10,v170
 v_mul_f32 v171,v10,v171
 v_mul_f32 v172,v10,v172
 s_waitcnt lgkmcnt(6)
 mf 120,24,64,120
 v_mul_f32 v173,v10,v173
 v_mul_f32 v174,v10,v174
 v_mul_f32 v175,v10,v175
 cv 168,168,169
 cv 169,170,171
 mf 120,28,72,120
 cv 170,172,173
 cv 171,174,175
 ds_write_b128 v4,v[168:171] offset:21504
 s_waitcnt lgkmcnt(0)
L_aloop1_s:
 s_barrier
 tr 16,3,33792
 tr 18,3,34048
 tr 20,3,33824
 tr 22,3,34080
 tr 24,3,33856
 tr 26,3,34112
 mz 124,32,48
 tr 28,3,33888
 tr 30,3,34144
 v_exp_f32 v88,v88
 mf 124,36,56,124
 tr 32,3,33920
 tr 34,3,34176
 v_exp_f32 v89,v89
 mf 124,40,64,124
 tr 36,3,33952
 tr 38,3,34208
 v_exp_f32 v90,v90
 mf 124,44,72,124
 tr 40,3,33984
 tr 42,3,34240
 v_exp_f32 v91,v91
 s_waitcnt lgkmcnt(10)
 mz 144,16,80
 tr 44,3,34016
 tr 46,3,34272
 v_exp_f32 v92,v92
 mz 248,6,80
 v_exp_f32 v93,v93
 mz 148,20,80
 tr 16,3,34304
 tr 18,3,34560
 v_exp_f32 v94,v94
 s_waitcnt lgkmcnt(10)
 mz 152,24,80
 tr 20,3,34336
 tr 22,3,34592
 v_exp_f32 v95,v95
 mz 156,28,80
 tr 24,3,34368
 tr 26,3,34624
 cv 88,88,89
 s_waitcnt lgkmcnt(10)
 mz 160,32,80
 tr 28,3,34400
 tr 30,3,34656
 cv 89,90,91
 mz 164,36,80
 tr 32,3,34432
 tr 34,3,34688
 cv 90,92,93
 s_waitcnt lgkmcnt(10)
 mz 168,40,80
 tr 36,3,34464
 tr 38,3,34720
 cv 91,94,95
 mz 172,44,80
 tr 40,3,34496
 tr 42,3,34752
 s_waitcnt lgkmcnt(10)
 mf 144,16,88,144
 tr 44,3,34528
 tr 46,3,34784
 mf 248,6,88,248
 mf 148,20,88,148
 s_waitcnt lgkmcnt(8)
 mf 152,24,88,152
 mf 156,28,88,156
 s_cmp_lg_u32 s39,1
 s_waitcnt lgkmcnt(0)
 s_cbranch_scc1 L_nokeep_s
 ds_read_b128 v[208:211],v4
 ds_read_b128 v[216:219],v4 offset:7168
 ds_read_b128 v[224:227],v4 offset:14336
 ds_read_b128 v[232:235],v4 offset:21504
 s_waitcnt lgkmcnt(0)
L_nokeep_s:
 s_barrier
 ds_read_b128 v[16:19],v2 offset:16896
 ds_read_b128 v[20:23],v2 offset:16960
 ds_read_b128 v[24:27],v2 offset:17024
 mf 160,32,88,160
 ds_read_b128 v[28:31],v2 offset:17088
 v_exp_f32 v112,v112
 mf 164,36,88,164
 ds_read_b128 v[32:35],v2 offset:17152
 v_exp_f32 v113,v113
 mf 168,40,88,168
 ds_read_b128 v[36:39],v2 offset:17216
 v_exp_f32 v114,v114
 mf 172,44,88,172
 ds_read_b128 v[40:43],v2 offset:17280
 v_exp_f32 v115,v115
 s_waitcnt lgkmcnt(5)
 mz 80,16,48
 ds_read_b128 v[44:47],v2 offset:17344
 v_exp_f32 v116,v116
 mf 80,20,56,80
 ds_read_b128 v[16:19],v2 offset:17408
 v_exp_f32 v117,v117
 s_waitcnt lgkmcnt(5)
 mf 80,24,64,80
 ds_read_b128 v[20:23],v2 offset:17472
 v_exp_f32 v118,v118
 mf 80,28,72,80
 ds_read_b128 v[24:27],v2 offset:17536
 v_exp_f32 v119,v119
 cv 112,112,113
 s_waitcnt lgkmcnt(5)
 mz 84,32,48
 ds_read_b128 v[28:31],v2 offset:17600
 cv 113,114,115
 cv 114,116,117
 cv 115,118,119
 mf 84,36,56,84
 ds_read_b128 v[32:35],v2 offset:17664
 v_exp_f32 v120,v120
 s_waitcnt lgkmcnt(5)
 mf 84,40,64,84
 ds_read_b128 v[36:39],v2 offset:17728
 v_exp_f32 v121,v121
 v_exp_f32 v122,v122
 mf 84,44,72,84
 ds_read_b128 v[40:43],v2 offset:17792
 v_exp_f32 v123,v123
 s_waitcnt lgkmcnt(5)
 mz 88,16,48
 ds_read_b128 v[44:47],v2 offset:17856
 v_exp_f32 v124,v124
 v_exp_f32 v125,v125
 mf 88,20,56,88
 v_exp_f32 v126,v126
 s_waitcnt lgkmcnt(4)
 mf 88,24,64,88
 v_exp_f32 v127,v127
 cv 120,120,121
 mf 88,28,72,88
 cv 121,122,123
 cv 122,124,125
 cv 123,126,127
 s_waitcnt lgkmcnt(0)
 s_barrier
 tr 16,3,50688
 tr 18,3,50944
 tr 20,3,50720
 tr 22,3,50976
 tr 24,3,50752
 tr 26,3,51008
 mz 92,32,48
 tr 28,3,50784
 tr 30,3,51040
 mf 92,36,56,92
 tr 32,3,50816
 tr 34,3,51072
 mf 92,40,64,92
 tr 36,3,50848
 tr 38,3,51104
 mf 92,44,72,92
 tr 40,3,50880
 tr 42,3,51136
 s_waitcnt lgkmcnt(10)
 mf 144,16,112,144
 tr 44,3,50912
 tr 46,3,51168
 mf 248,6,112,248
 v_mbcnt_lo_u32_b32 v1,-1,0
 mf 148,20,112,148
 tr 16,3,51200
 tr 18,3,51456
 v_mbcnt_hi_u32_b32 v1,-1,v1
 s_add_u32 s47,s36,s39
 s_waitcnt lgkmcnt(10)
 mf 152,24,112,152
 tr 20,3,51232
 tr 22,3,51488
 v_lshrrev_b32 v0,2,v1
 mf 156,28,112,156
 tr 24,3,51264
 tr 26,3,51520
 v_lshlrev_b32 v0,13,v0
 s_waitcnt lgkmcnt(10)
 mf 160,32,112,160
 tr 28,3,51296
 tr 30,3,51552
 v_and_b32 v1,3,v1
 mf 164,36,112,164
 tr 32,3,51328
 tr 34,3,51584
 v_lshl_add_u32 v0,v1,6,v0
 s_lshl_b32 s46,s35,18
 s_lshl_b32 s47,s47,8
 s_add_u32 s46,s46,s47
 s_add_u32 s46,s46,512
 s_cmp_lt_u32 s39,2
 s_cselect_b32 s46,s46,0
 s_waitcnt lgkmcnt(10)
 mf 168,40,112,168
 tr 36,3,51360
 tr 38,3,51616
 mf 172,44,112,172
 tr 40,3,51392
 tr 42,3,51648
 s_waitcnt lgkmcnt(10)
 mf 144,16,120,144
 tr 44,3,51424
 tr 46,3,51680
 mf 248,6,120,248
 buffer_load_dword v176,v0,s[16:19],s46 offen
 mf 148,20,120,148
 s_add_u32 s46,s46,131072
 s_waitcnt lgkmcnt(8)
 mf 152,24,120,152
 buffer_load_dword v177,v0,s[16:19],s46 offen
 mf 156,28,120,156
 s_waitcnt lgkmcnt(0)
 s_barrier
 ds_read_b128 v[16:19],v2
 ds_read_b128 v[20:23],v2 offset:64
 ds_read_b128 v[24:27],v2 offset:128
 mf 160,32,120,160
 ds_read_b128 v[28:31],v2 offset:192
 v_exp_f32 v80,v80
 mf 164,36,120,164
 ds_read_b128 v[32:35],v2 offset:256
 v_exp_f32 v81,v81
 mf 168,40,120,168
 ds_read_b128 v[36:39],v2 offset:320
 v_exp_f32 v82,v82
 mf 172,44,120,172
 ds_read_b128 v[40:43],v2 offset:384
 v_exp_f32 v83,v83
 s_waitcnt lgkmcnt(5)
 mz 112,16,48
 ds_read_b128 v[44:47],v2 offset:448
 v_exp_f32 v84,v84
 mf 112,20,56,112
 ds_read_b128 v[16:19],v2 offset:512
 v_exp_f32 v85,v85
 s_waitcnt lgkmcnt(5)
 mf 112,24,64,112
 ds_read_b128 v[20:23],v2 offset:576
 v_exp_f32 v86,v86
 mf 112,28,72,112
 ds_read_b128 v[24:27],v2 offset:640
 v_exp_f32 v87,v87
 cv 80,80,81
 s_waitcnt lgkmcnt(5)
 mz 116,32,48
 ds_read_b128 v[28:31],v2 offset:704
 cv 81,82,83
 cv 82,84,85
 cv 83,86,87
 mf 116,36,56,116
 ds_read_b128 v[32:35],v2 offset:768
 v_exp_f32 v88,v88
 s_waitcnt lgkmcnt(5)
 mf 116,40,64,116
 ds_read_b128 v[36:39],v2 offset:832
 v_exp_f32 v89,v89
 v_exp_f32 v90,v90
 mf 116,44,72,116
 ds_read_b128 v[40:43],v2 offset:896
 v_exp_f32 v91,v91
 s_waitcnt lgkmcnt(5)
 mz 120,16,48
 ds_read_b128 v[44:47],v2 offset:960
 v_exp_f32 v92,v92
 v_exp_f32 v93,v93
 mf 120,20,56,120
 v_exp_f32 v94,v94
 s_waitcnt lgkmcnt(4)
 mf 120,24,64,120
 v_exp_f32 v95,v95
 cv 88,88,89
 mf 120,28,72,120
 cv 89,90,91
 cv 90,92,93
 cv 91,94,95
 s_waitcnt lgkmcnt(0)
 s_barrier
 tr 16,3,33792
 tr 18,3,34048
 tr 20,3,33824
 tr 22,3,34080
 tr 24,3,33856
 tr 26,3,34112
 mz 124,32,48
 tr 28,3,33888
 tr 30,3,34144
 mf 124,36,56,124
 tr 32,3,33920
 tr 34,3,34176
 mf 124,40,64,124
 tr 36,3,33952
 tr 38,3,34208
 mf 124,44,72,124
 tr 40,3,33984
 tr 42,3,34240
 s_waitcnt lgkmcnt(10)
 mf 144,16,80,144
 tr 44,3,34016
 tr 46,3,34272
 mf 248,6,80,248
 mf 148,20,80,148
 tr 16,3,34304
 tr 18,3,34560
 s_waitcnt lgkmcnt(10)
 mf 152,24,80,152
 tr 20,3,34336
 tr 22,3,34592
 mf 156,28,80,156
 tr 24,3,34368
 tr 26,3,34624
 s_waitcnt lgkmcnt(10)
 mf 160,32,80,160
 tr 28,3,34400
 tr 30,3,34656
 mf 164,36,80,164
 tr 32,3,34432
 tr 34,3,34688
 s_waitcnt lgkmcnt(10)
 mf 168,40,80,168
 tr 36,3,34464
 tr 38,3,34720
 mf 172,44,80,172
 tr 40,3,34496
 tr 42,3,34752
 s_waitcnt lgkmcnt(10)
 mf 144,16,88,144
 tr 44,3,34528
 tr 46,3,34784
 mf 248,6,88,248
 mf 148,20,88,148
 s_waitcnt lgkmcnt(8)
 mf 152,24,88,152
 mf 156,28,88,156
 s_waitcnt lgkmcnt(0)
 s_barrier
 ds_read_b128 v[16:19],v2 offset:16896
 ds_read_b128 v[20:23],v2 offset:16960
 ds_read_b128 v[24:27],v2 offset:17024
 mf 160,32,88,160
 ds_read_b128 v[28:31],v2 offset:17088
 v_exp_f32 v112,v112
 mf 164,36,88,164
 ds_read_b128 v[32:35],v2 offset:17152
 v_exp_f32 v113,v113
 mf 168,40,88,168
 ds_read_b128 v[36:39],v2 offset:17216
 v_exp_f32 v114,v114
 mf 172,44,88,172
 ds_read_b128 v[40:43],v2 offset:17280
 v_exp_f32 v115,v115
 s_waitcnt lgkmcnt(5)
 mz 80,16,48
 ds_read_b128 v[44:47],v2 offset:17344
 v_exp_f32 v116,v116
 mf 80,20,56,80
 ds_read_b128 v[16:19],v2 offset:17408
 v_exp_f32 v117,v117
 s_waitcnt lgkmcnt(5)
 mf 80,24,64,80
 ds_read_b128 v[20:23],v2 offset:17472
 v_exp_f32 v118,v118
 mf 80,28,72,80
 ds_read_b128 v[24:27],v2 offset:17536
 v_exp_f32 v119,v119
 cv 112,112,113
 s_waitcnt lgkmcnt(5)
 mz 84,32,48
 ds_read_b128 v[28:31],v2 offset:17600
 cv 113,114,115
 cv 114,116,117
 cv 115,118,119
 mf 84,36,56,84
 ds_read_b128 v[32:35],v2 offset:17664
 v_exp_f32 v120,v120
 s_waitcnt lgkmcnt(5)
 mf 84,40,64,84
 ds_read_b128 v[36:39],v2 offset:17728
 v_exp_f32 v121,v121
 v_exp_f32 v122,v122
 mf 84,44,72,84
 ds_read_b128 v[40:43],v2 offset:17792
 v_exp_f32 v123,v123
 s_waitcnt lgkmcnt(5)
 mz 88,16,48
 ds_read_b128 v[44:47],v2 offset:17856
 v_exp_f32 v124,v124
 v_exp_f32 v125,v125
 mf 88,20,56,88
 v_exp_f32 v126,v126
 s_waitcnt lgkmcnt(4)
 mf 88,24,64,88
 v_exp_f32 v127,v127
 cv 120,120,121
 mf 88,28,72,88
 cv 121,122,123
 cv 122,124,125
 cv 123,126,127
 s_waitcnt lgkmcnt(0)
 s_barrier
 tr 16,3,50688
 tr 18,3,50944
 tr 20,3,50720
 tr 22,3,50976
 tr 24,3,50752
 tr 26,3,51008
 mz 92,32,48
 tr 28,3,50784
 tr 30,3,51040
 mf 92,36,56,92
 tr 32,3,50816
 tr 34,3,51072
 mf 92,40,64,92
 tr 36,3,50848
 tr 38,3,51104
 mf 92,44,72,92
 tr 40,3,50880
 tr 42,3,51136
 s_waitcnt lgkmcnt(10)
 mf 144,16,112,144
 tr 44,3,50912
 tr 46,3,51168
 mf 248,6,112,248
 v_mbcnt_lo_u32_b32 v1,-1,0
 mf 148,20,112,148
 tr 16,3,51200
 tr 18,3,51456
 v_mbcnt_hi_u32_b32 v1,-1,v1
 s_waitcnt lgkmcnt(10)
 mf 152,24,112,152
 tr 20,3,51232
 tr 22,3,51488
 s_add_u32 s47,s36,s39
 v_lshlrev_b32 v0,6,v1
 mf 156,28,112,156
 tr 24,3,51264
 tr 26,3,51520
 s_lshl_b32 s46,s35,13
 s_lshl_b32 s47,s47,17
 s_add_u32 s46,s46,s47
 s_waitcnt lgkmcnt(10)
 mf 160,32,112,160
 tr 28,3,51296
 tr 30,3,51552
 mf 164,36,112,164
 tr 32,3,51328
 tr 34,3,51584
 s_waitcnt lgkmcnt(10)
 mf 168,40,112,168
 tr 36,3,51360
 tr 38,3,51616
 mf 172,44,112,172
 tr 40,3,51392
 tr 42,3,51648
 s_waitcnt lgkmcnt(10)
 mf 144,16,120,144
 tr 44,3,51424
 tr 46,3,51680
 mf 248,6,120,248
 buffer_load_dword v178,v0,s[20:23],s46 offen
 mf 148,20,120,148
 s_add_u32 s46,s46,4096
 s_waitcnt lgkmcnt(8)
 mf 152,24,120,152
 buffer_load_dword v179,v0,s[20:23],s46 offen
 mf 156,28,120,156
 s_waitcnt lgkmcnt(0)
 s_barrier
 ds_read_b128 v[16:19],v2
 ds_read_b128 v[20:23],v2 offset:64
 ds_read_b128 v[24:27],v2 offset:128
 mf 160,32,120,160
 ds_read_b128 v[28:31],v2 offset:192
 v_exp_f32 v80,v80
 mf 164,36,120,164
 ds_read_b128 v[32:35],v2 offset:256
 v_exp_f32 v81,v81
 mf 168,40,120,168
 ds_read_b128 v[36:39],v2 offset:320
 v_exp_f32 v82,v82
 mf 172,44,120,172
 ds_read_b128 v[40:43],v2 offset:384
 v_exp_f32 v83,v83
 s_waitcnt lgkmcnt(5)
 mz 112,16,48
 ds_read_b128 v[44:47],v2 offset:448
 v_exp_f32 v84,v84
 mf 112,20,56,112
 ds_read_b128 v[16:19],v2 offset:512
 v_exp_f32 v85,v85
 s_waitcnt lgkmcnt(5)
 mf 112,24,64,112
 ds_read_b128 v[20:23],v2 offset:576
 v_exp_f32 v86,v86
 mf 112,28,72,112
 ds_read_b128 v[24:27],v2 offset:640
 v_exp_f32 v87,v87
 cv 80,80,81
 s_waitcnt lgkmcnt(5)
 mz 116,32,48
 ds_read_b128 v[28:31],v2 offset:704
 cv 81,82,83
 cv 82,84,85
 cv 83,86,87
 mf 116,36,56,116
 ds_read_b128 v[32:35],v2 offset:768
 v_exp_f32 v88,v88
 s_waitcnt lgkmcnt(5)
 mf 116,40,64,116
 ds_read_b128 v[36:39],v2 offset:832
 v_exp_f32 v89,v89
 v_exp_f32 v90,v90
 mf 116,44,72,116
 ds_read_b128 v[40:43],v2 offset:896
 v_exp_f32 v91,v91
 s_waitcnt lgkmcnt(5)
 mz 120,16,48
 ds_read_b128 v[44:47],v2 offset:960
 v_exp_f32 v92,v92
 v_exp_f32 v93,v93
 mf 120,20,56,120
 v_exp_f32 v94,v94
 s_waitcnt lgkmcnt(4)
 mf 120,24,64,120
 v_exp_f32 v95,v95
 cv 88,88,89
 mf 120,28,72,120
 cv 89,90,91
 cv 90,92,93
 cv 91,94,95
 s_waitcnt lgkmcnt(0)
 s_barrier
 tr 16,3,33792
 tr 18,3,34048
 tr 20,3,33824
 tr 22,3,34080
 tr 24,3,33856
 tr 26,3,34112
 mz 124,32,48
 tr 28,3,33888
 tr 30,3,34144
 mf 124,36,56,124
 tr 32,3,33920
 tr 34,3,34176
 mf 124,40,64,124
 tr 36,3,33952
 tr 38,3,34208
 mf 124,44,72,124
 tr 40,3,33984
 tr 42,3,34240
 s_waitcnt lgkmcnt(10)
 mf 144,16,80,144
 tr 44,3,34016
 tr 46,3,34272
 mf 248,6,80,248
 mf 148,20,80,148
 tr 16,3,34304
 tr 18,3,34560
 s_waitcnt lgkmcnt(10)
 mf 152,24,80,152
 tr 20,3,34336
 tr 22,3,34592
 mf 156,28,80,156
 tr 24,3,34368
 tr 26,3,34624
 s_waitcnt lgkmcnt(10)
 mf 160,32,80,160
 tr 28,3,34400
 tr 30,3,34656
 mf 164,36,80,164
 tr 32,3,34432
 tr 34,3,34688
 s_waitcnt lgkmcnt(10)
 mf 168,40,80,168
 tr 36,3,34464
 tr 38,3,34720
 mf 172,44,80,172
 tr 40,3,34496
 tr 42,3,34752
 s_waitcnt lgkmcnt(10)
 mf 144,16,88,144
 tr 44,3,34528
 tr 46,3,34784
 mf 248,6,88,248
 mf 148,20,88,148
 s_waitcnt lgkmcnt(8)
 mf 152,24,88,152
 mf 156,28,88,156
 s_waitcnt lgkmcnt(0)
 s_barrier
 ds_read_b128 v[16:19],v2 offset:16896
 ds_read_b128 v[20:23],v2 offset:16960
 ds_read_b128 v[24:27],v2 offset:17024
 mf 160,32,88,160
 ds_read_b128 v[28:31],v2 offset:17088
 v_exp_f32 v112,v112
 mf 164,36,88,164
 ds_read_b128 v[32:35],v2 offset:17152
 v_exp_f32 v113,v113
 mf 168,40,88,168
 ds_read_b128 v[36:39],v2 offset:17216
 v_exp_f32 v114,v114
 mf 172,44,88,172
 ds_read_b128 v[40:43],v2 offset:17280
 v_exp_f32 v115,v115
 s_waitcnt lgkmcnt(5)
 mz 80,16,48
 ds_read_b128 v[44:47],v2 offset:17344
 v_exp_f32 v116,v116
 mf 80,20,56,80
 ds_read_b128 v[16:19],v2 offset:17408
 v_exp_f32 v117,v117
 s_waitcnt lgkmcnt(5)
 mf 80,24,64,80
 ds_read_b128 v[20:23],v2 offset:17472
 v_exp_f32 v118,v118
 mf 80,28,72,80
 ds_read_b128 v[24:27],v2 offset:17536
 v_exp_f32 v119,v119
 cv 112,112,113
 s_waitcnt lgkmcnt(5)
 mz 84,32,48
 ds_read_b128 v[28:31],v2 offset:17600
 cv 113,114,115
 cv 114,116,117
 cv 115,118,119
 mf 84,36,56,84
 ds_read_b128 v[32:35],v2 offset:17664
 v_exp_f32 v120,v120
 s_waitcnt lgkmcnt(5)
 mf 84,40,64,84
 ds_read_b128 v[36:39],v2 offset:17728
 v_exp_f32 v121,v121
 v_exp_f32 v122,v122
 mf 84,44,72,84
 ds_read_b128 v[40:43],v2 offset:17792
 v_exp_f32 v123,v123
 s_waitcnt lgkmcnt(5)
 mz 88,16,48
 ds_read_b128 v[44:47],v2 offset:17856
 v_exp_f32 v124,v124
 v_exp_f32 v125,v125
 mf 88,20,56,88
 v_exp_f32 v126,v126
 s_waitcnt lgkmcnt(4)
 mf 88,24,64,88
 v_exp_f32 v127,v127
 cv 120,120,121
 mf 88,28,72,88
 cv 121,122,123
 cv 122,124,125
 cv 123,126,127
 s_waitcnt lgkmcnt(0)
 s_barrier
 tr 16,3,50688
 tr 18,3,50944
 tr 20,3,50720
 tr 22,3,50976
 tr 24,3,50752
 tr 26,3,51008
 mz 92,32,48
 tr 28,3,50784
 tr 30,3,51040
 mf 92,36,56,92
 tr 32,3,50816
 tr 34,3,51072
 mf 92,40,64,92
 tr 36,3,50848
 tr 38,3,51104
 mf 92,44,72,92
 tr 40,3,50880
 tr 42,3,51136
 s_waitcnt lgkmcnt(10)
 mf 144,16,112,144
 tr 44,3,50912
 tr 46,3,51168
 mf 248,6,112,248
 mf 148,20,112,148
 tr 16,3,51200
 tr 18,3,51456
 s_waitcnt lgkmcnt(10)
 mf 152,24,112,152
 tr 20,3,51232
 tr 22,3,51488
 mf 156,28,112,156
 tr 24,3,51264
 tr 26,3,51520
 s_waitcnt lgkmcnt(10)
 mf 160,32,112,160
 tr 28,3,51296
 tr 30,3,51552
 mf 164,36,112,164
 tr 32,3,51328
 tr 34,3,51584
 s_waitcnt lgkmcnt(10)
 mf 168,40,112,168
 tr 36,3,51360
 tr 38,3,51616
 mf 172,44,112,172
 tr 40,3,51392
 tr 42,3,51648
 s_waitcnt lgkmcnt(10)
 mf 144,16,120,144
 tr 44,3,51424
 tr 46,3,51680
 mf 248,6,120,248
 mf 148,20,120,148
 s_waitcnt lgkmcnt(8)
 mf 152,24,120,152
 mf 156,28,120,156
 s_waitcnt lgkmcnt(0)
 s_barrier
 ds_read_b128 v[16:19],v2
 ds_read_b128 v[20:23],v2 offset:64
 ds_read_b128 v[24:27],v2 offset:128
 mf 160,32,120,160
 ds_read_b128 v[28:31],v2 offset:192
 v_exp_f32 v80,v80
 mf 164,36,120,164
 ds_read_b128 v[32:35],v2 offset:256
 v_exp_f32 v81,v81
 mf 168,40,120,168
 ds_read_b128 v[36:39],v2 offset:320
 v_exp_f32 v82,v82
 mf 172,44,120,172
 ds_read_b128 v[40:43],v2 offset:384
 v_exp_f32 v83,v83
 s_waitcnt lgkmcnt(5)
 mz 112,16,48
 ds_read_b128 v[44:47],v2 offset:448
 v_exp_f32 v84,v84
 mf 112,20,56,112
 ds_read_b128 v[16:19],v2 offset:512
 v_exp_f32 v85,v85
 s_waitcnt lgkmcnt(5)
 mf 112,24,64,112
 ds_read_b128 v[20:23],v2 offset:576
 v_exp_f32 v86,v86
 mf 112,28,72,112
 ds_read_b128 v[24:27],v2 offset:640
 v_exp_f32 v87,v87
 cv 80,80,81
 s_waitcnt lgkmcnt(5)
 mz 116,32,48
 ds_read_b128 v[28:31],v2 offset:704
 cv 81,82,83
 cv 82,84,85
 cv 83,86,87
 mf 116,36,56,116
 ds_read_b128 v[32:35],v2 offset:768
 v_exp_f32 v88,v88
 s_waitcnt lgkmcnt(5)
 mf 116,40,64,116
 ds_read_b128 v[36:39],v2 offset:832
 v_exp_f32 v89,v89
 v_exp_f32 v90,v90
 mf 116,44,72,116
 ds_read_b128 v[40:43],v2 offset:896
 v_exp_f32 v91,v91
 s_waitcnt lgkmcnt(5)
 mz 120,16,48
 ds_read_b128 v[44:47],v2 offset:960
 v_exp_f32 v92,v92
 v_exp_f32 v93,v93
 mf 120,20,56,120
 v_exp_f32 v94,v94
 s_waitcnt lgkmcnt(4)
 mf 120,24,64,120
 v_exp_f32 v95,v95
 cv 88,88,89
 mf 120,28,72,120
 cv 89,90,91
 cv 90,92,93
 cv 91,94,95
 s_waitcnt lgkmcnt(0)
 s_barrier
 tr 16,3,33792
 tr 18,3,34048
 tr 20,3,33824
 tr 22,3,34080
 tr 24,3,33856
 tr 26,3,34112
 mz 124,32,48
 tr 28,3,33888
 tr 30,3,34144
 mf 124,36,56,124
 tr 32,3,33920
 tr 34,3,34176
 mf 124,40,64,124
 tr 36,3,33952
 tr 38,3,34208
 mf 124,44,72,124
 tr 40,3,33984
 tr 42,3,34240
 s_waitcnt lgkmcnt(10)
 mf 144,16,80,144
 tr 44,3,34016
 tr 46,3,34272
 mf 248,6,80,248
 mf 148,20,80,148
 tr 16,3,34304
 tr 18,3,34560
 s_waitcnt lgkmcnt(10)
 mf 152,24,80,152
 tr 20,3,34336
 tr 22,3,34592
 mf 156,28,80,156
 tr 24,3,34368
 tr 26,3,34624
 s_waitcnt lgkmcnt(10)
 mf 160,32,80,160
 tr 28,3,34400
 tr 30,3,34656
 mf 164,36,80,164
 tr 32,3,34432
 tr 34,3,34688
 ds_read_b128 v[48:51],v4
 s_waitcnt lgkmcnt(11)
 mf 168,40,80,168
 tr 36,3,34464
 tr 38,3,34720
 mf 172,44,80,172
 tr 40,3,34496
 tr 42,3,34752
 ds_read_b128 v[56:59],v4 offset:7168
 s_waitcnt lgkmcnt(12)
 mf 144,16,88,144
 tr 44,3,34528
 tr 46,3,34784
 mf 248,6,88,248
 ds_read_b128 v[64:67],v4 offset:14336
 mf 148,20,88,148
 s_waitcnt lgkmcnt(11)
 mf 152,24,88,152
 ds_read_b128 v[72:75],v4 offset:21504
 mf 156,28,88,156
 s_cmp_eq_u32 s39,3
 s_waitcnt lgkmcnt(0)
 s_cbranch_scc1 L_alast_s
 s_barrier
 ds_read_b128 v[16:19],v2 offset:16896
 ds_read_b128 v[20:23],v2 offset:16960
 ds_read_b128 v[24:27],v2 offset:17024
 mf 160,32,88,160
 ds_read_b128 v[28:31],v2 offset:17088
 v_exp_f32 v112,v112
 mf 164,36,88,164
 ds_read_b128 v[32:35],v2 offset:17152
 v_exp_f32 v113,v113
 mf 168,40,88,168
 ds_read_b128 v[36:39],v2 offset:17216
 v_exp_f32 v114,v114
 mf 172,44,88,172
 ds_read_b128 v[40:43],v2 offset:17280
 v_exp_f32 v115,v115
 s_waitcnt lgkmcnt(5)
 mz 80,16,48
 ds_read_b128 v[44:47],v2 offset:17344
 v_exp_f32 v116,v116
 mf 80,20,56,80
 ds_read_b128 v[16:19],v2 offset:17408
 v_exp_f32 v117,v117
 s_waitcnt lgkmcnt(5)
 mf 80,24,64,80
 ds_read_b128 v[20:23],v2 offset:17472
 v_exp_f32 v118,v118
 mf 80,28,72,80
 ds_read_b128 v[24:27],v2 offset:17536
 v_exp_f32 v119,v119
 cv 112,112,113
 s_waitcnt lgkmcnt(5)
 mz 84,32,48
 ds_read_b128 v[28:31],v2 offset:17600
 cv 113,114,115
 cv 114,116,117
 cv 115,118,119
 mf 84,36,56,84
 ds_read_b128 v[32:35],v2 offset:17664
 v_exp_f32 v120,v120
 s_waitcnt lgkmcnt(5)
 mf 84,40,64,84
 ds_read_b128 v[36:39],v2 offset:17728
 v_exp_f32 v121,v121
 v_exp_f32 v122,v122
 mf 84,44,72,84
 ds_read_b128 v[40:43],v2 offset:17792
 v_exp_f32 v123,v123
 s_waitcnt lgkmcnt(5)
 mz 88,16,48
 ds_read_b128 v[44:47],v2 offset:17856
 v_exp_f32 v124,v124
 v_exp_f32 v125,v125
 mf 88,20,56,88
 v_exp_f32 v126,v126
 s_waitcnt lgkmcnt(4)
 mf 88,24,64,88
 v_exp_f32 v127,v127
 cv 120,120,121
 mf 88,28,72,88
 cv 121,122,123
 cv 122,124,125
 cv 123,126,127
 s_waitcnt lgkmcnt(0)
 s_barrier
 tr 16,3,50688
 tr 18,3,50944
 tr 20,3,50720
 tr 22,3,50976
 tr 24,3,50752
 tr 26,3,51008
 mz 92,32,48
 tr 28,3,50784
 tr 30,3,51040
 mf 92,36,56,92
 tr 32,3,50816
 tr 34,3,51072
 mf 92,40,64,92
 tr 36,3,50848
 tr 38,3,51104
 mf 92,44,72,92
 tr 40,3,50880
 tr 42,3,51136
 s_waitcnt lgkmcnt(10)
 mf 144,16,112,144
 tr 44,3,50912
 tr 46,3,51168
 mf 248,6,112,248
 mf 148,20,112,148
 tr 16,3,51200
 tr 18,3,51456
 s_waitcnt lgkmcnt(10)
 mf 152,24,112,152
 tr 20,3,51232
 tr 22,3,51488
 mf 156,28,112,156
 tr 24,3,51264
 tr 26,3,51520
 s_waitcnt lgkmcnt(10)
 mf 160,32,112,160
 tr 28,3,51296
 tr 30,3,51552
 mf 164,36,112,164
 tr 32,3,51328
 tr 34,3,51584
 s_waitcnt lgkmcnt(10)
 mf 168,40,112,168
 tr 36,3,51360
 tr 38,3,51616
 mf 172,44,112,172
 tr 40,3,51392
 tr 42,3,51648
 s_waitcnt lgkmcnt(10)
 mf 144,16,120,144
 tr 44,3,51424
 tr 46,3,51680
 mf 248,6,120,248
 mf 148,20,120,148
 s_waitcnt lgkmcnt(8)
 mf 152,24,120,152
 mf 156,28,120,156
 s_add_u32 s39,s39,1
 s_waitcnt lgkmcnt(0)
 s_branch L_aloop_s
L_alast_s:
 s_barrier
 tr 16,3,50688
 tr 18,3,50944
 tr 20,3,50720
 tr 22,3,50976
 tr 24,3,50752
 tr 26,3,51008
 mf 160,32,88,160
 tr 28,3,50784
 tr 30,3,51040
 v_exp_f32 v112,v112
 v_exp_f32 v113,v113
 v_exp_f32 v114,v114
 mf 164,36,88,164
 tr 32,3,50816
 tr 34,3,51072
 v_exp_f32 v115,v115
 v_exp_f32 v116,v116
 mf 168,40,88,168
 tr 36,3,50848
 tr 38,3,51104
 v_exp_f32 v117,v117
 v_exp_f32 v118,v118
 v_exp_f32 v119,v119
 mf 172,44,88,172
 tr 40,3,50880
 tr 42,3,51136
 cv 112,112,113
 cv 113,114,115
 cv 114,116,117
 cv 115,118,119
 s_waitcnt lgkmcnt(10)
 s_nop 0
 mf 144,16,112,144
 tr 44,3,50912
 tr 46,3,51168
 v_exp_f32 v120,v120
 mf 248,6,112,248
 v_exp_f32 v121,v121
 mf 148,20,112,148
 tr 16,3,51200
 tr 18,3,51456
 v_exp_f32 v122,v122
 s_waitcnt lgkmcnt(10)
 mf 152,24,112,152
 tr 20,3,51232
 tr 22,3,51488
 v_exp_f32 v123,v123
 mf 156,28,112,156
 tr 24,3,51264
 tr 26,3,51520
 v_exp_f32 v124,v124
 s_waitcnt lgkmcnt(10)
 mf 160,32,112,160
 tr 28,3,51296
 tr 30,3,51552
 v_exp_f32 v125,v125
 mf 164,36,112,164
 tr 32,3,51328
 tr 34,3,51584
 v_exp_f32 v126,v126
 s_waitcnt lgkmcnt(10)
 mf 168,40,112,168
 tr 36,3,51360
 tr 38,3,51616
 v_exp_f32 v127,v127
 cv 120,120,121
 mf 172,44,112,172
 tr 40,3,51392
 tr 42,3,51648
 cv 121,122,123
 cv 122,124,125
 cv 123,126,127
 s_waitcnt lgkmcnt(10)
 s_nop 0
 mf 144,16,120,144
 tr 44,3,51424
 tr 46,3,51680
 mf 248,6,120,248
 mf 148,20,120,148
 s_waitcnt lgkmcnt(8)
 mf 152,24,120,152
 mf 156,28,120,156
 s_lshl_b32 s42,s54,2
 v_mov_b32 v9,0
 buffer_load_dword v9,v9,s[64:67],s42 offen sc1
 s_waitcnt lgkmcnt(0)
 s_barrier
 mf 160,32,120,160
 ds_read_b128 v[80:83],v4
 ds_read_b128 v[88:91],v4 offset:7168
 ds_read_b128 v[96:99],v4 offset:14336
 ds_read_b128 v[104:107],v4 offset:21504
 v_mbcnt_lo_u32_b32 v13,-1,0
 v_mbcnt_hi_u32_b32 v13,-1,v13
 v_bfe_u32 v11,v13,3,2
 v_mul_u32_u24 v2,1056,v11
 v_lshrrev_b32 v11,5,v13
 v_lshl_add_u32 v2,v11,8,v2
 v_bfe_u32 v11,v13,2,1
 v_lshl_add_u32 v2,v11,7,v2
 v_and_b32 v11,3,v13
 v_lshl_add_u32 v2,v11,3,v2
 mf 164,36,120,164
 mf 168,40,120,168
 mf 172,44,120,172
 v_rcp_f32 v10,v248
 s_nop 0
 v_max_f32 v11,v10,v248
 v_cmp_nge_f32 vcc,s101,v11
 s_nop 0
 s_or_b64 s[94:95],s[94:95],vcc
 v_mul_f32 v144,v10,v144
 v_mul_f32 v145,v10,v145
 v_mul_f32 v146,v10,v146
 v_mul_f32 v147,v10,v147
 v_mul_f32 v148,v10,v148
 v_mul_f32 v149,v10,v149
 v_mul_f32 v150,v10,v150
 v_mul_f32 v151,v10,v151
 cv 144,144,145
 cv 145,146,147
 cv 146,148,149
 cv 147,150,151
 ds_write_b128 v4,v[144:147]
 v_mul_f32 v152,v10,v152
 v_mul_f32 v153,v10,v153
 v_mul_f32 v154,v10,v154
 v_mul_f32 v155,v10,v155
 v_mul_f32 v156,v10,v156
 v_mul_f32 v157,v10,v157
 v_mul_f32 v158,v10,v158
 v_mul_f32 v159,v10,v159
 cv 152,152,153
 cv 153,154,155
 cv 154,156,157
 cv 155,158,159
 ds_write_b128 v4,v[152:155] offset:7168
 v_mul_f32 v160,v10,v160
 v_mul_f32 v161,v10,v161
 v_mul_f32 v162,v10,v162
 v_mul_f32 v163,v10,v163
 v_mul_f32 v164,v10,v164
 v_mul_f32 v165,v10,v165
 v_mul_f32 v166,v10,v166
 v_mul_f32 v167,v10,v167
 cv 160,160,161
 cv 161,162,163
 cv 162,164,165
 cv 163,166,167
 ds_write_b128 v4,v[160:163] offset:14336
 v_mul_f32 v168,v10,v168
 v_mul_f32 v169,v10,v169
 v_mul_f32 v170,v10,v170
 v_mul_f32 v171,v10,v171
 v_mul_f32 v172,v10,v172
 v_mul_f32 v173,v10,v173
 v_mul_f32 v174,v10,v174
 v_mul_f32 v175,v10,v175
 cv 168,168,169
 cv 169,170,171
 cv 170,172,173
 cv 171,174,175
 ds_write_b128 v4,v[168:171] offset:21504
 s_cmp_eq_u64 s[94:95],0
 s_waitcnt lgkmcnt(0)
 s_cbranch_scc1 L_good_s
 v_mov_b32 v10,16880
 ds_write_b32 v10,v10
 s_waitcnt lgkmcnt(0)
L_good_s:
 s_setprio 0
 s_barrier
 ds_read_b64_tr_b16 v[16:17],v2
 tr 18,2,512
 tr 20,2,32
 tr 22,2,544
 tr 24,2,64
 tr 26,2,576
 tr 28,2,96
 tr 30,2,608
 tr 148,2,4224
 tr 150,2,4736
 tr 156,2,4256
 tr 158,2,4768
 tr 164,2,4288
 tr 166,2,4800
 s_waitcnt lgkmcnt(10)
 mz 112,16,208
 tr 172,2,4320
 tr 174,2,4832
 mz 116,20,208
 tr 16,2,8448
 tr 18,2,8960
 s_waitcnt lgkmcnt(10)
 mz 120,24,208
 tr 20,2,8480
 tr 22,2,8992
 mz 124,28,208
 tr 24,2,8512
 tr 26,2,9024
 s_waitcnt lgkmcnt(10)
 mf 112,148,216,112
 tr 28,2,8544
 tr 30,2,9056
 mf 116,156,216,116
 tr 148,2,12672
 tr 150,2,13184
 s_waitcnt lgkmcnt(10)
 mf 120,164,216,120
 tr 156,2,12704
 tr 158,2,13216
 v_mov_b32 v10,16880
 mf 124,172,216,124
 tr 164,2,12736
 tr 166,2,13248
 s_waitcnt lgkmcnt(10)
 mf 112,16,224,112
 tr 172,2,12768
 tr 174,2,13280
 mf 116,20,224,116
 s_waitcnt lgkmcnt(8)
 mf 120,24,224,120
 ds_read_b32 v10,v10
 mf 124,28,224,124
 s_waitcnt lgkmcnt(0)
 v_readfirstlane_b32 s40,v10
 s_nop 0
 s_cmp_lg_u32 s40,0
 s_cbranch_scc1 X_restart
 s_waitcnt vmcnt(0)
L_rdy_s:
 v_readfirstlane_b32 s55,v9
 s_add_u32 s100,s100,1
 s_cmp_gt_u32 s100,0x40000
 s_cbranch_scc1 L_rdyok_s
 s_cmp_ge_u32 s55,8
 s_cbranch_scc1 L_rdyok_s
 v_mov_b32 v9,0
 buffer_load_dword v9,v9,s[64:67],s42 offen sc1
 s_waitcnt vmcnt(0)
 s_branch L_rdy_s
L_rdyok_s:
 s_barrier
 tr 16,2,16896
 tr 18,2,17408
 tr 20,2,16928
 tr 22,2,17440
 tr 24,2,16960
 tr 26,2,17472
 mf 112,148,232,112
 tr 28,2,16992
 tr 30,2,17504
 v_mbcnt_lo_u32_b32 v10,-1,0
 mf 116,156,232,116
 tr 148,2,21120
 tr 150,2,21632
 v_mbcnt_hi_u32_b32 v10,-1,v10
 mf 120,164,232,120
 tr 156,2,21152
 tr 158,2,21664
 s_lshl_b32 s47,s37,2
 s_add_u32 s47,s47,s33
 s_lshl_b32 s47,s47,2
 v_cmp_eq_u32 vcc,0,v10
 mf 124,172,232,124
 tr 164,2,21184
 tr 166,2,21696
 v_mov_b32 v10,s47
 s_waitcnt lgkmcnt(10)
 mf 112,16,48,112
 tr 172,2,21216
 tr 174,2,21728
 v_mov_b32 v7,0x40000000
 mf 116,20,48,116
 tr 16,2,25344
 tr 18,2,25856
 s_waitcnt lgkmcnt(10)
 mf 120,24,48,120
 tr 20,2,25376
 tr 22,2,25888
 v_cndmask_b32 v7,v7,v10,vcc
 mf 124,28,48,124
 tr 24,2,25408
 tr 26,2,25920
 s_lshl_b32 s40,s33,12
 s_waitcnt lgkmcnt(10)
 mf 112,148,56,112
 tr 28,2,25440
 tr 30,2,25952
 v_lshlrev_b32 v3,4,v13
 mf 116,156,56,116
 tr 148,2,29568
 tr 150,2,30080
 s_waitcnt lgkmcnt(10)
 mf 120,164,56,120
 tr 156,2,29600
 tr 158,2,30112
 v_add_u32 v3,s40,v3
 mf 124,172,56,124
 tr 164,2,29632
 tr 166,2,30144
 s_mov_b32 s40,0
 s_cmp_eq_u32 s33,3
 s_cselect_b32 s40,0x40000000,s40
 s_waitcnt lgkmcnt(10)
 mf 112,16,64,112
 tr 172,2,29664
 tr 174,2,30176
 v_add_u32 v6,s40,v3
 mf 116,20,64,116
 s_waitcnt lgkmcnt(8)
 mf 120,24,64,120
 v_add_u32 v8,67584,v2
 mf 124,28,64,124
 s_waitcnt lgkmcnt(0)
 s_barrier
 tr 16,2,33792
 tr 18,2,34304
 tr 20,2,33824
 tr 22,2,34336
 tr 24,2,33856
 tr 26,2,34368
 mf 112,148,72,112
 tr 28,2,33888
 tr 30,2,34400
 mf 116,156,72,116
 tr 148,2,38016
 tr 150,2,38528
 mf 120,164,72,120
 tr 156,2,38048
 tr 158,2,38560
 mf 124,172,72,124
 tr 164,2,38080
 tr 166,2,38592
 s_waitcnt lgkmcnt(10)
 mf 112,16,80,112
 tr 172,2,38112
 tr 174,2,38624
 mf 116,20,80,116
 tr 16,2,42240
 tr 18,2,42752
 s_waitcnt lgkmcnt(10)
 mf 120,24,80,120
 tr 20,2,42272
 tr 22,2,42784
 mf 124,28,80,124
 tr 24,2,42304
 tr 26,2,42816
 s_waitcnt lgkmcnt(10)
 mf 112,148,88,112
 tr 28,2,42336
 tr 30,2,42848
 mf 116,156,88,116
 tr 148,2,46464
 tr 150,2,46976
 s_waitcnt lgkmcnt(10)
 mf 120,164,88,120
 tr 156,2,46496
 tr 158,2,47008
 mf 124,172,88,124
 tr 164,2,46528
 tr 166,2,47040
 s_waitcnt lgkmcnt(10)
 mf 112,16,96,112
 tr 172,2,46560
 tr 174,2,47072
 mf 116,20,96,116
 s_waitcnt lgkmcnt(8)
 mf 120,24,96,120
 mf 124,28,96,124
 s_waitcnt lgkmcnt(0)
 s_barrier
 tr 16,2,50688
 tr 18,2,51200
 tr 20,2,50720
 tr 22,2,51232
 tr 24,2,50752
 tr 26,2,51264
 mf 112,148,104,112
 tr 28,2,50784
 tr 30,2,51296
 mf 116,156,104,116
 tr 148,2,54912
 tr 150,2,55424
 mf 120,164,104,120
 tr 156,2,54944
 tr 158,2,55456
 mf 124,172,104,124
 tr 164,2,54976
 tr 166,2,55488
 s_waitcnt lgkmcnt(10)
 mf 112,16,144,112
 tr 172,2,55008
 tr 174,2,55520
 mf 116,20,144,116
 tr 16,2,59136
 tr 18,2,59648
 s_waitcnt lgkmcnt(10)
 mf 120,24,144,120
 tr 20,2,59168
 tr 22,2,59680
 mf 124,28,144,124
 tr 24,2,59200
 tr 26,2,59712
 s_waitcnt lgkmcnt(10)
 mf 112,148,152,112
 tr 28,2,59232
 tr 30,2,59744
 mf 116,156,152,116
 tr 148,2,63360
 tr 150,2,63872
 s_waitcnt lgkmcnt(10)
 mf 120,164,152,120
 tr 156,2,63392
 tr 158,2,63904
 mf 124,172,152,124
 tr 164,2,63424
 tr 166,2,63936
 s_waitcnt lgkmcnt(10)
 mf 112,16,160,112
 tr 172,2,63456
 tr 174,2,63968
 mf 116,20,160,116
 s_waitcnt lgkmcnt(8)
 mf 120,24,160,120
 mf 124,28,160,124
 s_waitcnt lgkmcnt(0)
 s_barrier
 ds_read_b64_tr_b16 v[16:17],v2
 tr 18,2,512
 tr 20,2,32
 tr 22,2,544
 tr 24,2,64
 tr 26,2,576
 mf 112,148,168,112
 tr 28,2,96
 tr 30,2,608
 mf 116,156,168,116
 tr 148,2,4224
 tr 150,2,4736
 mf 120,164,168,120
 tr 156,2,4256
 tr 158,2,4768
 mf 124,172,168,124
 tr 164,2,4288
 tr 166,2,4800
 s_waitcnt lgkmcnt(10)
 mz 32,16,208
 tr 172,2,4320
 tr 174,2,4832
 cv 112,112,113
 cv 113,114,115
 mz 36,20,208
 tr 16,2,8448
 tr 18,2,8960
 cv 114,116,117
 cv 115,118,119
 s_waitcnt lgkmcnt(10)
 mz 40,24,208
 tr 20,2,8480
 tr 22,2,8992
 ds_write_b128 v4,v[112:115]
 mz 44,28,208
 tr 24,2,8512
 tr 26,2,9024
 cv 120,120,121
 s_waitcnt lgkmcnt(11)
 mf 32,148,216,32
 tr 28,2,8544
 tr 30,2,9056
 cv 121,122,123
 cv 122,124,125
 mf 36,156,216,36
 tr 148,2,12672
 tr 150,2,13184
 cv 123,126,127
 s_waitcnt lgkmcnt(11)
 mf 40,164,216,40
 tr 156,2,12704
 tr 158,2,13216
 ds_write_b128 v4,v[120:123] offset:7168
 mf 44,172,216,44
 tr 164,2,12736
 tr 166,2,13248
 s_waitcnt lgkmcnt(12)
 mf 32,16,224,32
 tr 172,2,12768
 tr 174,2,13280
 mf 36,20,224,36
 s_waitcnt lgkmcnt(9)
 mf 40,24,224,40
 mf 44,28,224,44
 s_waitcnt lgkmcnt(0)
 s_barrier
 tr 16,2,16896
 tr 18,2,17408
 tr 20,2,16928
 tr 22,2,17440
 tr 24,2,16960
 tr 26,2,17472
 mf 32,148,232,32
 tr 28,2,16992
 tr 30,2,17504
 mf 36,156,232,36
 tr 148,2,21120
 tr 150,2,21632
 mf 40,164,232,40
 tr 156,2,21152
 tr 158,2,21664
 mf 44,172,232,44
 tr 164,2,21184
 tr 166,2,21696
 s_waitcnt lgkmcnt(10)
 mf 32,16,48,32
 tr 172,2,21216
 tr 174,2,21728
 mf 36,20,48,36
 tr 16,2,25344
 tr 18,2,25856
 s_waitcnt lgkmcnt(10)
 mf 40,24,48,40
 tr 20,2,25376
 tr 22,2,25888
 mf 44,28,48,44
 tr 24,2,25408
 tr 26,2,25920
 s_waitcnt lgkmcnt(10)
 mf 32,148,56,32
 tr 28,2,25440
 tr 30,2,25952
 mf 36,156,56,36
 tr 148,2,29568
 tr 150,2,30080
 s_waitcnt lgkmcnt(10)
 mf 40,164,56,40
 tr 156,2,29600
 tr 158,2,30112
 mf 44,172,56,44
 tr 164,2,29632
 tr 166,2,30144
 s_waitcnt lgkmcnt(10)
 mf 32,16,64,32
 tr 172,2,29664
 tr 174,2,30176
 mf 36,20,64,36
 s_waitcnt lgkmcnt(8)
 mf 40,24,64,40
 mf 44,28,64,44
 tr 16,2,33792
 tr 18,2,34304
 tr 20,2,33824
 tr 22,2,34336
 tr 24,2,33856
 tr 26,2,34368
 s_waitcnt lgkmcnt(10)
 mf 32,148,72,32
 tr 28,2,33888
 tr 30,2,34400
 mf 36,156,72,36
 tr 148,2,38016
 tr 150,2,38528
 s_waitcnt lgkmcnt(10)
 mf 40,164,72,40
 tr 156,2,38048
 tr 158,2,38560
 mf 44,172,72,44
 tr 164,2,38080
 tr 166,2,38592
 s_waitcnt lgkmcnt(10)
 mf 32,16,80,32
 tr 172,2,38112
 tr 174,2,38624
 mf 36,20,80,36
 tr 16,2,42240
 tr 18,2,42752
 s_waitcnt lgkmcnt(10)
 mf 40,24,80,40
 tr 20,2,42272
 tr 22,2,42784
 mf 44,28,80,44
 tr 24,2,42304
 tr 26,2,42816
 s_waitcnt lgkmcnt(10)
 mf 32,148,88,32
 tr 28,2,42336
 tr 30,2,42848
 mf 36,156,88,36
 tr 148,2,46464
 tr 150,2,46976
 s_waitcnt lgkmcnt(10)
 mf 40,164,88,40
 tr 156,2,46496
 tr 158,2,47008
 mf 44,172,88,44
 tr 164,2,46528
 tr 166,2,47040
 s_waitcnt lgkmcnt(10)
 mf 32,16,96,32
 tr 172,2,46560
 tr 174,2,47072
 mf 36,20,96,36
 s_waitcnt lgkmcnt(8)
 mf 40,24,96,40
 mf 44,28,96,44
 tr 16,2,50688
 tr 18,2,51200
 tr 20,2,50720
 tr 22,2,51232
 tr 24,2,50752
 tr 26,2,51264
 s_waitcnt lgkmcnt(10)
 mf 32,148,104,32
 tr 28,2,50784
 tr 30,2,51296
 mf 36,156,104,36
 tr 148,2,54912
 tr 150,2,55424
 s_waitcnt lgkmcnt(10)
 mf 40,164,104,40
 tr 156,2,54944
 tr 158,2,55456
 mf 44,172,104,44
 tr 164,2,54976
 tr 166,2,55488
 s_waitcnt lgkmcnt(10)
 mf 32,16,144,32
 tr 172,2,55008
 tr 174,2,55520
 mf 36,20,144,36
 tr 16,2,59136
 tr 18,2,59648
 s_waitcnt lgkmcnt(10)
 mf 40,24,144,40
 tr 20,2,59168
 tr 22,2,59680
 mf 44,28,144,44
 tr 24,2,59200
 tr 26,2,59712
 s_waitcnt lgkmcnt(10)
 mf 32,148,152,32
 tr 28,2,59232
 tr 30,2,59744
 mf 36,156,152,36
 tr 148,2,63360
 tr 150,2,63872
 s_waitcnt lgkmcnt(10)
 mf 40,164,152,40
 tr 156,2,63392
 tr 158,2,63904
 mf 44,172,152,44
 tr 164,2,63424
 tr 166,2,63936
 s_waitcnt lgkmcnt(10)
 mf 32,16,160,32
 tr 172,2,63456
 tr 174,2,63968
 mf 36,20,160,36
 s_waitcnt lgkmcnt(8)
 mf 40,24,160,40
 mf 44,28,160,44
 s_waitcnt lgkmcnt(4)
 mf 32,148,168,32
 mf 36,156,168,36
 s_waitcnt lgkmcnt(0)
 mf 40,164,168,40
 mf 44,172,168,44
 s_nop 3
 cv 32,32,33
 cv 33,34,35
 cv 34,36,37
 cv 35,38,39
 ds_write_b128 v4,v[32:35] offset:14336
 cv 40,40,41
 cv 41,42,43
 cv 42,44,45
 cv 43,46,47
 ds_write_b128 v4,v[40:43] offset:21504
 s_waitcnt lgkmcnt(0)
 s_barrier
 ds_read_b64_tr_b16 v[16:17],v8
 tr 18,8,512
 tr 20,8,32
 tr 22,8,544
 tr 24,8,64
 tr 26,8,576
 tr 28,8,96
 tr 30,8,608
 tr 148,8,4224
 tr 150,8,4736
 tr 156,8,4256
 tr 158,8,4768
 tr 164,8,4288
 tr 166,8,4800
 s_waitcnt lgkmcnt(10)
 mz 112,16,208
 tr 172,8,4320
 tr 174,8,4832
 mz 116,20,208
 tr 16,8,8448
 tr 18,8,8960
 s_waitcnt lgkmcnt(10)
 mz 120,24,208
 tr 20,8,8480
 tr 22,8,8992
 mz 124,28,208
 tr 24,8,8512
 tr 26,8,9024
 s_waitcnt lgkmcnt(10)
 mf 112,148,216,112
 tr 28,8,8544
 tr 30,8,9056
 mf 116,156,216,116
 tr 148,8,12672
 tr 150,8,13184
 s_waitcnt lgkmcnt(10)
 mf 120,164,216,120
 tr 156,8,12704
 tr 158,8,13216
 mf 124,172,216,124
 tr 164,8,12736
 tr 166,8,13248
 s_waitcnt lgkmcnt(10)
 mf 112,16,224,112
 tr 172,8,12768
 tr 174,8,13280
 mf 116,20,224,116
 s_waitcnt lgkmcnt(8)
 mf 120,24,224,120
 mf 124,28,224,124
 tr 16,8,16896
 tr 18,8,17408
 tr 20,8,16928
 tr 22,8,17440
 tr 24,8,16960
 tr 26,8,17472
 s_waitcnt lgkmcnt(10)
 mf 112,148,232,112
 tr 28,8,16992
 tr 30,8,17504
 mf 116,156,232,116
 tr 148,8,21120
 tr 150,8,21632
 s_waitcnt lgkmcnt(10)
 mf 120,164,232,120
 tr 156,8,21152
 tr 158,8,21664
 mf 124,172,232,124
 tr 164,8,21184
 tr 166,8,21696
 s_waitcnt lgkmcnt(10)
 mf 112,16,48,112
 tr 172,8,21216
 tr 174,8,21728
 mf 116,20,48,116
 tr 16,8,25344
 tr 18,8,25856
 s_waitcnt lgkmcnt(10)
 mf 120,24,48,120
 tr 20,8,25376
 tr 22,8,25888
 mf 124,28,48,124
 tr 24,8,25408
 tr 26,8,25920
 s_waitcnt lgkmcnt(10)
 mf 112,148,56,112
 tr 28,8,25440
 tr 30,8,25952
 mf 116,156,56,116
 tr 148,8,29568
 tr 150,8,30080
 s_waitcnt lgkmcnt(10)
 mf 120,164,56,120
 tr 156,8,29600
 tr 158,8,30112
 mf 124,172,56,124
 tr 164,8,29632
 tr 166,8,30144
 s_waitcnt lgkmcnt(10)
 mf 112,16,64,112
 tr 172,8,29664
 tr 174,8,30176
 mf 116,20,64,116
 s_waitcnt lgkmcnt(8)
 mf 120,24,64,120
 mf 124,28,64,124
 tr 16,8,33792
 tr 18,8,34304
 tr 20,8,33824
 tr 22,8,34336
 tr 24,8,33856
 tr 26,8,34368
 s_waitcnt lgkmcnt(10)
 mf 112,148,72,112
 tr 28,8,33888
 tr 30,8,34400
 mf 116,156,72,116
 tr 148,8,38016
 tr 150,8,38528
 s_waitcnt lgkmcnt(10)
 mf 120,164,72,120
 tr 156,8,38048
 tr 158,8,38560
 mf 124,172,72,124
 tr 164,8,38080
 tr 166,8,38592
 s_waitcnt lgkmcnt(10)
 mf 112,16,80,112
 tr 172,8,38112
 tr 174,8,38624
 mf 116,20,80,116
 tr 16,8,42240
 tr 18,8,42752
 s_waitcnt lgkmcnt(10)
 mf 120,24,80,120
 tr 20,8,42272
 tr 22,8,42784
 mf 124,28,80,124
 tr 24,8,42304
 tr 26,8,42816
 s_waitcnt lgkmcnt(10)
 mf 112,148,88,112
 tr 28,8,42336
 tr 30,8,42848
 mf 116,156,88,116
 tr 148,8,46464
 tr 150,8,46976
 s_waitcnt lgkmcnt(10)
 mf 120,164,88,120
 tr 156,8,46496
 tr 158,8,47008
 mf 124,172,88,124
 tr 164,8,46528
 tr 166,8,47040
 s_waitcnt lgkmcnt(10)
 mf 112,16,96,112
 tr 172,8,46560
 tr 174,8,47072
 mf 116,20,96,116
 s_waitcnt lgkmcnt(8)
 mf 120,24,96,120
 mf 124,28,96,124
 ds_read_b64_tr_b16 v[16:17],v2
 tr 18,2,512
 tr 20,2,32
 tr 22,2,544
 tr 24,2,64
 tr 26,2,576
 s_waitcnt lgkmcnt(10)
 mf 112,148,104,112
 tr 28,2,96
 tr 30,2,608
 mf 116,156,104,116
 tr 148,2,4224
 tr 150,2,4736
 s_waitcnt lgkmcnt(10)
 mf 120,164,104,120
 tr 156,2,4256
 tr 158,2,4768
 mf 124,172,104,124
 tr 164,2,4288
 tr 166,2,4800
 s_waitcnt lgkmcnt(10)
 mf 112,16,144,112
 tr 172,2,4320
 tr 174,2,4832
 mf 116,20,144,116
 tr 16,2,8448
 tr 18,2,8960
 s_waitcnt lgkmcnt(10)
 mf 120,24,144,120
 tr 20,2,8480
 tr 22,2,8992
 mf 124,28,144,124
 tr 24,2,8512
 tr 26,2,9024
 s_waitcnt lgkmcnt(10)
 mf 112,148,152,112
 tr 28,2,8544
 tr 30,2,9056
 mf 116,156,152,116
 tr 148,2,12672
 tr 150,2,13184
 s_waitcnt lgkmcnt(10)
 mf 120,164,152,120
 tr 156,2,12704
 tr 158,2,13216
 mf 124,172,152,124
 tr 164,2,12736
 tr 166,2,13248
 s_waitcnt lgkmcnt(10)
 mf 112,16,160,112
 tr 172,2,12768
 tr 174,2,13280
 mf 116,20,160,116
 s_waitcnt lgkmcnt(8)
 mf 120,24,160,120
 mf 124,28,160,124
 s_waitcnt lgkmcnt(4)
 mf 112,148,168,112
 mf 116,156,168,116
 s_waitcnt lgkmcnt(0)
 mf 120,164,168,120
 mf 124,172,168,124
 s_nop 3
 cv 112,112,113
 cv 113,114,115
 cv 114,116,117
 cv 115,118,119
 ds_write_b128 v4,v[112:115]
 cv 120,120,121
 cv 121,122,123
 cv 122,124,125
 cv 123,126,127
 ds_write_b128 v4,v[120:123] offset:7168
 s_waitcnt lgkmcnt(0)
 s_barrier
 s_endpgm
X_restart:
 s_waitcnt vmcnt(0) lgkmcnt(0)
 s_barrier
 s_setprio 0
 s_mov_b32 s3,1
 v_mbcnt_lo_u32_b32 v0,-1,0
 v_mbcnt_hi_u32_b32 v0,-1,v0
 s_lshl_b32 s40,s32,6
 v_add_u32 v0,s40,v0
 s_branch X_top
X_safe:
 s_cmp_eq_u32 s32,3
 s_cbranch_scc1 L_attn_ys
 s_branch L_attn_y
L_proj_s:
 s_lshl_b32 s45,s33,15
 s_lshl_b32 s40,s36,17
 s_add_u32 s45,s45,s40
 v_lshrrev_b32 v8,4,v1
 v_and_b32 v9,15,v1
 v_xor_b32 v8,v8,v9
 v_lshlrev_b32 v64,4,v8
 v_and_b32 v8,3,v1
 v_lshl_add_u32 v64,v8,10,v64
 v_bfe_u32 v8,v1,2,2
 v_lshl_add_u32 v64,v8,8,v64
 s_lshl_b32 s46,s33,13
 v_add_u32 v64,s46,v64
 v_xor_b32 v65,64,v64
 v_xor_b32 v66,128,v64
 v_xor_b32 v67,192,v64
 v_bfe_u32 v8,v1,3,2
 v_mul_u32_u24 v3,1056,v8
 v_lshrrev_b32 v8,5,v1
 v_lshl_add_u32 v3,v8,8,v3
 v_bfe_u32 v8,v1,2,1
 v_lshl_add_u32 v3,v8,7,v3
 v_and_b32 v8,3,v1
 v_lshl_add_u32 v3,v8,3,v3
 v_add_u32 v3,67584,v3
 v_add_u32 v68,135168,v64
 v_add_u32 v69,135168,v65
 v_add_u32 v70,135168,v66
 v_add_u32 v71,135168,v67
 v_and_b32 v4,15,v1
 s_lshl_b32 s40,s33,5
 v_add_lshl_u32 v4,v4,s40,4
 v_lshrrev_b32 v8,4,v1
 v_mul_u32_u24 v8,1792,v8
 v_add_u32 v4,v4,v8
 v_add_u32 v4,135168,v4
 s_mov_b32 s40,256
 s_cmp_eq_u32 s33,3
 s_cselect_b32 s40,65536,s40
 v_add_u32 v5,s40,v4
 v_and_b32 v6,15,v1
 s_lshl_b32 s40,s33,5
 v_add_lshl_u32 v6,v6,s40,4
 v_lshrrev_b32 v8,5,v1
 v_mul_u32_u24 v8,1792,v8
 v_add_u32 v6,v6,v8
 v_bfe_u32 v8,v1,4,1
 v_lshl_add_u32 v6,v8,3,v6
 v_add_u32 v6,135168,v6
 s_mov_b32 s40,256
 s_cmp_eq_u32 s33,3
 s_cselect_b32 s40,65536,s40
 v_add_u32 v7,s40,v6
 s_lshl_b32 s40,s33,12
 v_add_u32 v1,s40,v14
 v_mov_b32 v5,v14
 s_barrier
 ds_read_b128 v[128:131],v64 offset:33792
 ds_read_b128 v[136:139],v65 offset:33792
 ds_read_b128 v[144:147],v66 offset:33792
 ds_read_b128 v[152:155],v67 offset:33792
 ds_read_b64_tr_b16 v[8:9],v3
 tr 10,3,512
 tr 12,3,32
 tr 14,3,544
 tr 16,3,64
 tr 18,3,576
 tr 20,3,96
 tr 22,3,608
 tr 72,3,4224
 tr 74,3,4736
 tr 76,3,4256
 tr 78,3,4768
 tr 80,3,4288
 tr 82,3,4800
 s_waitcnt lgkmcnt(10)
 mz 96,8,128
 tr 84,3,4320
 tr 86,3,4832
 mz 100,12,128
 tr 8,3,8448
 tr 10,3,8960
 s_waitcnt lgkmcnt(10)
 mz 104,16,128
 tr 12,3,8480
 tr 14,3,8992
 mz 108,20,128
 tr 16,3,8512
 tr 18,3,9024
 s_waitcnt lgkmcnt(10)
 mf 96,72,136,96
 tr 20,3,8544
 tr 22,3,9056
 mf 100,76,136,100
 tr 72,3,12672
 tr 74,3,13184
 s_waitcnt lgkmcnt(10)
 mf 104,80,136,104
 tr 76,3,12704
 tr 78,3,13216
 mf 108,84,136,108
 tr 80,3,12736
 tr 82,3,13248
 s_waitcnt lgkmcnt(10)
 mf 96,8,144,96
 tr 84,3,12768
 tr 86,3,13280
 mf 100,12,144,100
 s_waitcnt lgkmcnt(8)
 mf 104,16,144,104
 mf 108,20,144,108
 s_waitcnt lgkmcnt(0)
 s_barrier
 tr 8,3,16896
 tr 10,3,17408
 tr 12,3,16928
 tr 14,3,17440
 tr 16,3,16960
 tr 18,3,17472
 mf 96,72,152,96
 tr 20,3,16992
 tr 22,3,17504
 mf 100,76,152,100
 tr 72,3,21120
 tr 74,3,21632
 mf 104,80,152,104
 tr 76,3,21152
 tr 78,3,21664
 mf 108,84,152,108
 tr 80,3,21184
 tr 82,3,21696
 s_waitcnt lgkmcnt(10)
 mz 32,8,128
 tr 84,3,21216
 tr 86,3,21728
 mz 36,12,128
 tr 8,3,25344
 tr 10,3,25856
 s_waitcnt lgkmcnt(10)
 mz 40,16,128
 tr 12,3,25376
 tr 14,3,25888
 mz 44,20,128
 tr 16,3,25408
 tr 18,3,25920
 s_waitcnt lgkmcnt(10)
 mf 32,72,136,32
 tr 20,3,25440
 tr 22,3,25952
 mf 36,76,136,36
 tr 72,3,29568
 tr 74,3,30080
 s_waitcnt lgkmcnt(10)
 mf 40,80,136,40
 tr 76,3,29600
 tr 78,3,30112
 mf 44,84,136,44
 tr 80,3,29632
 tr 82,3,30144
 s_waitcnt lgkmcnt(10)
 mf 32,8,144,32
 tr 84,3,29664
 tr 86,3,30176
 mf 36,12,144,36
 s_waitcnt lgkmcnt(8)
 mf 40,16,144,40
 mf 44,20,144,44
 s_waitcnt vmcnt(0)
 s_waitcnt lgkmcnt(0)
 s_barrier
 ds_read_b128 v[160:163],v68
 ds_read_b128 v[168:171],v69
 ds_read_b128 v[176:179],v70
 ds_read_b128 v[184:187],v71
 tr 8,3,33792
 tr 10,3,34304
 tr 12,3,33824
 tr 14,3,34336
 tr 16,3,33856
 tr 18,3,34368
 mf 32,72,152,32
 tr 20,3,33888
 tr 22,3,34400
 mf 36,76,152,36
 tr 72,3,38016
 tr 74,3,38528
 mf 40,80,152,40
 tr 76,3,38048
 tr 78,3,38560
 mf 44,84,152,44
 tr 80,3,38080
 tr 82,3,38592
 s_waitcnt lgkmcnt(10)
 mf 96,8,160,96
 tr 84,3,38112
 tr 86,3,38624
 mf 100,12,160,100
 tr 8,3,42240
 tr 10,3,42752
 s_waitcnt lgkmcnt(10)
 mf 104,16,160,104
 tr 12,3,42272
 tr 14,3,42784
 mf 108,20,160,108
 tr 16,3,42304
 tr 18,3,42816
 s_waitcnt lgkmcnt(10)
 mf 96,72,168,96
 tr 20,3,42336
 tr 22,3,42848
 mf 100,76,168,100
 tr 72,3,46464
 tr 74,3,46976
 s_waitcnt lgkmcnt(10)
 mf 104,80,168,104
 tr 76,3,46496
 tr 78,3,47008
 mf 108,84,168,108
 tr 80,3,46528
 tr 82,3,47040
 s_waitcnt lgkmcnt(10)
 mf 96,8,176,96
 tr 84,3,46560
 tr 86,3,47072
 mf 100,12,176,100
 s_waitcnt lgkmcnt(8)
 mf 104,16,176,104
 mf 108,20,176,108
 s_waitcnt lgkmcnt(0)
 s_barrier
 tr 8,3,50688
 tr 10,3,51200
 tr 12,3,50720
 tr 14,3,51232
 tr 16,3,50752
 tr 18,3,51264
 mf 96,72,184,96
 tr 20,3,50784
 tr 22,3,51296
 mf 100,76,184,100
 tr 72,3,54912
 tr 74,3,55424
 mf 104,80,184,104
 tr 76,3,54944
 tr 78,3,55456
 mf 108,84,184,108
 tr 80,3,54976
 tr 82,3,55488
 s_waitcnt lgkmcnt(10)
 mf 32,8,160,32
 tr 84,3,55008
 tr 86,3,55520
 mf 36,12,160,36
 tr 8,3,59136
 tr 10,3,59648
 s_waitcnt lgkmcnt(10)
 mf 40,16,160,40
 tr 12,3,59168
 tr 14,3,59680
 mf 44,20,160,44
 tr 16,3,59200
 tr 18,3,59712
 s_waitcnt lgkmcnt(10)
 mf 32,72,168,32
 tr 20,3,59232
 tr 22,3,59744
 mf 36,76,168,36
 tr 72,3,63360
 tr 74,3,63872
 s_waitcnt lgkmcnt(10)
 mf 40,80,168,40
 tr 76,3,63392
 tr 78,3,63904
 mf 44,84,168,44
 tr 80,3,63424
 tr 82,3,63936
 s_waitcnt lgkmcnt(10)
 mf 32,8,176,32
 tr 84,3,63456
 tr 86,3,63968
 mf 36,12,176,36
 s_waitcnt lgkmcnt(8)
 mf 40,16,176,40
 mf 44,20,176,44
 s_waitcnt lgkmcnt(0)
 s_barrier
 ds_read_b128 v[192:195],v64 offset:33792
 ds_read_b128 v[200:203],v65 offset:33792
 ds_read_b128 v[208:211],v66 offset:33792
 ds_read_b128 v[216:219],v67 offset:33792
 ds_read_b64_tr_b16 v[8:9],v3
 tr 10,3,512
 tr 12,3,32
 tr 14,3,544
 tr 16,3,64
 tr 18,3,576
 mf 32,72,184,32
 tr 20,3,96
 tr 22,3,608
 mf 36,76,184,36
 tr 72,3,4224
 tr 74,3,4736
 mf 40,80,184,40
 tr 76,3,4256
 tr 78,3,4768
 mf 44,84,184,44
 tr 80,3,4288
 tr 82,3,4800
 s_waitcnt lgkmcnt(10)
 mf 96,8,192,96
 tr 84,3,4320
 tr 86,3,4832
 mf 100,12,192,100
 tr 8,3,8448
 tr 10,3,8960
 s_waitcnt lgkmcnt(10)
 mf 104,16,192,104
 tr 12,3,8480
 tr 14,3,8992
 mf 108,20,192,108
 tr 16,3,8512
 tr 18,3,9024
 s_waitcnt lgkmcnt(10)
 mf 96,72,200,96
 tr 20,3,8544
 tr 22,3,9056
 mf 100,76,200,100
 tr 72,3,12672
 tr 74,3,13184
 s_waitcnt lgkmcnt(10)
 mf 104,80,200,104
 tr 76,3,12704
 tr 78,3,13216
 mf 108,84,200,108
 tr 80,3,12736
 tr 82,3,13248
 s_waitcnt lgkmcnt(10)
 mf 96,8,208,96
 tr 84,3,12768
 tr 86,3,13280
 mf 100,12,208,100
 s_waitcnt lgkmcnt(8)
 mf 104,16,208,104
 mf 108,20,208,108
 s_waitcnt lgkmcnt(0)
 s_barrier
 ds_read_b128 v[224:227],v68
 ds_read_b128 v[232:235],v69
 ds_read_b128 v[240:243],v70
 ds_read_b128 v[248:251],v71
 tr 8,3,16896
 tr 10,3,17408
 tr 12,3,16928
 tr 14,3,17440
 tr 16,3,16960
 tr 18,3,17472
 mf 96,72,216,96
 tr 20,3,16992
 tr 22,3,17504
 s_xor_b32 s46,s53,0
 s_add_u32 s46,s46,s44
 s_add_u32 m0,s41,67584
 s_add_u32 s40,s46,256
 mf 100,76,216,100
 tr 72,3,21120
 tr 74,3,21632
 mf 104,80,216,104
 tr 76,3,21152
 tr 78,3,21664
 mf 108,84,216,108
 tr 80,3,21184
 tr 82,3,21696
 s_waitcnt lgkmcnt(10)
 mf 96,8,224,96
 tr 84,3,21216
 tr 86,3,21728
 mf 100,12,224,100
 tr 8,3,25344
 tr 10,3,25856
 s_waitcnt lgkmcnt(10)
 mf 104,16,224,104
 tr 12,3,25376
 tr 14,3,25888
 mf 108,20,224,108
 tr 16,3,25408
 tr 18,3,25920
 s_waitcnt lgkmcnt(10)
 mf 96,72,232,96
 tr 20,3,25440
 tr 22,3,25952
 buffer_load_dwordx4 v2,s[16:19],s40 offen lds
 mf 100,76,232,100
 tr 72,3,29568
 tr 74,3,30080
 s_add_u32 m0,s41,68640
 s_add_u32 s40,s46,16640
 s_waitcnt lgkmcnt(10)
 mf 104,80,232,104
 tr 76,3,29600
 tr 78,3,30112
 buffer_load_dwordx4 v2,s[16:19],s40 offen lds
 mf 108,84,232,108
 tr 80,3,29632
 tr 82,3,30144
 s_add_u32 m0,s41,69696
 s_add_u32 s40,s46,65792
 s_waitcnt lgkmcnt(10)
 mf 96,8,240,96
 tr 84,3,29664
 tr 86,3,30176
 buffer_load_dwordx4 v2,s[16:19],s40 offen lds
 mf 100,12,240,100
 s_add_u32 m0,s41,70752
 s_add_u32 s40,s46,82176
 s_waitcnt lgkmcnt(8)
 mf 104,16,240,104
 buffer_load_dwordx4 v2,s[16:19],s40 offen lds
 mf 108,20,240,108
 s_waitcnt lgkmcnt(0)
 s_barrier
 tr 8,3,33792
 tr 10,3,34304
 tr 12,3,33824
 tr 14,3,34336
 tr 16,3,33856
 tr 18,3,34368
 mf 96,72,248,96
 tr 20,3,33888
 tr 22,3,34400
 s_xor_b32 s46,s53,1048576
 s_add_u32 s46,s46,s44
 s_add_u32 m0,s41,84480
 s_add_u32 s40,s46,256
 buffer_load_dwordx4 v2,s[16:19],s40 offen lds
 mf 100,76,248,100
 tr 72,3,38016
 tr 74,3,38528
 s_add_u32 m0,s41,85536
 s_add_u32 s40,s46,16640
 buffer_load_dwordx4 v2,s[16:19],s40 offen lds
 mf 104,80,248,104
 tr 76,3,38048
 tr 78,3,38560
 s_add_u32 m0,s41,86592
 mf 108,84,248,108
 tr 80,3,38080
 tr 82,3,38592
 s_waitcnt lgkmcnt(10)
 mf 32,8,192,32
 tr 84,3,38112
 tr 86,3,38624
 v_mul_f32 v96,s38,v96
 v_mul_f32 v97,s38,v97
 v_mul_f32 v98,s38,v98
 v_mul_f32 v99,s38,v99
 mf 36,12,192,36
 tr 8,3,42240
 tr 10,3,42752
 v_mul_f32 v100,s38,v100
 v_mul_f32 v101,s38,v101
 v_mul_f32 v102,s38,v102
 v_mul_f32 v103,s38,v103
 s_waitcnt lgkmcnt(10)
 mf 40,16,192,40
 tr 12,3,42272
 tr 14,3,42784
 cv 96,96,97
 cv 97,98,99
 cv 98,100,101
 cv 99,102,103
 mf 44,20,192,44
 tr 16,3,42304
 tr 18,3,42816
 ds_write_b64 v6,v[96:97]
 s_waitcnt lgkmcnt(11)
 mf 32,72,200,32
 tr 20,3,42336
 tr 22,3,42848
 ds_write_b64 v6,v[98:99] offset:3584
 v_mul_f32 v104,s38,v104
 mf 36,76,200,36
 tr 72,3,46464
 tr 74,3,46976
 v_mul_f32 v105,s38,v105
 v_mul_f32 v106,s38,v106
 v_mul_f32 v107,s38,v107
 v_mul_f32 v108,s38,v108
 s_waitcnt lgkmcnt(12)
 mf 40,80,200,40
 tr 76,3,46496
 tr 78,3,47008
 v_mul_f32 v109,s38,v109
 v_mul_f32 v110,s38,v110
 v_mul_f32 v111,s38,v111
 cv 104,104,105
 mf 44,84,200,44
 tr 80,3,46528
 tr 82,3,47040
 cv 105,106,107
 cv 106,108,109
 cv 107,110,111
 s_waitcnt lgkmcnt(12)
 mf 32,8,208,32
 tr 84,3,46560
 tr 86,3,47072
 ds_write_b64 v6,v[104:105] offset:7168
 mf 36,12,208,36
 ds_write_b64 v6,v[106:107] offset:10752
 s_add_u32 s40,s46,65792
 s_waitcnt lgkmcnt(11)
 mf 40,16,208,40
 buffer_load_dwordx4 v2,s[16:19],s40 offen lds
 s_add_u32 m0,s41,87648
 mf 44,20,208,44
 s_add_u32 s40,s46,82176
 buffer_load_dwordx4 v2,s[16:19],s40 offen lds
 s_waitcnt lgkmcnt(0)
 s_barrier
 tr 8,3,50688
 tr 10,3,51200
 tr 12,3,50720
 tr 14,3,51232
 tr 16,3,50752
 tr 18,3,51264
 mf 32,72,216,32
 tr 20,3,50784
 tr 22,3,51296
 s_mov_b32 m0,33792
 s_mov_b32 s40,0
 buffer_load_dwordx4 v5,s[12:15],s40 offen nt lds
 mf 36,76,216,36
 tr 72,3,54912
 tr 74,3,55424
 s_mov_b32 m0,33824
 s_nop 0
 buffer_load_dwordx4 v5,s[12:15],s40 offen offset:1024 nt lds
 mf 40,80,216,40
 tr 76,3,54944
 tr 78,3,55456
 s_mov_b32 m0,33856
 s_nop 0
 buffer_load_dwordx4 v5,s[12:15],s40 offen offset:2048 nt lds
 s_mov_b32 m0,33888
 mf 44,84,216,44
 tr 80,3,54976
 tr 82,3,55488
 buffer_load_dwordx4 v5,s[12:15],s40 offen offset:3072 nt lds
 s_mov_b32 m0,38016
 s_waitcnt lgkmcnt(10)
 mf 32,8,224,32
 tr 84,3,55008
 tr 86,3,55520
 s_mov_b32 s40,4096
 buffer_load_dwordx4 v5,s[12:15],s40 offen nt lds
 mf 36,12,224,36
 tr 8,3,59136
 tr 10,3,59648
 s_mov_b32 m0,38048
 s_nop 0
 buffer_load_dwordx4 v5,s[12:15],s40 offen offset:1024 nt lds
 s_mov_b32 m0,38080
 s_waitcnt lgkmcnt(10)
 mf 40,16,224,40
 tr 12,3,59168
 tr 14,3,59680
 buffer_load_dwordx4 v5,s[12:15],s40 offen offset:2048 nt lds
 s_mov_b32 m0,38112
 mf 44,20,224,44
 tr 16,3,59200
 tr 18,3,59712
 buffer_load_dwordx4 v5,s[12:15],s40 offen offset:3072 nt lds
 s_mov_b32 m0,42240
 s_mov_b32 s40,8192
 s_waitcnt lgkmcnt(10)
 mf 32,72,232,32
 tr 20,3,59232
 tr 22,3,59744
 buffer_load_dwordx4 v5,s[12:15],s40 offen nt lds
 s_mov_b32 m0,42272
 mf 36,76,232,36
 tr 72,3,63360
 tr 74,3,63872
 buffer_load_dwordx4 v5,s[12:15],s40 offen offset:1024 nt lds
 s_mov_b32 m0,42304
 s_waitcnt lgkmcnt(10)
 mf 40,80,232,40
 tr 76,3,63392
 tr 78,3,63904
 buffer_load_dwordx4 v5,s[12:15],s40 offen offset:2048 nt lds
 s_mov_b32 m0,42336
 mf 44,84,232,44
 tr 80,3,63424
 tr 82,3,63936
 buffer_load_dwordx4 v5,s[12:15],s40 offen offset:3072 nt lds
 s_mov_b32 m0,46464
 s_mov_b32 s40,12288
 s_waitcnt lgkmcnt(10)
 mf 32,8,240,32
 tr 84,3,63456
 tr 86,3,63968
 buffer_load_dwordx4 v5,s[12:15],s40 offen nt lds
 s_mov_b32 m0,46496
 mf 36,12,240,36
 buffer_load_dwordx4 v5,s[12:15],s40 offen offset:1024 nt lds
 s_mov_b32 m0,46528
 s_waitcnt lgkmcnt(8)
 mf 40,16,240,40
 buffer_load_dwordx4 v5,s[12:15],s40 offen offset:2048 nt lds
 s_mov_b32 m0,46560
 mf 44,20,240,44
 buffer_load_dwordx4 v5,s[12:15],s40 offen offset:3072 nt lds
 s_xor_b32 s46,s53,2097152
 s_add_u32 s46,s46,s44
 s_waitcnt lgkmcnt(4)
 mf 32,72,248,32
 s_add_u32 m0,s41,101376
 s_add_u32 s40,s46,256
 buffer_load_dwordx4 v2,s[16:19],s40 offen lds
 mf 36,76,248,36
 s_add_u32 m0,s41,102432
 s_add_u32 s40,s46,16640
 buffer_load_dwordx4 v2,s[16:19],s40 offen lds
 s_waitcnt lgkmcnt(0)
 mf 40,80,248,40
 s_add_u32 m0,s41,103488
 s_add_u32 s40,s46,65792
 buffer_load_dwordx4 v2,s[16:19],s40 offen lds
 mf 44,84,248,44
 s_add_u32 m0,s41,104544
 s_add_u32 s40,s46,82176
 buffer_load_dwordx4 v2,s[16:19],s40 offen lds
 v_mul_f32 v32,s38,v32
 v_mul_f32 v33,s38,v33
 v_mul_f32 v34,s38,v34
 v_mul_f32 v35,s38,v35
 v_mul_f32 v36,s38,v36
 v_mul_f32 v37,s38,v37
 v_mul_f32 v38,s38,v38
 v_mul_f32 v39,s38,v39
 cv 32,32,33
 cv 33,34,35
 cv 34,36,37
 cv 35,38,39
 ds_write_b64 v6,v[32:33] offset:14336
 ds_write_b64 v6,v[34:35] offset:17920
 v_mul_f32 v40,s38,v40
 v_mul_f32 v41,s38,v41
 v_mul_f32 v42,s38,v42
 v_mul_f32 v43,s38,v43
 v_mul_f32 v44,s38,v44
 v_mul_f32 v45,s38,v45
 v_mul_f32 v46,s38,v46
 v_mul_f32 v47,s38,v47
 cv 40,40,41
 cv 41,42,43
 cv 42,44,45
 cv 43,46,47
 ds_write_b64 v6,v[40:41] offset:21504
 ds_write_b64 v6,v[42:43] offset:25088
 s_waitcnt vmcnt(24)
 s_waitcnt lgkmcnt(0)
 s_barrier
 ds_read_b64_tr_b16 v[16:17],v3
 tr 18,3,512
 tr 20,3,32
 tr 22,3,544
 tr 24,3,64
 tr 26,3,576
 tr 28,3,96
 tr 30,3,608
 tr 8,3,4224
 tr 10,3,4736
 s_waitcnt lgkmcnt(6)
 mz 96,16,128
 tr 12,3,4256
 tr 14,3,4768
 s_xor_b32 s46,s53,3145728
 s_add_u32 s46,s46,s44
 s_add_u32 m0,s41,118272
 s_add_u32 s40,s46,256
 mz 100,20,128
 tr 16,3,4288
 tr 18,3,4800
 s_waitcnt lgkmcnt(6)
 mz 104,24,128
 tr 20,3,4320
 tr 22,3,4832
 mz 108,28,128
 tr 24,3,8448
 tr 26,3,8960
 s_waitcnt lgkmcnt(6)
 mf 96,8,136,96
 tr 28,3,8480
 tr 30,3,8992
 mf 100,12,136,100
 tr 8,3,8512
 tr 10,3,9024
 buffer_load_dwordx4 v2,s[16:19],s40 offen lds
 s_waitcnt lgkmcnt(6)
 mf 104,16,136,104
 tr 12,3,8544
 tr 14,3,9056
 s_add_u32 m0,s41,119328
 s_add_u32 s40,s46,16640
 mf 108,20,136,108
 tr 16,3,12672
 tr 18,3,13184
 buffer_load_dwordx4 v2,s[16:19],s40 offen lds
 s_waitcnt lgkmcnt(6)
 mf 96,24,144,96
 tr 20,3,12704
 tr 22,3,13216
 s_add_u32 m0,s41,120384
 s_add_u32 s40,s46,65792
 mf 100,28,144,100
 tr 24,3,12736
 tr 26,3,13248
 buffer_load_dwordx4 v2,s[16:19],s40 offen lds
 s_waitcnt lgkmcnt(6)
 mf 104,8,144,104
 tr 28,3,12768
 tr 30,3,13280
 s_add_u32 m0,s41,121440
 s_add_u32 s40,s46,82176
 mf 108,12,144,108
 buffer_load_dwordx4 v2,s[16:19],s40 offen lds
 s_waitcnt lgkmcnt(4)
 mf 96,16,152,96
 s_waitcnt vmcnt(24)
 s_waitcnt lgkmcnt(0)
 s_barrier
 tr 8,3,16896
 tr 10,3,17408
 tr 12,3,16928
 tr 14,3,17440
 mf 100,20,152,100
 tr 16,3,16960
 tr 18,3,17472
 s_mov_b32 m0,16896
 s_mov_b32 s40,32768
 buffer_load_dwordx4 v5,s[8:11],s40 offen nt lds
 s_mov_b32 m0,16928
 s_nop 0
 buffer_load_dwordx4 v5,s[8:11],s40 offen offset:1024 nt lds
 s_mov_b32 m0,16960
 s_nop 0
 buffer_load_dwordx4 v5,s[8:11],s40 offen offset:2048 nt lds
 s_mov_b32 m0,16992
 s_nop 0
 buffer_load_dwordx4 v5,s[8:11],s40 offen offset:3072 nt lds
 s_mov_b32 m0,21120
 s_mov_b32 s40,36864
 mf 104,24,152,104
 tr 20,3,16992
 tr 22,3,17504
 buffer_load_dwordx4 v5,s[8:11],s40 offen nt lds
 s_mov_b32 m0,21152
 s_nop 0
 buffer_load_dwordx4 v5,s[8:11],s40 offen offset:1024 nt lds
 s_mov_b32 m0,21184
 s_nop 0
 buffer_load_dwordx4 v5,s[8:11],s40 offen offset:2048 nt lds
 s_mov_b32 m0,21216
 s_nop 0
 buffer_load_dwordx4 v5,s[8:11],s40 offen offset:3072 nt lds
 s_mov_b32 m0,25344
 s_mov_b32 s40,40960
 mf 108,28,152,108
 tr 24,3,21120
 tr 26,3,21632
 buffer_load_dwordx4 v5,s[8:11],s40 offen nt lds
 s_mov_b32 m0,25376
 s_nop 0
 buffer_load_dwordx4 v5,s[8:11],s40 offen offset:1024 nt lds
 s_mov_b32 m0,25408
 s_nop 0
 buffer_load_dwordx4 v5,s[8:11],s40 offen offset:2048 nt lds
 s_mov_b32 m0,25440
 s_nop 0
 buffer_load_dwordx4 v5,s[8:11],s40 offen offset:3072 nt lds
 s_mov_b32 m0,29568
 s_mov_b32 s40,45056
 s_waitcnt lgkmcnt(6)
 mf 96,8,160,96
 tr 28,3,21152
 tr 30,3,21664
 buffer_load_dwordx4 v5,s[8:11],s40 offen nt lds
 s_mov_b32 m0,29600
 s_nop 0
 buffer_load_dwordx4 v5,s[8:11],s40 offen offset:1024 nt lds
 s_mov_b32 m0,29632
 s_nop 0
 buffer_load_dwordx4 v5,s[8:11],s40 offen offset:2048 nt lds
 s_mov_b32 m0,29664
 s_nop 0
 buffer_load_dwordx4 v5,s[8:11],s40 offen offset:3072 nt lds
 s_mov_b32 m0,50688
 s_mov_b32 s40,16384
 mf 100,12,160,100
 tr 8,3,21184
 tr 10,3,21696
 buffer_load_dwordx4 v5,s[12:15],s40 offen nt lds
 s_mov_b32 m0,50720
 s_nop 0
 buffer_load_dwordx4 v5,s[12:15],s40 offen offset:1024 nt lds
 s_mov_b32 m0,50752
 s_nop 0
 buffer_load_dwordx4 v5,s[12:15],s40 offen offset:2048 nt lds
 s_mov_b32 m0,50784
 s_nop 0
 buffer_load_dwordx4 v5,s[12:15],s40 offen offset:3072 nt lds
 s_mov_b32 m0,54912
 s_mov_b32 s40,20480
 buffer_load_dwordx4 v5,s[12:15],s40 offen nt lds
 s_waitcnt lgkmcnt(6)
 mf 104,16,160,104
 tr 12,3,21216
 tr 14,3,21728
 s_mov_b32 m0,54944
 s_nop 0
 buffer_load_dwordx4 v5,s[12:15],s40 offen offset:1024 nt lds
 s_mov_b32 m0,54976
 s_nop 0
 buffer_load_dwordx4 v5,s[12:15],s40 offen offset:2048 nt lds
 s_mov_b32 m0,55008
 s_nop 0
 buffer_load_dwordx4 v5,s[12:15],s40 offen offset:3072 nt lds
 s_mov_b32 m0,59136
 s_mov_b32 s40,24576
 buffer_load_dwordx4 v5,s[12:15],s40 offen nt lds
 s_mov_b32 m0,59168
 mf 108,20,160,108
 buffer_load_dwordx4 v5,s[12:15],s40 offen offset:1024 nt lds
 s_mov_b32 m0,59200
 s_nop 0
 buffer_load_dwordx4 v5,s[12:15],s40 offen offset:2048 nt lds
 s_mov_b32 m0,59232
 s_nop 0
 buffer_load_dwordx4 v5,s[12:15],s40 offen offset:3072 nt lds
 s_mov_b32 m0,63360
 s_mov_b32 s40,28672
 buffer_load_dwordx4 v5,s[12:15],s40 offen nt lds
 s_mov_b32 m0,63392
 s_nop 0
 buffer_load_dwordx4 v5,s[12:15],s40 offen offset:1024 nt lds
 s_waitcnt lgkmcnt(4)
 mf 96,24,168,96
 s_mov_b32 m0,63424
 s_nop 0
 buffer_load_dwordx4 v5,s[12:15],s40 offen offset:2048 nt lds
 s_mov_b32 m0,63456
 s_nop 0
 buffer_load_dwordx4 v5,s[12:15],s40 offen offset:3072 nt lds
 s_xor_b32 s46,s53,0
 s_add_u32 s46,s46,s44
 s_add_u32 m0,s41,67584
 s_add_u32 s40,s46,384
 buffer_load_dwordx4 v2,s[16:19],s40 offen lds
 s_add_u32 m0,s41,68640
 s_add_u32 s40,s46,16768
 buffer_load_dwordx4 v2,s[16:19],s40 offen lds
 s_waitcnt vmcnt(38)
 s_waitcnt lgkmcnt(0)
 s_barrier
 tr 16,3,25344
 tr 18,3,25856
 tr 20,3,25376
 tr 22,3,25888
 mf 100,28,168,100
 tr 24,3,25408
 tr 26,3,25920
 s_xor_b32 s46,s53,0
 s_add_u32 s46,s46,s44
 s_add_u32 m0,s41,69696
 s_add_u32 s40,s46,65920
 mf 104,8,168,104
 tr 28,3,25440
 tr 30,3,25952
 mf 108,12,168,108
 tr 8,3,29568
 tr 10,3,30080
 s_waitcnt lgkmcnt(6)
 mf 96,16,176,96
 tr 12,3,29600
 tr 14,3,30112
 mf 100,20,176,100
 tr 16,3,29632
 tr 18,3,30144
 s_waitcnt lgkmcnt(6)
 mf 104,24,176,104
 tr 20,3,29664
 tr 22,3,30176
 mf 108,28,176,108
 tr 24,3,33792
 tr 26,3,34304
 s_waitcnt lgkmcnt(6)
 mf 96,8,184,96
 tr 28,3,33824
 tr 30,3,34336
 mf 100,12,184,100
 tr 8,3,33856
 tr 10,3,34368
 buffer_load_dwordx4 v2,s[16:19],s40 offen lds
 s_waitcnt lgkmcnt(6)
 mf 104,16,184,104
 tr 12,3,33888
 tr 14,3,34400
 s_add_u32 m0,s41,70752
 s_add_u32 s40,s46,82304
 mf 108,20,184,108
 buffer_load_dwordx4 v2,s[16:19],s40 offen lds
 s_waitcnt lgkmcnt(4)
 mf 96,24,192,96
 s_waitcnt vmcnt(20)
 s_waitcnt lgkmcnt(0)
 s_barrier
 tr 16,3,38016
 tr 18,3,38528
 tr 20,3,38048
 tr 22,3,38560
 mf 100,28,192,100
 tr 24,3,38080
 tr 26,3,38592
 s_mov_b32 m0,0
 s_mov_b32 s40,49152
 buffer_load_dwordx4 v5,s[8:11],s40 offen nt lds
 s_mov_b32 m0,32
 s_nop 0
 buffer_load_dwordx4 v5,s[8:11],s40 offen offset:1024 nt lds
 s_mov_b32 m0,64
 mf 104,8,192,104
 tr 28,3,38112
 tr 30,3,38624
 buffer_load_dwordx4 v5,s[8:11],s40 offen offset:2048 nt lds
 s_mov_b32 m0,96
 s_nop 0
 buffer_load_dwordx4 v5,s[8:11],s40 offen offset:3072 nt lds
 s_mov_b32 m0,4224
 s_mov_b32 s40,53248
 mf 108,12,192,108
 tr 8,3,42240
 tr 10,3,42752
 buffer_load_dwordx4 v5,s[8:11],s40 offen nt lds
 s_mov_b32 m0,4256
 s_nop 0
 buffer_load_dwordx4 v5,s[8:11],s40 offen offset:1024 nt lds
 s_mov_b32 m0,4288
 s_waitcnt lgkmcnt(6)
 mf 96,16,200,96
 tr 12,3,42272
 tr 14,3,42784
 buffer_load_dwordx4 v5,s[8:11],s40 offen offset:2048 nt lds
 s_mov_b32 m0,4320
 s_nop 0
 buffer_load_dwordx4 v5,s[8:11],s40 offen offset:3072 nt lds
 s_mov_b32 m0,8448
 s_mov_b32 s40,57344
 mf 100,20,200,100
 tr 16,3,42304
 tr 18,3,42816
 buffer_load_dwordx4 v5,s[8:11],s40 offen nt lds
 s_mov_b32 m0,8480
 s_nop 0
 buffer_load_dwordx4 v5,s[8:11],s40 offen offset:1024 nt lds
 s_mov_b32 m0,8512
 s_nop 0
 buffer_load_dwordx4 v5,s[8:11],s40 offen offset:2048 nt lds
 s_waitcnt lgkmcnt(6)
 mf 104,24,200,104
 tr 20,3,42336
 tr 22,3,42848
 s_mov_b32 m0,8544
 s_nop 0
 buffer_load_dwordx4 v5,s[8:11],s40 offen offset:3072 nt lds
 s_mov_b32 m0,12672
 s_mov_b32 s40,61440
 buffer_load_dwordx4 v5,s[8:11],s40 offen nt lds
 s_mov_b32 m0,12704
 mf 108,28,200,108
 buffer_load_dwordx4 v5,s[8:11],s40 offen offset:1024 nt lds
 s_mov_b32 m0,12736
 s_nop 0
 buffer_load_dwordx4 v5,s[8:11],s40 offen offset:2048 nt lds
 s_mov_b32 m0,12768
 s_nop 0
 buffer_load_dwordx4 v5,s[8:11],s40 offen offset:3072 nt lds
 s_waitcnt lgkmcnt(4)
 mf 96,8,208,96
 s_xor_b32 s46,s53,1048576
 s_add_u32 s46,s46,s44
 s_add_u32 m0,s41,84480
 s_add_u32 s40,s46,384
 buffer_load_dwordx4 v2,s[16:19],s40 offen lds
 s_add_u32 m0,s41,85536
 s_add_u32 s40,s46,16768
 buffer_load_dwordx4 v2,s[16:19],s40 offen lds
 s_waitcnt vmcnt(22)
 s_waitcnt lgkmcnt(0)
 s_barrier
 tr 24,3,46464
 tr 26,3,46976
 tr 28,3,46496
 tr 30,3,47008
 mf 100,12,208,100
 tr 8,3,46528
 tr 10,3,47040
 s_mov_b32 m0,33792
 s_mov_b32 s40,32768
 buffer_load_dwordx4 v5,s[12:15],s40 offen nt lds
 s_mov_b32 m0,33824
 mf 104,16,208,104
 tr 12,3,46560
 tr 14,3,47072
 buffer_load_dwordx4 v5,s[12:15],s40 offen offset:1024 nt lds
 s_mov_b32 m0,33856
 s_nop 0
 buffer_load_dwordx4 v5,s[12:15],s40 offen offset:2048 nt lds
 mf 108,20,208,108
 tr 16,3,50688
 tr 18,3,51200
 s_mov_b32 m0,33888
 s_nop 0
 buffer_load_dwordx4 v5,s[12:15],s40 offen offset:3072 nt lds
 s_mov_b32 m0,38016
 s_mov_b32 s40,36864
 s_waitcnt lgkmcnt(6)
 mf 96,24,216,96
 tr 20,3,50720
 tr 22,3,51232
 buffer_load_dwordx4 v5,s[12:15],s40 offen nt lds
 s_mov_b32 m0,38048
 s_nop 0
 buffer_load_dwordx4 v5,s[12:15],s40 offen offset:1024 nt lds
 mf 100,28,216,100
 tr 24,3,50752
 tr 26,3,51264
 s_mov_b32 m0,38080
 s_nop 0
 buffer_load_dwordx4 v5,s[12:15],s40 offen offset:2048 nt lds
 s_mov_b32 m0,38112
 s_nop 0
 buffer_load_dwordx4 v5,s[12:15],s40 offen offset:3072 nt lds
 s_waitcnt lgkmcnt(6)
 mf 104,8,216,104
 tr 28,3,50784
 tr 30,3,51296
 s_mov_b32 m0,42240
 s_mov_b32 s40,40960
 buffer_load_dwordx4 v5,s[12:15],s40 offen nt lds
 s_mov_b32 m0,42272
 mf 108,12,216,108
 tr 8,3,54912
 tr 10,3,55424
 buffer_load_dwordx4 v5,s[12:15],s40 offen offset:1024 nt lds
 s_mov_b32 m0,42304
 s_nop 0
 buffer_load_dwordx4 v5,s[12:15],s40 offen offset:2048 nt lds
 s_waitcnt lgkmcnt(6)
 mf 96,16,224,96
 tr 12,3,54944
 tr 14,3,55456
 s_mov_b32 m0,42336
 s_nop 0
 buffer_load_dwordx4 v5,s[12:15],s40 offen offset:3072 nt lds
 s_mov_b32 m0,46464
 s_mov_b32 s40,45056
 mf 100,20,224,100
 tr 16,3,54976
 tr 18,3,55488
 buffer_load_dwordx4 v5,s[12:15],s40 offen nt lds
 s_mov_b32 m0,46496
 s_nop 0
 buffer_load_dwordx4 v5,s[12:15],s40 offen offset:1024 nt lds
 s_waitcnt lgkmcnt(6)
 mf 104,24,224,104
 tr 20,3,55008
 tr 22,3,55520
 s_mov_b32 m0,46528
 s_nop 0
 buffer_load_dwordx4 v5,s[12:15],s40 offen offset:2048 nt lds
 s_mov_b32 m0,46560
 mf 108,28,224,108
 buffer_load_dwordx4 v5,s[12:15],s40 offen offset:3072 nt lds
 s_xor_b32 s46,s53,1048576
 s_add_u32 s46,s46,s44
 s_add_u32 m0,s41,86592
 s_add_u32 s40,s46,65920
 s_waitcnt lgkmcnt(4)
 mf 96,8,232,96
 buffer_load_dwordx4 v2,s[16:19],s40 offen lds
 s_add_u32 m0,s41,87648
 s_add_u32 s40,s46,82304
 buffer_load_dwordx4 v2,s[16:19],s40 offen lds
 s_waitcnt vmcnt(20)
 s_waitcnt lgkmcnt(0)
 s_barrier
 tr 24,3,59136
 tr 26,3,59648
 tr 28,3,59168
 tr 30,3,59680
 mf 100,12,232,100
 tr 8,3,59200
 tr 10,3,59712
 s_mov_b32 m0,16896
 s_mov_b32 s40,65536
 buffer_load_dwordx4 v5,s[8:11],s40 offen nt lds
 s_mov_b32 m0,16928
 s_nop 0
 buffer_load_dwordx4 v5,s[8:11],s40 offen offset:1024 nt lds
 s_mov_b32 m0,16960
 mf 104,16,232,104
 tr 12,3,59232
 tr 14,3,59744
 buffer_load_dwordx4 v5,s[8:11],s40 offen offset:2048 nt lds
 s_mov_b32 m0,16992
 s_nop 0
 buffer_load_dwordx4 v5,s[8:11],s40 offen offset:3072 nt lds
 s_mov_b32 m0,21120
 s_mov_b32 s40,69632
 mf 108,20,232,108
 tr 16,3,63360
 tr 18,3,63872
 buffer_load_dwordx4 v5,s[8:11],s40 offen nt lds
 s_mov_b32 m0,21152
 s_nop 0
 buffer_load_dwordx4 v5,s[8:11],s40 offen offset:1024 nt lds
 s_mov_b32 m0,21184
 s_waitcnt lgkmcnt(6)
 mf 96,24,240,96
 tr 20,3,63392
 tr 22,3,63904
 buffer_load_dwordx4 v5,s[8:11],s40 offen offset:2048 nt lds
 s_mov_b32 m0,21216
 s_nop 0
 buffer_load_dwordx4 v5,s[8:11],s40 offen offset:3072 nt lds
 s_mov_b32 m0,25344
 s_mov_b32 s40,73728
 mf 100,28,240,100
 tr 24,3,63424
 tr 26,3,63936
 buffer_load_dwordx4 v5,s[8:11],s40 offen nt lds
 s_mov_b32 m0,25376
 s_nop 0
 buffer_load_dwordx4 v5,s[8:11],s40 offen offset:1024 nt lds
 s_mov_b32 m0,25408
 s_nop 0
 buffer_load_dwordx4 v5,s[8:11],s40 offen offset:2048 nt lds
 s_waitcnt lgkmcnt(6)
 mf 104,8,240,104
 tr 28,3,63456
 tr 30,3,63968
 s_mov_b32 m0,25440
 s_nop 0
 buffer_load_dwordx4 v5,s[8:11],s40 offen offset:3072 nt lds
 s_mov_b32 m0,29568
 s_mov_b32 s40,77824
 buffer_load_dwordx4 v5,s[8:11],s40 offen nt lds
 s_mov_b32 m0,29600
 mf 108,12,240,108
 buffer_load_dwordx4 v5,s[8:11],s40 offen offset:1024 nt lds
 s_mov_b32 m0,29632
 s_nop 0
 buffer_load_dwordx4 v5,s[8:11],s40 offen offset:2048 nt lds
 s_mov_b32 m0,29664
 s_nop 0
 buffer_load_dwordx4 v5,s[8:11],s40 offen offset:3072 nt lds
 s_waitcnt lgkmcnt(4)
 mf 96,16,248,96
 s_xor_b32 s46,s53,2097152
 s_add_u32 s46,s46,s44
 s_add_u32 m0,s41,101376
 s_add_u32 s40,s46,384
 buffer_load_dwordx4 v2,s[16:19],s40 offen lds
 s_add_u32 m0,s41,102432
 s_add_u32 s40,s46,16768
 buffer_load_dwordx4 v2,s[16:19],s40 offen lds
 s_waitcnt vmcnt(20)
 s_waitcnt lgkmcnt(0)
 s_barrier
 ds_read_b64_tr_b16 v[8:9],v3
 tr 10,3,512
 tr 12,3,32
 tr 14,3,544
 mf 100,20,248,100
 tr 16,3,64
 tr 18,3,576
 s_mov_b32 m0,50688
 s_mov_b32 s40,49152
 buffer_load_dwordx4 v5,s[12:15],s40 offen nt lds
 s_mov_b32 m0,50720
 s_nop 0
 buffer_load_dwordx4 v5,s[12:15],s40 offen offset:1024 nt lds
 s_mov_b32 m0,50752
 s_nop 0
 buffer_load_dwordx4 v5,s[12:15],s40 offen offset:2048 nt lds
 s_mov_b32 m0,50784
 s_nop 0
 buffer_load_dwordx4 v5,s[12:15],s40 offen offset:3072 nt lds
 s_mov_b32 m0,54912
 s_mov_b32 s40,53248
 buffer_load_dwordx4 v5,s[12:15],s40 offen nt lds
 s_mov_b32 m0,54944
 s_nop 0
 buffer_load_dwordx4 v5,s[12:15],s40 offen offset:1024 nt lds
 s_mov_b32 m0,54976
 s_nop 0
 buffer_load_dwordx4 v5,s[12:15],s40 offen offset:2048 nt lds
 s_mov_b32 m0,55008
 s_nop 0
 buffer_load_dwordx4 v5,s[12:15],s40 offen offset:3072 nt lds
 s_mov_b32 m0,59136
 s_mov_b32 s40,57344
 mf 104,24,248,104
 tr 20,3,96
 tr 22,3,608
 buffer_load_dwordx4 v5,s[12:15],s40 offen nt lds
 s_mov_b32 m0,59168
 s_nop 0
 buffer_load_dwordx4 v5,s[12:15],s40 offen offset:1024 nt lds
 s_mov_b32 m0,59200
 s_nop 0
 buffer_load_dwordx4 v5,s[12:15],s40 offen offset:2048 nt lds
 s_mov_b32 m0,59232
 s_nop 0
 buffer_load_dwordx4 v5,s[12:15],s40 offen offset:3072 nt lds
 s_mov_b32 m0,63360
 s_mov_b32 s40,61440
 buffer_load_dwordx4 v5,s[12:15],s40 offen nt lds
 s_mov_b32 m0,63392
 s_nop 0
 buffer_load_dwordx4 v5,s[12:15],s40 offen offset:1024 nt lds
 s_mov_b32 m0,63424
 s_nop 0
 buffer_load_dwordx4 v5,s[12:15],s40 offen offset:2048 nt lds
 s_mov_b32 m0,63456
 s_nop 0
 buffer_load_dwordx4 v5,s[12:15],s40 offen offset:3072 nt lds
 mf 108,28,248,108
 v_mul_f32 v96,s38,v96
 v_mul_f32 v97,s38,v97
 v_mul_f32 v98,s38,v98
 v_mul_f32 v99,s38,v99
 v_mul_f32 v100,s38,v100
 v_mul_f32 v101,s38,v101
 v_mul_f32 v102,s38,v102
 v_mul_f32 v103,s38,v103
 cv 96,96,97
 cv 97,98,99
 cv 98,100,101
 cv 99,102,103
 ds_write_b64 v6,v[96:97]
 ds_write_b64 v6,v[98:99] offset:3584
 v_mul_f32 v104,s38,v104
 v_mul_f32 v105,s38,v105
 v_mul_f32 v106,s38,v106
 v_mul_f32 v107,s38,v107
 v_mul_f32 v108,s38,v108
 v_mul_f32 v109,s38,v109
 v_mul_f32 v110,s38,v110
 v_mul_f32 v111,s38,v111
 cv 104,104,105
 cv 105,106,107
 cv 106,108,109
 cv 107,110,111
 ds_write_b64 v6,v[104:105] offset:7168
 ds_write_b64 v6,v[106:107] offset:10752
 s_waitcnt lgkmcnt(8)
 mz 96,8,128
 s_xor_b32 s46,s53,2097152
 s_add_u32 s46,s46,s44
 s_add_u32 m0,s41,103488
 s_add_u32 s40,s46,65920
 buffer_load_dwordx4 v2,s[16:19],s40 offen lds
 s_add_u32 m0,s41,104544
 s_add_u32 s40,s46,82304
 buffer_load_dwordx4 v2,s[16:19],s40 offen lds
 s_xor_b32 s46,s53,3145728
 s_add_u32 s46,s46,s44
 s_add_u32 m0,s41,118272
 s_add_u32 s40,s46,384
 buffer_load_dwordx4 v2,s[16:19],s40 offen lds
 s_waitcnt vmcnt(21)
 s_waitcnt lgkmcnt(0)
 s_barrier
 tr 24,3,4224
 tr 26,3,4736
 tr 28,3,4256
 tr 30,3,4768
 mz 100,12,128
 tr 8,3,4288
 tr 10,3,4800
 s_mov_b32 m0,0
 s_mov_b32 s40,81920
 buffer_load_dwordx4 v5,s[8:11],s40 offen nt lds
 s_mov_b32 m0,32
 s_nop 0
 buffer_load_dwordx4 v5,s[8:11],s40 offen offset:1024 nt lds
 s_mov_b32 m0,64
 mz 104,16,128
 tr 12,3,4320
 tr 14,3,4832
 buffer_load_dwordx4 v5,s[8:11],s40 offen offset:2048 nt lds
 s_mov_b32 m0,96
 s_nop 0
 buffer_load_dwordx4 v5,s[8:11],s40 offen offset:3072 nt lds
 s_mov_b32 m0,4224
 s_mov_b32 s40,86016
 mz 108,20,128
 tr 16,3,8448
 tr 18,3,8960
 buffer_load_dwordx4 v5,s[8:11],s40 offen nt lds
 s_mov_b32 m0,4256
 s_nop 0
 buffer_load_dwordx4 v5,s[8:11],s40 offen offset:1024 nt lds
 s_mov_b32 m0,4288
 s_waitcnt lgkmcnt(6)
 mf 96,24,136,96
 tr 20,3,8480
 tr 22,3,8992
 buffer_load_dwordx4 v5,s[8:11],s40 offen offset:2048 nt lds
 s_mov_b32 m0,4320
 s_nop 0
 buffer_load_dwordx4 v5,s[8:11],s40 offen offset:3072 nt lds
 s_mov_b32 m0,8448
 s_mov_b32 s40,90112
 mf 100,28,136,100
 tr 24,3,8512
 tr 26,3,9024
 buffer_load_dwordx4 v5,s[8:11],s40 offen nt lds
 s_mov_b32 m0,8480
 s_nop 0
 buffer_load_dwordx4 v5,s[8:11],s40 offen offset:1024 nt lds
 s_mov_b32 m0,8512
 s_nop 0
 buffer_load_dwordx4 v5,s[8:11],s40 offen offset:2048 nt lds
 s_waitcnt lgkmcnt(6)
 mf 104,8,136,104
 tr 28,3,8544
 tr 30,3,9056
 s_mov_b32 m0,8544
 s_nop 0
 buffer_load_dwordx4 v5,s[8:11],s40 offen offset:3072 nt lds
 s_mov_b32 m0,12672
 s_mov_b32 s40,94208
 buffer_load_dwordx4 v5,s[8:11],s40 offen nt lds
 s_mov_b32 m0,12704
 mf 108,12,136,108
 buffer_load_dwordx4 v5,s[8:11],s40 offen offset:1024 nt lds
 s_mov_b32 m0,12736
 s_nop 0
 buffer_load_dwordx4 v5,s[8:11],s40 offen offset:2048 nt lds
 s_mov_b32 m0,12768
 s_nop 0
 buffer_load_dwordx4 v5,s[8:11],s40 offen offset:3072 nt lds
 s_waitcnt lgkmcnt(4)
 mf 96,16,144,96
 s_xor_b32 s46,s53,3145728
 s_add_u32 s46,s46,s44
 s_add_u32 m0,s41,119328
 s_add_u32 s40,s46,16768
 buffer_load_dwordx4 v2,s[16:19],s40 offen lds
 s_add_u32 m0,s41,120384
 s_add_u32 s40,s46,65920
 buffer_load_dwordx4 v2,s[16:19],s40 offen lds
 s_waitcnt vmcnt(21)
 s_waitcnt lgkmcnt(0)
 s_barrier
 tr 8,3,12672
 tr 10,3,13184
 tr 12,3,12704
 tr 14,3,13216
 mf 100,20,144,100
 tr 16,3,12736
 tr 18,3,13248
 s_mov_b32 m0,33792
 s_mov_b32 s40,65536
 buffer_load_dwordx4 v5,s[12:15],s40 offen nt lds
 s_mov_b32 m0,33824
 mf 104,24,144,104
 tr 20,3,12768
 tr 22,3,13280
 buffer_load_dwordx4 v5,s[12:15],s40 offen offset:1024 nt lds
 s_mov_b32 m0,33856
 mf 108,28,144,108
 tr 24,3,16896
 tr 26,3,17408
 buffer_load_dwordx4 v5,s[12:15],s40 offen offset:2048 nt lds
 s_mov_b32 m0,33888
 s_nop 0
 buffer_load_dwordx4 v5,s[12:15],s40 offen offset:3072 nt lds
 s_waitcnt lgkmcnt(6)
 mf 96,8,152,96
 tr 28,3,16928
 tr 30,3,17440
 s_mov_b32 m0,38016
 s_mov_b32 s40,69632
 buffer_load_dwordx4 v5,s[12:15],s40 offen nt lds
 s_mov_b32 m0,38048
 mf 100,12,152,100
 tr 8,3,16960
 tr 10,3,17472
 buffer_load_dwordx4 v5,s[12:15],s40 offen offset:1024 nt lds
 s_mov_b32 m0,38080
 s_nop 0
 buffer_load_dwordx4 v5,s[12:15],s40 offen offset:2048 nt lds
 s_waitcnt lgkmcnt(6)
 mf 104,16,152,104
 tr 12,3,16992
 tr 14,3,17504
 s_mov_b32 m0,38112
 s_nop 0
 buffer_load_dwordx4 v5,s[12:15],s40 offen offset:3072 nt lds
 s_mov_b32 m0,42240
 s_mov_b32 s40,73728
 mf 108,20,152,108
 tr 16,3,21120
 tr 18,3,21632
 buffer_load_dwordx4 v5,s[12:15],s40 offen nt lds
 s_mov_b32 m0,42272
 s_nop 0
 buffer_load_dwordx4 v5,s[12:15],s40 offen offset:1024 nt lds
 s_waitcnt lgkmcnt(6)
 mf 96,24,160,96
 tr 20,3,21152
 tr 22,3,21664
 s_mov_b32 m0,42304
 s_nop 0
 buffer_load_dwordx4 v5,s[12:15],s40 offen offset:2048 nt lds
 s_mov_b32 m0,42336
 mf 100,28,160,100
 tr 24,3,21184
 tr 26,3,21696
 buffer_load_dwordx4 v5,s[12:15],s40 offen offset:3072 nt lds
 s_mov_b32 m0,46464
 s_mov_b32 s40,77824
 buffer_load_dwordx4 v5,s[12:15],s40 offen nt lds
 s_waitcnt lgkmcnt(6)
 mf 104,8,160,104
 tr 28,3,21216
 tr 30,3,21728
 s_mov_b32 m0,46496
 s_nop 0
 buffer_load_dwordx4 v5,s[12:15],s40 offen offset:1024 nt lds
 s_mov_b32 m0,46528
 mf 108,12,160,108
 buffer_load_dwordx4 v5,s[12:15],s40 offen offset:2048 nt lds
 s_mov_b32 m0,46560
 s_nop 0
 buffer_load_dwordx4 v5,s[12:15],s40 offen offset:3072 nt lds
 s_waitcnt lgkmcnt(4)
 mf 96,16,168,96
 s_xor_b32 s46,s53,3145728
 s_add_u32 s46,s46,s44
 s_add_u32 m0,s41,121440
 s_add_u32 s40,s46,82304
 buffer_load_dwordx4 v2,s[16:19],s40 offen lds
 s_waitcnt vmcnt(19)
 s_waitcnt lgkmcnt(0)
 s_barrier
 tr 8,3,25344
 tr 10,3,25856
 tr 12,3,25376
 tr 14,3,25888
 mf 100,20,168,100
 tr 16,3,25408
 tr 18,3,25920
 s_mov_b32 m0,16896
 s_mov_b32 s40,98304
 buffer_load_dwordx4 v5,s[8:11],s40 offen nt lds
 s_mov_b32 m0,16928
 s_nop 0
 buffer_load_dwordx4 v5,s[8:11],s40 offen offset:1024 nt lds
 s_mov_b32 m0,16960
 mf 104,24,168,104
 tr 20,3,25440
 tr 22,3,25952
 buffer_load_dwordx4 v5,s[8:11],s40 offen offset:2048 nt lds
 s_mov_b32 m0,16992
 s_nop 0
 buffer_load_dwordx4 v5,s[8:11],s40 offen offset:3072 nt lds
 s_mov_b32 m0,21120
 s_mov_b32 s40,102400
 mf 108,28,168,108
 tr 24,3,29568
 tr 26,3,30080
 buffer_load_dwordx4 v5,s[8:11],s40 offen nt lds
 s_mov_b32 m0,21152
 s_nop 0
 buffer_load_dwordx4 v5,s[8:11],s40 offen offset:1024 nt lds
 s_mov_b32 m0,21184
 s_waitcnt lgkmcnt(6)
 mf 96,8,176,96
 tr 28,3,29600
 tr 30,3,30112
 buffer_load_dwordx4 v5,s[8:11],s40 offen offset:2048 nt lds
 s_mov_b32 m0,21216
 s_nop 0
 buffer_load_dwordx4 v5,s[8:11],s40 offen offset:3072 nt lds
 s_mov_b32 m0,25344
 s_mov_b32 s40,106496
 mf 100,12,176,100
 tr 8,3,29632
 tr 10,3,30144
 buffer_load_dwordx4 v5,s[8:11],s40 offen nt lds
 s_mov_b32 m0,25376
 s_nop 0
 buffer_load_dwordx4 v5,s[8:11],s40 offen offset:1024 nt lds
 s_mov_b32 m0,25408
 s_nop 0
 buffer_load_dwordx4 v5,s[8:11],s40 offen offset:2048 nt lds
 s_waitcnt lgkmcnt(6)
 mf 104,16,176,104
 tr 12,3,29664
 tr 14,3,30176
 s_mov_b32 m0,25440
 s_nop 0
 buffer_load_dwordx4 v5,s[8:11],s40 offen offset:3072 nt lds
 s_mov_b32 m0,29568
 s_mov_b32 s40,110592
 buffer_load_dwordx4 v5,s[8:11],s40 offen nt lds
 s_mov_b32 m0,29600
 mf 108,20,176,108
 buffer_load_dwordx4 v5,s[8:11],s40 offen offset:1024 nt lds
 s_mov_b32 m0,29632
 s_nop 0
 buffer_load_dwordx4 v5,s[8:11],s40 offen offset:2048 nt lds
 s_mov_b32 m0,29664
 s_nop 0
 buffer_load_dwordx4 v5,s[8:11],s40 offen offset:3072 nt lds
 s_waitcnt lgkmcnt(4)
 mf 96,24,184,96
 s_xor_b32 s46,s53,0
 s_add_u32 s46,s46,s44
 s_add_u32 m0,s41,67584
 s_add_u32 s40,s46,512
 buffer_load_dwordx4 v2,s[16:19],s40 offen lds
 s_add_u32 m0,s41,68640
 s_add_u32 s40,s46,16896
 buffer_load_dwordx4 v2,s[16:19],s40 offen lds
 s_waitcnt vmcnt(19)
 s_waitcnt lgkmcnt(0)
 s_barrier
 tr 16,3,33792
 tr 18,3,34304
 tr 20,3,33824
 tr 22,3,34336
 mf 100,28,184,100
 tr 24,3,33856
 tr 26,3,34368
 s_mov_b32 m0,50688
 s_mov_b32 s40,81920
 buffer_load_dwordx4 v5,s[12:15],s40 offen nt lds
 s_mov_b32 m0,50720
 s_nop 0
 buffer_load_dwordx4 v5,s[12:15],s40 offen offset:1024 nt lds
 mf 104,8,184,104
 tr 28,3,33888
 tr 30,3,34400
 s_mov_b32 m0,50752
 s_nop 0
 buffer_load_dwordx4 v5,s[12:15],s40 offen offset:2048 nt lds
 s_mov_b32 m0,50784
 s_nop 0
 buffer_load_dwordx4 v5,s[12:15],s40 offen offset:3072 nt lds
 mf 108,12,184,108
 tr 8,3,38016
 tr 10,3,38528
 s_mov_b32 m0,54912
 s_mov_b32 s40,86016
 buffer_load_dwordx4 v5,s[12:15],s40 offen nt lds
 s_mov_b32 m0,54944
 s_waitcnt lgkmcnt(6)
 mf 96,16,192,96
 tr 12,3,38048
 tr 14,3,38560
 buffer_load_dwordx4 v5,s[12:15],s40 offen offset:1024 nt lds
 s_mov_b32 m0,54976
 s_nop 0
 buffer_load_dwordx4 v5,s[12:15],s40 offen offset:2048 nt lds
 mf 100,20,192,100
 tr 16,3,38080
 tr 18,3,38592
 s_mov_b32 m0,55008
 s_nop 0
 buffer_load_dwordx4 v5,s[12:15],s40 offen offset:3072 nt lds
 s_mov_b32 m0,59136
 s_mov_b32 s40,90112
 s_waitcnt lgkmcnt(6)
 mf 104,24,192,104
 tr 20,3,38112
 tr 22,3,38624
 buffer_load_dwordx4 v5,s[12:15],s40 offen nt lds
 s_mov_b32 m0,59168
 s_nop 0
 buffer_load_dwordx4 v5,s[12:15],s40 offen offset:1024 nt lds
 mf 108,28,192,108
 tr 24,3,42240
 tr 26,3,42752
 s_mov_b32 m0,59200
 s_nop 0
 buffer_load_dwordx4 v5,s[12:15],s40 offen offset:2048 nt lds
 s_mov_b32 m0,59232
 s_nop 0
 buffer_load_dwordx4 v5,s[12:15],s40 offen offset:3072 nt lds
 s_waitcnt lgkmcnt(6)
 mf 96,8,200,96
 tr 28,3,42272
 tr 30,3,42784
 s_mov_b32 m0,63360
 s_mov_b32 s40,94208
 buffer_load_dwordx4 v5,s[12:15],s40 offen nt lds
 s_mov_b32 m0,63392
 mf 100,12,200,100
 tr 8,3,42304
 tr 10,3,42816
 buffer_load_dwordx4 v5,s[12:15],s40 offen offset:1024 nt lds
 s_mov_b32 m0,63424
 s_nop 0
 buffer_load_dwordx4 v5,s[12:15],s40 offen offset:2048 nt lds
 s_waitcnt lgkmcnt(6)
 mf 104,16,200,104
 tr 12,3,42336
 tr 14,3,42848
 s_mov_b32 m0,63456
 s_nop 0
 buffer_load_dwordx4 v5,s[12:15],s40 offen offset:3072 nt lds
 s_xor_b32 s46,s53,0
 s_add_u32 s46,s46,s44
 s_add_u32 m0,s41,69696
 s_add_u32 s40,s46,66048
 mf 108,20,200,108
 buffer_load_dwordx4 v2,s[16:19],s40 offen lds
 s_add_u32 m0,s41,70752
 s_add_u32 s40,s46,82432
 buffer_load_dwordx4 v2,s[16:19],s40 offen lds
 s_waitcnt lgkmcnt(4)
 mf 96,24,208,96
 s_xor_b32 s46,s53,1048576
 s_add_u32 s46,s46,s44
 s_add_u32 m0,s41,84480
 s_add_u32 s40,s46,512
 buffer_load_dwordx4 v2,s[16:19],s40 offen lds
 s_waitcnt vmcnt(21)
 s_waitcnt lgkmcnt(0)
 s_barrier
 tr 16,3,46464
 tr 18,3,46976
 tr 20,3,46496
 tr 22,3,47008
 mf 100,28,208,100
 tr 24,3,46528
 tr 26,3,47040
 s_mov_b32 m0,0
 s_mov_b32 s40,114688
 buffer_load_dwordx4 v5,s[8:11],s40 offen nt lds
 s_mov_b32 m0,32
 s_nop 0
 buffer_load_dwordx4 v5,s[8:11],s40 offen offset:1024 nt lds
 s_mov_b32 m0,64
 mf 104,8,208,104
 tr 28,3,46560
 tr 30,3,47072
 buffer_load_dwordx4 v5,s[8:11],s40 offen offset:2048 nt lds
 s_mov_b32 m0,96
 s_nop 0
 buffer_load_dwordx4 v5,s[8:11],s40 offen offset:3072 nt lds
 s_mov_b32 m0,4224
 s_mov_b32 s40,118784
 mf 108,12,208,108
 tr 8,3,50688
 tr 10,3,51200
 buffer_load_dwordx4 v5,s[8:11],s40 offen nt lds
 s_mov_b32 m0,4256
 s_nop 0
 buffer_load_dwordx4 v5,s[8:11],s40 offen offset:1024 nt lds
 s_mov_b32 m0,4288
 s_waitcnt lgkmcnt(6)
 mf 96,16,216,96
 tr 12,3,50720
 tr 14,3,51232
 buffer_load_dwordx4 v5,s[8:11],s40 offen offset:2048 nt lds
 s_mov_b32 m0,4320
 s_nop 0
 buffer_load_dwordx4 v5,s[8:11],s40 offen offset:3072 nt lds
 s_mov_b32 m0,8448
 s_mov_b32 s40,122880
 mf 100,20,216,100
 tr 16,3,50752
 tr 18,3,51264
 buffer_load_dwordx4 v5,s[8:11],s40 offen nt lds
 s_mov_b32 m0,8480
 s_nop 0
 buffer_load_dwordx4 v5,s[8:11],s40 offen offset:1024 nt lds
 s_mov_b32 m0,8512
 s_nop 0
 buffer_load_dwordx4 v5,s[8:11],s40 offen offset:2048 nt lds
 s_waitcnt lgkmcnt(6)
 mf 104,24,216,104
 tr 20,3,50784
 tr 22,3,51296
 s_mov_b32 m0,8544
 s_nop 0
 buffer_load_dwordx4 v5,s[8:11],s40 offen offset:3072 nt lds
 s_mov_b32 m0,12672
 s_mov_b32 s40,126976
 buffer_load_dwordx4 v5,s[8:11],s40 offen nt lds
 s_mov_b32 m0,12704
 mf 108,28,216,108
 buffer_load_dwordx4 v5,s[8:11],s40 offen offset:1024 nt lds
 s_mov_b32 m0,12736
 s_nop 0
 buffer_load_dwordx4 v5,s[8:11],s40 offen offset:2048 nt lds
 s_mov_b32 m0,12768
 s_nop 0
 buffer_load_dwordx4 v5,s[8:11],s40 offen offset:3072 nt lds
 s_waitcnt lgkmcnt(4)
 mf 96,8,224,96
 s_xor_b32 s46,s53,1048576
 s_add_u32 s46,s46,s44
 s_add_u32 m0,s41,85536
 s_add_u32 s40,s46,16896
 buffer_load_dwordx4 v2,s[16:19],s40 offen lds
 s_add_u32 m0,s41,86592
 s_add_u32 s40,s46,66048
 buffer_load_dwordx4 v2,s[16:19],s40 offen lds
 s_waitcnt vmcnt(21)
 s_waitcnt lgkmcnt(0)
 s_barrier
 tr 24,3,54912
 tr 26,3,55424
 tr 28,3,54944
 tr 30,3,55456
 mf 100,12,224,100
 tr 8,3,54976
 tr 10,3,55488
 s_mov_b32 m0,33792
 s_mov_b32 s40,98304
 buffer_load_dwordx4 v5,s[12:15],s40 offen nt lds
 s_mov_b32 m0,33824
 s_nop 0
 buffer_load_dwordx4 v5,s[12:15],s40 offen offset:1024 nt lds
 mf 104,16,224,104
 tr 12,3,55008
 tr 14,3,55520
 s_mov_b32 m0,33856
 s_nop 0
 buffer_load_dwordx4 v5,s[12:15],s40 offen offset:2048 nt lds
 s_mov_b32 m0,33888
 s_nop 0
 buffer_load_dwordx4 v5,s[12:15],s40 offen offset:3072 nt lds
 mf 108,20,224,108
 tr 16,3,59136
 tr 18,3,59648
 s_mov_b32 m0,38016
 s_mov_b32 s40,102400
 buffer_load_dwordx4 v5,s[12:15],s40 offen nt lds
 s_mov_b32 m0,38048
 s_waitcnt lgkmcnt(6)
 mf 96,24,232,96
 tr 20,3,59168
 tr 22,3,59680
 buffer_load_dwordx4 v5,s[12:15],s40 offen offset:1024 nt lds
 s_mov_b32 m0,38080
 s_nop 0
 buffer_load_dwordx4 v5,s[12:15],s40 offen offset:2048 nt lds
 mf 100,28,232,100
 tr 24,3,59200
 tr 26,3,59712
 s_mov_b32 m0,38112
 s_nop 0
 buffer_load_dwordx4 v5,s[12:15],s40 offen offset:3072 nt lds
 s_mov_b32 m0,42240
 s_mov_b32 s40,106496
 s_waitcnt lgkmcnt(6)
 mf 104,8,232,104
 tr 28,3,59232
 tr 30,3,59744
 buffer_load_dwordx4 v5,s[12:15],s40 offen nt lds
 s_mov_b32 m0,42272
 s_nop 0
 buffer_load_dwordx4 v5,s[12:15],s40 offen offset:1024 nt lds
 mf 108,12,232,108
 tr 8,3,63360
 tr 10,3,63872
 s_mov_b32 m0,42304
 s_nop 0
 buffer_load_dwordx4 v5,s[12:15],s40 offen offset:2048 nt lds
 s_mov_b32 m0,42336
 s_nop 0
 buffer_load_dwordx4 v5,s[12:15],s40 offen offset:3072 nt lds
 s_waitcnt lgkmcnt(6)
 mf 96,16,240,96
 tr 12,3,63392
 tr 14,3,63904
 s_mov_b32 m0,46464
 s_mov_b32 s40,110592
 buffer_load_dwordx4 v5,s[12:15],s40 offen nt lds
 s_mov_b32 m0,46496
 mf 100,20,240,100
 tr 16,3,63424
 tr 18,3,63936
 buffer_load_dwordx4 v5,s[12:15],s40 offen offset:1024 nt lds
 s_mov_b32 m0,46528
 s_nop 0
 buffer_load_dwordx4 v5,s[12:15],s40 offen offset:2048 nt lds
 s_waitcnt lgkmcnt(6)
 mf 104,24,240,104
 tr 20,3,63456
 tr 22,3,63968
 s_mov_b32 m0,46560
 s_nop 0
 buffer_load_dwordx4 v5,s[12:15],s40 offen offset:3072 nt lds
 s_xor_b32 s46,s53,1048576
 s_add_u32 s46,s46,s44
 s_add_u32 m0,s41,87648
 s_add_u32 s40,s46,82432
 mf 108,28,240,108
 buffer_load_dwordx4 v2,s[16:19],s40 offen lds
 s_xor_b32 s46,s53,2097152
 s_add_u32 s46,s46,s44
 s_add_u32 m0,s41,101376
 s_add_u32 s40,s46,512
 s_waitcnt lgkmcnt(4)
 mf 96,8,248,96
 buffer_load_dwordx4 v2,s[16:19],s40 offen lds
 s_add_u32 m0,s41,102432
 s_add_u32 s40,s46,16896
 buffer_load_dwordx4 v2,s[16:19],s40 offen lds
 s_waitcnt vmcnt(21)
 s_waitcnt lgkmcnt(0)
 s_barrier
 ds_read_b64_tr_b16 v[24:25],v3
 tr 26,3,512
 tr 28,3,32
 tr 30,3,544
 mf 100,12,248,100
 tr 8,3,64
 tr 10,3,576
 s_xor_b32 s46,s53,2097152
 s_add_u32 s46,s46,s44
 s_add_u32 m0,s41,103488
 s_add_u32 s40,s46,66048
 buffer_load_dwordx4 v2,s[16:19],s40 offen lds
 s_add_u32 m0,s41,104544
 s_add_u32 s40,s46,82432
 buffer_load_dwordx4 v2,s[16:19],s40 offen lds
 s_xor_b32 s46,s53,3145728
 mf 104,16,248,104
 tr 12,3,96
 tr 14,3,608
 mf 108,20,248,108
 v_mul_f32 v96,s38,v96
 v_mul_f32 v97,s38,v97
 v_mul_f32 v98,s38,v98
 v_mul_f32 v99,s38,v99
 v_mul_f32 v100,s38,v100
 v_mul_f32 v101,s38,v101
 v_mul_f32 v102,s38,v102
 v_mul_f32 v103,s38,v103
 cv 96,96,97
 cv 97,98,99
 cv 98,100,101
 cv 99,102,103
 ds_write_b64 v6,v[96:97] offset:14336
 ds_write_b64 v6,v[98:99] offset:17920
 v_mul_f32 v104,s38,v104
 v_mul_f32 v105,s38,v105
 v_mul_f32 v106,s38,v106
 v_mul_f32 v107,s38,v107
 v_mul_f32 v108,s38,v108
 v_mul_f32 v109,s38,v109
 v_mul_f32 v110,s38,v110
 v_mul_f32 v111,s38,v111
 cv 104,104,105
 cv 105,106,107
 cv 106,108,109
 cv 107,110,111
 ds_write_b64 v6,v[104:105] offset:21504
 ds_write_b64 v6,v[106:107] offset:25088
 s_add_u32 s46,s46,s44
 s_add_u32 m0,s41,118272
 s_add_u32 s40,s46,512
 buffer_load_dwordx4 v2,s[16:19],s40 offen lds
 s_mov_b32 m0,16896
 s_mov_b32 s40,131072
 buffer_load_dwordx4 v5,s[8:11],s40 offen nt lds
 s_mov_b32 m0,16928
 s_nop 0
 buffer_load_dwordx4 v5,s[8:11],s40 offen offset:1024 nt lds
 s_mov_b32 m0,16960
 s_nop 0
 buffer_load_dwordx4 v5,s[8:11],s40 offen offset:2048 nt lds
 s_mov_b32 m0,16992
 s_waitcnt lgkmcnt(8)
 mz 96,24,128
 buffer_load_dwordx4 v5,s[8:11],s40 offen offset:3072 nt lds
 s_mov_b32 m0,21120
 s_mov_b32 s40,135168
 buffer_load_dwordx4 v5,s[8:11],s40 offen nt lds
 s_mov_b32 m0,21152
 s_nop 0
 buffer_load_dwordx4 v5,s[8:11],s40 offen offset:1024 nt lds
 s_mov_b32 m0,21184
 s_nop 0
 buffer_load_dwordx4 v5,s[8:11],s40 offen offset:2048 nt lds
 s_mov_b32 m0,21216
 s_nop 0
 buffer_load_dwordx4 v5,s[8:11],s40 offen offset:3072 nt lds
 s_mov_b32 m0,25344
 s_mov_b32 s40,139264
 buffer_load_dwordx4 v5,s[8:11],s40 offen nt lds
 s_mov_b32 m0,25376
 s_nop 0
 buffer_load_dwordx4 v5,s[8:11],s40 offen offset:1024 nt lds
 s_mov_b32 m0,25408
 s_nop 0
 buffer_load_dwordx4 v5,s[8:11],s40 offen offset:2048 nt lds
 s_mov_b32 m0,25440
 s_nop 0
 buffer_load_dwordx4 v5,s[8:11],s40 offen offset:3072 nt lds
 s_mov_b32 m0,29568
 s_mov_b32 s40,143360
 buffer_load_dwordx4 v5,s[8:11],s40 offen nt lds
 s_mov_b32 m0,29600
 s_nop 0
 buffer_load_dwordx4 v5,s[8:11],s40 offen offset:1024 nt lds
 s_mov_b32 m0,29632
 s_nop 0
 buffer_load_dwordx4 v5,s[8:11],s40 offen offset:2048 nt lds
 s_mov_b32 m0,29664
 s_nop 0
 buffer_load_dwordx4 v5,s[8:11],s40 offen offset:3072 nt lds
 s_waitcnt vmcnt(22)
 s_waitcnt lgkmcnt(0)
 s_barrier
 tr 16,3,4224
 tr 18,3,4736
 tr 20,3,4256
 tr 22,3,4768
 mz 100,28,128
 tr 24,3,4288
 tr 26,3,4800
 s_xor_b32 s46,s53,3145728
 s_add_u32 s46,s46,s44
 s_add_u32 m0,s41,119328
 s_add_u32 s40,s46,16896
 buffer_load_dwordx4 v2,s[16:19],s40 offen lds
 s_add_u32 m0,s41,120384
 s_add_u32 s40,s46,66048
 buffer_load_dwordx4 v2,s[16:19],s40 offen lds
 mz 104,8,128
 tr 28,3,4320
 tr 30,3,4832
 mz 108,12,128
 tr 8,3,8448
 tr 10,3,8960
 s_waitcnt lgkmcnt(6)
 mf 96,16,136,96
 tr 12,3,8480
 tr 14,3,8992
 mf 100,20,136,100
 tr 16,3,8512
 tr 18,3,9024
 s_mov_b32 m0,50688
 s_mov_b32 s40,114688
 buffer_load_dwordx4 v5,s[12:15],s40 offen nt lds
 s_mov_b32 m0,50720
 s_nop 0
 buffer_load_dwordx4 v5,s[12:15],s40 offen offset:1024 nt lds
 s_mov_b32 m0,50752
 s_nop 0
 buffer_load_dwordx4 v5,s[12:15],s40 offen offset:2048 nt lds
 s_mov_b32 m0,50784
 s_nop 0
 buffer_load_dwordx4 v5,s[12:15],s40 offen offset:3072 nt lds
 s_waitcnt lgkmcnt(6)
 mf 104,24,136,104
 tr 20,3,8544
 tr 22,3,9056
 s_mov_b32 m0,54912
 s_mov_b32 s40,118784
 buffer_load_dwordx4 v5,s[12:15],s40 offen nt lds
 s_mov_b32 m0,54944
 s_nop 0
 buffer_load_dwordx4 v5,s[12:15],s40 offen offset:1024 nt lds
 s_mov_b32 m0,54976
 s_nop 0
 buffer_load_dwordx4 v5,s[12:15],s40 offen offset:2048 nt lds
 s_mov_b32 m0,55008
 s_nop 0
 buffer_load_dwordx4 v5,s[12:15],s40 offen offset:3072 nt lds
 mf 108,28,136,108
 s_mov_b32 m0,59136
 s_mov_b32 s40,122880
 buffer_load_dwordx4 v5,s[12:15],s40 offen nt lds
 s_mov_b32 m0,59168
 s_nop 0
 buffer_load_dwordx4 v5,s[12:15],s40 offen offset:1024 nt lds
 s_mov_b32 m0,59200
 s_nop 0
 buffer_load_dwordx4 v5,s[12:15],s40 offen offset:2048 nt lds
 s_mov_b32 m0,59232
 s_nop 0
 buffer_load_dwordx4 v5,s[12:15],s40 offen offset:3072 nt lds
 s_waitcnt lgkmcnt(4)
 mf 96,8,144,96
 s_mov_b32 m0,63360
 s_mov_b32 s40,126976
 buffer_load_dwordx4 v5,s[12:15],s40 offen nt lds
 s_mov_b32 m0,63392
 s_nop 0
 buffer_load_dwordx4 v5,s[12:15],s40 offen offset:1024 nt lds
 s_mov_b32 m0,63424
 s_nop 0
 buffer_load_dwordx4 v5,s[12:15],s40 offen offset:2048 nt lds
 s_mov_b32 m0,63456
 s_nop 0
 buffer_load_dwordx4 v5,s[12:15],s40 offen offset:3072 nt lds
 s_waitcnt vmcnt(18)
 s_waitcnt lgkmcnt(0)
 s_barrier
 tr 24,3,12672
 tr 26,3,13184
 tr 28,3,12704
 tr 30,3,13216
 mf 100,12,144,100
 tr 8,3,12736
 tr 10,3,13248
 s_xor_b32 s46,s53,3145728
 s_add_u32 s46,s46,s44
 s_add_u32 m0,s41,121440
 s_add_u32 s40,s46,82432
 buffer_load_dwordx4 v2,s[16:19],s40 offen lds
 mf 104,16,144,104
 tr 12,3,12768
 tr 14,3,13280
 mf 108,20,144,108
 tr 16,3,16896
 tr 18,3,17408
 s_waitcnt lgkmcnt(6)
 mf 96,24,152,96
 tr 20,3,16928
 tr 22,3,17440
 mf 100,28,152,100
 tr 24,3,16960
 tr 26,3,17472
 s_mov_b32 m0,0
 s_mov_b32 s40,147456
 buffer_load_dwordx4 v5,s[8:11],s40 offen nt lds
 s_mov_b32 m0,32
 s_nop 0
 buffer_load_dwordx4 v5,s[8:11],s40 offen offset:1024 nt lds
 s_mov_b32 m0,64
 s_nop 0
 buffer_load_dwordx4 v5,s[8:11],s40 offen offset:2048 nt lds
 s_mov_b32 m0,96
 s_nop 0
 buffer_load_dwordx4 v5,s[8:11],s40 offen offset:3072 nt lds
 s_waitcnt lgkmcnt(6)
 mf 104,8,152,104
 tr 28,3,16992
 tr 30,3,17504
 s_mov_b32 m0,4224
 s_mov_b32 s40,151552
 buffer_load_dwordx4 v5,s[8:11],s40 offen nt lds
 s_mov_b32 m0,4256
 s_nop 0
 buffer_load_dwordx4 v5,s[8:11],s40 offen offset:1024 nt lds
 s_mov_b32 m0,4288
 s_nop 0
 buffer_load_dwordx4 v5,s[8:11],s40 offen offset:2048 nt lds
 s_mov_b32 m0,4320
 s_nop 0
 buffer_load_dwordx4 v5,s[8:11],s40 offen offset:3072 nt lds
 mf 108,12,152,108
 s_mov_b32 m0,8448
 s_mov_b32 s40,155648
 buffer_load_dwordx4 v5,s[8:11],s40 offen nt lds
 s_mov_b32 m0,8480
 s_nop 0
 buffer_load_dwordx4 v5,s[8:11],s40 offen offset:1024 nt lds
 s_mov_b32 m0,8512
 s_nop 0
 buffer_load_dwordx4 v5,s[8:11],s40 offen offset:2048 nt lds
 s_mov_b32 m0,8544
 s_nop 0
 buffer_load_dwordx4 v5,s[8:11],s40 offen offset:3072 nt lds
 s_waitcnt lgkmcnt(4)
 mf 96,16,160,96
 s_mov_b32 m0,12672
 s_mov_b32 s40,159744
 buffer_load_dwordx4 v5,s[8:11],s40 offen nt lds
 s_mov_b32 m0,12704
 s_nop 0
 buffer_load_dwordx4 v5,s[8:11],s40 offen offset:1024 nt lds
 s_mov_b32 m0,12736
 s_nop 0
 buffer_load_dwordx4 v5,s[8:11],s40 offen offset:2048 nt lds
 s_mov_b32 m0,12768
 s_nop 0
 buffer_load_dwordx4 v5,s[8:11],s40 offen offset:3072 nt lds
 s_waitcnt vmcnt(17)
 s_waitcnt lgkmcnt(0)
 s_barrier
 tr 8,3,21120
 tr 10,3,21632
 tr 12,3,21152
 tr 14,3,21664
 mf 100,20,160,100
 tr 16,3,21184
 tr 18,3,21696
 s_xor_b32 s46,s53,0
 s_add_u32 s46,s46,s44
 s_add_u32 m0,s41,67584
 s_add_u32 s40,s46,640
 buffer_load_dwordx4 v2,s[16:19],s40 offen lds
 s_add_u32 m0,s41,68640
 s_add_u32 s40,s46,17024
 buffer_load_dwordx4 v2,s[16:19],s40 offen lds
 mf 104,24,160,104
 tr 20,3,21216
 tr 22,3,21728
 s_add_u32 m0,s41,69696
 s_add_u32 s40,s46,66176
 buffer_load_dwordx4 v2,s[16:19],s40 offen lds
 mf 108,28,160,108
 tr 24,3,25344
 tr 26,3,25856
 s_waitcnt lgkmcnt(6)
 mf 96,8,168,96
 tr 28,3,25376
 tr 30,3,25888
 mf 100,12,168,100
 tr 8,3,25408
 tr 10,3,25920
 s_waitcnt lgkmcnt(6)
 mf 104,16,168,104
 tr 12,3,25440
 tr 14,3,25952
 mf 108,20,168,108
 tr 16,3,29568
 tr 18,3,30080
 s_mov_b32 m0,33792
 s_mov_b32 s40,131072
 buffer_load_dwordx4 v5,s[12:15],s40 offen nt lds
 s_mov_b32 m0,33824
 s_nop 0
 buffer_load_dwordx4 v5,s[12:15],s40 offen offset:1024 nt lds
 s_mov_b32 m0,33856
 s_nop 0
 buffer_load_dwordx4 v5,s[12:15],s40 offen offset:2048 nt lds
 s_waitcnt lgkmcnt(6)
 mf 96,24,176,96
 tr 20,3,29600
 tr 22,3,30112
 s_mov_b32 m0,33888
 s_nop 0
 buffer_load_dwordx4 v5,s[12:15],s40 offen offset:3072 nt lds
 s_mov_b32 m0,38016
 s_mov_b32 s40,135168
 buffer_load_dwordx4 v5,s[12:15],s40 offen nt lds
 s_mov_b32 m0,38048
 s_nop 0
 buffer_load_dwordx4 v5,s[12:15],s40 offen offset:1024 nt lds
 mf 100,28,176,100
 tr 24,3,29632
 tr 26,3,30144
 s_mov_b32 m0,38080
 s_nop 0
 buffer_load_dwordx4 v5,s[12:15],s40 offen offset:2048 nt lds
 s_mov_b32 m0,38112
 s_nop 0
 buffer_load_dwordx4 v5,s[12:15],s40 offen offset:3072 nt lds
 s_mov_b32 m0,42240
 s_mov_b32 s40,139264
 s_waitcnt lgkmcnt(6)
 mf 104,8,176,104
 tr 28,3,29664
 tr 30,3,30176
 buffer_load_dwordx4 v5,s[12:15],s40 offen nt lds
 s_mov_b32 m0,42272
 s_nop 0
 buffer_load_dwordx4 v5,s[12:15],s40 offen offset:1024 nt lds
 s_mov_b32 m0,42304
 s_nop 0
 buffer_load_dwordx4 v5,s[12:15],s40 offen offset:2048 nt lds
 mf 108,12,176,108
 s_mov_b32 m0,42336
 s_nop 0
 buffer_load_dwordx4 v5,s[12:15],s40 offen offset:3072 nt lds
 s_mov_b32 m0,46464
 s_mov_b32 s40,143360
 buffer_load_dwordx4 v5,s[12:15],s40 offen nt lds
 s_mov_b32 m0,46496
 s_waitcnt lgkmcnt(4)
 mf 96,16,184,96
 buffer_load_dwordx4 v5,s[12:15],s40 offen offset:1024 nt lds
 s_mov_b32 m0,46528
 s_nop 0
 buffer_load_dwordx4 v5,s[12:15],s40 offen offset:2048 nt lds
 s_mov_b32 m0,46560
 s_nop 0
 buffer_load_dwordx4 v5,s[12:15],s40 offen offset:3072 nt lds
 s_waitcnt vmcnt(19)
 s_waitcnt lgkmcnt(0)
 s_barrier
 tr 8,3,33792
 tr 10,3,34304
 tr 12,3,33824
 tr 14,3,34336
 mf 100,20,184,100
 tr 16,3,33856
 tr 18,3,34368
 s_xor_b32 s46,s53,0
 s_add_u32 s46,s46,s44
 s_add_u32 m0,s41,70752
 s_add_u32 s40,s46,82560
 buffer_load_dwordx4 v2,s[16:19],s40 offen lds
 s_xor_b32 s46,s53,1048576
 s_add_u32 s46,s46,s44
 s_add_u32 m0,s41,84480
 s_add_u32 s40,s46,640
 mf 104,24,184,104
 tr 20,3,33888
 tr 22,3,34400
 buffer_load_dwordx4 v2,s[16:19],s40 offen lds
 s_add_u32 m0,s41,85536
 s_add_u32 s40,s46,17024
 mf 108,28,184,108
 tr 24,3,38016
 tr 26,3,38528
 buffer_load_dwordx4 v2,s[16:19],s40 offen lds
 s_add_u32 m0,s41,86592
 s_add_u32 s40,s46,66176
 s_waitcnt lgkmcnt(6)
 mf 96,8,192,96
 tr 28,3,38048
 tr 30,3,38560
 buffer_load_dwordx4 v2,s[16:19],s40 offen lds
 mf 100,12,192,100
 tr 8,3,38080
 tr 10,3,38592
 s_waitcnt lgkmcnt(6)
 mf 104,16,192,104
 tr 12,3,38112
 tr 14,3,38624
 mf 108,20,192,108
 tr 16,3,42240
 tr 18,3,42752
 s_waitcnt lgkmcnt(6)
 mf 96,24,200,96
 tr 20,3,42272
 tr 22,3,42784
 mf 100,28,200,100
 tr 24,3,42304
 tr 26,3,42816
 s_mov_b32 m0,16896
 s_mov_b32 s40,163840
 buffer_load_dwordx4 v5,s[8:11],s40 offen nt lds
 s_mov_b32 m0,16928
 s_nop 0
 buffer_load_dwordx4 v5,s[8:11],s40 offen offset:1024 nt lds
 s_waitcnt lgkmcnt(6)
 mf 104,8,200,104
 tr 28,3,42336
 tr 30,3,42848
 s_mov_b32 m0,16960
 s_nop 0
 buffer_load_dwordx4 v5,s[8:11],s40 offen offset:2048 nt lds
 s_mov_b32 m0,16992
 s_nop 0
 buffer_load_dwordx4 v5,s[8:11],s40 offen offset:3072 nt lds
 mf 108,12,200,108
 tr 8,3,46464
 tr 10,3,46976
 s_mov_b32 m0,21120
 s_mov_b32 s40,167936
 buffer_load_dwordx4 v5,s[8:11],s40 offen nt lds
 s_mov_b32 m0,21152
 s_nop 0
 buffer_load_dwordx4 v5,s[8:11],s40 offen offset:1024 nt lds
 s_waitcnt lgkmcnt(6)
 mf 96,16,208,96
 tr 12,3,46496
 tr 14,3,47008
 s_mov_b32 m0,21184
 s_nop 0
 buffer_load_dwordx4 v5,s[8:11],s40 offen offset:2048 nt lds
 s_mov_b32 m0,21216
 s_nop 0
 buffer_load_dwordx4 v5,s[8:11],s40 offen offset:3072 nt lds
 mf 100,20,208,100
 tr 16,3,46528
 tr 18,3,47040
 s_mov_b32 m0,25344
 s_mov_b32 s40,172032
 buffer_load_dwordx4 v5,s[8:11],s40 offen nt lds
 s_mov_b32 m0,25376
 s_nop 0
 buffer_load_dwordx4 v5,s[8:11],s40 offen offset:1024 nt lds
 s_waitcnt lgkmcnt(6)
 mf 104,24,208,104
 tr 20,3,46560
 tr 22,3,47072
 s_mov_b32 m0,25408
 s_nop 0
 buffer_load_dwordx4 v5,s[8:11],s40 offen offset:2048 nt lds
 s_mov_b32 m0,25440
 s_nop 0
 buffer_load_dwordx4 v5,s[8:11],s40 offen offset:3072 nt lds
 mf 108,28,208,108
 s_mov_b32 m0,29568
 s_mov_b32 s40,176128
 buffer_load_dwordx4 v5,s[8:11],s40 offen nt lds
 s_mov_b32 m0,29600
 s_nop 0
 buffer_load_dwordx4 v5,s[8:11],s40 offen offset:1024 nt lds
 s_waitcnt lgkmcnt(4)
 mf 96,8,216,96
 s_mov_b32 m0,29632
 s_nop 0
 buffer_load_dwordx4 v5,s[8:11],s40 offen offset:2048 nt lds
 s_mov_b32 m0,29664
 s_nop 0
 buffer_load_dwordx4 v5,s[8:11],s40 offen offset:3072 nt lds
 s_waitcnt vmcnt(20)
 s_waitcnt lgkmcnt(0)
 s_barrier
 tr 24,3,50688
 tr 26,3,51200
 tr 28,3,50720
 tr 30,3,51232
 mf 100,12,216,100
 tr 8,3,50752
 tr 10,3,51264
 s_xor_b32 s46,s53,1048576
 s_add_u32 s46,s46,s44
 s_add_u32 m0,s41,87648
 s_add_u32 s40,s46,82560
 buffer_load_dwordx4 v2,s[16:19],s40 offen lds
 s_xor_b32 s46,s53,2097152
 s_add_u32 s46,s46,s44
 s_add_u32 m0,s41,101376
 s_add_u32 s40,s46,640
 buffer_load_dwordx4 v2,s[16:19],s40 offen lds
 s_add_u32 m0,s41,102432
 s_add_u32 s40,s46,17024
 buffer_load_dwordx4 v2,s[16:19],s40 offen lds
 mf 104,16,216,104
 tr 12,3,50784
 tr 14,3,51296
 mf 108,20,216,108
 tr 16,3,54912
 tr 18,3,55424
 ds_read_b128 v[32:35],v4
 ds_read_b128 v[40:43],v4 offset:7168
 ds_read_b128 v[48:51],v4 offset:14336
 ds_read_b128 v[56:59],v4 offset:21504
 s_waitcnt lgkmcnt(10)
 mf 96,24,224,96
 tr 20,3,54944
 tr 22,3,55456
 mf 100,28,224,100
 tr 24,3,54976
 tr 26,3,55488
 s_mov_b32 m0,50688
 s_mov_b32 s40,147456
 buffer_load_dwordx4 v5,s[12:15],s40 offen nt lds
 s_mov_b32 m0,50720
 s_nop 0
 buffer_load_dwordx4 v5,s[12:15],s40 offen offset:1024 nt lds
 s_mov_b32 m0,50752
 s_nop 0
 buffer_load_dwordx4 v5,s[12:15],s40 offen offset:2048 nt lds
 s_mov_b32 m0,50784
 s_nop 0
 buffer_load_dwordx4 v5,s[12:15],s40 offen offset:3072 nt lds
 s_waitcnt lgkmcnt(10)
 mf 104,8,224,104
 tr 28,3,55008
 tr 30,3,55520
 s_mov_b32 m0,54912
 s_mov_b32 s40,151552
 buffer_load_dwordx4 v5,s[12:15],s40 offen nt lds
 s_mov_b32 m0,54944
 s_nop 0
 buffer_load_dwordx4 v5,s[12:15],s40 offen offset:1024 nt lds
 s_mov_b32 m0,54976
 s_nop 0
 buffer_load_dwordx4 v5,s[12:15],s40 offen offset:2048 nt lds
 s_mov_b32 m0,55008
 s_nop 0
 buffer_load_dwordx4 v5,s[12:15],s40 offen offset:3072 nt lds
 mf 108,12,224,108
 s_mov_b32 m0,59136
 s_mov_b32 s40,155648
 buffer_load_dwordx4 v5,s[12:15],s40 offen nt lds
 s_mov_b32 m0,59168
 s_nop 0
 buffer_load_dwordx4 v5,s[12:15],s40 offen offset:1024 nt lds
 s_mov_b32 m0,59200
 s_nop 0
 buffer_load_dwordx4 v5,s[12:15],s40 offen offset:2048 nt lds
 s_mov_b32 m0,59232
 s_nop 0
 buffer_load_dwordx4 v5,s[12:15],s40 offen offset:3072 nt lds
 s_waitcnt lgkmcnt(4)
 mf 96,16,232,96
 s_mov_b32 m0,63360
 s_mov_b32 s40,159744
 buffer_load_dwordx4 v5,s[12:15],s40 offen nt lds
 s_mov_b32 m0,63392
 s_nop 0
 buffer_load_dwordx4 v5,s[12:15],s40 offen offset:1024 nt lds
 s_mov_b32 m0,63424
 s_nop 0
 buffer_load_dwordx4 v5,s[12:15],s40 offen offset:2048 nt lds
 s_mov_b32 m0,63456
 s_nop 0
 buffer_load_dwordx4 v5,s[12:15],s40 offen offset:3072 nt lds
 s_waitcnt vmcnt(19)
 s_waitcnt lgkmcnt(0)
 s_barrier
 tr 8,3,59136
 tr 10,3,59648
 tr 12,3,59168
 tr 14,3,59680
 mf 100,20,232,100
 tr 16,3,59200
 tr 18,3,59712
 s_xor_b32 s46,s53,2097152
 s_add_u32 s46,s46,s44
 s_add_u32 m0,s41,103488
 s_add_u32 s40,s46,66176
 buffer_load_dwordx4 v2,s[16:19],s40 offen lds
 s_add_u32 m0,s41,104544
 s_add_u32 s40,s46,82560
 buffer_load_dwordx4 v2,s[16:19],s40 offen lds
 mf 104,24,232,104
 tr 20,3,59232
 tr 22,3,59744
 mf 108,28,232,108
 tr 24,3,63360
 tr 26,3,63872
 s_waitcnt lgkmcnt(6)
 mf 96,8,240,96
 tr 28,3,63392
 tr 30,3,63904
 mf 100,12,240,100
 tr 8,3,63424
 tr 10,3,63936
 s_mov_b32 m0,0
 s_mov_b32 s40,180224
 buffer_load_dwordx4 v5,s[8:11],s40 offen nt lds
 s_mov_b32 m0,32
 s_nop 0
 buffer_load_dwordx4 v5,s[8:11],s40 offen offset:1024 nt lds
 s_mov_b32 m0,64
 s_nop 0
 buffer_load_dwordx4 v5,s[8:11],s40 offen offset:2048 nt lds
 s_mov_b32 m0,96
 s_nop 0
 buffer_load_dwordx4 v5,s[8:11],s40 offen offset:3072 nt lds
 s_waitcnt lgkmcnt(6)
 mf 104,16,240,104
 tr 12,3,63456
 tr 14,3,63968
 s_mov_b32 m0,4224
 s_mov_b32 s40,184320
 buffer_load_dwordx4 v5,s[8:11],s40 offen nt lds
 s_mov_b32 m0,4256
 s_nop 0
 buffer_load_dwordx4 v5,s[8:11],s40 offen offset:1024 nt lds
 s_mov_b32 m0,4288
 s_nop 0
 buffer_load_dwordx4 v5,s[8:11],s40 offen offset:2048 nt lds
 s_mov_b32 m0,4320
 s_nop 0
 buffer_load_dwordx4 v5,s[8:11],s40 offen offset:3072 nt lds
 mf 108,20,240,108
 s_mov_b32 m0,8448
 s_mov_b32 s40,188416
 buffer_load_dwordx4 v5,s[8:11],s40 offen nt lds
 s_mov_b32 m0,8480
 s_nop 0
 buffer_load_dwordx4 v5,s[8:11],s40 offen offset:1024 nt lds
 s_mov_b32 m0,8512
 s_nop 0
 buffer_load_dwordx4 v5,s[8:11],s40 offen offset:2048 nt lds
 s_mov_b32 m0,8544
 s_nop 0
 buffer_load_dwordx4 v5,s[8:11],s40 offen offset:3072 nt lds
 s_waitcnt lgkmcnt(4)
 mf 96,24,248,96
 s_mov_b32 m0,12672
 s_mov_b32 s40,192512
 buffer_load_dwordx4 v5,s[8:11],s40 offen nt lds
 s_mov_b32 m0,12704
 s_nop 0
 buffer_load_dwordx4 v5,s[8:11],s40 offen offset:1024 nt lds
 s_mov_b32 m0,12736
 s_nop 0
 buffer_load_dwordx4 v5,s[8:11],s40 offen offset:2048 nt lds
 s_mov_b32 m0,12768
 s_nop 0
 buffer_load_dwordx4 v5,s[8:11],s40 offen offset:3072 nt lds
 s_waitcnt vmcnt(18)
 s_waitcnt lgkmcnt(0)
 s_barrier
 mf 100,28,248,100
 s_xor_b32 s46,s53,3145728
 s_add_u32 s46,s46,s44
 s_add_u32 m0,s41,118272
 s_add_u32 s40,s46,640
 buffer_load_dwordx4 v2,s[16:19],s40 offen lds
 s_add_u32 m0,s41,119328
 s_add_u32 s40,s46,17024
 buffer_load_dwordx4 v2,s[16:19],s40 offen lds
 mf 104,8,248,104
 mf 108,12,248,108
 v_mul_f32 v96,s38,v96
 v_mul_f32 v97,s38,v97
 v_mul_f32 v98,s38,v98
 v_mul_f32 v99,s38,v99
 v_mul_f32 v100,s38,v100
 v_mul_f32 v101,s38,v101
 v_mul_f32 v102,s38,v102
 v_mul_f32 v103,s38,v103
 cv 96,96,97
 cv 97,98,99
 cv 98,100,101
 cv 99,102,103
 ds_write_b64 v6,v[96:97]
 ds_write_b64 v6,v[98:99] offset:3584
 v_mul_f32 v104,s38,v104
 v_mul_f32 v105,s38,v105
 v_mul_f32 v106,s38,v106
 v_mul_f32 v107,s38,v107
 v_mul_f32 v108,s38,v108
 v_mul_f32 v109,s38,v109
 v_mul_f32 v110,s38,v110
 v_mul_f32 v111,s38,v111
 cv 104,104,105
 cv 105,106,107
 cv 106,108,109
 cv 107,110,111
 ds_write_b64 v6,v[104:105] offset:7168
 ds_write_b64 v6,v[106:107] offset:10752
 s_mov_b32 m0,33792
 s_mov_b32 s40,163840
 buffer_load_dwordx4 v5,s[12:15],s40 offen nt lds
 s_mov_b32 m0,33824
 s_nop 0
 buffer_load_dwordx4 v5,s[12:15],s40 offen offset:1024 nt lds
 s_mov_b32 m0,33856
 s_nop 0
 buffer_load_dwordx4 v5,s[12:15],s40 offen offset:2048 nt lds
 s_mov_b32 m0,33888
 s_nop 0
 buffer_load_dwordx4 v5,s[12:15],s40 offen offset:3072 nt lds
 s_mov_b32 m0,38016
 s_mov_b32 s40,167936
 buffer_load_dwordx4 v5,s[12:15],s40 offen nt lds
 s_mov_b32 m0,38048
 s_nop 0
 buffer_load_dwordx4 v5,s[12:15],s40 offen offset:1024 nt lds
 s_mov_b32 m0,38080
 s_nop 0
 buffer_load_dwordx4 v5,s[12:15],s40 offen offset:2048 nt lds
 s_mov_b32 m0,38112
 s_nop 0
 buffer_load_dwordx4 v5,s[12:15],s40 offen offset:3072 nt lds
 s_mov_b32 m0,42240
 s_mov_b32 s40,172032
 buffer_load_dwordx4 v5,s[12:15],s40 offen nt lds
 s_mov_b32 m0,42272
 s_nop 0
 buffer_load_dwordx4 v5,s[12:15],s40 offen offset:1024 nt lds
 s_mov_b32 m0,42304
 s_nop 0
 buffer_load_dwordx4 v5,s[12:15],s40 offen offset:2048 nt lds
 s_mov_b32 m0,42336
 s_nop 0
 buffer_load_dwordx4 v5,s[12:15],s40 offen offset:3072 nt lds
 s_mov_b32 m0,46464
 s_mov_b32 s40,176128
 buffer_load_dwordx4 v5,s[12:15],s40 offen nt lds
 s_mov_b32 m0,46496
 s_nop 0
 buffer_load_dwordx4 v5,s[12:15],s40 offen offset:1024 nt lds
 s_mov_b32 m0,46528
 s_nop 0
 buffer_load_dwordx4 v5,s[12:15],s40 offen offset:2048 nt lds
 s_mov_b32 m0,46560
 s_nop 0
 buffer_load_dwordx4 v5,s[12:15],s40 offen offset:3072 nt lds
 s_waitcnt vmcnt(18)
 s_waitcnt lgkmcnt(0)
 s_barrier
 ds_read_b64_tr_b16 v[16:17],v3
 tr 18,3,512
 tr 20,3,32
 tr 22,3,544
 tr 24,3,64
 tr 26,3,576
 tr 28,3,96
 tr 30,3,608
 tr 8,3,4224
 tr 10,3,4736
 s_waitcnt lgkmcnt(6)
 mz 96,16,128
 tr 12,3,4256
 tr 14,3,4768
 s_xor_b32 s46,s53,3145728
 s_add_u32 s46,s46,s44
 s_add_u32 m0,s41,120384
 s_add_u32 s40,s46,66176
 buffer_load_dwordx4 v2,s[16:19],s40 offen lds
 s_add_u32 m0,s41,121440
 s_add_u32 s40,s46,82560
 buffer_load_dwordx4 v2,s[16:19],s40 offen lds
 mz 100,20,128
 tr 16,3,4288
 tr 18,3,4800
 s_waitcnt lgkmcnt(6)
 mz 104,24,128
 tr 20,3,4320
 tr 22,3,4832
 mz 108,28,128
 s_mov_b32 m0,16896
 s_mov_b32 s40,196608
 buffer_load_dwordx4 v5,s[8:11],s40 offen nt lds
 s_mov_b32 m0,16928
 s_nop 0
 buffer_load_dwordx4 v5,s[8:11],s40 offen offset:1024 nt lds
 s_mov_b32 m0,16960
 s_nop 0
 buffer_load_dwordx4 v5,s[8:11],s40 offen offset:2048 nt lds
 s_mov_b32 m0,16992
 s_nop 0
 buffer_load_dwordx4 v5,s[8:11],s40 offen offset:3072 nt lds
 s_mov_b32 m0,21120
 s_mov_b32 s40,200704
 buffer_load_dwordx4 v5,s[8:11],s40 offen nt lds
 s_mov_b32 m0,21152
 s_nop 0
 buffer_load_dwordx4 v5,s[8:11],s40 offen offset:1024 nt lds
 s_mov_b32 m0,21184
 s_nop 0
 buffer_load_dwordx4 v5,s[8:11],s40 offen offset:2048 nt lds
 s_mov_b32 m0,21216
 s_nop 0
 buffer_load_dwordx4 v5,s[8:11],s40 offen offset:3072 nt lds
 s_waitcnt lgkmcnt(4)
 mf 96,8,136,96
 s_mov_b32 m0,25344
 s_mov_b32 s40,204800
 buffer_load_dwordx4 v5,s[8:11],s40 offen nt lds
 s_mov_b32 m0,25376
 s_nop 0
 buffer_load_dwordx4 v5,s[8:11],s40 offen offset:1024 nt lds
 s_mov_b32 m0,25408
 s_nop 0
 buffer_load_dwordx4 v5,s[8:11],s40 offen offset:2048 nt lds
 s_mov_b32 m0,25440
 s_nop 0
 buffer_load_dwordx4 v5,s[8:11],s40 offen offset:3072 nt lds
 s_mov_b32 m0,29568
 s_mov_b32 s40,208896
 buffer_load_dwordx4 v5,s[8:11],s40 offen nt lds
 s_mov_b32 m0,29600
 s_nop 0
 buffer_load_dwordx4 v5,s[8:11],s40 offen offset:1024 nt lds
 s_mov_b32 m0,29632
 s_nop 0
 buffer_load_dwordx4 v5,s[8:11],s40 offen offset:2048 nt lds
 s_mov_b32 m0,29664
 s_nop 0
 buffer_load_dwordx4 v5,s[8:11],s40 offen offset:3072 nt lds
 s_waitcnt vmcnt(18)
 s_waitcnt lgkmcnt(0)
 s_barrier
 tr 24,3,8448
 tr 26,3,8960
 tr 28,3,8480
 tr 30,3,8992
 mf 100,12,136,100
 tr 8,3,8512
 tr 10,3,9024
 mf 104,16,136,104
 tr 12,3,8544
 tr 14,3,9056
 mf 108,20,136,108
 tr 16,3,12672
 tr 18,3,13184
 s_waitcnt lgkmcnt(6)
 mf 96,24,144,96
 tr 20,3,12704
 tr 22,3,13216
 mf 100,28,144,100
 tr 24,3,12736
 tr 26,3,13248
 s_mov_b32 m0,50688
 s_mov_b32 s40,180224
 buffer_load_dwordx4 v5,s[12:15],s40 offen nt lds
 s_mov_b32 m0,50720
 s_nop 0
 buffer_load_dwordx4 v5,s[12:15],s40 offen offset:1024 nt lds
 s_mov_b32 m0,50752
 s_nop 0
 buffer_load_dwordx4 v5,s[12:15],s40 offen offset:2048 nt lds
 s_mov_b32 m0,50784
 s_nop 0
 buffer_load_dwordx4 v5,s[12:15],s40 offen offset:3072 nt lds
 s_waitcnt lgkmcnt(6)
 mf 104,8,144,104
 tr 28,3,12768
 tr 30,3,13280
 s_mov_b32 m0,54912
 s_mov_b32 s40,184320
 buffer_load_dwordx4 v5,s[12:15],s40 offen nt lds
 s_mov_b32 m0,54944
 s_nop 0
 buffer_load_dwordx4 v5,s[12:15],s40 offen offset:1024 nt lds
 s_mov_b32 m0,54976
 s_nop 0
 buffer_load_dwordx4 v5,s[12:15],s40 offen offset:2048 nt lds
 s_mov_b32 m0,55008
 s_nop 0
 buffer_load_dwordx4 v5,s[12:15],s40 offen offset:3072 nt lds
 mf 108,12,144,108
 s_mov_b32 m0,59136
 s_mov_b32 s40,188416
 buffer_load_dwordx4 v5,s[12:15],s40 offen nt lds
 s_mov_b32 m0,59168
 s_nop 0
 buffer_load_dwordx4 v5,s[12:15],s40 offen offset:1024 nt lds
 s_mov_b32 m0,59200
 s_nop 0
 buffer_load_dwordx4 v5,s[12:15],s40 offen offset:2048 nt lds
 s_mov_b32 m0,59232
 s_nop 0
 buffer_load_dwordx4 v5,s[12:15],s40 offen offset:3072 nt lds
 s_waitcnt lgkmcnt(4)
 mf 96,16,152,96
 s_mov_b32 m0,63360
 s_mov_b32 s40,192512
 buffer_load_dwordx4 v5,s[12:15],s40 offen nt lds
 s_mov_b32 m0,63392
 s_nop 0
 buffer_load_dwordx4 v5,s[12:15],s40 offen offset:1024 nt lds
 s_mov_b32 m0,63424
 s_nop 0
 buffer_load_dwordx4 v5,s[12:15],s40 offen offset:2048 nt lds
 s_mov_b32 m0,63456
 s_nop 0
 buffer_load_dwordx4 v5,s[12:15],s40 offen offset:3072 nt lds
 s_waitcnt vmcnt(16)
 s_waitcnt lgkmcnt(0)
 s_barrier
 tr 8,3,16896
 tr 10,3,17408
 tr 12,3,16928
 tr 14,3,17440
 mf 100,20,152,100
 tr 16,3,16960
 tr 18,3,17472
 s_xor_b32 s46,s53,0
 s_add_u32 s46,s46,s44
 s_add_u32 m0,s41,67584
 s_add_u32 s40,s46,768
 buffer_load_dwordx4 v2,s[16:19],s40 offen lds
 s_add_u32 m0,s41,68640
 s_add_u32 s40,s46,17152
 buffer_load_dwordx4 v2,s[16:19],s40 offen lds
 mf 104,24,152,104
 tr 20,3,16992
 tr 22,3,17504
 mf 108,28,152,108
 tr 24,3,21120
 tr 26,3,21632
 s_waitcnt lgkmcnt(6)
 mf 96,8,160,96
 tr 28,3,21152
 tr 30,3,21664
 mf 100,12,160,100
 tr 8,3,21184
 tr 10,3,21696
 s_mov_b32 m0,0
 s_mov_b32 s40,212992
 buffer_load_dwordx4 v5,s[8:11],s40 offen nt lds
 s_mov_b32 m0,32
 s_nop 0
 buffer_load_dwordx4 v5,s[8:11],s40 offen offset:1024 nt lds
 s_mov_b32 m0,64
 s_nop 0
 buffer_load_dwordx4 v5,s[8:11],s40 offen offset:2048 nt lds
 s_mov_b32 m0,96
 s_nop 0
 buffer_load_dwordx4 v5,s[8:11],s40 offen offset:3072 nt lds
 s_waitcnt lgkmcnt(6)
 mf 104,16,160,104
 tr 12,3,21216
 tr 14,3,21728
 s_mov_b32 m0,4224
 s_mov_b32 s40,217088
 buffer_load_dwordx4 v5,s[8:11],s40 offen nt lds
 s_mov_b32 m0,4256
 s_nop 0
 buffer_load_dwordx4 v5,s[8:11],s40 offen offset:1024 nt lds
 s_mov_b32 m0,4288
 s_nop 0
 buffer_load_dwordx4 v5,s[8:11],s40 offen offset:2048 nt lds
 s_mov_b32 m0,4320
 s_nop 0
 buffer_load_dwordx4 v5,s[8:11],s40 offen offset:3072 nt lds
 mf 108,20,160,108
 s_mov_b32 m0,8448
 s_mov_b32 s40,221184
 buffer_load_dwordx4 v5,s[8:11],s40 offen nt lds
 s_mov_b32 m0,8480
 s_nop 0
 buffer_load_dwordx4 v5,s[8:11],s40 offen offset:1024 nt lds
 s_mov_b32 m0,8512
 s_nop 0
 buffer_load_dwordx4 v5,s[8:11],s40 offen offset:2048 nt lds
 s_mov_b32 m0,8544
 s_nop 0
 buffer_load_dwordx4 v5,s[8:11],s40 offen offset:3072 nt lds
 s_waitcnt lgkmcnt(4)
 mf 96,24,168,96
 s_mov_b32 m0,12672
 s_mov_b32 s40,225280
 buffer_load_dwordx4 v5,s[8:11],s40 offen nt lds
 s_mov_b32 m0,12704
 s_nop 0
 buffer_load_dwordx4 v5,s[8:11],s40 offen offset:1024 nt lds
 s_mov_b32 m0,12736
 s_nop 0
 buffer_load_dwordx4 v5,s[8:11],s40 offen offset:2048 nt lds
 s_mov_b32 m0,12768
 s_nop 0
 buffer_load_dwordx4 v5,s[8:11],s40 offen offset:3072 nt lds
 s_waitcnt vmcnt(18)
 s_waitcnt lgkmcnt(0)
 s_barrier
 tr 16,3,25344
 tr 18,3,25856
 tr 20,3,25376
 tr 22,3,25888
 mf 100,28,168,100
 tr 24,3,25408
 tr 26,3,25920
 s_xor_b32 s46,s53,0
 s_add_u32 s46,s46,s44
 s_add_u32 m0,s41,69696
 s_add_u32 s40,s46,66304
 buffer_load_dwordx4 v2,s[16:19],s40 offen lds
 s_add_u32 m0,s41,70752
 s_add_u32 s40,s46,82688
 buffer_load_dwordx4 v2,s[16:19],s40 offen lds
 mf 104,8,168,104
 tr 28,3,25440
 tr 30,3,25952
 mf 108,12,168,108
 tr 8,3,29568
 tr 10,3,30080
 s_waitcnt lgkmcnt(6)
 mf 96,16,176,96
 tr 12,3,29600
 tr 14,3,30112
 mf 100,20,176,100
 tr 16,3,29632
 tr 18,3,30144
 s_mov_b32 m0,33792
 s_mov_b32 s40,196608
 buffer_load_dwordx4 v5,s[12:15],s40 offen nt lds
 s_mov_b32 m0,33824
 s_nop 0
 buffer_load_dwordx4 v5,s[12:15],s40 offen offset:1024 nt lds
 s_mov_b32 m0,33856
 s_nop 0
 buffer_load_dwordx4 v5,s[12:15],s40 offen offset:2048 nt lds
 s_mov_b32 m0,33888
 s_nop 0
 buffer_load_dwordx4 v5,s[12:15],s40 offen offset:3072 nt lds
 s_waitcnt lgkmcnt(6)
 mf 104,24,176,104
 tr 20,3,29664
 tr 22,3,30176
 s_mov_b32 m0,38016
 s_mov_b32 s40,200704
 buffer_load_dwordx4 v5,s[12:15],s40 offen nt lds
 s_mov_b32 m0,38048
 s_nop 0
 buffer_load_dwordx4 v5,s[12:15],s40 offen offset:1024 nt lds
 s_mov_b32 m0,38080
 s_nop 0
 buffer_load_dwordx4 v5,s[12:15],s40 offen offset:2048 nt lds
 s_mov_b32 m0,38112
 s_nop 0
 buffer_load_dwordx4 v5,s[12:15],s40 offen offset:3072 nt lds
 mf 108,28,176,108
 s_mov_b32 m0,42240
 s_mov_b32 s40,204800
 buffer_load_dwordx4 v5,s[12:15],s40 offen nt lds
 s_mov_b32 m0,42272
 s_nop 0
 buffer_load_dwordx4 v5,s[12:15],s40 offen offset:1024 nt lds
 s_mov_b32 m0,42304
 s_nop 0
 buffer_load_dwordx4 v5,s[12:15],s40 offen offset:2048 nt lds
 s_mov_b32 m0,42336
 s_nop 0
 buffer_load_dwordx4 v5,s[12:15],s40 offen offset:3072 nt lds
 s_waitcnt lgkmcnt(4)
 mf 96,8,184,96
 s_mov_b32 m0,46464
 s_mov_b32 s40,208896
 buffer_load_dwordx4 v5,s[12:15],s40 offen nt lds
 s_mov_b32 m0,46496
 s_nop 0
 buffer_load_dwordx4 v5,s[12:15],s40 offen offset:1024 nt lds
 s_mov_b32 m0,46528
 s_nop 0
 buffer_load_dwordx4 v5,s[12:15],s40 offen offset:2048 nt lds
 s_mov_b32 m0,46560
 s_nop 0
 buffer_load_dwordx4 v5,s[12:15],s40 offen offset:3072 nt lds
 s_waitcnt vmcnt(18)
 s_waitcnt lgkmcnt(0)
 s_barrier
 tr 24,3,33792
 tr 26,3,34304
 tr 28,3,33824
 tr 30,3,34336
 mf 100,12,184,100
 tr 8,3,33856
 tr 10,3,34368
 s_xor_b32 s46,s53,1048576
 s_add_u32 s46,s46,s44
 s_add_u32 m0,s41,84480
 s_add_u32 s40,s46,768
 buffer_load_dwordx4 v2,s[16:19],s40 offen lds
 s_add_u32 m0,s41,85536
 s_add_u32 s40,s46,17152
 buffer_load_dwordx4 v2,s[16:19],s40 offen lds
 mf 104,16,184,104
 tr 12,3,33888
 tr 14,3,34400
 mf 108,20,184,108
 tr 16,3,38016
 tr 18,3,38528
 s_waitcnt lgkmcnt(6)
 mf 96,24,192,96
 tr 20,3,38048
 tr 22,3,38560
 mf 100,28,192,100
 tr 24,3,38080
 tr 26,3,38592
 s_mov_b32 m0,16896
 s_mov_b32 s40,229376
 buffer_load_dwordx4 v5,s[8:11],s40 offen nt lds
 s_mov_b32 m0,16928
 s_nop 0
 buffer_load_dwordx4 v5,s[8:11],s40 offen offset:1024 nt lds
 s_mov_b32 m0,16960
 s_nop 0
 buffer_load_dwordx4 v5,s[8:11],s40 offen offset:2048 nt lds
 s_mov_b32 m0,16992
 s_nop 0
 buffer_load_dwordx4 v5,s[8:11],s40 offen offset:3072 nt lds
 s_waitcnt lgkmcnt(6)
 mf 104,8,192,104
 tr 28,3,38112
 tr 30,3,38624
 s_mov_b32 m0,21120
 s_mov_b32 s40,233472
 buffer_load_dwordx4 v5,s[8:11],s40 offen nt lds
 s_mov_b32 m0,21152
 s_nop 0
 buffer_load_dwordx4 v5,s[8:11],s40 offen offset:1024 nt lds
 s_mov_b32 m0,21184
 s_nop 0
 buffer_load_dwordx4 v5,s[8:11],s40 offen offset:2048 nt lds
 s_mov_b32 m0,21216
 s_nop 0
 buffer_load_dwordx4 v5,s[8:11],s40 offen offset:3072 nt lds
 mf 108,12,192,108
 s_mov_b32 m0,25344
 s_mov_b32 s40,237568
 buffer_load_dwordx4 v5,s[8:11],s40 offen nt lds
 s_mov_b32 m0,25376
 s_nop 0
 buffer_load_dwordx4 v5,s[8:11],s40 offen offset:1024 nt lds
 s_mov_b32 m0,25408
 s_nop 0
 buffer_load_dwordx4 v5,s[8:11],s40 offen offset:2048 nt lds
 s_mov_b32 m0,25440
 s_nop 0
 buffer_load_dwordx4 v5,s[8:11],s40 offen offset:3072 nt lds
 s_waitcnt lgkmcnt(4)
 mf 96,16,200,96
 s_mov_b32 m0,29568
 s_mov_b32 s40,241664
 buffer_load_dwordx4 v5,s[8:11],s40 offen nt lds
 s_mov_b32 m0,29600
 s_nop 0
 buffer_load_dwordx4 v5,s[8:11],s40 offen offset:1024 nt lds
 s_mov_b32 m0,29632
 s_nop 0
 buffer_load_dwordx4 v5,s[8:11],s40 offen offset:2048 nt lds
 s_mov_b32 m0,29664
 s_nop 0
 buffer_load_dwordx4 v5,s[8:11],s40 offen offset:3072 nt lds
 s_waitcnt vmcnt(18)
 s_waitcnt lgkmcnt(0)
 s_barrier
 tr 8,3,42240
 tr 10,3,42752
 tr 12,3,42272
 tr 14,3,42784
 mf 100,20,200,100
 tr 16,3,42304
 tr 18,3,42816
 s_xor_b32 s46,s53,1048576
 s_add_u32 s46,s46,s44
 s_add_u32 m0,s41,86592
 s_add_u32 s40,s46,66304
 buffer_load_dwordx4 v2,s[16:19],s40 offen lds
 s_add_u32 m0,s41,87648
 s_add_u32 s40,s46,82688
 buffer_load_dwordx4 v2,s[16:19],s40 offen lds
 mf 104,24,200,104
 tr 20,3,42336
 tr 22,3,42848
 mf 108,28,200,108
 tr 24,3,46464
 tr 26,3,46976
 s_waitcnt lgkmcnt(6)
 mf 96,8,208,96
 tr 28,3,46496
 tr 30,3,47008
 mf 100,12,208,100
 tr 8,3,46528
 tr 10,3,47040
 s_mov_b32 m0,50688
 s_mov_b32 s40,212992
 buffer_load_dwordx4 v5,s[12:15],s40 offen nt lds
 s_mov_b32 m0,50720
 s_nop 0
 buffer_load_dwordx4 v5,s[12:15],s40 offen offset:1024 nt lds
 s_mov_b32 m0,50752
 s_nop 0
 buffer_load_dwordx4 v5,s[12:15],s40 offen offset:2048 nt lds
 s_mov_b32 m0,50784
 s_nop 0
 buffer_load_dwordx4 v5,s[12:15],s40 offen offset:3072 nt lds
 s_waitcnt lgkmcnt(6)
 mf 104,16,208,104
 tr 12,3,46560
 tr 14,3,47072
 s_mov_b32 m0,54912
 s_mov_b32 s40,217088
 buffer_load_dwordx4 v5,s[12:15],s40 offen nt lds
 s_mov_b32 m0,54944
 s_nop 0
 buffer_load_dwordx4 v5,s[12:15],s40 offen offset:1024 nt lds
 s_mov_b32 m0,54976
 s_nop 0
 buffer_load_dwordx4 v5,s[12:15],s40 offen offset:2048 nt lds
 s_mov_b32 m0,55008
 s_nop 0
 buffer_load_dwordx4 v5,s[12:15],s40 offen offset:3072 nt lds
 mf 108,20,208,108
 s_mov_b32 m0,59136
 s_mov_b32 s40,221184
 buffer_load_dwordx4 v5,s[12:15],s40 offen nt lds
 s_mov_b32 m0,59168
 s_nop 0
 buffer_load_dwordx4 v5,s[12:15],s40 offen offset:1024 nt lds
 s_mov_b32 m0,59200
 s_nop 0
 buffer_load_dwordx4 v5,s[12:15],s40 offen offset:2048 nt lds
 s_mov_b32 m0,59232
 s_nop 0
 buffer_load_dwordx4 v5,s[12:15],s40 offen offset:3072 nt lds
 s_waitcnt lgkmcnt(4)
 mf 96,24,216,96
 s_mov_b32 m0,63360
 s_mov_b32 s40,225280
 buffer_load_dwordx4 v5,s[12:15],s40 offen nt lds
 s_mov_b32 m0,63392
 s_nop 0
 buffer_load_dwordx4 v5,s[12:15],s40 offen offset:1024 nt lds
 s_mov_b32 m0,63424
 s_nop 0
 buffer_load_dwordx4 v5,s[12:15],s40 offen offset:2048 nt lds
 s_mov_b32 m0,63456
 s_nop 0
 buffer_load_dwordx4 v5,s[12:15],s40 offen offset:3072 nt lds
 s_waitcnt vmcnt(18)
 s_waitcnt lgkmcnt(0)
 s_barrier
 tr 16,3,50688
 tr 18,3,51200
 tr 20,3,50720
 tr 22,3,51232
 mf 100,28,216,100
 tr 24,3,50752
 tr 26,3,51264
 s_xor_b32 s46,s53,2097152
 s_add_u32 s46,s46,s44
 s_add_u32 m0,s41,101376
 s_add_u32 s40,s46,768
 buffer_load_dwordx4 v2,s[16:19],s40 offen lds
 s_add_u32 m0,s41,102432
 s_add_u32 s40,s46,17152
 buffer_load_dwordx4 v2,s[16:19],s40 offen lds
 mf 104,8,216,104
 tr 28,3,50784
 tr 30,3,51296
 mf 108,12,216,108
 tr 8,3,54912
 tr 10,3,55424
 s_waitcnt lgkmcnt(6)
 mf 96,16,224,96
 tr 12,3,54944
 tr 14,3,55456
 mf 100,20,224,100
 tr 16,3,54976
 tr 18,3,55488
 s_mov_b32 m0,0
 s_mov_b32 s40,245760
 buffer_load_dwordx4 v5,s[8:11],s40 offen nt lds
 s_mov_b32 m0,32
 s_nop 0
 buffer_load_dwordx4 v5,s[8:11],s40 offen offset:1024 nt lds
 s_mov_b32 m0,64
 s_nop 0
 buffer_load_dwordx4 v5,s[8:11],s40 offen offset:2048 nt lds
 s_mov_b32 m0,96
 s_nop 0
 buffer_load_dwordx4 v5,s[8:11],s40 offen offset:3072 nt lds
 s_waitcnt lgkmcnt(6)
 mf 104,24,224,104
 tr 20,3,55008
 tr 22,3,55520
 s_mov_b32 m0,4224
 s_mov_b32 s40,249856
 buffer_load_dwordx4 v5,s[8:11],s40 offen nt lds
 s_mov_b32 m0,4256
 s_nop 0
 buffer_load_dwordx4 v5,s[8:11],s40 offen offset:1024 nt lds
 s_mov_b32 m0,4288
 s_nop 0
 buffer_load_dwordx4 v5,s[8:11],s40 offen offset:2048 nt lds
 s_mov_b32 m0,4320
 s_nop 0
 buffer_load_dwordx4 v5,s[8:11],s40 offen offset:3072 nt lds
 mf 108,28,224,108
 s_mov_b32 m0,8448
 s_mov_b32 s40,253952
 buffer_load_dwordx4 v5,s[8:11],s40 offen nt lds
 s_mov_b32 m0,8480
 s_nop 0
 buffer_load_dwordx4 v5,s[8:11],s40 offen offset:1024 nt lds
 s_mov_b32 m0,8512
 s_nop 0
 buffer_load_dwordx4 v5,s[8:11],s40 offen offset:2048 nt lds
 s_mov_b32 m0,8544
 s_nop 0
 buffer_load_dwordx4 v5,s[8:11],s40 offen offset:3072 nt lds
 s_waitcnt lgkmcnt(4)
 mf 96,8,232,96
 s_mov_b32 m0,12672
 s_mov_b32 s40,258048
 buffer_load_dwordx4 v5,s[8:11],s40 offen nt lds
 s_mov_b32 m0,12704
 s_nop 0
 buffer_load_dwordx4 v5,s[8:11],s40 offen offset:1024 nt lds
 s_mov_b32 m0,12736
 s_nop 0
 buffer_load_dwordx4 v5,s[8:11],s40 offen offset:2048 nt lds
 s_mov_b32 m0,12768
 s_nop 0
 buffer_load_dwordx4 v5,s[8:11],s40 offen offset:3072 nt lds
 s_waitcnt vmcnt(18)
 s_waitcnt lgkmcnt(0)
 s_barrier
 tr 24,3,59136
 tr 26,3,59648
 tr 28,3,59168
 tr 30,3,59680
 mf 100,12,232,100
 tr 8,3,59200
 tr 10,3,59712
 s_xor_b32 s46,s53,2097152
 s_add_u32 s46,s46,s44
 s_add_u32 m0,s41,103488
 s_add_u32 s40,s46,66304
 buffer_load_dwordx4 v2,s[16:19],s40 offen lds
 s_add_u32 m0,s41,104544
 s_add_u32 s40,s46,82688
 buffer_load_dwordx4 v2,s[16:19],s40 offen lds
 mf 104,16,232,104
 tr 12,3,59232
 tr 14,3,59744
 mf 108,20,232,108
 tr 16,3,63360
 tr 18,3,63872
 s_waitcnt lgkmcnt(6)
 mf 96,24,240,96
 tr 20,3,63392
 tr 22,3,63904
 mf 100,28,240,100
 tr 24,3,63424
 tr 26,3,63936
 s_mov_b32 m0,33792
 s_mov_b32 s40,229376
 buffer_load_dwordx4 v5,s[12:15],s40 offen nt lds
 s_mov_b32 m0,33824
 s_nop 0
 buffer_load_dwordx4 v5,s[12:15],s40 offen offset:1024 nt lds
 s_mov_b32 m0,33856
 s_nop 0
 buffer_load_dwordx4 v5,s[12:15],s40 offen offset:2048 nt lds
 s_mov_b32 m0,33888
 s_nop 0
 buffer_load_dwordx4 v5,s[12:15],s40 offen offset:3072 nt lds
 s_waitcnt lgkmcnt(6)
 mf 104,8,240,104
 tr 28,3,63456
 tr 30,3,63968
 s_mov_b32 m0,38016
 s_mov_b32 s40,233472
 buffer_load_dwordx4 v5,s[12:15],s40 offen nt lds
 s_mov_b32 m0,38048
 s_nop 0
 buffer_load_dwordx4 v5,s[12:15],s40 offen offset:1024 nt lds
 s_mov_b32 m0,38080
 s_nop 0
 buffer_load_dwordx4 v5,s[12:15],s40 offen offset:2048 nt lds
 s_mov_b32 m0,38112
 s_nop 0
 buffer_load_dwordx4 v5,s[12:15],s40 offen offset:3072 nt lds
 mf 108,12,240,108
 s_mov_b32 m0,42240
 s_mov_b32 s40,237568
 buffer_load_dwordx4 v5,s[12:15],s40 offen nt lds
 s_mov_b32 m0,42272
 s_nop 0
 buffer_load_dwordx4 v5,s[12:15],s40 offen offset:1024 nt lds
 s_mov_b32 m0,42304
 s_nop 0
 buffer_load_dwordx4 v5,s[12:15],s40 offen offset:2048 nt lds
 s_mov_b32 m0,42336
 s_nop 0
 buffer_load_dwordx4 v5,s[12:15],s40 offen offset:3072 nt lds
 s_waitcnt lgkmcnt(4)
 mf 96,16,248,96
 s_mov_b32 m0,46464
 s_mov_b32 s40,241664
 buffer_load_dwordx4 v5,s[12:15],s40 offen nt lds
 s_mov_b32 m0,46496
 s_nop 0
 buffer_load_dwordx4 v5,s[12:15],s40 offen offset:1024 nt lds
 s_mov_b32 m0,46528
 s_nop 0
 buffer_load_dwordx4 v5,s[12:15],s40 offen offset:2048 nt lds
 s_mov_b32 m0,46560
 s_nop 0
 buffer_load_dwordx4 v5,s[12:15],s40 offen offset:3072 nt lds
 s_waitcnt vmcnt(18)
 s_waitcnt lgkmcnt(0)
 s_barrier
 ds_read_b64_tr_b16 v[8:9],v3
 tr 10,3,512
 tr 12,3,32
 tr 14,3,544
 mf 100,20,248,100
 tr 16,3,64
 tr 18,3,576
 s_xor_b32 s46,s53,3145728
 s_add_u32 s46,s46,s44
 s_add_u32 m0,s41,118272
 s_add_u32 s40,s46,768
 buffer_load_dwordx4 v2,s[16:19],s40 offen lds
 s_add_u32 m0,s41,119328
 s_add_u32 s40,s46,17152
 buffer_load_dwordx4 v2,s[16:19],s40 offen lds
 mf 104,24,248,104
 tr 20,3,96
 tr 22,3,608
 mf 108,28,248,108
 v_mul_f32 v96,s38,v96
 v_mul_f32 v97,s38,v97
 v_mul_f32 v98,s38,v98
 v_mul_f32 v99,s38,v99
 v_mul_f32 v100,s38,v100
 v_mul_f32 v101,s38,v101
 v_mul_f32 v102,s38,v102
 v_mul_f32 v103,s38,v103
 cv 96,96,97
 cv 97,98,99
 cv 98,100,101
 cv 99,102,103
 ds_write_b64 v6,v[96:97] offset:14336
 ds_write_b64 v6,v[98:99] offset:17920
 v_mul_f32 v104,s38,v104
 v_mul_f32 v105,s38,v105
 v_mul_f32 v106,s38,v106
 v_mul_f32 v107,s38,v107
 v_mul_f32 v108,s38,v108
 v_mul_f32 v109,s38,v109
 v_mul_f32 v110,s38,v110
 v_mul_f32 v111,s38,v111
 cv 104,104,105
 cv 105,106,107
 cv 106,108,109
 cv 107,110,111
 ds_write_b64 v6,v[104:105] offset:21504
 ds_write_b64 v6,v[106:107] offset:25088
 s_mov_b32 m0,16896
 s_mov_b32 s40,262144
 buffer_load_dwordx4 v5,s[8:11],s40 offen nt lds
 s_mov_b32 m0,16928
 s_nop 0
 buffer_load_dwordx4 v5,s[8:11],s40 offen offset:1024 nt lds
 s_mov_b32 m0,16960
 s_nop 0
 buffer_load_dwordx4 v5,s[8:11],s40 offen offset:2048 nt lds
 s_mov_b32 m0,16992
 s_nop 0
 buffer_load_dwordx4 v5,s[8:11],s40 offen offset:3072 nt lds
 s_waitcnt lgkmcnt(8)
 mz 96,8,128
 s_mov_b32 m0,21120
 s_mov_b32 s40,266240
 buffer_load_dwordx4 v5,s[8:11],s40 offen nt lds
 s_mov_b32 m0,21152
 s_nop 0
 buffer_load_dwordx4 v5,s[8:11],s40 offen offset:1024 nt lds
 s_mov_b32 m0,21184
 s_nop 0
 buffer_load_dwordx4 v5,s[8:11],s40 offen offset:2048 nt lds
 s_mov_b32 m0,21216
 s_nop 0
 buffer_load_dwordx4 v5,s[8:11],s40 offen offset:3072 nt lds
 s_mov_b32 m0,25344
 s_mov_b32 s40,270336
 buffer_load_dwordx4 v5,s[8:11],s40 offen nt lds
 s_mov_b32 m0,25376
 s_nop 0
 buffer_load_dwordx4 v5,s[8:11],s40 offen offset:1024 nt lds
 s_mov_b32 m0,25408
 s_nop 0
 buffer_load_dwordx4 v5,s[8:11],s40 offen offset:2048 nt lds
 s_mov_b32 m0,25440
 s_nop 0
 buffer_load_dwordx4 v5,s[8:11],s40 offen offset:3072 nt lds
 s_mov_b32 m0,29568
 s_mov_b32 s40,274432
 buffer_load_dwordx4 v5,s[8:11],s40 offen nt lds
 s_mov_b32 m0,29600
 s_nop 0
 buffer_load_dwordx4 v5,s[8:11],s40 offen offset:1024 nt lds
 s_mov_b32 m0,29632
 s_nop 0
 buffer_load_dwordx4 v5,s[8:11],s40 offen offset:2048 nt lds
 s_mov_b32 m0,29664
 s_nop 0
 buffer_load_dwordx4 v5,s[8:11],s40 offen offset:3072 nt lds
 s_waitcnt vmcnt(18)
 s_waitcnt lgkmcnt(0)
 s_barrier
 tr 24,3,4224
 tr 26,3,4736
 tr 28,3,4256
 tr 30,3,4768
 mz 100,12,128
 tr 8,3,4288
 tr 10,3,4800
 s_xor_b32 s46,s53,3145728
 s_add_u32 s46,s46,s44
 s_add_u32 m0,s41,120384
 s_add_u32 s40,s46,66304
 buffer_load_dwordx4 v2,s[16:19],s40 offen lds
 s_add_u32 m0,s41,121440
 s_add_u32 s40,s46,82688
 buffer_load_dwordx4 v2,s[16:19],s40 offen lds
 mz 104,16,128
 tr 12,3,4320
 tr 14,3,4832
 mz 108,20,128
 tr 16,3,8448
 tr 18,3,8960
 s_waitcnt lgkmcnt(6)
 mf 96,24,136,96
 tr 20,3,8480
 tr 22,3,8992
 mf 100,28,136,100
 tr 24,3,8512
 tr 26,3,9024
 s_mov_b32 m0,50688
 s_mov_b32 s40,245760
 buffer_load_dwordx4 v5,s[12:15],s40 offen nt lds
 s_mov_b32 m0,50720
 s_nop 0
 buffer_load_dwordx4 v5,s[12:15],s40 offen offset:1024 nt lds
 s_mov_b32 m0,50752
 s_nop 0
 buffer_load_dwordx4 v5,s[12:15],s40 offen offset:2048 nt lds
 s_mov_b32 m0,50784
 s_nop 0
 buffer_load_dwordx4 v5,s[12:15],s40 offen offset:3072 nt lds
 s_waitcnt lgkmcnt(6)
 mf 104,8,136,104
 tr 28,3,8544
 tr 30,3,9056
 s_mov_b32 m0,54912
 s_mov_b32 s40,249856
 buffer_load_dwordx4 v5,s[12:15],s40 offen nt lds
 s_mov_b32 m0,54944
 s_nop 0
 buffer_load_dwordx4 v5,s[12:15],s40 offen offset:1024 nt lds
 s_mov_b32 m0,54976
 s_nop 0
 buffer_load_dwordx4 v5,s[12:15],s40 offen offset:2048 nt lds
 s_mov_b32 m0,55008
 s_nop 0
 buffer_load_dwordx4 v5,s[12:15],s40 offen offset:3072 nt lds
 mf 108,12,136,108
 s_mov_b32 m0,59136
 s_mov_b32 s40,253952
 buffer_load_dwordx4 v5,s[12:15],s40 offen nt lds
 s_mov_b32 m0,59168
 s_nop 0
 buffer_load_dwordx4 v5,s[12:15],s40 offen offset:1024 nt lds
 s_mov_b32 m0,59200
 s_nop 0
 buffer_load_dwordx4 v5,s[12:15],s40 offen offset:2048 nt lds
 s_mov_b32 m0,59232
 s_nop 0
 buffer_load_dwordx4 v5,s[12:15],s40 offen offset:3072 nt lds
 s_waitcnt lgkmcnt(4)
 mf 96,16,144,96
 s_mov_b32 m0,63360
 s_mov_b32 s40,258048
 buffer_load_dwordx4 v5,s[12:15],s40 offen nt lds
 s_mov_b32 m0,63392
 s_nop 0
 buffer_load_dwordx4 v5,s[12:15],s40 offen offset:1024 nt lds
 s_mov_b32 m0,63424
 s_nop 0
 buffer_load_dwordx4 v5,s[12:15],s40 offen offset:2048 nt lds
 s_mov_b32 m0,63456
 s_nop 0
 buffer_load_dwordx4 v5,s[12:15],s40 offen offset:3072 nt lds
 s_waitcnt vmcnt(18)
 s_waitcnt lgkmcnt(0)
 s_barrier
 tr 8,3,12672
 tr 10,3,13184
 tr 12,3,12704
 tr 14,3,13216
 mf 100,20,144,100
 tr 16,3,12736
 tr 18,3,13248
 mf 104,24,144,104
 tr 20,3,12768
 tr 22,3,13280
 mf 108,28,144,108
 tr 24,3,16896
 tr 26,3,17408
 s_waitcnt lgkmcnt(6)
 mf 96,8,152,96
 tr 28,3,16928
 tr 30,3,17440
 mf 100,12,152,100
 tr 8,3,16960
 tr 10,3,17472
 s_mov_b32 m0,0
 s_mov_b32 s40,278528
 buffer_load_dwordx4 v5,s[8:11],s40 offen nt lds
 s_mov_b32 m0,32
 s_nop 0
 buffer_load_dwordx4 v5,s[8:11],s40 offen offset:1024 nt lds
 s_mov_b32 m0,64
 s_nop 0
 buffer_load_dwordx4 v5,s[8:11],s40 offen offset:2048 nt lds
 s_mov_b32 m0,96
 s_nop 0
 buffer_load_dwordx4 v5,s[8:11],s40 offen offset:3072 nt lds
 s_waitcnt lgkmcnt(6)
 mf 104,16,152,104
 tr 12,3,16992
 tr 14,3,17504
 s_mov_b32 m0,4224
 s_mov_b32 s40,282624
 buffer_load_dwordx4 v5,s[8:11],s40 offen nt lds
 s_mov_b32 m0,4256
 s_nop 0
 buffer_load_dwordx4 v5,s[8:11],s40 offen offset:1024 nt lds
 s_mov_b32 m0,4288
 s_nop 0
 buffer_load_dwordx4 v5,s[8:11],s40 offen offset:2048 nt lds
 s_mov_b32 m0,4320
 s_nop 0
 buffer_load_dwordx4 v5,s[8:11],s40 offen offset:3072 nt lds
 mf 108,20,152,108
 s_mov_b32 m0,8448
 s_mov_b32 s40,286720
 buffer_load_dwordx4 v5,s[8:11],s40 offen nt lds
 s_mov_b32 m0,8480
 s_nop 0
 buffer_load_dwordx4 v5,s[8:11],s40 offen offset:1024 nt lds
 s_mov_b32 m0,8512
 s_nop 0
 buffer_load_dwordx4 v5,s[8:11],s40 offen offset:2048 nt lds
 s_mov_b32 m0,8544
 s_nop 0
 buffer_load_dwordx4 v5,s[8:11],s40 offen offset:3072 nt lds
 s_waitcnt lgkmcnt(4)
 mf 96,24,160,96
 s_mov_b32 m0,12672
 s_mov_b32 s40,290816
 buffer_load_dwordx4 v5,s[8:11],s40 offen nt lds
 s_mov_b32 m0,12704
 s_nop 0
 buffer_load_dwordx4 v5,s[8:11],s40 offen offset:1024 nt lds
 s_mov_b32 m0,12736
 s_nop 0
 buffer_load_dwordx4 v5,s[8:11],s40 offen offset:2048 nt lds
 s_mov_b32 m0,12768
 s_nop 0
 buffer_load_dwordx4 v5,s[8:11],s40 offen offset:3072 nt lds
 s_waitcnt vmcnt(16)
 s_waitcnt lgkmcnt(0)
 s_barrier
 tr 16,3,21120
 tr 18,3,21632
 tr 20,3,21152
 tr 22,3,21664
 mf 100,28,160,100
 tr 24,3,21184
 tr 26,3,21696
 s_xor_b32 s46,s53,0
 s_add_u32 s46,s46,s44
 s_add_u32 m0,s41,67584
 s_add_u32 s40,s46,896
 buffer_load_dwordx4 v2,s[16:19],s40 offen lds
 s_add_u32 m0,s41,68640
 s_add_u32 s40,s46,17280
 buffer_load_dwordx4 v2,s[16:19],s40 offen lds
 mf 104,8,160,104
 tr 28,3,21216
 tr 30,3,21728
 s_add_u32 m0,s41,69696
 s_add_u32 s40,s46,66432
 buffer_load_dwordx4 v2,s[16:19],s40 offen lds
 mf 108,12,160,108
 tr 8,3,25344
 tr 10,3,25856
 s_waitcnt lgkmcnt(6)
 mf 96,16,168,96
 tr 12,3,25376
 tr 14,3,25888
 mf 100,20,168,100
 tr 16,3,25408
 tr 18,3,25920
 s_waitcnt lgkmcnt(6)
 mf 104,24,168,104
 tr 20,3,25440
 tr 22,3,25952
 mf 108,28,168,108
 tr 24,3,29568
 tr 26,3,30080
 s_mov_b32 m0,33792
 s_mov_b32 s40,262144
 buffer_load_dwordx4 v5,s[12:15],s40 offen nt lds
 s_mov_b32 m0,33824
 s_nop 0
 buffer_load_dwordx4 v5,s[12:15],s40 offen offset:1024 nt lds
 s_mov_b32 m0,33856
 s_nop 0
 buffer_load_dwordx4 v5,s[12:15],s40 offen offset:2048 nt lds
 s_waitcnt lgkmcnt(6)
 mf 96,8,176,96
 tr 28,3,29600
 tr 30,3,30112
 s_mov_b32 m0,33888
 s_nop 0
 buffer_load_dwordx4 v5,s[12:15],s40 offen offset:3072 nt lds
 s_mov_b32 m0,38016
 s_mov_b32 s40,266240
 buffer_load_dwordx4 v5,s[12:15],s40 offen nt lds
 s_mov_b32 m0,38048
 s_nop 0
 buffer_load_dwordx4 v5,s[12:15],s40 offen offset:1024 nt lds
 mf 100,12,176,100
 tr 8,3,29632
 tr 10,3,30144
 s_mov_b32 m0,38080
 s_nop 0
 buffer_load_dwordx4 v5,s[12:15],s40 offen offset:2048 nt lds
 s_mov_b32 m0,38112
 s_nop 0
 buffer_load_dwordx4 v5,s[12:15],s40 offen offset:3072 nt lds
 s_mov_b32 m0,42240
 s_mov_b32 s40,270336
 s_waitcnt lgkmcnt(6)
 mf 104,16,176,104
 tr 12,3,29664
 tr 14,3,30176
 buffer_load_dwordx4 v5,s[12:15],s40 offen nt lds
 s_mov_b32 m0,42272
 s_nop 0
 buffer_load_dwordx4 v5,s[12:15],s40 offen offset:1024 nt lds
 s_mov_b32 m0,42304
 s_nop 0
 buffer_load_dwordx4 v5,s[12:15],s40 offen offset:2048 nt lds
 mf 108,20,176,108
 s_mov_b32 m0,42336
 s_nop 0
 buffer_load_dwordx4 v5,s[12:15],s40 offen offset:3072 nt lds
 s_mov_b32 m0,46464
 s_mov_b32 s40,274432
 buffer_load_dwordx4 v5,s[12:15],s40 offen nt lds
 s_mov_b32 m0,46496
 s_waitcnt lgkmcnt(4)
 mf 96,24,184,96
 buffer_load_dwordx4 v5,s[12:15],s40 offen offset:1024 nt lds
 s_mov_b32 m0,46528
 s_nop 0
 buffer_load_dwordx4 v5,s[12:15],s40 offen offset:2048 nt lds
 s_mov_b32 m0,46560
 s_nop 0
 buffer_load_dwordx4 v5,s[12:15],s40 offen offset:3072 nt lds
 s_waitcnt vmcnt(19)
 s_waitcnt lgkmcnt(0)
 s_barrier
 tr 16,3,33792
 tr 18,3,34304
 tr 20,3,33824
 tr 22,3,34336
 mf 100,28,184,100
 tr 24,3,33856
 tr 26,3,34368
 s_xor_b32 s46,s53,0
 s_add_u32 s46,s46,s44
 s_add_u32 m0,s41,70752
 s_add_u32 s40,s46,82816
 buffer_load_dwordx4 v2,s[16:19],s40 offen lds
 s_xor_b32 s46,s53,1048576
 s_add_u32 s46,s46,s44
 s_add_u32 m0,s41,84480
 s_add_u32 s40,s46,896
 mf 104,8,184,104
 tr 28,3,33888
 tr 30,3,34400
 buffer_load_dwordx4 v2,s[16:19],s40 offen lds
 s_add_u32 m0,s41,85536
 s_add_u32 s40,s46,17280
 mf 108,12,184,108
 tr 8,3,38016
 tr 10,3,38528
 buffer_load_dwordx4 v2,s[16:19],s40 offen lds
 s_add_u32 m0,s41,86592
 s_add_u32 s40,s46,66432
 s_waitcnt lgkmcnt(6)
 mf 96,16,192,96
 tr 12,3,38048
 tr 14,3,38560
 buffer_load_dwordx4 v2,s[16:19],s40 offen lds
 mf 100,20,192,100
 tr 16,3,38080
 tr 18,3,38592
 s_waitcnt lgkmcnt(6)
 mf 104,24,192,104
 tr 20,3,38112
 tr 22,3,38624
 mf 108,28,192,108
 tr 24,3,42240
 tr 26,3,42752
 s_waitcnt lgkmcnt(6)
 mf 96,8,200,96
 tr 28,3,42272
 tr 30,3,42784
 mf 100,12,200,100
 tr 8,3,42304
 tr 10,3,42816
 s_mov_b32 m0,16896
 s_mov_b32 s40,294912
 buffer_load_dwordx4 v5,s[8:11],s40 offen nt lds
 s_mov_b32 m0,16928
 s_nop 0
 buffer_load_dwordx4 v5,s[8:11],s40 offen offset:1024 nt lds
 s_waitcnt lgkmcnt(6)
 mf 104,16,200,104
 tr 12,3,42336
 tr 14,3,42848
 s_mov_b32 m0,16960
 s_nop 0
 buffer_load_dwordx4 v5,s[8:11],s40 offen offset:2048 nt lds
 s_mov_b32 m0,16992
 s_nop 0
 buffer_load_dwordx4 v5,s[8:11],s40 offen offset:3072 nt lds
 mf 108,20,200,108
 tr 16,3,46464
 tr 18,3,46976
 s_mov_b32 m0,21120
 s_mov_b32 s40,299008
 buffer_load_dwordx4 v5,s[8:11],s40 offen nt lds
 s_mov_b32 m0,21152
 s_nop 0
 buffer_load_dwordx4 v5,s[8:11],s40 offen offset:1024 nt lds
 s_waitcnt lgkmcnt(6)
 mf 96,24,208,96
 tr 20,3,46496
 tr 22,3,47008
 s_mov_b32 m0,21184
 s_nop 0
 buffer_load_dwordx4 v5,s[8:11],s40 offen offset:2048 nt lds
 s_mov_b32 m0,21216
 s_nop 0
 buffer_load_dwordx4 v5,s[8:11],s40 offen offset:3072 nt lds
 mf 100,28,208,100
 tr 24,3,46528
 tr 26,3,47040
 s_mov_b32 m0,25344
 s_mov_b32 s40,303104
 buffer_load_dwordx4 v5,s[8:11],s40 offen nt lds
 s_mov_b32 m0,25376
 s_nop 0
 buffer_load_dwordx4 v5,s[8:11],s40 offen offset:1024 nt lds
 s_waitcnt lgkmcnt(6)
 mf 104,8,208,104
 tr 28,3,46560
 tr 30,3,47072
 s_mov_b32 m0,25408
 s_nop 0
 buffer_load_dwordx4 v5,s[8:11],s40 offen offset:2048 nt lds
 s_mov_b32 m0,25440
 s_nop 0
 buffer_load_dwordx4 v5,s[8:11],s40 offen offset:3072 nt lds
 mf 108,12,208,108
 s_mov_b32 m0,29568
 s_mov_b32 s40,307200
 buffer_load_dwordx4 v5,s[8:11],s40 offen nt lds
 s_mov_b32 m0,29600
 s_nop 0
 buffer_load_dwordx4 v5,s[8:11],s40 offen offset:1024 nt lds
 s_waitcnt lgkmcnt(4)
 mf 96,16,216,96
 s_mov_b32 m0,29632
 s_nop 0
 buffer_load_dwordx4 v5,s[8:11],s40 offen offset:2048 nt lds
 s_mov_b32 m0,29664
 s_nop 0
 buffer_load_dwordx4 v5,s[8:11],s40 offen offset:3072 nt lds
 s_waitcnt vmcnt(20)
 s_waitcnt lgkmcnt(0)
 s_barrier
 tr 8,3,50688
 tr 10,3,51200
 tr 12,3,50720
 tr 14,3,51232
 mf 100,20,216,100
 tr 16,3,50752
 tr 18,3,51264
 s_xor_b32 s46,s53,1048576
 s_add_u32 s46,s46,s44
 s_add_u32 m0,s41,87648
 s_add_u32 s40,s46,82816
 buffer_load_dwordx4 v2,s[16:19],s40 offen lds
 s_xor_b32 s46,s53,2097152
 s_add_u32 s46,s46,s44
 s_add_u32 m0,s41,101376
 s_add_u32 s40,s46,896
 buffer_load_dwordx4 v2,s[16:19],s40 offen lds
 s_add_u32 m0,s41,102432
 s_add_u32 s40,s46,17280
 buffer_load_dwordx4 v2,s[16:19],s40 offen lds
 mf 104,24,216,104
 tr 20,3,50784
 tr 22,3,51296
 mf 108,28,216,108
 tr 24,3,54912
 tr 26,3,55424
 ds_read_b128 v[64:67],v4
 ds_read_b128 v[72:75],v4 offset:7168
 ds_read_b128 v[80:83],v4 offset:14336
 ds_read_b128 v[88:91],v4 offset:21504
 s_waitcnt lgkmcnt(10)
 mf 96,8,224,96
 tr 28,3,54944
 tr 30,3,55456
 mf 100,12,224,100
 tr 8,3,54976
 tr 10,3,55488
 s_mov_b32 m0,50688
 s_mov_b32 s40,278528
 buffer_load_dwordx4 v5,s[12:15],s40 offen nt lds
 s_mov_b32 m0,50720
 s_nop 0
 buffer_load_dwordx4 v5,s[12:15],s40 offen offset:1024 nt lds
 s_mov_b32 m0,50752
 s_nop 0
 buffer_load_dwordx4 v5,s[12:15],s40 offen offset:2048 nt lds
 s_mov_b32 m0,50784
 s_nop 0
 buffer_load_dwordx4 v5,s[12:15],s40 offen offset:3072 nt lds
 s_waitcnt lgkmcnt(10)
 mf 104,16,224,104
 tr 12,3,55008
 tr 14,3,55520
 s_mov_b32 m0,54912
 s_mov_b32 s40,282624
 buffer_load_dwordx4 v5,s[12:15],s40 offen nt lds
 s_mov_b32 m0,54944
 s_nop 0
 buffer_load_dwordx4 v5,s[12:15],s40 offen offset:1024 nt lds
 s_mov_b32 m0,54976
 s_nop 0
 buffer_load_dwordx4 v5,s[12:15],s40 offen offset:2048 nt lds
 s_mov_b32 m0,55008
 s_nop 0
 buffer_load_dwordx4 v5,s[12:15],s40 offen offset:3072 nt lds
 mf 108,20,224,108
 s_mov_b32 m0,59136
 s_mov_b32 s40,286720
 buffer_load_dwordx4 v5,s[12:15],s40 offen nt lds
 s_mov_b32 m0,59168
 s_nop 0
 buffer_load_dwordx4 v5,s[12:15],s40 offen offset:1024 nt lds
 s_mov_b32 m0,59200
 s_nop 0
 buffer_load_dwordx4 v5,s[12:15],s40 offen offset:2048 nt lds
 s_mov_b32 m0,59232
 s_nop 0
 buffer_load_dwordx4 v5,s[12:15],s40 offen offset:3072 nt lds
 s_waitcnt lgkmcnt(4)
 mf 96,24,232,96
 s_mov_b32 m0,63360
 s_mov_b32 s40,290816
 buffer_load_dwordx4 v5,s[12:15],s40 offen nt lds
 s_mov_b32 m0,63392
 s_nop 0
 buffer_load_dwordx4 v5,s[12:15],s40 offen offset:1024 nt lds
 s_mov_b32 m0,63424
 s_nop 0
 buffer_load_dwordx4 v5,s[12:15],s40 offen offset:2048 nt lds
 s_mov_b32 m0,63456
 s_nop 0
 buffer_load_dwordx4 v5,s[12:15],s40 offen offset:3072 nt lds
 s_waitcnt vmcnt(19)
 s_waitcnt lgkmcnt(0)
 s_barrier
 tr 16,3,59136
 tr 18,3,59648
 tr 20,3,59168
 tr 22,3,59680
 mf 100,28,232,100
 tr 24,3,59200
 tr 26,3,59712
 s_xor_b32 s46,s53,2097152
 s_add_u32 s46,s46,s44
 s_add_u32 m0,s41,103488
 s_add_u32 s40,s46,66432
 buffer_load_dwordx4 v2,s[16:19],s40 offen lds
 s_add_u32 m0,s41,104544
 s_add_u32 s40,s46,82816
 buffer_load_dwordx4 v2,s[16:19],s40 offen lds
 mf 104,8,232,104
 tr 28,3,59232
 tr 30,3,59744
 mf 108,12,232,108
 tr 8,3,63360
 tr 10,3,63872
 s_waitcnt lgkmcnt(6)
 mf 96,16,240,96
 tr 12,3,63392
 tr 14,3,63904
 mf 100,20,240,100
 tr 16,3,63424
 tr 18,3,63936
 s_mov_b32 m0,0
 s_mov_b32 s40,311296
 buffer_load_dwordx4 v5,s[8:11],s40 offen nt lds
 s_mov_b32 m0,32
 s_nop 0
 buffer_load_dwordx4 v5,s[8:11],s40 offen offset:1024 nt lds
 s_mov_b32 m0,64
 s_nop 0
 buffer_load_dwordx4 v5,s[8:11],s40 offen offset:2048 nt lds
 s_mov_b32 m0,96
 s_nop 0
 buffer_load_dwordx4 v5,s[8:11],s40 offen offset:3072 nt lds
 s_waitcnt lgkmcnt(6)
 mf 104,24,240,104
 tr 20,3,63456
 tr 22,3,63968
 s_mov_b32 m0,4224
 s_mov_b32 s40,315392
 buffer_load_dwordx4 v5,s[8:11],s40 offen nt lds
 s_mov_b32 m0,4256
 s_nop 0
 buffer_load_dwordx4 v5,s[8:11],s40 offen offset:1024 nt lds
 s_mov_b32 m0,4288
 s_nop 0
 buffer_load_dwordx4 v5,s[8:11],s40 offen offset:2048 nt lds
 s_mov_b32 m0,4320
 s_nop 0
 buffer_load_dwordx4 v5,s[8:11],s40 offen offset:3072 nt lds
 mf 108,28,240,108
 s_mov_b32 m0,8448
 s_mov_b32 s40,319488
 buffer_load_dwordx4 v5,s[8:11],s40 offen nt lds
 s_mov_b32 m0,8480
 s_nop 0
 buffer_load_dwordx4 v5,s[8:11],s40 offen offset:1024 nt lds
 s_mov_b32 m0,8512
 s_nop 0
 buffer_load_dwordx4 v5,s[8:11],s40 offen offset:2048 nt lds
 s_mov_b32 m0,8544
 s_nop 0
 buffer_load_dwordx4 v5,s[8:11],s40 offen offset:3072 nt lds
 s_waitcnt lgkmcnt(4)
 mf 96,8,248,96
 s_mov_b32 m0,12672
 s_mov_b32 s40,323584
 buffer_load_dwordx4 v5,s[8:11],s40 offen nt lds
 s_mov_b32 m0,12704
 s_nop 0
 buffer_load_dwordx4 v5,s[8:11],s40 offen offset:1024 nt lds
 s_mov_b32 m0,12736
 s_nop 0
 buffer_load_dwordx4 v5,s[8:11],s40 offen offset:2048 nt lds
 s_mov_b32 m0,12768
 s_nop 0
 buffer_load_dwordx4 v5,s[8:11],s40 offen offset:3072 nt lds
 s_waitcnt vmcnt(18)
 s_waitcnt lgkmcnt(0)
 s_barrier
 mf 100,12,248,100
 s_xor_b32 s46,s53,3145728
 s_add_u32 s46,s46,s44
 s_add_u32 m0,s41,118272
 s_add_u32 s40,s46,896
 buffer_load_dwordx4 v2,s[16:19],s40 offen lds
 s_add_u32 m0,s41,119328
 s_add_u32 s40,s46,17280
 buffer_load_dwordx4 v2,s[16:19],s40 offen lds
 mf 104,16,248,104
 mf 108,20,248,108
 v_mul_f32 v96,s38,v96
 v_mul_f32 v97,s38,v97
 v_mul_f32 v98,s38,v98
 v_mul_f32 v99,s38,v99
 v_mul_f32 v100,s38,v100
 v_mul_f32 v101,s38,v101
 v_mul_f32 v102,s38,v102
 v_mul_f32 v103,s38,v103
 cv 96,96,97
 cv 97,98,99
 cv 98,100,101
 cv 99,102,103
 ds_write_b64 v6,v[96:97]
 ds_write_b64 v6,v[98:99] offset:3584
 v_mul_f32 v104,s38,v104
 v_mul_f32 v105,s38,v105
 v_mul_f32 v106,s38,v106
 v_mul_f32 v107,s38,v107
 v_mul_f32 v108,s38,v108
 v_mul_f32 v109,s38,v109
 v_mul_f32 v110,s38,v110
 v_mul_f32 v111,s38,v111
 cv 104,104,105
 cv 105,106,107
 cv 106,108,109
 cv 107,110,111
 ds_write_b64 v6,v[104:105] offset:7168
 ds_write_b64 v6,v[106:107] offset:10752
 s_mov_b32 m0,33792
 s_mov_b32 s40,294912
 buffer_load_dwordx4 v5,s[12:15],s40 offen nt lds
 s_mov_b32 m0,33824
 s_nop 0
 buffer_load_dwordx4 v5,s[12:15],s40 offen offset:1024 nt lds
 s_mov_b32 m0,33856
 s_nop 0
 buffer_load_dwordx4 v5,s[12:15],s40 offen offset:2048 nt lds
 s_mov_b32 m0,33888
 s_nop 0
 buffer_load_dwordx4 v5,s[12:15],s40 offen offset:3072 nt lds
 s_mov_b32 m0,38016
 s_mov_b32 s40,299008
 buffer_load_dwordx4 v5,s[12:15],s40 offen nt lds
 s_mov_b32 m0,38048
 s_nop 0
 buffer_load_dwordx4 v5,s[12:15],s40 offen offset:1024 nt lds
 s_mov_b32 m0,38080
 s_nop 0
 buffer_load_dwordx4 v5,s[12:15],s40 offen offset:2048 nt lds
 s_mov_b32 m0,38112
 s_nop 0
 buffer_load_dwordx4 v5,s[12:15],s40 offen offset:3072 nt lds
 s_mov_b32 m0,42240
 s_mov_b32 s40,303104
 buffer_load_dwordx4 v5,s[12:15],s40 offen nt lds
 s_mov_b32 m0,42272
 s_nop 0
 buffer_load_dwordx4 v5,s[12:15],s40 offen offset:1024 nt lds
 s_mov_b32 m0,42304
 s_nop 0
 buffer_load_dwordx4 v5,s[12:15],s40 offen offset:2048 nt lds
 s_mov_b32 m0,42336
 s_nop 0
 buffer_load_dwordx4 v5,s[12:15],s40 offen offset:3072 nt lds
 s_mov_b32 m0,46464
 s_mov_b32 s40,307200
 buffer_load_dwordx4 v5,s[12:15],s40 offen nt lds
 s_mov_b32 m0,46496
 s_nop 0
 buffer_load_dwordx4 v5,s[12:15],s40 offen offset:1024 nt lds
 s_mov_b32 m0,46528
 s_nop 0
 buffer_load_dwordx4 v5,s[12:15],s40 offen offset:2048 nt lds
 s_mov_b32 m0,46560
 s_nop 0
 buffer_load_dwordx4 v5,s[12:15],s40 offen offset:3072 nt lds
 s_waitcnt vmcnt(18)
 s_waitcnt lgkmcnt(0)
 s_barrier
 ds_read_b64_tr_b16 v[24:25],v3
 tr 26,3,512
 tr 28,3,32
 tr 30,3,544
 tr 8,3,64
 tr 10,3,576
 tr 12,3,96
 tr 14,3,608
 tr 16,3,4224
 tr 18,3,4736
 s_waitcnt lgkmcnt(6)
 mz 96,24,128
 tr 20,3,4256
 tr 22,3,4768
 s_xor_b32 s46,s53,3145728
 s_add_u32 s46,s46,s44
 s_add_u32 m0,s41,120384
 s_add_u32 s40,s46,66432
 buffer_load_dwordx4 v2,s[16:19],s40 offen lds
 s_add_u32 m0,s41,121440
 s_add_u32 s40,s46,82816
 buffer_load_dwordx4 v2,s[16:19],s40 offen lds
 mz 100,28,128
 tr 24,3,4288
 tr 26,3,4800
 s_waitcnt lgkmcnt(6)
 mz 104,8,128
 tr 28,3,4320
 tr 30,3,4832
 mz 108,12,128
 s_mov_b32 m0,16896
 s_mov_b32 s40,327680
 buffer_load_dwordx4 v5,s[8:11],s40 offen nt lds
 s_mov_b32 m0,16928
 s_nop 0
 buffer_load_dwordx4 v5,s[8:11],s40 offen offset:1024 nt lds
 s_mov_b32 m0,16960
 s_nop 0
 buffer_load_dwordx4 v5,s[8:11],s40 offen offset:2048 nt lds
 s_mov_b32 m0,16992
 s_nop 0
 buffer_load_dwordx4 v5,s[8:11],s40 offen offset:3072 nt lds
 s_mov_b32 m0,21120
 s_mov_b32 s40,331776
 buffer_load_dwordx4 v5,s[8:11],s40 offen nt lds
 s_mov_b32 m0,21152
 s_nop 0
 buffer_load_dwordx4 v5,s[8:11],s40 offen offset:1024 nt lds
 s_mov_b32 m0,21184
 s_nop 0
 buffer_load_dwordx4 v5,s[8:11],s40 offen offset:2048 nt lds
 s_mov_b32 m0,21216
 s_nop 0
 buffer_load_dwordx4 v5,s[8:11],s40 offen offset:3072 nt lds
 s_waitcnt lgkmcnt(4)
 mf 96,16,136,96
 s_mov_b32 m0,25344
 s_mov_b32 s40,335872
 buffer_load_dwordx4 v5,s[8:11],s40 offen nt lds
 s_mov_b32 m0,25376
 s_nop 0
 buffer_load_dwordx4 v5,s[8:11],s40 offen offset:1024 nt lds
 s_mov_b32 m0,25408
 s_nop 0
 buffer_load_dwordx4 v5,s[8:11],s40 offen offset:2048 nt lds
 s_mov_b32 m0,25440
 s_nop 0
 buffer_load_dwordx4 v5,s[8:11],s40 offen offset:3072 nt lds
 s_mov_b32 m0,29568
 s_mov_b32 s40,339968
 buffer_load_dwordx4 v5,s[8:11],s40 offen nt lds
 s_mov_b32 m0,29600
 s_nop 0
 buffer_load_dwordx4 v5,s[8:11],s40 offen offset:1024 nt lds
 s_mov_b32 m0,29632
 s_nop 0
 buffer_load_dwordx4 v5,s[8:11],s40 offen offset:2048 nt lds
 s_mov_b32 m0,29664
 s_nop 0
 buffer_load_dwordx4 v5,s[8:11],s40 offen offset:3072 nt lds
 s_waitcnt vmcnt(18)
 s_waitcnt lgkmcnt(0)
 s_barrier
 tr 8,3,8448
 tr 10,3,8960
 tr 12,3,8480
 tr 14,3,8992
 mf 100,20,136,100
 tr 16,3,8512
 tr 18,3,9024
 mf 104,24,136,104
 tr 20,3,8544
 tr 22,3,9056
 mf 108,28,136,108
 tr 24,3,12672
 tr 26,3,13184
 s_waitcnt lgkmcnt(6)
 mf 96,8,144,96
 tr 28,3,12704
 tr 30,3,13216
 mf 100,12,144,100
 tr 8,3,12736
 tr 10,3,13248
 s_mov_b32 m0,50688
 s_mov_b32 s40,311296
 buffer_load_dwordx4 v5,s[12:15],s40 offen nt lds
 s_mov_b32 m0,50720
 s_nop 0
 buffer_load_dwordx4 v5,s[12:15],s40 offen offset:1024 nt lds
 s_mov_b32 m0,50752
 s_nop 0
 buffer_load_dwordx4 v5,s[12:15],s40 offen offset:2048 nt lds
 s_mov_b32 m0,50784
 s_nop 0
 buffer_load_dwordx4 v5,s[12:15],s40 offen offset:3072 nt lds
 s_waitcnt lgkmcnt(6)
 mf 104,16,144,104
 tr 12,3,12768
 tr 14,3,13280
 s_mov_b32 m0,54912
 s_mov_b32 s40,315392
 buffer_load_dwordx4 v5,s[12:15],s40 offen nt lds
 s_mov_b32 m0,54944
 s_nop 0
 buffer_load_dwordx4 v5,s[12:15],s40 offen offset:1024 nt lds
 s_mov_b32 m0,54976
 s_nop 0
 buffer_load_dwordx4 v5,s[12:15],s40 offen offset:2048 nt lds
 s_mov_b32 m0,55008
 s_nop 0
 buffer_load_dwordx4 v5,s[12:15],s40 offen offset:3072 nt lds
 mf 108,20,144,108
 s_mov_b32 m0,59136
 s_mov_b32 s40,319488
 buffer_load_dwordx4 v5,s[12:15],s40 offen nt lds
 s_mov_b32 m0,59168
 s_nop 0
 buffer_load_dwordx4 v5,s[12:15],s40 offen offset:1024 nt lds
 s_mov_b32 m0,59200
 s_nop 0
 buffer_load_dwordx4 v5,s[12:15],s40 offen offset:2048 nt lds
 s_mov_b32 m0,59232
 s_nop 0
 buffer_load_dwordx4 v5,s[12:15],s40 offen offset:3072 nt lds
 s_waitcnt lgkmcnt(4)
 mf 96,24,152,96
 s_mov_b32 m0,63360
 s_mov_b32 s40,323584
 buffer_load_dwordx4 v5,s[12:15],s40 offen nt lds
 s_mov_b32 m0,63392
 s_nop 0
 buffer_load_dwordx4 v5,s[12:15],s40 offen offset:1024 nt lds
 s_mov_b32 m0,63424
 s_nop 0
 buffer_load_dwordx4 v5,s[12:15],s40 offen offset:2048 nt lds
 s_mov_b32 m0,63456
 s_nop 0
 buffer_load_dwordx4 v5,s[12:15],s40 offen offset:3072 nt lds
 s_waitcnt vmcnt(16)
 s_waitcnt lgkmcnt(0)
 s_barrier
 tr 16,3,16896
 tr 18,3,17408
 tr 20,3,16928
 tr 22,3,17440
 mf 100,28,152,100
 tr 24,3,16960
 tr 26,3,17472
 v_and_b32 v2,0x70,v1
 v_bfe_u32 v0,v1,7,1
 v_lshl_add_u32 v2,v0,10,v2
 v_bfe_u32 v0,v1,8,2
 v_lshl_add_u32 v2,v0,13,v2
 s_add_u32 s46,s37,1
 s_and_b32 s46,s46,7
 s_lshl_b32 s46,s46,7
 s_add_u32 s46,s46,s45
 s_add_u32 m0,s41,67584
 s_add_u32 s40,s46,0
 buffer_load_dwordx4 v2,s[20:23],s40 offen lds
 s_add_u32 m0,s41,68640
 s_add_u32 s40,s46,2048
 mf 104,8,152,104
 tr 28,3,16992
 tr 30,3,17504
 buffer_load_dwordx4 v2,s[20:23],s40 offen lds
 mf 108,12,152,108
 tr 8,3,21120
 tr 10,3,21632
 s_waitcnt lgkmcnt(6)
 mf 96,16,160,96
 tr 12,3,21152
 tr 14,3,21664
 mf 100,20,160,100
 tr 16,3,21184
 tr 18,3,21696
 s_mov_b32 m0,0
 s_mov_b32 s40,344064
 buffer_load_dwordx4 v5,s[8:11],s40 offen nt lds
 s_mov_b32 m0,32
 s_nop 0
 buffer_load_dwordx4 v5,s[8:11],s40 offen offset:1024 nt lds
 s_mov_b32 m0,64
 s_nop 0
 buffer_load_dwordx4 v5,s[8:11],s40 offen offset:2048 nt lds
 s_mov_b32 m0,96
 s_nop 0
 buffer_load_dwordx4 v5,s[8:11],s40 offen offset:3072 nt lds
 s_waitcnt lgkmcnt(6)
 mf 104,24,160,104
 tr 20,3,21216
 tr 22,3,21728
 s_mov_b32 m0,4224
 s_mov_b32 s40,348160
 buffer_load_dwordx4 v5,s[8:11],s40 offen nt lds
 s_mov_b32 m0,4256
 s_nop 0
 buffer_load_dwordx4 v5,s[8:11],s40 offen offset:1024 nt lds
 s_mov_b32 m0,4288
 s_nop 0
 buffer_load_dwordx4 v5,s[8:11],s40 offen offset:2048 nt lds
 s_mov_b32 m0,4320
 s_nop 0
 buffer_load_dwordx4 v5,s[8:11],s40 offen offset:3072 nt lds
 mf 108,28,160,108
 s_mov_b32 m0,8448
 s_mov_b32 s40,352256
 buffer_load_dwordx4 v5,s[8:11],s40 offen nt lds
 s_mov_b32 m0,8480
 s_nop 0
 buffer_load_dwordx4 v5,s[8:11],s40 offen offset:1024 nt lds
 s_mov_b32 m0,8512
 s_nop 0
 buffer_load_dwordx4 v5,s[8:11],s40 offen offset:2048 nt lds
 s_mov_b32 m0,8544
 s_nop 0
 buffer_load_dwordx4 v5,s[8:11],s40 offen offset:3072 nt lds
 s_waitcnt lgkmcnt(4)
 mf 96,8,168,96
 s_mov_b32 m0,12672
 s_mov_b32 s40,356352
 buffer_load_dwordx4 v5,s[8:11],s40 offen nt lds
 s_mov_b32 m0,12704
 s_nop 0
 buffer_load_dwordx4 v5,s[8:11],s40 offen offset:1024 nt lds
 s_mov_b32 m0,12736
 s_nop 0
 buffer_load_dwordx4 v5,s[8:11],s40 offen offset:2048 nt lds
 s_mov_b32 m0,12768
 s_nop 0
 buffer_load_dwordx4 v5,s[8:11],s40 offen offset:3072 nt lds
 s_waitcnt vmcnt(18)
 s_waitcnt lgkmcnt(0)
 s_barrier
 tr 24,3,25344
 tr 26,3,25856
 tr 28,3,25376
 tr 30,3,25888
 mf 100,12,168,100
 tr 8,3,25408
 tr 10,3,25920
 s_add_u32 s46,s37,1
 s_and_b32 s46,s46,7
 s_lshl_b32 s46,s46,7
 s_add_u32 s46,s46,s45
 s_add_u32 m0,s41,69696
 s_add_u32 s40,s46,4096
 buffer_load_dwordx4 v2,s[20:23],s40 offen lds
 s_add_u32 m0,s41,70752
 s_add_u32 s40,s46,6144
 buffer_load_dwordx4 v2,s[20:23],s40 offen lds
 mf 104,16,168,104
 tr 12,3,25440
 tr 14,3,25952
 mf 108,20,168,108
 tr 16,3,29568
 tr 18,3,30080
 s_waitcnt lgkmcnt(6)
 mf 96,24,176,96
 tr 20,3,29600
 tr 22,3,30112
 mf 100,28,176,100
 tr 24,3,29632
 tr 26,3,30144
 s_mov_b32 m0,33792
 s_mov_b32 s40,327680
 buffer_load_dwordx4 v5,s[12:15],s40 offen nt lds
 s_mov_b32 m0,33824
 s_nop 0
 buffer_load_dwordx4 v5,s[12:15],s40 offen offset:1024 nt lds
 s_mov_b32 m0,33856
 s_nop 0
 buffer_load_dwordx4 v5,s[12:15],s40 offen offset:2048 nt lds
 s_mov_b32 m0,33888
 s_nop 0
 buffer_load_dwordx4 v5,s[12:15],s40 offen offset:3072 nt lds
 s_waitcnt lgkmcnt(6)
 mf 104,8,176,104
 tr 28,3,29664
 tr 30,3,30176
 s_mov_b32 m0,38016
 s_mov_b32 s40,331776
 buffer_load_dwordx4 v5,s[12:15],s40 offen nt lds
 s_mov_b32 m0,38048
 s_nop 0
 buffer_load_dwordx4 v5,s[12:15],s40 offen offset:1024 nt lds
 s_mov_b32 m0,38080
 s_nop 0
 buffer_load_dwordx4 v5,s[12:15],s40 offen offset:2048 nt lds
 s_mov_b32 m0,38112
 s_nop 0
 buffer_load_dwordx4 v5,s[12:15],s40 offen offset:3072 nt lds
 mf 108,12,176,108
 s_mov_b32 m0,42240
 s_mov_b32 s40,335872
 buffer_load_dwordx4 v5,s[12:15],s40 offen nt lds
 s_mov_b32 m0,42272
 s_nop 0
 buffer_load_dwordx4 v5,s[12:15],s40 offen offset:1024 nt lds
 s_mov_b32 m0,42304
 s_nop 0
 buffer_load_dwordx4 v5,s[12:15],s40 offen offset:2048 nt lds
 s_mov_b32 m0,42336
 s_nop 0
 buffer_load_dwordx4 v5,s[12:15],s40 offen offset:3072 nt lds
 s_waitcnt lgkmcnt(4)
 mf 96,16,184,96
 s_mov_b32 m0,46464
 s_mov_b32 s40,339968
 buffer_load_dwordx4 v5,s[12:15],s40 offen nt lds
 s_mov_b32 m0,46496
 s_nop 0
 buffer_load_dwordx4 v5,s[12:15],s40 offen offset:1024 nt lds
 s_mov_b32 m0,46528
 s_nop 0
 buffer_load_dwordx4 v5,s[12:15],s40 offen offset:2048 nt lds
 s_mov_b32 m0,46560
 s_nop 0
 buffer_load_dwordx4 v5,s[12:15],s40 offen offset:3072 nt lds
 s_waitcnt vmcnt(18)
 s_waitcnt lgkmcnt(0)
 s_barrier
 tr 8,3,33792
 tr 10,3,34304
 tr 12,3,33824
 tr 14,3,34336
 mf 100,20,184,100
 tr 16,3,33856
 tr 18,3,34368
 s_add_u32 s46,s37,2
 s_and_b32 s46,s46,7
 s_lshl_b32 s46,s46,7
 s_add_u32 s46,s46,s45
 s_add_u32 m0,s41,84480
 s_add_u32 s40,s46,0
 buffer_load_dwordx4 v2,s[20:23],s40 offen lds
 s_add_u32 m0,s41,85536
 s_add_u32 s40,s46,2048
 buffer_load_dwordx4 v2,s[20:23],s40 offen lds
 mf 104,24,184,104
 tr 20,3,33888
 tr 22,3,34400
 mf 108,28,184,108
 tr 24,3,38016
 tr 26,3,38528
 s_waitcnt lgkmcnt(6)
 mf 96,8,192,96
 tr 28,3,38048
 tr 30,3,38560
 mf 100,12,192,100
 tr 8,3,38080
 tr 10,3,38592
 s_mov_b32 m0,16896
 s_mov_b32 s40,360448
 buffer_load_dwordx4 v5,s[8:11],s40 offen nt lds
 s_mov_b32 m0,16928
 s_nop 0
 buffer_load_dwordx4 v5,s[8:11],s40 offen offset:1024 nt lds
 s_mov_b32 m0,16960
 s_nop 0
 buffer_load_dwordx4 v5,s[8:11],s40 offen offset:2048 nt lds
 s_mov_b32 m0,16992
 s_nop 0
 buffer_load_dwordx4 v5,s[8:11],s40 offen offset:3072 nt lds
 s_waitcnt lgkmcnt(6)
 mf 104,16,192,104
 tr 12,3,38112
 tr 14,3,38624
 s_mov_b32 m0,21120
 s_mov_b32 s40,364544
 buffer_load_dwordx4 v5,s[8:11],s40 offen nt lds
 s_mov_b32 m0,21152
 s_nop 0
 buffer_load_dwordx4 v5,s[8:11],s40 offen offset:1024 nt lds
 s_mov_b32 m0,21184
 s_nop 0
 buffer_load_dwordx4 v5,s[8:11],s40 offen offset:2048 nt lds
 s_mov_b32 m0,21216
 s_nop 0
 buffer_load_dwordx4 v5,s[8:11],s40 offen offset:3072 nt lds
 mf 108,20,192,108
 s_mov_b32 m0,25344
 s_mov_b32 s40,368640
 buffer_load_dwordx4 v5,s[8:11],s40 offen nt lds
 s_mov_b32 m0,25376
 s_nop 0
 buffer_load_dwordx4 v5,s[8:11],s40 offen offset:1024 nt lds
 s_mov_b32 m0,25408
 s_nop 0
 buffer_load_dwordx4 v5,s[8:11],s40 offen offset:2048 nt lds
 s_mov_b32 m0,25440
 s_nop 0
 buffer_load_dwordx4 v5,s[8:11],s40 offen offset:3072 nt lds
 s_waitcnt lgkmcnt(4)
 mf 96,24,200,96
 s_mov_b32 m0,29568
 s_mov_b32 s40,372736
 buffer_load_dwordx4 v5,s[8:11],s40 offen nt lds
 s_mov_b32 m0,29600
 s_nop 0
 buffer_load_dwordx4 v5,s[8:11],s40 offen offset:1024 nt lds
 s_mov_b32 m0,29632
 s_nop 0
 buffer_load_dwordx4 v5,s[8:11],s40 offen offset:2048 nt lds
 s_mov_b32 m0,29664
 s_nop 0
 buffer_load_dwordx4 v5,s[8:11],s40 offen offset:3072 nt lds
 s_waitcnt vmcnt(18)
 s_waitcnt lgkmcnt(0)
 s_barrier
 tr 16,3,42240
 tr 18,3,42752
 tr 20,3,42272
 tr 22,3,42784
 mf 100,28,200,100
 tr 24,3,42304
 tr 26,3,42816
 s_add_u32 s46,s37,2
 s_and_b32 s46,s46,7
 s_lshl_b32 s46,s46,7
 s_add_u32 s46,s46,s45
 s_add_u32 m0,s41,86592
 s_add_u32 s40,s46,4096
 buffer_load_dwordx4 v2,s[20:23],s40 offen lds
 s_add_u32 m0,s41,87648
 s_add_u32 s40,s46,6144
 buffer_load_dwordx4 v2,s[20:23],s40 offen lds
 mf 104,8,200,104
 tr 28,3,42336
 tr 30,3,42848
 mf 108,12,200,108
 tr 8,3,46464
 tr 10,3,46976
 s_waitcnt lgkmcnt(6)
 mf 96,16,208,96
 tr 12,3,46496
 tr 14,3,47008
 mf 100,20,208,100
 tr 16,3,46528
 tr 18,3,47040
 s_mov_b32 m0,50688
 s_mov_b32 s40,344064
 buffer_load_dwordx4 v5,s[12:15],s40 offen nt lds
 s_mov_b32 m0,50720
 s_nop 0
 buffer_load_dwordx4 v5,s[12:15],s40 offen offset:1024 nt lds
 s_mov_b32 m0,50752
 s_nop 0
 buffer_load_dwordx4 v5,s[12:15],s40 offen offset:2048 nt lds
 s_mov_b32 m0,50784
 s_nop 0
 buffer_load_dwordx4 v5,s[12:15],s40 offen offset:3072 nt lds
 s_waitcnt lgkmcnt(6)
 mf 104,24,208,104
 tr 20,3,46560
 tr 22,3,47072
 s_mov_b32 m0,54912
 s_mov_b32 s40,348160
 buffer_load_dwordx4 v5,s[12:15],s40 offen nt lds
 s_mov_b32 m0,54944
 s_nop 0
 buffer_load_dwordx4 v5,s[12:15],s40 offen offset:1024 nt lds
 s_mov_b32 m0,54976
 s_nop 0
 buffer_load_dwordx4 v5,s[12:15],s40 offen offset:2048 nt lds
 s_mov_b32 m0,55008
 s_nop 0
 buffer_load_dwordx4 v5,s[12:15],s40 offen offset:3072 nt lds
 mf 108,28,208,108
 s_mov_b32 m0,59136
 s_mov_b32 s40,352256
 buffer_load_dwordx4 v5,s[12:15],s40 offen nt lds
 s_mov_b32 m0,59168
 s_nop 0
 buffer_load_dwordx4 v5,s[12:15],s40 offen offset:1024 nt lds
 s_mov_b32 m0,59200
 s_nop 0
 buffer_load_dwordx4 v5,s[12:15],s40 offen offset:2048 nt lds
 s_mov_b32 m0,59232
 s_nop 0
 buffer_load_dwordx4 v5,s[12:15],s40 offen offset:3072 nt lds
 s_waitcnt lgkmcnt(4)
 mf 96,8,216,96
 s_mov_b32 m0,63360
 s_mov_b32 s40,356352
 buffer_load_dwordx4 v5,s[12:15],s40 offen nt lds
 s_mov_b32 m0,63392
 s_nop 0
 buffer_load_dwordx4 v5,s[12:15],s40 offen offset:1024 nt lds
 s_mov_b32 m0,63424
 s_nop 0
 buffer_load_dwordx4 v5,s[12:15],s40 offen offset:2048 nt lds
 s_mov_b32 m0,63456
 s_nop 0
 buffer_load_dwordx4 v5,s[12:15],s40 offen offset:3072 nt lds
 s_waitcnt vmcnt(18)
 s_waitcnt lgkmcnt(0)
 s_barrier
 tr 24,3,50688
 tr 26,3,51200
 tr 28,3,50720
 tr 30,3,51232
 mf 100,12,216,100
 tr 8,3,50752
 tr 10,3,51264
 s_add_u32 s46,s37,3
 s_and_b32 s46,s46,7
 s_lshl_b32 s46,s46,7
 s_add_u32 s46,s46,s45
 s_add_u32 m0,s41,101376
 s_add_u32 s40,s46,0
 buffer_load_dwordx4 v2,s[20:23],s40 offen lds
 s_add_u32 m0,s41,102432
 s_add_u32 s40,s46,2048
 buffer_load_dwordx4 v2,s[20:23],s40 offen lds
 mf 104,16,216,104
 tr 12,3,50784
 tr 14,3,51296
 mf 108,20,216,108
 tr 16,3,54912
 tr 18,3,55424
 s_waitcnt lgkmcnt(6)
 mf 96,24,224,96
 tr 20,3,54944
 tr 22,3,55456
 mf 100,28,224,100
 tr 24,3,54976
 tr 26,3,55488
 s_mov_b32 m0,0
 s_mov_b32 s40,376832
 buffer_load_dwordx4 v5,s[8:11],s40 offen nt lds
 s_mov_b32 m0,32
 s_nop 0
 buffer_load_dwordx4 v5,s[8:11],s40 offen offset:1024 nt lds
 s_mov_b32 m0,64
 s_nop 0
 buffer_load_dwordx4 v5,s[8:11],s40 offen offset:2048 nt lds
 s_mov_b32 m0,96
 s_nop 0
 buffer_load_dwordx4 v5,s[8:11],s40 offen offset:3072 nt lds
 s_waitcnt lgkmcnt(6)
 mf 104,8,224,104
 tr 28,3,55008
 tr 30,3,55520
 s_mov_b32 m0,4224
 s_mov_b32 s40,380928
 buffer_load_dwordx4 v5,s[8:11],s40 offen nt lds
 s_mov_b32 m0,4256
 s_nop 0
 buffer_load_dwordx4 v5,s[8:11],s40 offen offset:1024 nt lds
 s_mov_b32 m0,4288
 s_nop 0
 buffer_load_dwordx4 v5,s[8:11],s40 offen offset:2048 nt lds
 s_mov_b32 m0,4320
 s_nop 0
 buffer_load_dwordx4 v5,s[8:11],s40 offen offset:3072 nt lds
 mf 108,12,224,108
 s_mov_b32 m0,8448
 s_mov_b32 s40,385024
 buffer_load_dwordx4 v5,s[8:11],s40 offen nt lds
 s_mov_b32 m0,8480
 s_nop 0
 buffer_load_dwordx4 v5,s[8:11],s40 offen offset:1024 nt lds
 s_mov_b32 m0,8512
 s_nop 0
 buffer_load_dwordx4 v5,s[8:11],s40 offen offset:2048 nt lds
 s_mov_b32 m0,8544
 s_nop 0
 buffer_load_dwordx4 v5,s[8:11],s40 offen offset:3072 nt lds
 s_waitcnt lgkmcnt(4)
 mf 96,16,232,96
 s_mov_b32 m0,12672
 s_mov_b32 s40,389120
 buffer_load_dwordx4 v5,s[8:11],s40 offen nt lds
 s_mov_b32 m0,12704
 s_nop 0
 buffer_load_dwordx4 v5,s[8:11],s40 offen offset:1024 nt lds
 s_mov_b32 m0,12736
 s_nop 0
 buffer_load_dwordx4 v5,s[8:11],s40 offen offset:2048 nt lds
 s_mov_b32 m0,12768
 s_nop 0
 buffer_load_dwordx4 v5,s[8:11],s40 offen offset:3072 nt lds
 s_waitcnt vmcnt(18)
 s_waitcnt lgkmcnt(0)
 s_barrier
 tr 8,3,59136
 tr 10,3,59648
 tr 12,3,59168
 tr 14,3,59680
 mf 100,20,232,100
 tr 16,3,59200
 tr 18,3,59712
 s_add_u32 s46,s37,3
 s_and_b32 s46,s46,7
 s_lshl_b32 s46,s46,7
 s_add_u32 s46,s46,s45
 s_add_u32 m0,s41,103488
 s_add_u32 s40,s46,4096
 buffer_load_dwordx4 v2,s[20:23],s40 offen lds
 s_add_u32 m0,s41,104544
 s_add_u32 s40,s46,6144
 buffer_load_dwordx4 v2,s[20:23],s40 offen lds
 mf 104,24,232,104
 tr 20,3,59232
 tr 22,3,59744
 mf 108,28,232,108
 tr 24,3,63360
 tr 26,3,63872
 s_waitcnt lgkmcnt(6)
 mf 96,8,240,96
 tr 28,3,63392
 tr 30,3,63904
 mf 100,12,240,100
 tr 8,3,63424
 tr 10,3,63936
 s_mov_b32 m0,33792
 s_mov_b32 s40,360448
 buffer_load_dwordx4 v5,s[12:15],s40 offen nt lds
 s_mov_b32 m0,33824
 s_nop 0
 buffer_load_dwordx4 v5,s[12:15],s40 offen offset:1024 nt lds
 s_mov_b32 m0,33856
 s_nop 0
 buffer_load_dwordx4 v5,s[12:15],s40 offen offset:2048 nt lds
 s_mov_b32 m0,33888
 s_nop 0
 buffer_load_dwordx4 v5,s[12:15],s40 offen offset:3072 nt lds
 s_waitcnt lgkmcnt(6)
 mf 104,16,240,104
 tr 12,3,63456
 tr 14,3,63968
 s_mov_b32 m0,38016
 s_mov_b32 s40,364544
 buffer_load_dwordx4 v5,s[12:15],s40 offen nt lds
 s_mov_b32 m0,38048
 s_nop 0
 buffer_load_dwordx4 v5,s[12:15],s40 offen offset:1024 nt lds
 s_mov_b32 m0,38080
 s_nop 0
 buffer_load_dwordx4 v5,s[12:15],s40 offen offset:2048 nt lds
 s_mov_b32 m0,38112
 s_nop 0
 buffer_load_dwordx4 v5,s[12:15],s40 offen offset:3072 nt lds
 mf 108,20,240,108
 s_mov_b32 m0,42240
 s_mov_b32 s40,368640
 buffer_load_dwordx4 v5,s[12:15],s40 offen nt lds
 s_mov_b32 m0,42272
 s_nop 0
 buffer_load_dwordx4 v5,s[12:15],s40 offen offset:1024 nt lds
 s_mov_b32 m0,42304
 s_nop 0
 buffer_load_dwordx4 v5,s[12:15],s40 offen offset:2048 nt lds
 s_mov_b32 m0,42336
 s_nop 0
 buffer_load_dwordx4 v5,s[12:15],s40 offen offset:3072 nt lds
 s_waitcnt lgkmcnt(4)
 mf 96,24,248,96
 s_mov_b32 m0,46464
 s_mov_b32 s40,372736
 buffer_load_dwordx4 v5,s[12:15],s40 offen nt lds
 s_mov_b32 m0,46496
 s_nop 0
 buffer_load_dwordx4 v5,s[12:15],s40 offen offset:1024 nt lds
 s_mov_b32 m0,46528
 s_nop 0
 buffer_load_dwordx4 v5,s[12:15],s40 offen offset:2048 nt lds
 s_mov_b32 m0,46560
 s_nop 0
 buffer_load_dwordx4 v5,s[12:15],s40 offen offset:3072 nt lds
 s_waitcnt vmcnt(18)
 s_waitcnt lgkmcnt(0)
 s_barrier
 ds_read_b64_tr_b16 v[16:17],v3
 tr 18,3,512
 tr 20,3,32
 tr 22,3,544
 mf 100,28,248,100
 tr 24,3,64
 tr 26,3,576
 s_mov_b32 m0,16896
 s_mov_b32 s40,393216
 buffer_load_dwordx4 v5,s[8:11],s40 offen nt lds
 s_mov_b32 m0,16928
 s_nop 0
 buffer_load_dwordx4 v5,s[8:11],s40 offen offset:1024 nt lds
 s_mov_b32 m0,16960
 s_nop 0
 buffer_load_dwordx4 v5,s[8:11],s40 offen offset:2048 nt lds
 s_mov_b32 m0,16992
 mf 104,8,248,104
 tr 28,3,96
 tr 30,3,608
 buffer_load_dwordx4 v5,s[8:11],s40 offen offset:3072 nt lds
 s_mov_b32 m0,21120
 s_mov_b32 s40,397312
 buffer_load_dwordx4 v5,s[8:11],s40 offen nt lds
 s_mov_b32 m0,21152
 s_nop 0
 buffer_load_dwordx4 v5,s[8:11],s40 offen offset:1024 nt lds
 s_mov_b32 m0,21184
 mf 108,12,248,108
 tr 8,3,4224
 tr 10,3,4736
 buffer_load_dwordx4 v5,s[8:11],s40 offen offset:2048 nt lds
 s_mov_b32 m0,21216
 s_nop 0
 buffer_load_dwordx4 v5,s[8:11],s40 offen offset:3072 nt lds
 s_mov_b32 m0,25344
 s_mov_b32 s40,401408
 buffer_load_dwordx4 v5,s[8:11],s40 offen nt lds
 s_mov_b32 m0,25376
 s_waitcnt lgkmcnt(6)
 mz 128,16,32
 tr 12,3,4256
 tr 14,3,4768
 buffer_load_dwordx4 v5,s[8:11],s40 offen offset:1024 nt lds
 s_mov_b32 m0,25408
 s_nop 0
 buffer_load_dwordx4 v5,s[8:11],s40 offen offset:2048 nt lds
 s_mov_b32 m0,25440
 s_nop 0
 buffer_load_dwordx4 v5,s[8:11],s40 offen offset:3072 nt lds
 s_mov_b32 m0,29568
 s_mov_b32 s40,405504
 buffer_load_dwordx4 v5,s[8:11],s40 offen nt lds
 mz 132,20,32
 tr 16,3,4288
 tr 18,3,4800
 s_mov_b32 m0,29600
 s_nop 0
 buffer_load_dwordx4 v5,s[8:11],s40 offen offset:1024 nt lds
 s_mov_b32 m0,29632
 s_nop 0
 buffer_load_dwordx4 v5,s[8:11],s40 offen offset:2048 nt lds
 s_mov_b32 m0,29664
 s_nop 0
 buffer_load_dwordx4 v5,s[8:11],s40 offen offset:3072 nt lds
 v_mul_f32 v96,s38,v96
 v_mul_f32 v97,s38,v97
 s_waitcnt lgkmcnt(6)
 mz 136,24,32
 tr 20,3,4320
 tr 22,3,4832
 v_mul_f32 v98,s38,v98
 v_mul_f32 v99,s38,v99
 v_mul_f32 v100,s38,v100
 v_mul_f32 v101,s38,v101
 v_mul_f32 v102,s38,v102
 v_mul_f32 v103,s38,v103
 cv 96,96,97
 cv 97,98,99
 cv 98,100,101
 cv 99,102,103
 ds_write_b64 v6,v[96:97] offset:14336
 mz 140,28,32
 ds_write_b64 v6,v[98:99] offset:17920
 v_mul_f32 v104,s38,v104
 v_mul_f32 v105,s38,v105
 v_mul_f32 v106,s38,v106
 v_mul_f32 v107,s38,v107
 v_mul_f32 v108,s38,v108
 v_mul_f32 v109,s38,v109
 v_mul_f32 v110,s38,v110
 v_mul_f32 v111,s38,v111
 cv 104,104,105
 cv 105,106,107
 cv 106,108,109
 cv 107,110,111
 s_waitcnt lgkmcnt(6)
 mf 128,8,40,128
 ds_write_b64 v6,v[104:105] offset:21504
 ds_write_b64 v6,v[106:107] offset:25088
 s_add_u32 s46,s37,4
 s_and_b32 s46,s46,7
 s_lshl_b32 s46,s46,7
 s_add_u32 s46,s46,s45
 s_add_u32 m0,s41,118272
 s_add_u32 s40,s46,0
 buffer_load_dwordx4 v2,s[20:23],s40 offen lds
 s_add_u32 m0,s41,119328
 s_add_u32 s40,s46,2048
 buffer_load_dwordx4 v2,s[20:23],s40 offen lds
 s_waitcnt vmcnt(18)
 s_waitcnt lgkmcnt(0)
 s_barrier
 tr 24,3,8448
 tr 26,3,8960
 tr 28,3,8480
 tr 30,3,8992
 mf 132,12,40,132
 tr 8,3,8512
 tr 10,3,9024
 s_mov_b32 m0,50688
 s_mov_b32 s40,376832
 buffer_load_dwordx4 v5,s[12:15],s40 offen nt lds
 s_mov_b32 m0,50720
 s_nop 0
 buffer_load_dwordx4 v5,s[12:15],s40 offen offset:1024 nt lds
 s_mov_b32 m0,50752
 mf 136,16,40,136
 tr 12,3,8544
 tr 14,3,9056
 buffer_load_dwordx4 v5,s[12:15],s40 offen offset:2048 nt lds
 s_mov_b32 m0,50784
 s_nop 0
 buffer_load_dwordx4 v5,s[12:15],s40 offen offset:3072 nt lds
 s_mov_b32 m0,54912
 s_mov_b32 s40,380928
 mf 140,20,40,140
 tr 16,3,12672
 tr 18,3,13184
 buffer_load_dwordx4 v5,s[12:15],s40 offen nt lds
 s_mov_b32 m0,54944
 s_nop 0
 buffer_load_dwordx4 v5,s[12:15],s40 offen offset:1024 nt lds
 s_mov_b32 m0,54976
 s_waitcnt lgkmcnt(6)
 mf 128,24,48,128
 tr 20,3,12704
 tr 22,3,13216
 buffer_load_dwordx4 v5,s[12:15],s40 offen offset:2048 nt lds
 s_mov_b32 m0,55008
 s_nop 0
 buffer_load_dwordx4 v5,s[12:15],s40 offen offset:3072 nt lds
 s_mov_b32 m0,59136
 s_mov_b32 s40,385024
 mf 132,28,48,132
 tr 24,3,12736
 tr 26,3,13248
 buffer_load_dwordx4 v5,s[12:15],s40 offen nt lds
 s_mov_b32 m0,59168
 s_nop 0
 buffer_load_dwordx4 v5,s[12:15],s40 offen offset:1024 nt lds
 s_mov_b32 m0,59200
 s_nop 0
 buffer_load_dwordx4 v5,s[12:15],s40 offen offset:2048 nt lds
 s_waitcnt lgkmcnt(6)
 mf 136,8,48,136
 tr 28,3,12768
 tr 30,3,13280
 s_mov_b32 m0,59232
 s_nop 0
 buffer_load_dwordx4 v5,s[12:15],s40 offen offset:3072 nt lds
 s_mov_b32 m0,63360
 s_mov_b32 s40,389120
 buffer_load_dwordx4 v5,s[12:15],s40 offen nt lds
 s_mov_b32 m0,63392
 mf 140,12,48,140
 buffer_load_dwordx4 v5,s[12:15],s40 offen offset:1024 nt lds
 s_mov_b32 m0,63424
 s_nop 0
 buffer_load_dwordx4 v5,s[12:15],s40 offen offset:2048 nt lds
 s_mov_b32 m0,63456
 s_nop 0
 buffer_load_dwordx4 v5,s[12:15],s40 offen offset:3072 nt lds
 s_waitcnt lgkmcnt(4)
 mf 128,16,56,128
 s_add_u32 s46,s37,4
 s_and_b32 s46,s46,7
 s_lshl_b32 s46,s46,7
 s_add_u32 s46,s46,s45
 s_add_u32 m0,s41,120384
 s_add_u32 s40,s46,4096
 buffer_load_dwordx4 v2,s[20:23],s40 offen lds
 s_add_u32 m0,s41,121440
 s_add_u32 s40,s46,6144
 buffer_load_dwordx4 v2,s[20:23],s40 offen lds
 v_mbcnt_lo_u32_b32 v0,-1,0
 v_mbcnt_hi_u32_b32 v0,-1,v0
 s_lshl_b32 s47,s37,2
 s_add_u32 s47,s47,s33
 s_lshl_b32 s47,s47,2
 v_cmp_eq_u32 vcc,0,v0
 v_mov_b32 v0,s47
 v_mov_b32 v7,0x40000000
 v_cndmask_b32 v7,v7,v0,vcc
 s_mov_b32 s40,0
 s_cmp_eq_u32 s33,3
 s_cselect_b32 s40,0x40000000,s40
 v_add_u32 v6,s40,v1
 s_waitcnt vmcnt(20)
 s_waitcnt lgkmcnt(0)
 s_barrier
 tr 8,3,16896
 tr 10,3,17408
 tr 12,3,16928
 tr 14,3,17440
 mf 132,20,56,132
 tr 16,3,16960
 tr 18,3,17472
 s_mov_b32 m0,0
 s_mov_b32 s40,409600
 buffer_load_dwordx4 v5,s[8:11],s40 offen nt lds
 s_mov_b32 m0,32
 s_nop 0
 buffer_load_dwordx4 v5,s[8:11],s40 offen offset:1024 nt lds
 mf 136,24,56,136
 tr 20,3,16992
 tr 22,3,17504
 s_mov_b32 m0,64
 s_nop 0
 buffer_load_dwordx4 v5,s[8:11],s40 offen offset:2048 nt lds
 s_mov_b32 m0,96
 s_nop 0
 buffer_load_dwordx4 v5,s[8:11],s40 offen offset:3072 nt lds
 mf 140,28,56,140
 tr 24,3,21120
 tr 26,3,21632
 s_mov_b32 m0,4224
 s_mov_b32 s40,413696
 buffer_load_dwordx4 v5,s[8:11],s40 offen nt lds
 s_mov_b32 m0,4256
 s_waitcnt lgkmcnt(6)
 mz 160,8,32
 tr 28,3,21152
 tr 30,3,21664
 buffer_load_dwordx4 v5,s[8:11],s40 offen offset:1024 nt lds
 s_mov_b32 m0,4288
 s_nop 0
 buffer_load_dwordx4 v5,s[8:11],s40 offen offset:2048 nt lds
 mz 164,12,32
 tr 8,3,21184
 tr 10,3,21696
 s_mov_b32 m0,4320
 s_nop 0
 buffer_load_dwordx4 v5,s[8:11],s40 offen offset:3072 nt lds
 s_mov_b32 m0,8448
 s_mov_b32 s40,417792
 s_waitcnt lgkmcnt(6)
 mz 168,16,32
 tr 12,3,21216
 tr 14,3,21728
 buffer_load_dwordx4 v5,s[8:11],s40 offen nt lds
 s_mov_b32 m0,8480
 s_nop 0
 buffer_load_dwordx4 v5,s[8:11],s40 offen offset:1024 nt lds
 mz 172,20,32
 tr 16,3,25344
 tr 18,3,25856
 s_mov_b32 m0,8512
 s_nop 0
 buffer_load_dwordx4 v5,s[8:11],s40 offen offset:2048 nt lds
 s_mov_b32 m0,8544
 s_nop 0
 buffer_load_dwordx4 v5,s[8:11],s40 offen offset:3072 nt lds
 s_waitcnt lgkmcnt(6)
 mf 160,24,40,160
 tr 20,3,25376
 tr 22,3,25888
 s_mov_b32 m0,12672
 s_mov_b32 s40,421888
 buffer_load_dwordx4 v5,s[8:11],s40 offen nt lds
 s_mov_b32 m0,12704
 mf 164,28,40,164
 tr 24,3,25408
 tr 26,3,25920
 buffer_load_dwordx4 v5,s[8:11],s40 offen offset:1024 nt lds
 s_mov_b32 m0,12736
 s_nop 0
 buffer_load_dwordx4 v5,s[8:11],s40 offen offset:2048 nt lds
 s_waitcnt lgkmcnt(6)
 mf 168,8,40,168
 tr 28,3,25440
 tr 30,3,25952
 s_mov_b32 m0,12768
 s_nop 0
 buffer_load_dwordx4 v5,s[8:11],s40 offen offset:3072 nt lds
 s_add_u32 s46,s37,5
 s_and_b32 s46,s46,7
 s_lshl_b32 s46,s46,7
 s_add_u32 s46,s46,s45
 s_add_u32 m0,s41,67584
 s_add_u32 s40,s46,0
 mf 172,12,40,172
 buffer_load_dwordx4 v2,s[20:23],s40 offen lds
 s_add_u32 m0,s41,68640
 s_add_u32 s40,s46,2048
 buffer_load_dwordx4 v2,s[20:23],s40 offen lds
 s_waitcnt lgkmcnt(4)
 mf 160,16,48,160
 s_add_u32 m0,s41,69696
 s_add_u32 s40,s46,4096
 buffer_load_dwordx4 v2,s[20:23],s40 offen lds
 s_waitcnt vmcnt(21)
 s_waitcnt lgkmcnt(0)
 s_barrier
 tr 8,3,29568
 tr 10,3,30080
 tr 12,3,29600
 tr 14,3,30112
 mf 164,20,48,164
 tr 16,3,29632
 tr 18,3,30144
 s_mov_b32 m0,33792
 s_mov_b32 s40,393216
 buffer_load_dwordx4 v5,s[12:15],s40 offen nt lds
 s_mov_b32 m0,33824
 mf 168,24,48,168
 tr 20,3,29664
 tr 22,3,30176
 buffer_load_dwordx4 v5,s[12:15],s40 offen offset:1024 nt lds
 s_mov_b32 m0,33856
 mf 172,28,48,172
 tr 24,3,33792
 tr 26,3,34304
 buffer_load_dwordx4 v5,s[12:15],s40 offen offset:2048 nt lds
 s_mov_b32 m0,33888
 s_nop 0
 buffer_load_dwordx4 v5,s[12:15],s40 offen offset:3072 nt lds
 s_waitcnt lgkmcnt(6)
 mf 160,8,56,160
 tr 28,3,33824
 tr 30,3,34336
 s_mov_b32 m0,38016
 s_mov_b32 s40,397312
 buffer_load_dwordx4 v5,s[12:15],s40 offen nt lds
 s_mov_b32 m0,38048
 mf 164,12,56,164
 tr 8,3,33856
 tr 10,3,34368
 buffer_load_dwordx4 v5,s[12:15],s40 offen offset:1024 nt lds
 s_mov_b32 m0,38080
 s_nop 0
 buffer_load_dwordx4 v5,s[12:15],s40 offen offset:2048 nt lds
 s_waitcnt lgkmcnt(6)
 mf 168,16,56,168
 tr 12,3,33888
 tr 14,3,34400
 s_mov_b32 m0,38112
 s_nop 0
 buffer_load_dwordx4 v5,s[12:15],s40 offen offset:3072 nt lds
 s_mov_b32 m0,42240
 s_mov_b32 s40,401408
 mf 172,20,56,172
 tr 16,3,38016
 tr 18,3,38528
 buffer_load_dwordx4 v5,s[12:15],s40 offen nt lds
 s_mov_b32 m0,42272
 s_nop 0
 buffer_load_dwordx4 v5,s[12:15],s40 offen offset:1024 nt lds
 s_waitcnt lgkmcnt(6)
 mz 192,24,32
 tr 20,3,38048
 tr 22,3,38560
 s_mov_b32 m0,42304
 s_nop 0
 buffer_load_dwordx4 v5,s[12:15],s40 offen offset:2048 nt lds
 s_mov_b32 m0,42336
 mz 196,28,32
 tr 24,3,38080
 tr 26,3,38592
 buffer_load_dwordx4 v5,s[12:15],s40 offen offset:3072 nt lds
 s_mov_b32 m0,46464
 s_mov_b32 s40,405504
 buffer_load_dwordx4 v5,s[12:15],s40 offen nt lds
 s_waitcnt lgkmcnt(6)
 mz 200,8,32
 tr 28,3,38112
 tr 30,3,38624
 s_mov_b32 m0,46496
 s_nop 0
 buffer_load_dwordx4 v5,s[12:15],s40 offen offset:1024 nt lds
 s_mov_b32 m0,46528
 mz 204,12,32
 buffer_load_dwordx4 v5,s[12:15],s40 offen offset:2048 nt lds
 s_mov_b32 m0,46560
 s_nop 0
 buffer_load_dwordx4 v5,s[12:15],s40 offen offset:3072 nt lds
 s_waitcnt lgkmcnt(4)
 mf 192,16,40,192
 s_add_u32 s46,s37,5
 s_and_b32 s46,s46,7
 s_lshl_b32 s46,s46,7
 s_add_u32 s46,s46,s45
 s_add_u32 m0,s41,70752
 s_add_u32 s40,s46,6144
 buffer_load_dwordx4 v2,s[20:23],s40 offen lds
 v_mbcnt_lo_u32_b32 v0,-1,0
 v_mbcnt_hi_u32_b32 v0,-1,v0
 s_lshl_b32 s40,s33,2
 v_min_u32 v0,7,v0
 v_lshlrev_b32 v0,4,v0
 v_add_u32 v0,s40,v0
 s_lshl_b32 s39,s37,7
 s_waitcnt vmcnt(20)
 s_waitcnt lgkmcnt(0)
 s_barrier
 tr 8,3,42240
 tr 10,3,42752
 tr 12,3,42272
 tr 14,3,42784
 mf 196,20,40,196
 tr 16,3,42304
 tr 18,3,42816
 s_mov_b32 m0,16896
 s_mov_b32 s40,425984
 buffer_load_dwordx4 v5,s[8:11],s40 offen nt lds
 s_mov_b32 m0,16928
 mf 200,24,40,200
 tr 20,3,42336
 tr 22,3,42848
 buffer_load_dwordx4 v5,s[8:11],s40 offen offset:1024 nt lds
 s_mov_b32 m0,16960
 mf 204,28,40,204
 tr 24,3,46464
 tr 26,3,46976
 buffer_load_dwordx4 v5,s[8:11],s40 offen offset:2048 nt lds
 s_mov_b32 m0,16992
 s_waitcnt lgkmcnt(6)
 mf 192,8,48,192
 tr 28,3,46496
 tr 30,3,47008
 buffer_load_dwordx4 v5,s[8:11],s40 offen offset:3072 nt lds
 s_mov_b32 m0,21120
 s_mov_b32 s40,430080
 mf 196,12,48,196
 tr 8,3,46528
 tr 10,3,47040
 buffer_load_dwordx4 v5,s[8:11],s40 offen nt lds
 s_mov_b32 m0,21152
 s_waitcnt lgkmcnt(6)
 mf 200,16,48,200
 tr 12,3,46560
 tr 14,3,47072
 buffer_load_dwordx4 v5,s[8:11],s40 offen offset:1024 nt lds
 s_mov_b32 m0,21184
 mf 204,20,48,204
 tr 16,3,50688
 tr 18,3,51200
 buffer_load_dwordx4 v5,s[8:11],s40 offen offset:2048 nt lds
 s_mov_b32 m0,21216
 s_waitcnt lgkmcnt(6)
 mf 192,24,56,192
 tr 20,3,50720
 tr 22,3,51232
 buffer_load_dwordx4 v5,s[8:11],s40 offen offset:3072 nt lds
 s_mov_b32 m0,25344
 s_mov_b32 s40,434176
 mf 196,28,56,196
 tr 24,3,50752
 tr 26,3,51264
 buffer_load_dwordx4 v5,s[8:11],s40 offen nt lds
 s_mov_b32 m0,25376
 s_nop 0
 buffer_load_dwordx4 v5,s[8:11],s40 offen offset:1024 nt lds
 s_waitcnt lgkmcnt(6)
 mf 200,8,56,200
 tr 28,3,50784
 tr 30,3,51296
 s_mov_b32 m0,25408
 s_nop 0
 buffer_load_dwordx4 v5,s[8:11],s40 offen offset:2048 nt lds
 s_mov_b32 m0,25440
 mf 204,12,56,204
 tr 8,3,54912
 tr 10,3,55424
 buffer_load_dwordx4 v5,s[8:11],s40 offen offset:3072 nt lds
 s_mov_b32 m0,29568
 s_mov_b32 s40,438272
 buffer_load_dwordx4 v5,s[8:11],s40 offen nt lds
 s_waitcnt lgkmcnt(6)
 mz 224,16,32
 tr 12,3,54944
 tr 14,3,55456
 s_mov_b32 m0,29600
 s_nop 0
 buffer_load_dwordx4 v5,s[8:11],s40 offen offset:1024 nt lds
 s_mov_b32 m0,29632
 mz 228,20,32
 tr 16,3,54976
 tr 18,3,55488
 buffer_load_dwordx4 v5,s[8:11],s40 offen offset:2048 nt lds
 s_mov_b32 m0,29664
 s_nop 0
 buffer_load_dwordx4 v5,s[8:11],s40 offen offset:3072 nt lds
 s_waitcnt lgkmcnt(6)
 mz 232,24,32
 tr 20,3,55008
 tr 22,3,55520
 s_add_u32 s46,s37,1
 s_and_b32 s46,s46,7
 s_lshl_b32 s46,s46,7
 s_add_u32 s46,s46,s45
 s_add_u32 m0,s41,84480
 s_add_u32 s40,s46,131072
 buffer_load_dwordx4 v2,s[20:23],s40 offen lds
 s_add_u32 m0,s41,85536
 s_add_u32 s40,s46,133120
 mz 236,28,32
 buffer_load_dwordx4 v2,s[20:23],s40 offen lds
 s_add_u32 m0,s41,86592
 s_add_u32 s40,s46,135168
 buffer_load_dwordx4 v2,s[20:23],s40 offen lds
 s_waitcnt lgkmcnt(4)
 mf 224,8,40,224
 s_add_u32 m0,s41,87648
 s_add_u32 s40,s46,137216
 buffer_load_dwordx4 v2,s[20:23],s40 offen lds
 s_waitcnt vmcnt(20)
 s_waitcnt lgkmcnt(0)
 s_barrier
 tr 24,3,59136
 tr 26,3,59648
 tr 28,3,59168
 tr 30,3,59680
 mf 228,12,40,228
 tr 8,3,59200
 tr 10,3,59712
 s_mov_b32 m0,50688
 s_mov_b32 s40,409600
 buffer_load_dwordx4 v5,s[12:15],s40 offen nt lds
 s_mov_b32 m0,50720
 s_nop 0
 buffer_load_dwordx4 v5,s[12:15],s40 offen offset:1024 nt lds
 mf 232,16,40,232
 tr 12,3,59232
 tr 14,3,59744
 s_mov_b32 m0,50752
 s_nop 0
 buffer_load_dwordx4 v5,s[12:15],s40 offen offset:2048 nt lds
 s_mov_b32 m0,50784
 s_nop 0
 buffer_load_dwordx4 v5,s[12:15],s40 offen offset:3072 nt lds
 mf 236,20,40,236
 tr 16,3,63360
 tr 18,3,63872
 s_mov_b32 m0,54912
 s_mov_b32 s40,413696
 buffer_load_dwordx4 v5,s[12:15],s40 offen nt lds
 s_mov_b32 m0,54944
 s_waitcnt lgkmcnt(6)
 mf 224,24,48,224
 tr 20,3,63392
 tr 22,3,63904
 buffer_load_dwordx4 v5,s[12:15],s40 offen offset:1024 nt lds
 s_mov_b32 m0,54976
 s_nop 0
 buffer_load_dwordx4 v5,s[12:15],s40 offen offset:2048 nt lds
 mf 228,28,48,228
 tr 24,3,63424
 tr 26,3,63936
 s_mov_b32 m0,55008
 s_nop 0
 buffer_load_dwordx4 v5,s[12:15],s40 offen offset:3072 nt lds
 s_mov_b32 m0,59136
 s_mov_b32 s40,417792
 s_waitcnt lgkmcnt(6)
 mf 232,8,48,232
 tr 28,3,63456
 tr 30,3,63968
 buffer_load_dwordx4 v5,s[12:15],s40 offen nt lds
 s_mov_b32 m0,59168
 s_nop 0
 buffer_load_dwordx4 v5,s[12:15],s40 offen offset:1024 nt lds
 mf 236,12,48,236
 ds_read_b64_tr_b16 v[8:9],v3
 tr 10,3,512
 s_mov_b32 m0,59200
 s_nop 0
 buffer_load_dwordx4 v5,s[12:15],s40 offen offset:2048 nt lds
 s_mov_b32 m0,59232
 s_nop 0
 buffer_load_dwordx4 v5,s[12:15],s40 offen offset:3072 nt lds
 s_waitcnt lgkmcnt(6)
 mf 224,16,56,224
 tr 12,3,32
 tr 14,3,544
 s_mov_b32 m0,63360
 s_mov_b32 s40,421888
 buffer_load_dwordx4 v5,s[12:15],s40 offen nt lds
 s_mov_b32 m0,63392
 mf 228,20,56,228
 tr 16,3,64
 tr 18,3,576
 buffer_load_dwordx4 v5,s[12:15],s40 offen offset:1024 nt lds
 s_mov_b32 m0,63424
 s_nop 0
 buffer_load_dwordx4 v5,s[12:15],s40 offen offset:2048 nt lds
 s_waitcnt lgkmcnt(6)
 mf 232,24,56,232
 tr 20,3,96
 tr 22,3,608
 s_mov_b32 m0,63456
 s_nop 0
 buffer_load_dwordx4 v5,s[12:15],s40 offen offset:3072 nt lds
 s_add_u32 s46,s37,2
 s_and_b32 s46,s46,7
 s_lshl_b32 s46,s46,7
 s_add_u32 s46,s46,s45
 s_add_u32 m0,s41,101376
 s_add_u32 s40,s46,131072
 mf 236,28,56,236
 buffer_load_dwordx4 v2,s[20:23],s40 offen lds
 s_add_u32 m0,s41,102432
 s_add_u32 s40,s46,133120
 buffer_load_dwordx4 v2,s[20:23],s40 offen lds
 s_waitcnt lgkmcnt(4)
 mz 96,8,32
 s_add_u32 m0,s41,103488
 s_add_u32 s40,s46,135168
 buffer_load_dwordx4 v2,s[20:23],s40 offen lds
 s_waitcnt vmcnt(23)
 s_waitcnt lgkmcnt(0)
 s_barrier
 tr 24,3,4224
 tr 26,3,4736
 tr 28,3,4256
 tr 30,3,4768
 mz 100,12,32
 tr 8,3,4288
 tr 10,3,4800
 s_mov_b32 m0,0
 s_mov_b32 s40,442368
 buffer_load_dwordx4 v5,s[8:11],s40 offen nt lds
 s_mov_b32 m0,32
 s_nop 0
 buffer_load_dwordx4 v5,s[8:11],s40 offen offset:1024 nt lds
 mz 104,16,32
 tr 12,3,4320
 tr 14,3,4832
 s_mov_b32 m0,64
 s_nop 0
 buffer_load_dwordx4 v5,s[8:11],s40 offen offset:2048 nt lds
 s_mov_b32 m0,96
 s_nop 0
 buffer_load_dwordx4 v5,s[8:11],s40 offen offset:3072 nt lds
 mz 108,20,32
 tr 16,3,8448
 tr 18,3,8960
 s_mov_b32 m0,4224
 s_mov_b32 s40,446464
 buffer_load_dwordx4 v5,s[8:11],s40 offen nt lds
 s_mov_b32 m0,4256
 s_waitcnt lgkmcnt(6)
 mf 96,24,40,96
 tr 20,3,8480
 tr 22,3,8992
 buffer_load_dwordx4 v5,s[8:11],s40 offen offset:1024 nt lds
 s_mov_b32 m0,4288
 s_nop 0
 buffer_load_dwordx4 v5,s[8:11],s40 offen offset:2048 nt lds
 mf 100,28,40,100
 tr 24,3,8512
 tr 26,3,9024
 s_mov_b32 m0,4320
 s_nop 0
 buffer_load_dwordx4 v5,s[8:11],s40 offen offset:3072 nt lds
 s_mov_b32 m0,8448
 s_mov_b32 s40,450560
 buffer_load_dwordx4 v5,s[8:11],s40 offen nt lds
 s_waitcnt lgkmcnt(6)
 mf 104,8,40,104
 tr 28,3,8544
 tr 30,3,9056
 s_mov_b32 m0,8480
 s_nop 0
 buffer_load_dwordx4 v5,s[8:11],s40 offen offset:1024 nt lds
 s_mov_b32 m0,8512
 mf 108,12,40,108
 tr 8,3,12672
 tr 10,3,13184
 buffer_load_dwordx4 v5,s[8:11],s40 offen offset:2048 nt lds
 s_mov_b32 m0,8544
 s_nop 0
 buffer_load_dwordx4 v5,s[8:11],s40 offen offset:3072 nt lds
 s_waitcnt lgkmcnt(6)
 mf 96,16,48,96
 tr 12,3,12704
 tr 14,3,13216
 s_mov_b32 m0,12672
 s_mov_b32 s40,454656
 buffer_load_dwordx4 v5,s[8:11],s40 offen nt lds
 s_mov_b32 m0,12704
 mf 100,20,48,100
 tr 16,3,12736
 tr 18,3,13248
 buffer_load_dwordx4 v5,s[8:11],s40 offen offset:1024 nt lds
 s_mov_b32 m0,12736
 s_nop 0
 buffer_load_dwordx4 v5,s[8:11],s40 offen offset:2048 nt lds
 s_waitcnt lgkmcnt(6)
 mf 104,24,48,104
 tr 20,3,12768
 tr 22,3,13280
 s_mov_b32 m0,12768
 s_nop 0
 buffer_load_dwordx4 v5,s[8:11],s40 offen offset:3072 nt lds
 s_add_u32 s46,s37,2
 s_and_b32 s46,s46,7
 s_lshl_b32 s46,s46,7
 s_add_u32 s46,s46,s45
 s_add_u32 m0,s41,104544
 s_add_u32 s40,s46,137216
 mf 108,28,48,108
 buffer_load_dwordx4 v2,s[20:23],s40 offen lds
 s_add_u32 s46,s37,3
 s_and_b32 s46,s46,7
 s_lshl_b32 s46,s46,7
 s_add_u32 s46,s46,s45
 s_add_u32 m0,s41,118272
 s_add_u32 s40,s46,131072
 s_waitcnt lgkmcnt(4)
 mf 96,8,56,96
 buffer_load_dwordx4 v2,s[20:23],s40 offen lds
 s_add_u32 m0,s41,119328
 s_add_u32 s40,s46,133120
 buffer_load_dwordx4 v2,s[20:23],s40 offen lds
 s_waitcnt vmcnt(22)
 s_waitcnt lgkmcnt(0)
 s_barrier
 tr 24,3,16896
 tr 26,3,17408
 tr 28,3,16928
 tr 30,3,17440
 mf 100,12,56,100
 tr 8,3,16960
 tr 10,3,17472
 s_mov_b32 m0,33792
 s_mov_b32 s40,425984
 buffer_load_dwordx4 v5,s[12:15],s40 offen nt lds
 s_mov_b32 m0,33824
 s_nop 0
 buffer_load_dwordx4 v5,s[12:15],s40 offen offset:1024 nt lds
 s_mov_b32 m0,33856
 s_nop 0
 buffer_load_dwordx4 v5,s[12:15],s40 offen offset:2048 nt lds
 mf 104,16,56,104
 tr 12,3,16992
 tr 14,3,17504
 s_mov_b32 m0,33888
 s_nop 0
 buffer_load_dwordx4 v5,s[12:15],s40 offen offset:3072 nt lds
 s_mov_b32 m0,38016
 s_mov_b32 s40,430080
 buffer_load_dwordx4 v5,s[12:15],s40 offen nt lds
 s_mov_b32 m0,38048
 s_nop 0
 buffer_load_dwordx4 v5,s[12:15],s40 offen offset:1024 nt lds
 mf 108,20,56,108
 tr 16,3,21120
 tr 18,3,21632
 s_mov_b32 m0,38080
 s_nop 0
 buffer_load_dwordx4 v5,s[12:15],s40 offen offset:2048 nt lds
 s_mov_b32 m0,38112
 s_nop 0
 buffer_load_dwordx4 v5,s[12:15],s40 offen offset:3072 nt lds
 s_mov_b32 m0,42240
 s_mov_b32 s40,434176
 buffer_load_dwordx4 v5,s[12:15],s40 offen nt lds
 s_waitcnt lgkmcnt(6)
 mf 128,24,64,128
 tr 20,3,21152
 tr 22,3,21664
 s_mov_b32 m0,42272
 s_nop 0
 buffer_load_dwordx4 v5,s[12:15],s40 offen offset:1024 nt lds
 s_mov_b32 m0,42304
 s_nop 0
 buffer_load_dwordx4 v5,s[12:15],s40 offen offset:2048 nt lds
 s_mov_b32 m0,42336
 mf 132,28,64,132
 tr 24,3,21184
 tr 26,3,21696
 buffer_load_dwordx4 v5,s[12:15],s40 offen offset:3072 nt lds
 s_mov_b32 m0,46464
 s_mov_b32 s40,438272
 buffer_load_dwordx4 v5,s[12:15],s40 offen nt lds
 s_mov_b32 m0,46496
 s_nop 0
 buffer_load_dwordx4 v5,s[12:15],s40 offen offset:1024 nt lds
 s_waitcnt lgkmcnt(6)
 mf 136,8,64,136
 tr 28,3,21216
 tr 30,3,21728
 s_mov_b32 m0,46528
 s_nop 0
 buffer_load_dwordx4 v5,s[12:15],s40 offen offset:2048 nt lds
 s_mov_b32 m0,46560
 s_nop 0
 buffer_load_dwordx4 v5,s[12:15],s40 offen offset:3072 nt lds
 s_add_u32 s46,s37,3
 s_and_b32 s46,s46,7
 s_lshl_b32 s46,s46,7
 s_add_u32 s46,s46,s45
 s_add_u32 m0,s41,120384
 s_add_u32 s40,s46,135168
 mf 140,12,64,140
 buffer_load_dwordx4 v2,s[20:23],s40 offen lds
 s_add_u32 m0,s41,121440
 s_add_u32 s40,s46,137216
 buffer_load_dwordx4 v2,s[20:23],s40 offen lds
 s_add_u32 s46,s37,4
 s_and_b32 s46,s46,7
 s_lshl_b32 s46,s46,7
 s_add_u32 s46,s46,s45
 s_add_u32 m0,s41,67584
 s_add_u32 s40,s46,131072
 s_waitcnt lgkmcnt(4)
 mf 128,16,72,128
 buffer_load_dwordx4 v2,s[20:23],s40 offen lds
 ds_read_b128 v[32:35],v4
 ds_read_b128 v[40:43],v4 offset:7168
 ds_read_b128 v[48:51],v4 offset:14336
 ds_read_b128 v[56:59],v4 offset:21504
 s_waitcnt vmcnt(21)
 s_waitcnt lgkmcnt(0)
 s_barrier
 tr 8,3,25344
 tr 10,3,25856
 tr 12,3,25376
 tr 14,3,25888
 mf 132,20,72,132
 tr 16,3,25408
 tr 18,3,25920
 s_mov_b32 m0,16896
 s_mov_b32 s40,458752
 buffer_load_dwordx4 v5,s[8:11],s40 offen nt lds
 s_mov_b32 m0,16928
 s_nop 0
 buffer_load_dwordx4 v5,s[8:11],s40 offen offset:1024 nt lds
 mf 136,24,72,136
 tr 20,3,25440
 tr 22,3,25952
 s_mov_b32 m0,16960
 s_nop 0
 buffer_load_dwordx4 v5,s[8:11],s40 offen offset:2048 nt lds
 s_mov_b32 m0,16992
 s_nop 0
 buffer_load_dwordx4 v5,s[8:11],s40 offen offset:3072 nt lds
 mf 140,28,72,140
 tr 24,3,29568
 tr 26,3,30080
 s_mov_b32 m0,21120
 s_mov_b32 s40,462848
 buffer_load_dwordx4 v5,s[8:11],s40 offen nt lds
 s_mov_b32 m0,21152
 s_waitcnt lgkmcnt(6)
 mf 128,8,80,128
 tr 28,3,29600
 tr 30,3,30112
 buffer_load_dwordx4 v5,s[8:11],s40 offen offset:1024 nt lds
 s_mov_b32 m0,21184
 s_nop 0
 buffer_load_dwordx4 v5,s[8:11],s40 offen offset:2048 nt lds
 mf 132,12,80,132
 tr 8,3,29632
 tr 10,3,30144
 s_mov_b32 m0,21216
 s_nop 0
 buffer_load_dwordx4 v5,s[8:11],s40 offen offset:3072 nt lds
 s_mov_b32 m0,25344
 s_mov_b32 s40,466944
 s_waitcnt lgkmcnt(6)
 mf 136,16,80,136
 tr 12,3,29664
 tr 14,3,30176
 buffer_load_dwordx4 v5,s[8:11],s40 offen nt lds
 s_mov_b32 m0,25376
 s_nop 0
 buffer_load_dwordx4 v5,s[8:11],s40 offen offset:1024 nt lds
 mf 140,20,80,140
 tr 16,3,33792
 tr 18,3,34304
 s_mov_b32 m0,25408
 s_nop 0
 buffer_load_dwordx4 v5,s[8:11],s40 offen offset:2048 nt lds
 s_mov_b32 m0,25440
 s_nop 0
 buffer_load_dwordx4 v5,s[8:11],s40 offen offset:3072 nt lds
 s_waitcnt lgkmcnt(6)
 mf 128,24,88,128
 tr 20,3,33824
 tr 22,3,34336
 s_mov_b32 m0,29568
 s_mov_b32 s40,471040
 buffer_load_dwordx4 v5,s[8:11],s40 offen nt lds
 s_mov_b32 m0,29600
 mf 132,28,88,132
 tr 24,3,33856
 tr 26,3,34368
 buffer_load_dwordx4 v5,s[8:11],s40 offen offset:1024 nt lds
 s_mov_b32 m0,29632
 s_nop 0
 buffer_load_dwordx4 v5,s[8:11],s40 offen offset:2048 nt lds
 s_waitcnt lgkmcnt(6)
 mf 136,8,88,136
 tr 28,3,33888
 tr 30,3,34400
 s_mov_b32 m0,29664
 s_nop 0
 buffer_load_dwordx4 v5,s[8:11],s40 offen offset:3072 nt lds
 s_add_u32 s46,s37,4
 s_and_b32 s46,s46,7
 s_lshl_b32 s46,s46,7
 s_add_u32 s46,s46,s45
 s_add_u32 m0,s41,68640
 s_add_u32 s40,s46,133120
 mf 140,12,88,140
 buffer_load_dwordx4 v2,s[20:23],s40 offen lds
 s_add_u32 m0,s41,69696
 s_add_u32 s40,s46,135168
 buffer_load_dwordx4 v2,s[20:23],s40 offen lds
 s_waitcnt lgkmcnt(4)
 mf 160,16,64,160
 s_add_u32 m0,s41,70752
 s_add_u32 s40,s46,137216
 buffer_load_dwordx4 v2,s[20:23],s40 offen lds
 s_waitcnt vmcnt(22)
 s_waitcnt lgkmcnt(0)
 s_barrier
 tr 8,3,38016
 tr 10,3,38528
 tr 12,3,38048
 tr 14,3,38560
 mf 164,20,64,164
 tr 16,3,38080
 tr 18,3,38592
 s_mov_b32 m0,50688
 s_mov_b32 s40,442368
 buffer_load_dwordx4 v5,s[12:15],s40 offen nt lds
 s_mov_b32 m0,50720
 s_nop 0
 buffer_load_dwordx4 v5,s[12:15],s40 offen offset:1024 nt lds
 mf 168,24,64,168
 tr 20,3,38112
 tr 22,3,38624
 s_mov_b32 m0,50752
 s_nop 0
 buffer_load_dwordx4 v5,s[12:15],s40 offen offset:2048 nt lds
 s_mov_b32 m0,50784
 s_nop 0
 buffer_load_dwordx4 v5,s[12:15],s40 offen offset:3072 nt lds
 mf 172,28,64,172
 tr 24,3,42240
 tr 26,3,42752
 s_mov_b32 m0,54912
 s_mov_b32 s40,446464
 buffer_load_dwordx4 v5,s[12:15],s40 offen nt lds
 s_mov_b32 m0,54944
 s_waitcnt lgkmcnt(6)
 mf 160,8,72,160
 tr 28,3,42272
 tr 30,3,42784
 buffer_load_dwordx4 v5,s[12:15],s40 offen offset:1024 nt lds
 s_mov_b32 m0,54976
 s_nop 0
 buffer_load_dwordx4 v5,s[12:15],s40 offen offset:2048 nt lds
 mf 164,12,72,164
 tr 8,3,42304
 tr 10,3,42816
 s_mov_b32 m0,55008
 s_nop 0
 buffer_load_dwordx4 v5,s[12:15],s40 offen offset:3072 nt lds
 s_mov_b32 m0,59136
 s_mov_b32 s40,450560
 s_waitcnt lgkmcnt(6)
 mf 168,16,72,168
 tr 12,3,42336
 tr 14,3,42848
 buffer_load_dwordx4 v5,s[12:15],s40 offen nt lds
 s_mov_b32 m0,59168
 s_nop 0
 buffer_load_dwordx4 v5,s[12:15],s40 offen offset:1024 nt lds
 mf 172,20,72,172
 tr 16,3,46464
 tr 18,3,46976
 s_mov_b32 m0,59200
 s_nop 0
 buffer_load_dwordx4 v5,s[12:15],s40 offen offset:2048 nt lds
 s_mov_b32 m0,59232
 s_nop 0
 buffer_load_dwordx4 v5,s[12:15],s40 offen offset:3072 nt lds
 s_waitcnt lgkmcnt(6)
 mf 160,24,80,160
 tr 20,3,46496
 tr 22,3,47008
 s_mov_b32 m0,63360
 s_mov_b32 s40,454656
 buffer_load_dwordx4 v5,s[12:15],s40 offen nt lds
 s_mov_b32 m0,63392
 mf 164,28,80,164
 tr 24,3,46528
 tr 26,3,47040
 buffer_load_dwordx4 v5,s[12:15],s40 offen offset:1024 nt lds
 s_mov_b32 m0,63424
 s_nop 0
 buffer_load_dwordx4 v5,s[12:15],s40 offen offset:2048 nt lds
 s_waitcnt lgkmcnt(6)
 mf 168,8,80,168
 tr 28,3,46560
 tr 30,3,47072
 s_mov_b32 m0,63456
 s_nop 0
 buffer_load_dwordx4 v5,s[12:15],s40 offen offset:3072 nt lds
 s_add_u32 s46,s37,5
 s_and_b32 s46,s46,7
 s_lshl_b32 s46,s46,7
 s_add_u32 s46,s46,s45
 s_add_u32 m0,s41,84480
 s_add_u32 s40,s46,131072
 mf 172,12,80,172
 buffer_load_dwordx4 v2,s[20:23],s40 offen lds
 s_add_u32 m0,s41,85536
 s_add_u32 s40,s46,133120
 buffer_load_dwordx4 v2,s[20:23],s40 offen lds
 s_waitcnt lgkmcnt(4)
 mf 160,16,88,160
 s_add_u32 m0,s41,86592
 s_add_u32 s40,s46,135168
 buffer_load_dwordx4 v2,s[20:23],s40 offen lds
 s_waitcnt vmcnt(22)
 s_waitcnt lgkmcnt(0)
 s_barrier
 tr 8,3,50688
 tr 10,3,51200
 tr 12,3,50720
 tr 14,3,51232
 mf 164,20,88,164
 tr 16,3,50752
 tr 18,3,51264
 s_mov_b32 m0,0
 s_mov_b32 s40,475136
 buffer_load_dwordx4 v5,s[8:11],s40 offen nt lds
 s_mov_b32 m0,32
 s_nop 0
 buffer_load_dwordx4 v5,s[8:11],s40 offen offset:1024 nt lds
 mf 168,24,88,168
 tr 20,3,50784
 tr 22,3,51296
 s_mov_b32 m0,64
 s_nop 0
 buffer_load_dwordx4 v5,s[8:11],s40 offen offset:2048 nt lds
 s_mov_b32 m0,96
 s_nop 0
 buffer_load_dwordx4 v5,s[8:11],s40 offen offset:3072 nt lds
 mf 172,28,88,172
 tr 24,3,54912
 tr 26,3,55424
 s_mov_b32 m0,4224
 s_mov_b32 s40,479232
 buffer_load_dwordx4 v5,s[8:11],s40 offen nt lds
 s_mov_b32 m0,4256
 s_waitcnt lgkmcnt(6)
 mf 192,8,64,192
 tr 28,3,54944
 tr 30,3,55456
 buffer_load_dwordx4 v5,s[8:11],s40 offen offset:1024 nt lds
 s_mov_b32 m0,4288
 s_nop 0
 buffer_load_dwordx4 v5,s[8:11],s40 offen offset:2048 nt lds
 mf 196,12,64,196
 tr 8,3,54976
 tr 10,3,55488
 s_mov_b32 m0,4320
 s_nop 0
 buffer_load_dwordx4 v5,s[8:11],s40 offen offset:3072 nt lds
 s_mov_b32 m0,8448
 s_mov_b32 s40,483328
 buffer_load_dwordx4 v5,s[8:11],s40 offen nt lds
 s_waitcnt lgkmcnt(6)
 mf 200,16,64,200
 tr 12,3,55008
 tr 14,3,55520
 s_mov_b32 m0,8480
 s_nop 0
 buffer_load_dwordx4 v5,s[8:11],s40 offen offset:1024 nt lds
 s_mov_b32 m0,8512
 mf 204,20,64,204
 tr 16,3,59136
 tr 18,3,59648
 buffer_load_dwordx4 v5,s[8:11],s40 offen offset:2048 nt lds
 s_mov_b32 m0,8544
 s_nop 0
 buffer_load_dwordx4 v5,s[8:11],s40 offen offset:3072 nt lds
 s_waitcnt lgkmcnt(6)
 mf 192,24,72,192
 tr 20,3,59168
 tr 22,3,59680
 s_mov_b32 m0,12672
 s_mov_b32 s40,487424
 buffer_load_dwordx4 v5,s[8:11],s40 offen nt lds
 s_mov_b32 m0,12704
 mf 196,28,72,196
 tr 24,3,59200
 tr 26,3,59712
 buffer_load_dwordx4 v5,s[8:11],s40 offen offset:1024 nt lds
 s_mov_b32 m0,12736
 s_nop 0
 buffer_load_dwordx4 v5,s[8:11],s40 offen offset:2048 nt lds
 s_waitcnt lgkmcnt(6)
 mf 200,8,72,200
 tr 28,3,59232
 tr 30,3,59744
 s_mov_b32 m0,12768
 s_nop 0
 buffer_load_dwordx4 v5,s[8:11],s40 offen offset:3072 nt lds
 s_add_u32 s46,s37,5
 s_and_b32 s46,s46,7
 s_lshl_b32 s46,s46,7
 s_add_u32 s46,s46,s45
 s_add_u32 m0,s41,87648
 s_add_u32 s40,s46,137216
 mf 204,12,72,204
 buffer_load_dwordx4 v2,s[20:23],s40 offen lds
 s_add_u32 s46,s37,1
 s_and_b32 s46,s46,7
 s_lshl_b32 s46,s46,7
 s_add_u32 s46,s46,s45
 s_add_u32 m0,s41,101376
 s_add_u32 s40,s46,262144
 s_waitcnt lgkmcnt(4)
 mf 192,16,80,192
 buffer_load_dwordx4 v2,s[20:23],s40 offen lds
 s_add_u32 m0,s41,102432
 s_add_u32 s40,s46,264192
 buffer_load_dwordx4 v2,s[20:23],s40 offen lds
 s_waitcnt vmcnt(22)
 s_waitcnt lgkmcnt(0)
 s_barrier
 tr 8,3,63360
 tr 10,3,63872
 tr 12,3,63392
 tr 14,3,63904
 mf 196,20,80,196
 tr 16,3,63424
 tr 18,3,63936
 s_mov_b32 m0,33792
 s_mov_b32 s40,458752
 buffer_load_dwordx4 v5,s[12:15],s40 offen nt lds
 s_mov_b32 m0,33824
 mf 200,24,80,200
 tr 20,3,63456
 tr 22,3,63968
 buffer_load_dwordx4 v5,s[12:15],s40 offen offset:1024 nt lds
 s_mov_b32 m0,33856
 s_nop 0
 buffer_load_dwordx4 v5,s[12:15],s40 offen offset:2048 nt lds
 mf 204,28,80,204
 ds_read_b64_tr_b16 v[24:25],v3
 tr 26,3,512
 s_mov_b32 m0,33888
 s_nop 0
 buffer_load_dwordx4 v5,s[12:15],s40 offen offset:3072 nt lds
 s_mov_b32 m0,38016
 s_mov_b32 s40,462848
 s_waitcnt lgkmcnt(6)
 mf 192,8,88,192
 tr 28,3,32
 tr 30,3,544
 buffer_load_dwordx4 v5,s[12:15],s40 offen nt lds
 s_mov_b32 m0,38048
 s_nop 0
 buffer_load_dwordx4 v5,s[12:15],s40 offen offset:1024 nt lds
 mf 196,12,88,196
 tr 8,3,64
 tr 10,3,576
 s_mov_b32 m0,38080
 s_nop 0
 buffer_load_dwordx4 v5,s[12:15],s40 offen offset:2048 nt lds
 s_mov_b32 m0,38112
 s_nop 0
 buffer_load_dwordx4 v5,s[12:15],s40 offen offset:3072 nt lds
 s_waitcnt lgkmcnt(6)
 mf 200,16,88,200
 tr 12,3,96
 tr 14,3,608
 s_mov_b32 m0,42240
 s_mov_b32 s40,466944
 buffer_load_dwordx4 v5,s[12:15],s40 offen nt lds
 s_mov_b32 m0,42272
 mf 204,20,88,204
 tr 16,3,4224
 tr 18,3,4736
 buffer_load_dwordx4 v5,s[12:15],s40 offen offset:1024 nt lds
 s_mov_b32 m0,42304
 s_nop 0
 buffer_load_dwordx4 v5,s[12:15],s40 offen offset:2048 nt lds
 s_waitcnt lgkmcnt(6)
 mf 224,24,64,224
 tr 20,3,4256
 tr 22,3,4768
 s_mov_b32 m0,42336
 s_nop 0
 buffer_load_dwordx4 v5,s[12:15],s40 offen offset:3072 nt lds
 s_mov_b32 m0,46464
 s_mov_b32 s40,471040
 mf 228,28,64,228
 tr 24,3,4288
 tr 26,3,4800
 buffer_load_dwordx4 v5,s[12:15],s40 offen nt lds
 s_mov_b32 m0,46496
 s_nop 0
 buffer_load_dwordx4 v5,s[12:15],s40 offen offset:1024 nt lds
 s_waitcnt lgkmcnt(6)
 mf 232,8,64,232
 tr 28,3,4320
 tr 30,3,4832
 s_mov_b32 m0,46528
 s_nop 0
 buffer_load_dwordx4 v5,s[12:15],s40 offen offset:2048 nt lds
 s_mov_b32 m0,46560
 mf 236,12,64,236
 buffer_load_dwordx4 v5,s[12:15],s40 offen offset:3072 nt lds
 s_add_u32 s46,s37,1
 s_and_b32 s46,s46,7
 s_lshl_b32 s46,s46,7
 s_add_u32 s46,s46,s45
 s_add_u32 m0,s41,103488
 s_add_u32 s40,s46,266240
 s_waitcnt lgkmcnt(4)
 mf 224,16,72,224
 buffer_load_dwordx4 v2,s[20:23],s40 offen lds
 s_add_u32 m0,s41,104544
 s_add_u32 s40,s46,268288
 buffer_load_dwordx4 v2,s[20:23],s40 offen lds
 s_waitcnt vmcnt(20)
 s_waitcnt lgkmcnt(0)
 s_barrier
 tr 8,3,8448
 tr 10,3,8960
 tr 12,3,8480
 tr 14,3,8992
 mf 228,20,72,228
 tr 16,3,8512
 tr 18,3,9024
 s_mov_b32 m0,16896
 s_mov_b32 s40,491520
 buffer_load_dwordx4 v5,s[8:11],s40 offen nt lds
 s_mov_b32 m0,16928
 s_nop 0
 buffer_load_dwordx4 v5,s[8:11],s40 offen offset:1024 nt lds
 mf 232,24,72,232
 tr 20,3,8544
 tr 22,3,9056
 s_mov_b32 m0,16960
 s_nop 0
 buffer_load_dwordx4 v5,s[8:11],s40 offen offset:2048 nt lds
 s_mov_b32 m0,16992
 s_nop 0
 buffer_load_dwordx4 v5,s[8:11],s40 offen offset:3072 nt lds
 mf 236,28,72,236
 tr 24,3,12672
 tr 26,3,13184
 s_mov_b32 m0,21120
 s_mov_b32 s40,495616
 buffer_load_dwordx4 v5,s[8:11],s40 offen nt lds
 s_mov_b32 m0,21152
 s_nop 0
 buffer_load_dwordx4 v5,s[8:11],s40 offen offset:1024 nt lds
 s_waitcnt lgkmcnt(6)
 mf 224,8,80,224
 tr 28,3,12704
 tr 30,3,13216
 s_mov_b32 m0,21184
 s_nop 0
 buffer_load_dwordx4 v5,s[8:11],s40 offen offset:2048 nt lds
 s_mov_b32 m0,21216
 s_nop 0
 buffer_load_dwordx4 v5,s[8:11],s40 offen offset:3072 nt lds
 mf 228,12,80,228
 tr 8,3,12736
 tr 10,3,13248
 s_mov_b32 m0,25344
 s_mov_b32 s40,499712
 buffer_load_dwordx4 v5,s[8:11],s40 offen nt lds
 s_mov_b32 m0,25376
 s_nop 0
 buffer_load_dwordx4 v5,s[8:11],s40 offen offset:1024 nt lds
 s_waitcnt lgkmcnt(6)
 mf 232,16,80,232
 tr 12,3,12768
 tr 14,3,13280
 s_mov_b32 m0,25408
 s_nop 0
 buffer_load_dwordx4 v5,s[8:11],s40 offen offset:2048 nt lds
 s_mov_b32 m0,25440
 s_nop 0
 buffer_load_dwordx4 v5,s[8:11],s40 offen offset:3072 nt lds
 mf 236,20,80,236
 tr 16,3,16896
 tr 18,3,17408
 s_mov_b32 m0,29568
 s_mov_b32 s40,503808
 buffer_load_dwordx4 v5,s[8:11],s40 offen nt lds
 s_mov_b32 m0,29600
 s_nop 0
 buffer_load_dwordx4 v5,s[8:11],s40 offen offset:1024 nt lds
 s_waitcnt lgkmcnt(6)
 mf 224,24,88,224
 tr 20,3,16928
 tr 22,3,17440
 s_mov_b32 m0,29632
 s_nop 0
 buffer_load_dwordx4 v5,s[8:11],s40 offen offset:2048 nt lds
 s_mov_b32 m0,29664
 s_nop 0
 buffer_load_dwordx4 v5,s[8:11],s40 offen offset:3072 nt lds
 mf 228,28,88,228
 tr 24,3,16960
 tr 26,3,17472
 s_add_u32 s46,s37,2
 s_and_b32 s46,s46,7
 s_lshl_b32 s46,s46,7
 s_add_u32 s46,s46,s45
 s_add_u32 m0,s41,118272
 s_add_u32 s40,s46,262144
 buffer_load_dwordx4 v2,s[20:23],s40 offen lds
 s_add_u32 m0,s41,119328
 s_add_u32 s40,s46,264192
 s_waitcnt lgkmcnt(6)
 mf 232,8,88,232
 tr 28,3,16992
 tr 30,3,17504
 buffer_load_dwordx4 v2,s[20:23],s40 offen lds
 s_add_u32 m0,s41,120384
 s_add_u32 s40,s46,266240
 buffer_load_dwordx4 v2,s[20:23],s40 offen lds
 mf 236,12,88,236
 ds_write_b128 v4,v[64:67]
 ds_write_b128 v4,v[72:75] offset:7168
 s_waitcnt lgkmcnt(6)
 mf 96,16,64,96
 ds_write_b128 v4,v[80:83] offset:14336
 ds_write_b128 v4,v[88:91] offset:21504
 s_waitcnt vmcnt(21)
 s_waitcnt lgkmcnt(0)
 s_barrier
 tr 8,3,21120
 tr 10,3,21632
 tr 12,3,21152
 tr 14,3,21664
 mf 100,20,64,100
 tr 16,3,21184
 tr 18,3,21696
 s_mov_b32 m0,50688
 s_mov_b32 s40,475136
 buffer_load_dwordx4 v5,s[12:15],s40 offen nt lds
 s_mov_b32 m0,50720
 s_nop 0
 buffer_load_dwordx4 v5,s[12:15],s40 offen offset:1024 nt lds
 mf 104,24,64,104
 tr 20,3,21216
 tr 22,3,21728
 s_mov_b32 m0,50752
 s_nop 0
 buffer_load_dwordx4 v5,s[12:15],s40 offen offset:2048 nt lds
 s_mov_b32 m0,50784
 s_nop 0
 buffer_load_dwordx4 v5,s[12:15],s40 offen offset:3072 nt lds
 mf 108,28,64,108
 tr 24,3,25344
 tr 26,3,25856
 s_mov_b32 m0,54912
 s_mov_b32 s40,479232
 buffer_load_dwordx4 v5,s[12:15],s40 offen nt lds
 s_mov_b32 m0,54944
 s_waitcnt lgkmcnt(6)
 mf 96,8,72,96
 tr 28,3,25376
 tr 30,3,25888
 buffer_load_dwordx4 v5,s[12:15],s40 offen offset:1024 nt lds
 s_mov_b32 m0,54976
 s_nop 0
 buffer_load_dwordx4 v5,s[12:15],s40 offen offset:2048 nt lds
 mf 100,12,72,100
 tr 8,3,25408
 tr 10,3,25920
 s_mov_b32 m0,55008
 s_nop 0
 buffer_load_dwordx4 v5,s[12:15],s40 offen offset:3072 nt lds
 s_mov_b32 m0,59136
 s_mov_b32 s40,483328
 buffer_load_dwordx4 v5,s[12:15],s40 offen nt lds
 s_waitcnt lgkmcnt(6)
 mf 104,16,72,104
 tr 12,3,25440
 tr 14,3,25952
 s_mov_b32 m0,59168
 s_nop 0
 buffer_load_dwordx4 v5,s[12:15],s40 offen offset:1024 nt lds
 s_mov_b32 m0,59200
 mf 108,20,72,108
 tr 16,3,29568
 tr 18,3,30080
 buffer_load_dwordx4 v5,s[12:15],s40 offen offset:2048 nt lds
 s_mov_b32 m0,59232
 s_nop 0
 buffer_load_dwordx4 v5,s[12:15],s40 offen offset:3072 nt lds
 s_waitcnt lgkmcnt(6)
 mf 96,24,80,96
 tr 20,3,29600
 tr 22,3,30112
 s_mov_b32 m0,63360
 s_mov_b32 s40,487424
 buffer_load_dwordx4 v5,s[12:15],s40 offen nt lds
 s_mov_b32 m0,63392
 mf 100,28,80,100
 tr 24,3,29632
 tr 26,3,30144
 buffer_load_dwordx4 v5,s[12:15],s40 offen offset:1024 nt lds
 s_mov_b32 m0,63424
 s_nop 0
 buffer_load_dwordx4 v5,s[12:15],s40 offen offset:2048 nt lds
 s_waitcnt lgkmcnt(6)
 mf 104,8,80,104
 tr 28,3,29664
 tr 30,3,30176
 s_mov_b32 m0,63456
 s_nop 0
 buffer_load_dwordx4 v5,s[12:15],s40 offen offset:3072 nt lds
 s_add_u32 s46,s37,2
 s_and_b32 s46,s46,7
 s_lshl_b32 s46,s46,7
 s_add_u32 s46,s46,s45
 s_add_u32 m0,s41,121440
 s_add_u32 s40,s46,268288
 mf 108,12,80,108
 buffer_load_dwordx4 v2,s[20:23],s40 offen lds
 s_add_u32 s46,s37,3
 s_and_b32 s46,s46,7
 s_lshl_b32 s46,s46,7
 s_add_u32 s46,s46,s45
 s_add_u32 m0,s41,67584
 s_add_u32 s40,s46,262144
 s_waitcnt lgkmcnt(4)
 mf 96,16,88,96
 buffer_load_dwordx4 v2,s[20:23],s40 offen lds
 s_add_u32 m0,s41,68640
 s_add_u32 s40,s46,264192
 buffer_load_dwordx4 v2,s[20:23],s40 offen lds
 s_waitcnt vmcnt(22)
 s_waitcnt lgkmcnt(0)
 s_barrier
 tr 8,3,33792
 tr 10,3,34304
 tr 12,3,33824
 tr 14,3,34336
 mf 100,20,88,100
 tr 16,3,33856
 tr 18,3,34368
 s_mov_b32 m0,0
 s_mov_b32 s40,507904
 buffer_load_dwordx4 v5,s[8:11],s40 offen nt lds
 s_mov_b32 m0,32
 s_nop 0
 buffer_load_dwordx4 v5,s[8:11],s40 offen offset:1024 nt lds
 mf 104,24,88,104
 tr 20,3,33888
 tr 22,3,34400
 s_mov_b32 m0,64
 s_nop 0
 buffer_load_dwordx4 v5,s[8:11],s40 offen offset:2048 nt lds
 s_mov_b32 m0,96
 s_nop 0
 buffer_load_dwordx4 v5,s[8:11],s40 offen offset:3072 nt lds
 mf 108,28,88,108
 tr 24,3,38016
 tr 26,3,38528
 s_mov_b32 m0,4224
 s_mov_b32 s40,512000
 buffer_load_dwordx4 v5,s[8:11],s40 offen nt lds
 s_mov_b32 m0,4256
 s_waitcnt lgkmcnt(6)
 mf 128,8,32,128
 tr 28,3,38048
 tr 30,3,38560
 buffer_load_dwordx4 v5,s[8:11],s40 offen offset:1024 nt lds
 s_mov_b32 m0,4288
 s_nop 0
 buffer_load_dwordx4 v5,s[8:11],s40 offen offset:2048 nt lds
 mf 132,12,32,132
 tr 8,3,38080
 tr 10,3,38592
 s_mov_b32 m0,4320
 s_nop 0
 buffer_load_dwordx4 v5,s[8:11],s40 offen offset:3072 nt lds
 s_mov_b32 m0,8448
 s_mov_b32 s40,516096
 buffer_load_dwordx4 v5,s[8:11],s40 offen nt lds
 s_waitcnt lgkmcnt(6)
 mf 136,16,32,136
 tr 12,3,38112
 tr 14,3,38624
 s_mov_b32 m0,8480
 s_nop 0
 buffer_load_dwordx4 v5,s[8:11],s40 offen offset:1024 nt lds
 s_mov_b32 m0,8512
 mf 140,20,32,140
 tr 16,3,42240
 tr 18,3,42752
 buffer_load_dwordx4 v5,s[8:11],s40 offen offset:2048 nt lds
 s_mov_b32 m0,8544
 s_nop 0
 buffer_load_dwordx4 v5,s[8:11],s40 offen offset:3072 nt lds
 s_waitcnt lgkmcnt(6)
 mf 128,24,40,128
 tr 20,3,42272
 tr 22,3,42784
 s_mov_b32 m0,12672
 s_mov_b32 s40,520192
 buffer_load_dwordx4 v5,s[8:11],s40 offen nt lds
 s_mov_b32 m0,12704
 mf 132,28,40,132
 tr 24,3,42304
 tr 26,3,42816
 buffer_load_dwordx4 v5,s[8:11],s40 offen offset:1024 nt lds
 s_mov_b32 m0,12736
 s_nop 0
 buffer_load_dwordx4 v5,s[8:11],s40 offen offset:2048 nt lds
 s_waitcnt lgkmcnt(6)
 mf 136,8,40,136
 tr 28,3,42336
 tr 30,3,42848
 s_mov_b32 m0,12768
 s_nop 0
 buffer_load_dwordx4 v5,s[8:11],s40 offen offset:3072 nt lds
 s_add_u32 s46,s37,3
 s_and_b32 s46,s46,7
 s_lshl_b32 s46,s46,7
 s_add_u32 s46,s46,s45
 s_add_u32 m0,s41,69696
 s_add_u32 s40,s46,266240
 mf 140,12,40,140
 buffer_load_dwordx4 v2,s[20:23],s40 offen lds
 s_add_u32 m0,s41,70752
 s_add_u32 s40,s46,268288
 buffer_load_dwordx4 v2,s[20:23],s40 offen lds
 s_waitcnt lgkmcnt(4)
 mf 128,16,48,128
 s_add_u32 s46,s37,4
 s_and_b32 s46,s46,7
 s_lshl_b32 s46,s46,7
 s_add_u32 s46,s46,s45
 s_add_u32 m0,s41,84480
 s_add_u32 s40,s46,262144
 buffer_load_dwordx4 v2,s[20:23],s40 offen lds
 s_waitcnt vmcnt(21)
 s_waitcnt lgkmcnt(0)
 s_barrier
 tr 8,3,46464
 tr 10,3,46976
 tr 12,3,46496
 tr 14,3,47008
 mf 132,20,48,132
 tr 16,3,46528
 tr 18,3,47040
 s_mov_b32 m0,33792
 s_mov_b32 s40,491520
 buffer_load_dwordx4 v5,s[12:15],s40 offen nt lds
 s_mov_b32 m0,33824
 s_nop 0
 buffer_load_dwordx4 v5,s[12:15],s40 offen offset:1024 nt lds
 mf 136,24,48,136
 tr 20,3,46560
 tr 22,3,47072
 s_mov_b32 m0,33856
 s_nop 0
 buffer_load_dwordx4 v5,s[12:15],s40 offen offset:2048 nt lds
 s_mov_b32 m0,33888
 s_nop 0
 buffer_load_dwordx4 v5,s[12:15],s40 offen offset:3072 nt lds
 mf 140,28,48,140
 tr 24,3,50688
 tr 26,3,51200
 s_mov_b32 m0,38016
 s_mov_b32 s40,495616
 buffer_load_dwordx4 v5,s[12:15],s40 offen nt lds
 s_mov_b32 m0,38048
 s_nop 0
 buffer_load_dwordx4 v5,s[12:15],s40 offen offset:1024 nt lds
 s_waitcnt lgkmcnt(6)
 mf 128,8,56,128
 tr 28,3,50720
 tr 30,3,51232
 s_mov_b32 m0,38080
 s_nop 0
 buffer_load_dwordx4 v5,s[12:15],s40 offen offset:2048 nt lds
 s_mov_b32 m0,38112
 s_nop 0
 buffer_load_dwordx4 v5,s[12:15],s40 offen offset:3072 nt lds
 mf 132,12,56,132
 tr 8,3,50752
 tr 10,3,51264
 s_mov_b32 m0,42240
 s_mov_b32 s40,499712
 buffer_load_dwordx4 v5,s[12:15],s40 offen nt lds
 s_mov_b32 m0,42272
 s_nop 0
 buffer_load_dwordx4 v5,s[12:15],s40 offen offset:1024 nt lds
 s_waitcnt lgkmcnt(6)
 mf 136,16,56,136
 tr 12,3,50784
 tr 14,3,51296
 s_mov_b32 m0,42304
 s_nop 0
 buffer_load_dwordx4 v5,s[12:15],s40 offen offset:2048 nt lds
 s_mov_b32 m0,42336
 s_nop 0
 buffer_load_dwordx4 v5,s[12:15],s40 offen offset:3072 nt lds
 mf 140,20,56,140
 tr 16,3,54912
 tr 18,3,55424
 s_mov_b32 m0,46464
 s_mov_b32 s40,503808
 buffer_load_dwordx4 v5,s[12:15],s40 offen nt lds
 s_mov_b32 m0,46496
 s_nop 0
 buffer_load_dwordx4 v5,s[12:15],s40 offen offset:1024 nt lds
 s_waitcnt lgkmcnt(6)
 mf 160,24,32,160
 tr 20,3,54944
 tr 22,3,55456
 s_mov_b32 m0,46528
 s_nop 0
 buffer_load_dwordx4 v5,s[12:15],s40 offen offset:2048 nt lds
 s_mov_b32 m0,46560
 s_nop 0
 buffer_load_dwordx4 v5,s[12:15],s40 offen offset:3072 nt lds
 mf 164,28,32,164
 tr 24,3,54976
 tr 26,3,55488
 s_add_u32 s46,s37,6
 s_and_b32 s46,s46,7
 s_lshl_b32 s46,s46,7
 s_add_u32 s46,s46,s45
 s_add_u32 m0,s41,16896
 s_add_u32 s40,s46,131072
 buffer_load_dwordx4 v2,s[20:23],s40 offen lds
 s_add_u32 m0,s41,17952
 s_add_u32 s40,s46,133120
 buffer_load_dwordx4 v2,s[20:23],s40 offen lds
 s_waitcnt lgkmcnt(6)
 mf 168,8,32,168
 tr 28,3,55008
 tr 30,3,55520
 s_add_u32 m0,s41,19008
 s_add_u32 s40,s46,135168
 buffer_load_dwordx4 v2,s[20:23],s40 offen lds
 s_add_u32 m0,s41,20064
 s_add_u32 s40,s46,137216
 buffer_load_dwordx4 v2,s[20:23],s40 offen lds
 mf 172,12,32,172
 s_add_u32 s46,s37,4
 s_and_b32 s46,s46,7
 s_lshl_b32 s46,s46,7
 s_add_u32 s46,s46,s45
 s_add_u32 m0,s41,85536
 s_add_u32 s40,s46,264192
 buffer_load_dwordx4 v2,s[20:23],s40 offen lds
 s_add_u32 m0,s41,86592
 s_add_u32 s40,s46,266240
 s_waitcnt lgkmcnt(4)
 mf 160,16,40,160
 buffer_load_dwordx4 v2,s[20:23],s40 offen lds
 s_add_u32 m0,s41,87648
 s_add_u32 s40,s46,268288
 buffer_load_dwordx4 v2,s[20:23],s40 offen lds
 s_waitcnt vmcnt(24)
 s_waitcnt lgkmcnt(0)
 s_barrier
 tr 8,3,59136
 tr 10,3,59648
 tr 12,3,59168
 tr 14,3,59680
 mf 164,20,40,164
 tr 16,3,59200
 tr 18,3,59712
 s_mov_b32 m0,50688
 s_mov_b32 s40,507904
 buffer_load_dwordx4 v5,s[12:15],s40 offen nt lds
 s_mov_b32 m0,50720
 s_nop 0
 buffer_load_dwordx4 v5,s[12:15],s40 offen offset:1024 nt lds
 mf 168,24,40,168
 tr 20,3,59232
 tr 22,3,59744
 s_mov_b32 m0,50752
 s_nop 0
 buffer_load_dwordx4 v5,s[12:15],s40 offen offset:2048 nt lds
 s_mov_b32 m0,50784
 s_nop 0
 buffer_load_dwordx4 v5,s[12:15],s40 offen offset:3072 nt lds
 mf 172,28,40,172
 tr 24,3,63360
 tr 26,3,63872
 s_mov_b32 m0,54912
 s_mov_b32 s40,512000
 buffer_load_dwordx4 v5,s[12:15],s40 offen nt lds
 s_mov_b32 m0,54944
 s_waitcnt lgkmcnt(6)
 mf 160,8,48,160
 tr 28,3,63392
 tr 30,3,63904
 buffer_load_dwordx4 v5,s[12:15],s40 offen offset:1024 nt lds
 s_mov_b32 m0,54976
 s_nop 0
 buffer_load_dwordx4 v5,s[12:15],s40 offen offset:2048 nt lds
 mf 164,12,48,164
 tr 8,3,63424
 tr 10,3,63936
 s_mov_b32 m0,55008
 s_nop 0
 buffer_load_dwordx4 v5,s[12:15],s40 offen offset:3072 nt lds
 s_mov_b32 m0,59136
 s_mov_b32 s40,516096
 s_waitcnt lgkmcnt(6)
 mf 168,16,48,168
 tr 12,3,63456
 tr 14,3,63968
 buffer_load_dwordx4 v5,s[12:15],s40 offen nt lds
 s_mov_b32 m0,59168
 s_nop 0
 buffer_load_dwordx4 v5,s[12:15],s40 offen offset:1024 nt lds
 mf 172,20,48,172
 ds_read_b64_tr_b16 v[16:17],v3
 tr 18,3,512
 s_mov_b32 m0,59200
 s_nop 0
 buffer_load_dwordx4 v5,s[12:15],s40 offen offset:2048 nt lds
 s_mov_b32 m0,59232
 s_nop 0
 buffer_load_dwordx4 v5,s[12:15],s40 offen offset:3072 nt lds
 s_waitcnt lgkmcnt(6)
 mf 160,24,56,160
 tr 20,3,32
 tr 22,3,544
 s_mov_b32 m0,63360
 s_mov_b32 s40,520192
 buffer_load_dwordx4 v5,s[12:15],s40 offen nt lds
 s_mov_b32 m0,63392
 mf 164,28,56,164
 tr 24,3,64
 tr 26,3,576
 buffer_load_dwordx4 v5,s[12:15],s40 offen offset:1024 nt lds
 s_mov_b32 m0,63424
 s_nop 0
 buffer_load_dwordx4 v5,s[12:15],s40 offen offset:2048 nt lds
 s_waitcnt lgkmcnt(6)
 mf 168,8,56,168
 tr 28,3,96
 tr 30,3,608
 s_mov_b32 m0,63456
 s_nop 0
 buffer_load_dwordx4 v5,s[12:15],s40 offen offset:3072 nt lds
 s_add_u32 s46,s37,5
 s_and_b32 s46,s46,7
 s_lshl_b32 s46,s46,7
 s_add_u32 s46,s46,s45
 s_add_u32 m0,s41,101376
 s_add_u32 s40,s46,262144
 mf 172,12,56,172
 buffer_load_dwordx4 v2,s[20:23],s40 offen lds
 s_add_u32 m0,s41,102432
 s_add_u32 s40,s46,264192
 buffer_load_dwordx4 v2,s[20:23],s40 offen lds
 s_waitcnt lgkmcnt(4)
 mf 192,16,32,192
 s_add_u32 m0,s41,103488
 s_add_u32 s40,s46,266240
 buffer_load_dwordx4 v2,s[20:23],s40 offen lds
 s_waitcnt vmcnt(19)
 s_waitcnt lgkmcnt(0)
 s_barrier
 tr 8,3,4224
 tr 10,3,4736
 tr 12,3,4256
 tr 14,3,4768
 mf 196,20,32,196
 tr 16,3,4288
 tr 18,3,4800
 s_add_u32 s46,s37,6
 s_and_b32 s46,s46,7
 s_lshl_b32 s46,s46,7
 s_add_u32 s46,s46,s45
 s_add_u32 m0,s41,0
 s_add_u32 s40,s46,0
 mf 200,24,32,200
 tr 20,3,4320
 tr 22,3,4832
 buffer_load_dwordx4 v2,s[20:23],s40 offen lds
 mf 204,28,32,204
 tr 24,3,8448
 tr 26,3,8960
 s_add_u32 m0,s41,1056
 s_add_u32 s40,s46,2048
 s_waitcnt lgkmcnt(6)
 mf 192,8,40,192
 tr 28,3,8480
 tr 30,3,8992
 buffer_load_dwordx4 v2,s[20:23],s40 offen lds
 mf 196,12,40,196
 tr 8,3,8512
 tr 10,3,9024
 s_add_u32 m0,s41,2112
 s_add_u32 s40,s46,4096
 s_waitcnt lgkmcnt(6)
 mf 200,16,40,200
 tr 12,3,8544
 tr 14,3,9056
 buffer_load_dwordx4 v2,s[20:23],s40 offen lds
 mf 204,20,40,204
 tr 16,3,12672
 tr 18,3,13184
 s_add_u32 m0,s41,3168
 s_add_u32 s40,s46,6144
 s_waitcnt lgkmcnt(6)
 mf 192,24,48,192
 tr 20,3,12704
 tr 22,3,13216
 buffer_load_dwordx4 v2,s[20:23],s40 offen lds
 mf 196,28,48,196
 tr 24,3,12736
 tr 26,3,13248
 s_add_u32 s46,s37,5
 s_and_b32 s46,s46,7
 s_lshl_b32 s46,s46,7
 s_add_u32 s46,s46,s45
 s_add_u32 m0,s41,104544
 s_add_u32 s40,s46,268288
 s_waitcnt lgkmcnt(6)
 mf 200,8,48,200
 tr 28,3,12768
 tr 30,3,13280
 buffer_load_dwordx4 v2,s[20:23],s40 offen lds
 mf 204,12,48,204
 tr 8,3,16896
 tr 10,3,17408
 s_add_u32 s46,s37,1
 s_and_b32 s46,s46,7
 s_lshl_b32 s46,s46,7
 s_add_u32 s46,s46,s45
 s_add_u32 m0,s41,118272
 s_add_u32 s40,s46,393216
 s_waitcnt lgkmcnt(6)
 mf 192,16,56,192
 tr 12,3,16928
 tr 14,3,17440
 buffer_load_dwordx4 v2,s[20:23],s40 offen lds
 mf 196,20,56,196
 tr 16,3,16960
 tr 18,3,17472
 s_add_u32 m0,s41,119328
 s_add_u32 s40,s46,395264
 s_waitcnt lgkmcnt(6)
 mf 200,24,56,200
 tr 20,3,16992
 tr 22,3,17504
 buffer_load_dwordx4 v2,s[20:23],s40 offen lds
 mf 204,28,56,204
 s_add_u32 m0,s41,120384
 s_add_u32 s40,s46,397312
 s_waitcnt lgkmcnt(4)
 mf 224,8,32,224
 buffer_load_dwordx4 v2,s[20:23],s40 offen lds
 s_waitcnt vmcnt(3)
 s_waitcnt lgkmcnt(0)
 s_barrier
 tr 24,3,21120
 tr 26,3,21632
 tr 28,3,21152
 tr 30,3,21664
 mf 228,12,32,228
 tr 8,3,21184
 tr 10,3,21696
 s_add_u32 s46,s37,6
 s_and_b32 s46,s46,7
 s_lshl_b32 s46,s46,7
 s_add_u32 s46,s46,s45
 s_add_u32 m0,s41,33792
 s_add_u32 s40,s46,262144
 buffer_load_dwordx4 v2,s[20:23],s40 offen lds
 mf 232,16,32,232
 tr 12,3,21216
 tr 14,3,21728
 s_add_u32 m0,s41,34848
 s_add_u32 s40,s46,264192
 buffer_load_dwordx4 v2,s[20:23],s40 offen lds
 mf 236,20,32,236
 tr 16,3,25344
 tr 18,3,25856
 s_add_u32 m0,s41,35904
 s_add_u32 s40,s46,266240
 buffer_load_dwordx4 v2,s[20:23],s40 offen lds
 s_waitcnt lgkmcnt(6)
 mf 224,24,40,224
 tr 20,3,25376
 tr 22,3,25888
 s_add_u32 m0,s41,36960
 s_add_u32 s40,s46,268288
 buffer_load_dwordx4 v2,s[20:23],s40 offen lds
 mf 228,28,40,228
 tr 24,3,25408
 tr 26,3,25920
 s_add_u32 s46,s37,1
 s_and_b32 s46,s46,7
 s_lshl_b32 s46,s46,7
 s_add_u32 s46,s46,s45
 s_add_u32 m0,s41,121440
 s_add_u32 s40,s46,399360
 buffer_load_dwordx4 v2,s[20:23],s40 offen lds
 s_waitcnt lgkmcnt(6)
 mf 232,8,40,232
 tr 28,3,25440
 tr 30,3,25952
 s_add_u32 s46,s37,2
 s_and_b32 s46,s46,7
 s_lshl_b32 s46,s46,7
 s_add_u32 s46,s46,s45
 s_add_u32 m0,s41,67584
 s_add_u32 s40,s46,393216
 buffer_load_dwordx4 v2,s[20:23],s40 offen lds
 mf 236,12,40,236
 tr 8,3,29568
 tr 10,3,30080
 s_add_u32 m0,s41,68640
 s_add_u32 s40,s46,395264
 s_waitcnt lgkmcnt(6)
 mf 224,16,48,224
 tr 12,3,29600
 tr 14,3,30112
 buffer_load_dwordx4 v2,s[20:23],s40 offen lds
 mf 228,20,48,228
 tr 16,3,29632
 tr 18,3,30144
 s_add_u32 m0,s41,69696
 s_add_u32 s40,s46,397312
 s_waitcnt lgkmcnt(6)
 mf 232,24,48,232
 tr 20,3,29664
 tr 22,3,30176
 buffer_load_dwordx4 v2,s[20:23],s40 offen lds
 mf 236,28,48,236
 tr 24,3,33792
 tr 26,3,34304
 ds_write_b128 v4,v[32:35]
 s_waitcnt lgkmcnt(7)
 mf 224,8,56,224
 tr 28,3,33824
 tr 30,3,34336
 ds_write_b128 v4,v[40:43] offset:7168
 mf 228,12,56,228
 tr 8,3,33856
 tr 10,3,34368
 ds_write_b128 v4,v[48:51] offset:14336
 s_waitcnt lgkmcnt(9)
 mf 232,16,56,232
 tr 12,3,33888
 tr 14,3,34400
 mf 236,20,56,236
 ds_write_b128 v4,v[56:59] offset:21504
 s_waitcnt lgkmcnt(7)
 mf 96,24,32,96
 s_waitcnt lgkmcnt(0)
 s_barrier
 tr 16,3,38016
 tr 18,3,38528
 tr 20,3,38048
 tr 22,3,38560
 mf 100,28,32,100
 tr 24,3,38080
 tr 26,3,38592
 s_add_u32 s46,s37,6
 s_and_b32 s46,s46,7
 s_lshl_b32 s46,s46,7
 s_add_u32 s46,s46,s45
 s_add_u32 m0,s41,50688
 s_add_u32 s40,s46,393216
 buffer_load_dwordx4 v2,s[20:23],s40 offen lds
 mf 104,8,32,104
 tr 28,3,38112
 tr 30,3,38624
 s_add_u32 m0,s41,51744
 s_add_u32 s40,s46,395264
 buffer_load_dwordx4 v2,s[20:23],s40 offen lds
 mf 108,12,32,108
 tr 8,3,42240
 tr 10,3,42752
 s_add_u32 m0,s41,52800
 s_add_u32 s40,s46,397312
 s_waitcnt lgkmcnt(6)
 mf 96,16,40,96
 tr 12,3,42272
 tr 14,3,42784
 buffer_load_dwordx4 v2,s[20:23],s40 offen lds
 mf 100,20,40,100
 tr 16,3,42304
 tr 18,3,42816
 s_add_u32 m0,s41,53856
 s_add_u32 s40,s46,399360
 s_waitcnt lgkmcnt(6)
 mf 104,24,40,104
 tr 20,3,42336
 tr 22,3,42848
 buffer_load_dwordx4 v2,s[20:23],s40 offen lds
 mf 108,28,40,108
 tr 24,3,46464
 tr 26,3,46976
 s_add_u32 s46,s37,2
 s_and_b32 s46,s46,7
 s_lshl_b32 s46,s46,7
 s_add_u32 s46,s46,s45
 s_add_u32 m0,s41,70752
 s_add_u32 s40,s46,399360
 s_waitcnt lgkmcnt(6)
 mf 96,8,48,96
 tr 28,3,46496
 tr 30,3,47008
 buffer_load_dwordx4 v2,s[20:23],s40 offen lds
 mf 100,12,48,100
 tr 8,3,46528
 tr 10,3,47040
 s_add_u32 s46,s37,3
 s_and_b32 s46,s46,7
 s_lshl_b32 s46,s46,7
 s_add_u32 s46,s46,s45
 s_add_u32 m0,s41,84480
 s_add_u32 s40,s46,393216
 s_waitcnt lgkmcnt(6)
 mf 104,16,48,104
 tr 12,3,46560
 tr 14,3,47072
 buffer_load_dwordx4 v2,s[20:23],s40 offen lds
 mf 108,20,48,108
 s_add_u32 m0,s41,85536
 s_add_u32 s40,s46,395264
 s_waitcnt lgkmcnt(4)
 mf 96,24,56,96
 buffer_load_dwordx4 v2,s[20:23],s40 offen lds
 s_setprio 1
 s_waitcnt vmcnt(10)
 s_waitcnt lgkmcnt(0)
 s_barrier
 ds_read_b128 v[64:67],v4
 ds_read_b128 v[72:75],v4 offset:7168
 ds_read_b128 v[80:83],v4 offset:14336
 ds_read_b128 v[88:91],v4 offset:21504
 tr 16,3,50688
 tr 18,3,51200
 tr 20,3,50720
 tr 22,3,51232
 mf 100,28,56,100
 tr 24,3,50752
 tr 26,3,51264
 s_add_u32 s46,s37,3
 s_and_b32 s46,s46,7
 s_lshl_b32 s46,s46,7
 s_add_u32 s46,s46,s45
 s_add_u32 m0,s41,86592
 s_add_u32 s40,s46,397312
 mf 104,8,56,104
 tr 28,3,50784
 tr 30,3,51296
 mf 108,12,56,108
 tr 8,3,54912
 tr 10,3,55424
 s_waitcnt lgkmcnt(6)
 mf 128,16,64,128
 tr 12,3,54944
 tr 14,3,55456
 mf 132,20,64,132
 tr 16,3,54976
 tr 18,3,55488
 s_waitcnt lgkmcnt(6)
 mf 136,24,64,136
 tr 20,3,55008
 tr 22,3,55520
 mf 140,28,64,140
 tr 24,3,59136
 tr 26,3,59648
 buffer_load_dwordx4 v2,s[20:23],s40 offen lds
 s_waitcnt lgkmcnt(6)
 mf 128,8,72,128
 tr 28,3,59168
 tr 30,3,59680
 s_add_u32 m0,s41,87648
 s_add_u32 s40,s46,399360
 mf 132,12,72,132
 tr 8,3,59200
 tr 10,3,59712
 buffer_load_dwordx4 v2,s[20:23],s40 offen lds
 s_waitcnt lgkmcnt(6)
 mf 136,16,72,136
 tr 12,3,59232
 tr 14,3,59744
 s_add_u32 s46,s37,4
 s_and_b32 s46,s46,7
 s_lshl_b32 s46,s46,7
 s_add_u32 s46,s46,s45
 s_add_u32 m0,s41,101376
 s_add_u32 s40,s46,393216
 mf 140,20,72,140
 tr 16,3,63360
 tr 18,3,63872
 buffer_load_dwordx4 v2,s[20:23],s40 offen lds
 s_waitcnt lgkmcnt(6)
 mf 128,24,80,128
 tr 20,3,63392
 tr 22,3,63904
 s_add_u32 m0,s41,102432
 s_add_u32 s40,s46,395264
 mf 132,28,80,132
 tr 24,3,63424
 tr 26,3,63936
 buffer_load_dwordx4 v2,s[20:23],s40 offen lds
 s_waitcnt lgkmcnt(6)
 mf 136,8,80,136
 tr 28,3,63456
 tr 30,3,63968
 s_add_u32 m0,s41,103488
 s_add_u32 s40,s46,397312
 mf 140,12,80,140
 buffer_load_dwordx4 v2,s[20:23],s40 offen lds
 s_waitcnt lgkmcnt(4)
 mf 128,16,88,128
 s_add_u32 m0,s41,104544
 s_add_u32 s40,s46,399360
 mf 132,20,88,132
 buffer_load_dwordx4 v2,s[20:23],s40 offen lds
 s_waitcnt lgkmcnt(0)
 mf 136,24,88,136
 v_mov_b32 v32,16880
 mf 140,28,88,140
 ds_read_b32 v32,v32
 s_waitcnt lgkmcnt(0)
 v_readfirstlane_b32 s40,v32
 s_nop 0
 s_cmp_lg_u32 s40,0
 s_cbranch_scc1 X_restart
 s_mov_b32 s47,0
 cv 128,128,129
 cv 129,130,131
 cv 130,132,133
 cv 131,134,135
 buffer_store_dwordx4 v[128:131],v1,s[28:31],s47 offen sc1
 cv 136,136,137
 cv 137,138,139
 cv 138,140,141
 cv 139,142,143
 buffer_store_dwordx4 v[136:139],v1,s[28:31],s47 offen offset:1024 sc1
 s_waitcnt vmcnt(10)
 s_barrier
 ds_read_b64_tr_b16 v[8:9],v3
 tr 10,3,512
 tr 12,3,32
 tr 14,3,544
 tr 16,3,64
 tr 18,3,576
 tr 20,3,96
 tr 22,3,608
 tr 24,3,4224
 tr 26,3,4736
 s_waitcnt lgkmcnt(6)
 mf 160,8,64,160
 tr 28,3,4256
 tr 30,3,4768
 s_add_u32 s46,s37,7
 s_and_b32 s46,s46,7
 s_lshl_b32 s46,s46,7
 s_add_u32 s46,s46,s45
 s_add_u32 m0,s41,0
 s_add_u32 s40,s46,0
 mf 164,12,64,164
 tr 8,3,4288
 tr 10,3,4800
 buffer_load_dwordx4 v2,s[20:23],s40 offen lds
 s_waitcnt lgkmcnt(6)
 mf 168,16,64,168
 tr 12,3,4320
 tr 14,3,4832
 s_add_u32 m0,s41,1056
 s_add_u32 s40,s46,2048
 mf 172,20,64,172
 tr 16,3,8448
 tr 18,3,8960
 buffer_load_dwordx4 v2,s[20:23],s40 offen lds
 s_waitcnt lgkmcnt(6)
 mf 160,24,72,160
 tr 20,3,8480
 tr 22,3,8992
 s_add_u32 m0,s41,2112
 s_add_u32 s40,s46,4096
 mf 164,28,72,164
 tr 24,3,8512
 tr 26,3,9024
 buffer_load_dwordx4 v2,s[20:23],s40 offen lds
 s_waitcnt lgkmcnt(6)
 mf 168,8,72,168
 tr 28,3,8544
 tr 30,3,9056
 s_add_u32 m0,s41,3168
 s_add_u32 s40,s46,6144
 mf 172,12,72,172
 tr 8,3,12672
 tr 10,3,13184
 buffer_load_dwordx4 v2,s[20:23],s40 offen lds
 s_waitcnt lgkmcnt(6)
 mf 160,16,80,160
 tr 12,3,12704
 tr 14,3,13216
 s_add_u32 s46,s37,5
 s_and_b32 s46,s46,7
 s_lshl_b32 s46,s46,7
 s_add_u32 s46,s46,s45
 s_add_u32 m0,s41,118272
 s_add_u32 s40,s46,393216
 mf 164,20,80,164
 tr 16,3,12736
 tr 18,3,13248
 buffer_load_dwordx4 v2,s[20:23],s40 offen lds
 s_waitcnt lgkmcnt(6)
 mf 168,24,80,168
 tr 20,3,12768
 tr 22,3,13280
 s_add_u32 m0,s41,119328
 s_add_u32 s40,s46,395264
 mf 172,28,80,172
 buffer_load_dwordx4 v2,s[20:23],s40 offen lds
 s_waitcnt lgkmcnt(4)
 mf 160,8,88,160
 s_add_u32 m0,s41,120384
 s_add_u32 s40,s46,397312
 mf 164,12,88,164
 buffer_load_dwordx4 v2,s[20:23],s40 offen lds
 s_waitcnt lgkmcnt(0)
 mf 168,16,88,168
 s_add_u32 m0,s41,121440
 s_add_u32 s40,s46,399360
 mf 172,20,88,172
 buffer_load_dwordx4 v2,s[20:23],s40 offen lds
 s_mov_b32 s47,4194304
 cv 160,160,161
 cv 161,162,163
 cv 162,164,165
 cv 163,166,167
 buffer_store_dwordx4 v[160:163],v1,s[28:31],s47 offen sc1
 cv 168,168,169
 cv 169,170,171
 cv 170,172,173
 cv 171,174,175
 buffer_store_dwordx4 v[168:171],v1,s[28:31],s47 offen offset:1024 sc1
 s_waitcnt vmcnt(16)
 s_barrier
 tr 24,3,16896
 tr 26,3,17408
 tr 28,3,16928
 tr 30,3,17440
 tr 8,3,16960
 tr 10,3,17472
 tr 12,3,16992
 tr 14,3,17504
 tr 16,3,21120
 tr 18,3,21632
 s_waitcnt lgkmcnt(6)
 mf 192,24,64,192
 tr 20,3,21152
 tr 22,3,21664
 s_add_u32 s46,s37,7
 s_and_b32 s46,s46,7
 s_lshl_b32 s46,s46,7
 s_add_u32 s46,s46,s45
 s_add_u32 m0,s41,16896
 s_add_u32 s40,s46,131072
 mf 196,28,64,196
 tr 24,3,21184
 tr 26,3,21696
 buffer_load_dwordx4 v2,s[20:23],s40 offen lds
 s_waitcnt lgkmcnt(6)
 mf 200,8,64,200
 tr 28,3,21216
 tr 30,3,21728
 s_add_u32 m0,s41,17952
 s_add_u32 s40,s46,133120
 mf 204,12,64,204
 tr 8,3,25344
 tr 10,3,25856
 buffer_load_dwordx4 v2,s[20:23],s40 offen lds
 s_waitcnt lgkmcnt(6)
 mf 192,16,72,192
 tr 12,3,25376
 tr 14,3,25888
 s_add_u32 m0,s41,19008
 s_add_u32 s40,s46,135168
 mf 196,20,72,196
 tr 16,3,25408
 tr 18,3,25920
 buffer_load_dwordx4 v2,s[20:23],s40 offen lds
 s_waitcnt lgkmcnt(6)
 mf 200,24,72,200
 tr 20,3,25440
 tr 22,3,25952
 s_add_u32 m0,s41,20064
 s_add_u32 s40,s46,137216
 mf 204,28,72,204
 tr 24,3,29568
 tr 26,3,30080
 buffer_load_dwordx4 v2,s[20:23],s40 offen lds
 s_waitcnt lgkmcnt(6)
 mf 192,8,80,192
 tr 28,3,29600
 tr 30,3,30112
 s_add_u32 s46,s37,8
 s_and_b32 s46,s46,7
 s_lshl_b32 s46,s46,7
 s_add_u32 s46,s46,s45
 s_add_u32 m0,s41,67584
 s_add_u32 s40,s46,0
 mf 196,12,80,196
 tr 8,3,29632
 tr 10,3,30144
 buffer_load_dwordx4 v2,s[20:23],s40 offen lds
 s_waitcnt lgkmcnt(6)
 mf 200,16,80,200
 tr 12,3,29664
 tr 14,3,30176
 s_add_u32 m0,s41,68640
 s_add_u32 s40,s46,2048
 mf 204,20,80,204
 buffer_load_dwordx4 v2,s[20:23],s40 offen lds
 s_waitcnt lgkmcnt(4)
 mf 192,24,88,192
 s_add_u32 m0,s41,69696
 s_add_u32 s40,s46,4096
 mf 196,28,88,196
 buffer_load_dwordx4 v2,s[20:23],s40 offen lds
 s_waitcnt lgkmcnt(0)
 mf 200,8,88,200
 s_add_u32 m0,s41,70752
 s_add_u32 s40,s46,6144
 mf 204,12,88,204
 buffer_load_dwordx4 v2,s[20:23],s40 offen lds
 s_waitcnt vmcnt(18)
 s_add_u32 s47,s37,1
 s_and_b32 s47,s47,7
 s_lshl_b32 s47,s47,7
 buffer_store_dword v4,v7,s[96:99],s47 offen sc1
 s_mov_b32 s47,8388608
 cv 192,192,193
 cv 193,194,195
 cv 194,196,197
 cv 195,198,199
 buffer_store_dwordx4 v[192:195],v1,s[28:31],s47 offen sc1
 cv 200,200,201
 cv 201,202,203
 cv 202,204,205
 cv 203,206,207
 buffer_store_dwordx4 v[200:203],v1,s[28:31],s47 offen offset:1024 sc1
 s_barrier
 tr 16,3,33792
 tr 18,3,34304
 tr 20,3,33824
 tr 22,3,34336
 tr 24,3,33856
 tr 26,3,34368
 tr 28,3,33888
 tr 30,3,34400
 tr 8,3,38016
 tr 10,3,38528
 s_waitcnt lgkmcnt(6)
 mf 224,16,64,224
 tr 12,3,38048
 tr 14,3,38560
 s_add_u32 s46,s37,7
 s_and_b32 s46,s46,7
 s_lshl_b32 s46,s46,7
 s_add_u32 s46,s46,s45
 s_add_u32 m0,s41,33792
 s_add_u32 s40,s46,262144
 buffer_load_dwordx4 v2,s[20:23],s40 offen lds
 s_add_u32 m0,s41,34848
 s_add_u32 s40,s46,264192
 mf 228,20,64,228
 tr 16,3,38080
 tr 18,3,38592
 buffer_load_dwordx4 v2,s[20:23],s40 offen lds
 s_add_u32 m0,s41,35904
 s_add_u32 s40,s46,266240
 s_waitcnt lgkmcnt(6)
 mf 232,24,64,232
 tr 20,3,38112
 tr 22,3,38624
 buffer_load_dwordx4 v2,s[20:23],s40 offen lds
 s_add_u32 m0,s41,36960
 s_add_u32 s40,s46,268288
 mf 236,28,64,236
 tr 24,3,42240
 tr 26,3,42752
 buffer_load_dwordx4 v2,s[20:23],s40 offen lds
 s_add_u32 s46,s37,8
 s_and_b32 s46,s46,7
 s_lshl_b32 s46,s46,7
 s_add_u32 s46,s46,s45
 s_add_u32 m0,s41,84480
 s_add_u32 s40,s46,131072
 s_waitcnt lgkmcnt(6)
 mf 224,8,72,224
 tr 28,3,42272
 tr 30,3,42784
 buffer_load_dwordx4 v2,s[20:23],s40 offen lds
 s_add_u32 m0,s41,85536
 s_add_u32 s40,s46,133120
 mf 228,12,72,228
 tr 8,3,42304
 tr 10,3,42816
 buffer_load_dwordx4 v2,s[20:23],s40 offen lds
 s_add_u32 m0,s41,86592
 s_add_u32 s40,s46,135168
 s_waitcnt lgkmcnt(6)
 mf 232,16,72,232
 tr 12,3,42336
 tr 14,3,42848
 buffer_load_dwordx4 v2,s[20:23],s40 offen lds
 s_add_u32 m0,s41,87648
 s_add_u32 s40,s46,137216
 mf 236,20,72,236
 tr 16,3,46464
 tr 18,3,46976
 buffer_load_dwordx4 v2,s[20:23],s40 offen lds
 s_waitcnt lgkmcnt(6)
 mf 224,24,80,224
 tr 20,3,46496
 tr 22,3,47008
 v_mbcnt_lo_u32_b32 v152,-1,0
 v_mbcnt_hi_u32_b32 v152,-1,v152
 v_bfe_u32 v154,v152,2,1
 v_lshrrev_b32 v155,5,v152
 mf 228,28,80,228
 tr 24,3,46528
 tr 26,3,47040
 v_xor_b32 v154,v154,v155
 v_lshlrev_b32 v154,4,v154
 v_bfe_u32 v155,v152,3,2
 v_lshl_add_u32 v154,v155,1,v154
 s_waitcnt lgkmcnt(6)
 mf 232,8,80,232
 tr 28,3,46560
 tr 30,3,47072
 v_bfe_u32 v155,v152,1,1
 v_add_u32 v154,v154,v155
 v_and_b32 v155,1,v152
 v_lshlrev_b32 v155,4,v155
 v_mov_b32 v156,0x3f80
 mf 236,12,80,236
 v_lshlrev_b32 v155,v155,v156
 v_cmp_eq_u32 vcc,0,v154
 s_nop 1
 v_cndmask_b32 v144,0,v155,vcc
 v_cmp_eq_u32 vcc,1,v154
 s_waitcnt lgkmcnt(4)
 mf 224,16,88,224
 v_cndmask_b32 v145,0,v155,vcc
 v_cmp_eq_u32 vcc,2,v154
 s_nop 1
 v_cndmask_b32 v146,0,v155,vcc
 v_cmp_eq_u32 vcc,3,v154
 s_nop 1
 v_cndmask_b32 v147,0,v155,vcc
 mf 228,20,88,228
 v_cmp_eq_u32 vcc,4,v154
 s_nop 1
 v_cndmask_b32 v148,0,v155,vcc
 v_cmp_eq_u32 vcc,5,v154
 s_nop 1
 v_cndmask_b32 v149,0,v155,vcc
 s_waitcnt lgkmcnt(0)
 mf 232,24,88,232
 v_cmp_eq_u32 vcc,6,v154
 s_nop 1
 v_cndmask_b32 v150,0,v155,vcc
 v_cmp_eq_u32 vcc,7,v154
 s_nop 1
 v_cndmask_b32 v151,0,v155,vcc
 v_and_b32 v158,15,v152
 mf 236,28,88,236
 s_lshl_b32 s47,s33,5
 v_add_lshl_u32 v158,v158,s47,4
 v_and_b32 v155,48,v152
 v_lshl_add_u32 v158,v158,7,v155
 v_add_u32 v159,32768,v158
 s_waitcnt vmcnt(19)
 s_add_u32 s47,s37,2
 s_and_b32 s47,s47,7
 s_lshl_b32 s47,s47,7
 buffer_store_dword v4,v7,s[96:99],s47 offen sc1
 s_mov_b32 s47,12582912
 cv 224,224,225
 cv 225,226,227
 cv 226,228,229
 cv 227,230,231
 buffer_store_dwordx4 v[224:227],v1,s[28:31],s47 offen sc1
 cv 232,232,233
 cv 233,234,235
 cv 234,236,237
 cv 235,238,239
 buffer_store_dwordx4 v[232:235],v1,s[28:31],s47 offen offset:1024 sc1
 s_barrier
 tr 8,3,50688
 tr 10,3,51200
 tr 12,3,50720
 tr 14,3,51232
 tr 16,3,50752
 tr 18,3,51264
 tr 20,3,50784
 tr 22,3,51296
 tr 24,3,54912
 tr 26,3,55424
 s_waitcnt lgkmcnt(6)
 mf 96,8,64,96
 tr 28,3,54944
 tr 30,3,55456
 s_add_u32 s46,s37,7
 s_and_b32 s46,s46,7
 s_lshl_b32 s46,s46,7
 s_add_u32 s46,s46,s45
 s_add_u32 m0,s41,50688
 s_add_u32 s40,s46,393216
 mf 100,12,64,100
 tr 8,3,54976
 tr 10,3,55488
 buffer_load_dwordx4 v2,s[20:23],s40 offen lds
 s_waitcnt lgkmcnt(6)
 mf 104,16,64,104
 tr 12,3,55008
 tr 14,3,55520
 s_add_u32 m0,s41,51744
 s_add_u32 s40,s46,395264
 mf 108,20,64,108
 tr 16,3,59136
 tr 18,3,59648
 buffer_load_dwordx4 v2,s[20:23],s40 offen lds
 s_waitcnt lgkmcnt(6)
 mf 96,24,72,96
 tr 20,3,59168
 tr 22,3,59680
 s_add_u32 m0,s41,52800
 s_add_u32 s40,s46,397312
 mf 100,28,72,100
 tr 24,3,59200
 tr 26,3,59712
 buffer_load_dwordx4 v2,s[20:23],s40 offen lds
 s_waitcnt lgkmcnt(6)
 mf 104,8,72,104
 tr 28,3,59232
 tr 30,3,59744
 s_add_u32 m0,s41,53856
 s_add_u32 s40,s46,399360
 mf 108,12,72,108
 tr 8,3,63360
 tr 10,3,63872
 buffer_load_dwordx4 v2,s[20:23],s40 offen lds
 s_waitcnt lgkmcnt(6)
 mf 96,16,80,96
 tr 12,3,63392
 tr 14,3,63904
 s_add_u32 s46,s37,8
 s_and_b32 s46,s46,7
 s_lshl_b32 s46,s46,7
 s_add_u32 s46,s46,s45
 s_add_u32 m0,s41,101376
 s_add_u32 s40,s46,262144
 mf 100,20,80,100
 tr 16,3,63424
 tr 18,3,63936
 buffer_load_dwordx4 v2,s[20:23],s40 offen lds
 s_waitcnt lgkmcnt(6)
 mf 104,24,80,104
 tr 20,3,63456
 tr 22,3,63968
 s_add_u32 m0,s41,102432
 s_add_u32 s40,s46,264192
 mf 108,28,80,108
 buffer_load_dwordx4 v2,s[20:23],s40 offen lds
 s_waitcnt lgkmcnt(4)
 mf 96,8,88,96
 s_add_u32 m0,s41,103488
 s_add_u32 s40,s46,266240
 mf 100,12,88,100
 buffer_load_dwordx4 v2,s[20:23],s40 offen lds
 s_waitcnt lgkmcnt(0)
 mf 104,16,88,104
 s_add_u32 m0,s41,104544
 s_add_u32 s40,s46,268288
 mf 108,20,88,108
 buffer_load_dwordx4 v2,s[20:23],s40 offen lds
 s_waitcnt vmcnt(19)
 s_add_u32 s47,s37,3
 s_and_b32 s47,s47,7
 s_lshl_b32 s47,s47,7
 buffer_store_dword v4,v7,s[96:99],s47 offen sc1
 s_mov_b32 s47,16777216
 cv 96,96,97
 cv 97,98,99
 cv 98,100,101
 cv 99,102,103
 buffer_store_dwordx4 v[96:99],v1,s[28:31],s47 offen sc1
 cv 104,104,105
 cv 105,106,107
 cv 106,108,109
 cv 107,110,111
 buffer_store_dwordx4 v[104:107],v1,s[28:31],s47 offen offset:1024 sc1
 buffer_load_dword v153,v0,s[96:99],s39 offen sc1
 s_waitcnt vmcnt(8)
 s_barrier
 s_add_u32 s46,s37,8
 s_and_b32 s46,s46,7
 s_lshl_b32 s46,s46,7
 s_add_u32 s46,s46,s45
 s_add_u32 m0,s41,0
 s_add_u32 s40,s46,393216
 buffer_load_dwordx4 v2,s[20:23],s40 offen lds
 s_add_u32 m0,s41,1056
 s_add_u32 s40,s46,395264
 buffer_load_dwordx4 v2,s[20:23],s40 offen lds
 s_add_u32 m0,s41,2112
 s_add_u32 s40,s46,397312
 buffer_load_dwordx4 v2,s[20:23],s40 offen lds
 s_add_u32 m0,s41,3168
 s_add_u32 s40,s46,399360
 buffer_load_dwordx4 v2,s[20:23],s40 offen lds
 ds_read_b128 v[64:67],v4
 ds_read_b128 v[68:71],v4 offset:7168
 s_mov_b32 s47,20971520
 s_waitcnt lgkmcnt(1)
 buffer_store_dwordx4 v[64:67],v1,s[28:31],s47 offen sc1
 s_waitcnt lgkmcnt(0)
 buffer_store_dwordx4 v[68:71],v1,s[28:31],s47 offen offset:1024 sc1
 s_waitcnt vmcnt(6)
 v_cmp_ne_u32 vcc,0,v153
 s_nop 3
 s_mov_b32 s55,vcc_lo
 s_sub_u32 s46,s37,1
 s_and_b32 s46,s46,7
L_chk0_s:
 s_bitcmp1_b32 s55,s46
 s_cbranch_scc1 L_go0_s
 buffer_load_dword v153,v0,s[96:99],s39 offen sc1
 s_waitcnt vmcnt(0)
 v_cmp_ne_u32 vcc,0,v153
 s_add_u32 s100,s100,1
 s_nop 2
 s_mov_b32 s55,vcc_lo
 s_cmp_lt_u32 s100,0x40000
 s_cbranch_scc1 L_chk0_s
L_go0_s:
 s_lshl_b32 s46,s46,14
 s_add_u32 s46,s46,0
 buffer_load_dwordx4 v[128:131],v1,s[60:63],s46 offen sc1
 buffer_load_dwordx4 v[132:135],v1,s[60:63],s46 offen offset:1024 sc1
 s_sub_u32 s46,s37,2
 s_and_b32 s46,s46,7
L_chk1_s:
 s_bitcmp1_b32 s55,s46
 s_cbranch_scc1 L_go1_s
 buffer_load_dword v153,v0,s[96:99],s39 offen sc1
 s_waitcnt vmcnt(0)
 v_cmp_ne_u32 vcc,0,v153
 s_add_u32 s100,s100,1
 s_nop 2
 s_mov_b32 s55,vcc_lo
 s_cmp_lt_u32 s100,0x40000
 s_cbranch_scc1 L_chk1_s
L_go1_s:
 s_lshl_b32 s46,s46,14
 s_add_u32 s46,s46,4194304
 buffer_load_dwordx4 v[160:163],v1,s[60:63],s46 offen sc1
 buffer_load_dwordx4 v[164:167],v1,s[60:63],s46 offen offset:1024 sc1
 s_add_u32 s47,s37,4
 s_and_b32 s47,s47,7
 s_lshl_b32 s47,s47,7
 buffer_store_dword v4,v7,s[96:99],s47 offen sc1
 s_add_u32 s47,s37,5
 s_and_b32 s47,s47,7
 s_lshl_b32 s47,s47,7
 buffer_store_dword v4,v7,s[96:99],s47 offen sc1
 s_waitcnt vmcnt(6)
 s_add_u32 s47,s37,6
 s_and_b32 s47,s47,7
 s_lshl_b32 s47,s47,7
 buffer_store_dword v4,v7,s[96:99],s47 offen sc1
 buffer_load_dword v153,v0,s[96:99],s39 offen sc1
 s_barrier
 ds_read_b128 v[80:83],v4 offset:14336
 ds_read_b128 v[84:87],v4 offset:21504
 s_mov_b32 s47,25165824
 s_waitcnt lgkmcnt(1)
 buffer_store_dwordx4 v[80:83],v1,s[28:31],s47 offen sc1
 s_waitcnt lgkmcnt(0)
 buffer_store_dwordx4 v[84:87],v1,s[28:31],s47 offen offset:1024 sc1
 s_waitcnt vmcnt(2)
 v_cmp_ne_u32 vcc,0,v153
 s_nop 3
 s_mov_b32 s55,vcc_lo
 s_waitcnt vmcnt(0)
 s_add_u32 s47,s37,7
 s_and_b32 s47,s47,7
 s_lshl_b32 s47,s47,7
 buffer_store_dword v4,v7,s[96:99],s47 offen sc1
 s_sub_u32 s46,s37,3
 s_and_b32 s46,s46,7
L_chk2_s:
 s_bitcmp1_b32 s55,s46
 s_cbranch_scc1 L_go2_s
 buffer_load_dword v153,v0,s[96:99],s39 offen sc1
 s_waitcnt vmcnt(0)
 v_cmp_ne_u32 vcc,0,v153
 s_add_u32 s100,s100,1
 s_nop 2
 s_mov_b32 s55,vcc_lo
 s_cmp_lt_u32 s100,0x40000
 s_cbranch_scc1 L_chk2_s
L_go2_s:
 s_lshl_b32 s46,s46,14
 s_add_u32 s46,s46,8388608
 buffer_load_dwordx4 v[176:179],v1,s[60:63],s46 offen sc1
 buffer_load_dwordx4 v[180:183],v1,s[60:63],s46 offen offset:1024 sc1
 s_sub_u32 s46,s37,4
 s_and_b32 s46,s46,7
L_chk3_s:
 s_bitcmp1_b32 s55,s46
 s_cbranch_scc1 L_go3_s
 buffer_load_dword v153,v0,s[96:99],s39 offen sc1
 s_waitcnt vmcnt(0)
 v_cmp_ne_u32 vcc,0,v153
 s_add_u32 s100,s100,1
 s_nop 2
 s_mov_b32 s55,vcc_lo
 s_cmp_lt_u32 s100,0x40000
 s_cbranch_scc1 L_chk3_s
L_go3_s:
 s_lshl_b32 s46,s46,14
 s_add_u32 s46,s46,12582912
 buffer_load_dwordx4 v[192:195],v1,s[60:63],s46 offen sc1
 buffer_load_dwordx4 v[196:199],v1,s[60:63],s46 offen offset:1024 sc1
 s_sub_u32 s46,s37,5
 s_and_b32 s46,s46,7
L_chk4_s:
 s_bitcmp1_b32 s55,s46
 s_cbranch_scc1 L_go4_s
 buffer_load_dword v153,v0,s[96:99],s39 offen sc1
 s_waitcnt vmcnt(0)
 v_cmp_ne_u32 vcc,0,v153
 s_add_u32 s100,s100,1
 s_nop 2
 s_mov_b32 s55,vcc_lo
 s_cmp_lt_u32 s100,0x40000
 s_cbranch_scc1 L_chk4_s
L_go4_s:
 s_lshl_b32 s46,s46,14
 s_add_u32 s46,s46,16777216
 buffer_load_dwordx4 v[208:211],v1,s[60:63],s46 offen sc1
 buffer_load_dwordx4 v[212:215],v1,s[60:63],s46 offen offset:1024 sc1
 s_sub_u32 s46,s37,6
 s_and_b32 s46,s46,7
L_chk5_s:
 s_bitcmp1_b32 s55,s46
 s_cbranch_scc1 L_go5_s
 buffer_load_dword v153,v0,s[96:99],s39 offen sc1
 s_waitcnt vmcnt(0)
 v_cmp_ne_u32 vcc,0,v153
 s_add_u32 s100,s100,1
 s_nop 2
 s_mov_b32 s55,vcc_lo
 s_cmp_lt_u32 s100,0x40000
 s_cbranch_scc1 L_chk5_s
L_go5_s:
 s_lshl_b32 s46,s46,14
 s_add_u32 s46,s46,20971520
 buffer_load_dwordx4 v[224:227],v1,s[60:63],s46 offen sc1
 buffer_load_dwordx4 v[228:231],v1,s[60:63],s46 offen offset:1024 sc1
 mz 32,144,128
 mz 36,148,128
 mz 40,144,132
 mz 44,148,132
 mf 32,144,160,32
 mf 36,148,160,36
 mf 40,144,164,40
 mf 44,148,164,44
 s_waitcnt vmcnt(6)
 mf 32,144,176,32
 mf 36,148,176,36
 mf 40,144,180,40
 mf 44,148,180,44
 s_waitcnt vmcnt(4)
 mf 32,144,192,32
 mf 36,148,192,36
 mf 40,144,196,40
 mf 44,148,196,44
 s_sub_u32 s46,s37,7
 s_and_b32 s46,s46,7
L_chk6_s:
 s_bitcmp1_b32 s55,s46
 s_cbranch_scc1 L_go6_s
 buffer_load_dword v153,v0,s[96:99],s39 offen sc1
 s_waitcnt vmcnt(0)
 v_cmp_ne_u32 vcc,0,v153
 s_add_u32 s100,s100,1
 s_nop 2
 s_mov_b32 s55,vcc_lo
 s_cmp_lt_u32 s100,0x40000
 s_cbranch_scc1 L_chk6_s
L_go6_s:
 s_lshl_b32 s46,s46,14
 s_add_u32 s46,s46,25165824
 buffer_load_dwordx4 v[240:243],v1,s[60:63],s46 offen sc1
 buffer_load_dwordx4 v[244:247],v1,s[60:63],s46 offen offset:1024 sc1
 s_waitcnt vmcnt(4)
 mf 32,144,208,32
 mf 36,148,208,36
 mf 40,144,212,40
 mf 44,148,212,44
 s_waitcnt vmcnt(2)
 mf 32,144,224,32
 mf 36,148,224,36
 mf 40,144,228,40
 mf 44,148,228,44
 s_barrier
 ds_read_b128 v[96:99],v4
 ds_read_b128 v[100:103],v4 offset:7168
 s_waitcnt vmcnt(0)
 mf 32,144,240,32
 mf 36,148,240,36
 mf 40,144,244,40
 mf 44,148,244,44
 s_waitcnt lgkmcnt(1)
 mf 32,144,96,32
 mf 36,148,96,36
 s_waitcnt lgkmcnt(0)
 mf 40,144,100,40
 mf 44,148,100,44
 s_lshl_b32 s40,s34,10
 s_add_u32 s40,s40,s39
 s_nop 1
 cv 32,32,33
 cv 33,34,35
 cv 34,36,37
 cv 35,38,39
 buffer_store_dwordx4 v[32:35],v158,s[56:59],s40 offen nt
 cv 40,40,41
 cv 41,42,43
 cv 42,44,45
 cv 43,46,47
 buffer_store_dwordx4 v[40:43],v158,s[56:59],s40 offen offset:64 nt
 s_endpgm
L_codeend:
L_attn_y:
 s_and_b32 s40,s33,1
 s_mul_i32 s40,s40,4096
 s_lshr_b32 s46,s33,1
 s_mul_i32 s46,s46,8192
 s_add_u32 s40,s40,s46
 v_add_u32 v14,s40,v14
 s_waitcnt vmcnt(4)
 s_barrier
 s_xor_b32 s40,s52,256
 s_add_u32 m0,s42,135168
 s_nop 0
 buffer_load_dwordx4 v20,s[24:27],s40 offen lds
 buffer_load_dwordx4 v21,s[24:27],s40 offen offset:1024 lds
 buffer_load_dwordx4 v22,s[24:27],s40 offen offset:2048 lds
 buffer_load_dwordx4 v23,s[24:27],s40 offen offset:3072 lds
 s_xor_b32 s40,s52,16640
 s_add_u32 m0,s42,139264
 s_nop 0
 buffer_load_dwordx4 v20,s[24:27],s40 offen lds
 buffer_load_dwordx4 v21,s[24:27],s40 offen offset:1024 lds
 buffer_load_dwordx4 v22,s[24:27],s40 offen offset:2048 lds
 buffer_load_dwordx4 v23,s[24:27],s40 offen offset:3072 lds
 s_xor_b32 s46,s53,1048576
 s_add_u32 s46,s46,s44
 s_add_u32 m0,s41,101376
 s_add_u32 s40,s46,0
 buffer_load_dwordx4 v2,s[16:19],s40 offen lds
 s_add_u32 m0,s41,102432
 s_add_u32 s40,s46,16384
 buffer_load_dwordx4 v2,s[16:19],s40 offen lds
 s_add_u32 m0,s41,103488
 s_add_u32 s40,s46,65536
 buffer_load_dwordx4 v2,s[16:19],s40 offen lds
 s_add_u32 m0,s41,104544
 s_add_u32 s40,s46,81920
 buffer_load_dwordx4 v2,s[16:19],s40 offen lds
 s_waitcnt vmcnt(12)
 s_barrier
 s_xor_b32 s46,s53,1048576
 s_add_u32 s46,s46,s44
 s_add_u32 m0,s41,118272
 s_add_u32 s40,s46,128
 buffer_load_dwordx4 v2,s[16:19],s40 offen lds
 s_add_u32 m0,s41,119328
 s_add_u32 s40,s46,16512
 buffer_load_dwordx4 v2,s[16:19],s40 offen lds
 s_add_u32 m0,s41,120384
 s_add_u32 s40,s46,65664
 buffer_load_dwordx4 v2,s[16:19],s40 offen lds
 s_add_u32 m0,s41,121440
 s_add_u32 s40,s46,82048
 buffer_load_dwordx4 v2,s[16:19],s40 offen lds
 s_xor_b32 s46,s53,2097152
 s_add_u32 s46,s46,s44
 s_add_u32 m0,s41,67584
 s_add_u32 s40,s46,0
 buffer_load_dwordx4 v2,s[16:19],s40 offen lds
 s_add_u32 m0,s41,68640
 s_add_u32 s40,s46,16384
 buffer_load_dwordx4 v2,s[16:19],s40 offen lds
 s_add_u32 m0,s41,69696
 s_add_u32 s40,s46,65536
 buffer_load_dwordx4 v2,s[16:19],s40 offen lds
 s_add_u32 m0,s41,70752
 s_add_u32 s40,s46,81920
 buffer_load_dwordx4 v2,s[16:19],s40 offen lds
 s_waitcnt vmcnt(8)
 s_barrier
 s_xor_b32 s40,s52,512
 s_add_u32 m0,s42,33792
 s_nop 0
 buffer_load_dwordx4 v20,s[24:27],s40 offen lds
 buffer_load_dwordx4 v21,s[24:27],s40 offen offset:1024 lds
 buffer_load_dwordx4 v22,s[24:27],s40 offen offset:2048 lds
 buffer_load_dwordx4 v23,s[24:27],s40 offen offset:3072 lds
 s_xor_b32 s40,s52,16896
 s_add_u32 m0,s42,37888
 s_nop 0
 buffer_load_dwordx4 v20,s[24:27],s40 offen lds
 buffer_load_dwordx4 v21,s[24:27],s40 offen offset:1024 lds
 buffer_load_dwordx4 v22,s[24:27],s40 offen offset:2048 lds
 buffer_load_dwordx4 v23,s[24:27],s40 offen offset:3072 lds
 s_xor_b32 s46,s53,3145728
 s_add_u32 s46,s46,s44
 s_add_u32 m0,s41,84480
 s_add_u32 s40,s46,0
 buffer_load_dwordx4 v2,s[16:19],s40 offen lds
 s_add_u32 m0,s41,85536
 s_add_u32 s40,s46,16384
 buffer_load_dwordx4 v2,s[16:19],s40 offen lds
 s_add_u32 m0,s41,86592
 s_add_u32 s40,s46,65536
 buffer_load_dwordx4 v2,s[16:19],s40 offen lds
 s_add_u32 m0,s41,87648
 s_add_u32 s40,s46,81920
 buffer_load_dwordx4 v2,s[16:19],s40 offen lds
 s_waitcnt vmcnt(16)
 s_barrier
 s_xor_b32 s40,s52,768
 s_add_u32 m0,s42,135168
 s_nop 0
 buffer_load_dwordx4 v20,s[24:27],s40 offen lds
 buffer_load_dwordx4 v21,s[24:27],s40 offen offset:1024 lds
 buffer_load_dwordx4 v22,s[24:27],s40 offen offset:2048 lds
 buffer_load_dwordx4 v23,s[24:27],s40 offen offset:3072 lds
 s_xor_b32 s40,s52,17152
 s_add_u32 m0,s42,139264
 s_nop 0
 buffer_load_dwordx4 v20,s[24:27],s40 offen lds
 buffer_load_dwordx4 v21,s[24:27],s40 offen offset:1024 lds
 buffer_load_dwordx4 v22,s[24:27],s40 offen offset:2048 lds
 buffer_load_dwordx4 v23,s[24:27],s40 offen offset:3072 lds
 s_xor_b32 s46,s53,2097152
 s_add_u32 s46,s46,s44
 s_add_u32 m0,s41,101376
 s_add_u32 s40,s46,128
 buffer_load_dwordx4 v2,s[16:19],s40 offen lds
 s_add_u32 m0,s41,102432
 s_add_u32 s40,s46,16512
 buffer_load_dwordx4 v2,s[16:19],s40 offen lds
 s_add_u32 m0,s41,103488
 s_add_u32 s40,s46,65664
 buffer_load_dwordx4 v2,s[16:19],s40 offen lds
 s_add_u32 m0,s41,104544
 s_add_u32 s40,s46,82048
 buffer_load_dwordx4 v2,s[16:19],s40 offen lds
 s_mov_b32 s40,0
 s_add_u32 m0,s41,16896
 s_nop 0
 buffer_load_dwordx4 v14,s[8:11],s40 offen nt lds
 s_mov_b32 s40,1024
 s_add_u32 m0,s41,17952
 s_nop 0
 buffer_load_dwordx4 v14,s[8:11],s40 offen nt lds
 s_mov_b32 s40,2048
 s_add_u32 m0,s41,19008
 s_nop 0
 buffer_load_dwordx4 v14,s[8:11],s40 offen nt lds
 s_mov_b32 s40,3072
 s_add_u32 m0,s41,20064
 s_nop 0
 buffer_load_dwordx4 v14,s[8:11],s40 offen nt lds
 s_waitcnt vmcnt(20)
 s_barrier
 s_xor_b32 s46,s53,3145728
 s_add_u32 s46,s46,s44
 s_add_u32 m0,s41,118272
 s_add_u32 s40,s46,128
 buffer_load_dwordx4 v2,s[16:19],s40 offen lds
 s_add_u32 m0,s41,119328
 s_add_u32 s40,s46,16512
 buffer_load_dwordx4 v2,s[16:19],s40 offen lds
 s_add_u32 m0,s41,120384
 s_add_u32 s40,s46,65664
 buffer_load_dwordx4 v2,s[16:19],s40 offen lds
 s_add_u32 m0,s41,121440
 s_add_u32 s40,s46,82048
 buffer_load_dwordx4 v2,s[16:19],s40 offen lds
 s_waitcnt vmcnt(12)
 s_barrier
 v_mov_b32 v240,0
 v_mov_b32 v241,0
 v_mov_b32 v242,0
 v_mov_b32 v243,0
 v_mov_b32 v244,0
 v_mov_b32 v245,0
 v_mov_b32 v246,0
 v_mov_b32 v247,0
 s_waitcnt vmcnt(8)
 s_barrier
 s_mov_b32 s40,16384
 s_add_u32 m0,s41,0
 s_nop 0
 buffer_load_dwordx4 v14,s[8:11],s40 offen nt lds
 s_mov_b32 s40,17408
 s_add_u32 m0,s41,1056
 s_nop 0
 buffer_load_dwordx4 v14,s[8:11],s40 offen nt lds
 s_mov_b32 s40,18432
 s_add_u32 m0,s41,2112
 s_nop 0
 buffer_load_dwordx4 v14,s[8:11],s40 offen nt lds
 s_mov_b32 s40,19456
 s_add_u32 m0,s41,3168
 s_nop 0
 buffer_load_dwordx4 v14,s[8:11],s40 offen nt lds
 v_and_b32 v10,15,v1
 v_mul_u32_u24 v2,1056,v10
 v_and_b32 v10,48,v1
 v_add_u32 v2,v2,v10
 v_lshrrev_b32 v10,2,v1
 v_mul_u32_u24 v3,1056,v10
 v_and_b32 v10,3,v1
 v_lshl_add_u32 v3,v10,3,v3
 v_cmp_eq_u32 vcc,0,v10
 v_mov_b32 v11,0x3f803f80
 s_nop 0
 v_cndmask_b32 v6,0,v11,vcc
 v_cndmask_b32 v7,0,v11,vcc
 v_cndmask_b32 v8,0,v11,vcc
 v_cndmask_b32 v9,0,v11,vcc
 v_and_b32 v4,15,v1
 s_lshl_b32 s40,s33,5
 v_add_lshl_u32 v4,v4,s40,4
 v_lshrrev_b32 v10,4,v1
 v_mul_u32_u24 v10,1792,v10
 v_add_u32 v4,v4,v10
 v_add_u32 v4,135168,v4
 s_mov_b32 s40,256
 s_cmp_eq_u32 s33,3
 s_cselect_b32 s40,65536,s40
 v_add_u32 v5,s40,v4
 s_waitcnt vmcnt(4)
 s_barrier
 v_mov_b32 v10,16880
 v_mov_b32 v11,0
 ds_write_b32 v10,v11
 s_setprio 1
 s_waitcnt lgkmcnt(0)
 s_barrier
 ds_read_b128 v[48:51],v4
 ds_read_b128 v[52:55],v5
 ds_read_b128 v[56:59],v4 offset:7168
 ds_read_b128 v[60:63],v5 offset:7168
 ds_read_b128 v[64:67],v4 offset:14336
 ds_read_b128 v[68:71],v5 offset:14336
 ds_read_b128 v[72:75],v4 offset:21504
 ds_read_b128 v[76:79],v5 offset:21504
 ds_read_b128 v[16:19],v2 offset:16896
 ds_read_b128 v[20:23],v2 offset:16960
 ds_read_b128 v[24:27],v2 offset:17024
 ds_read_b128 v[28:31],v2 offset:17088
 ds_read_b128 v[32:35],v2 offset:17152
 ds_read_b128 v[36:39],v2 offset:17216
 ds_read_b128 v[40:43],v2 offset:17280
 s_waitcnt lgkmcnt(5)
 mf 80,16,48,240
 ds_read_b128 v[44:47],v2 offset:17344
 mf 96,16,52,244
 mf 80,20,56,80
 ds_read_b128 v[16:19],v2 offset:17408
 mf 96,20,60,96
 s_waitcnt lgkmcnt(5)
 mf 80,24,64,80
 ds_read_b128 v[20:23],v2 offset:17472
 mf 96,24,68,96
 mf 80,28,72,80
 ds_read_b128 v[24:27],v2 offset:17536
 mf 96,28,76,96
 s_waitcnt lgkmcnt(5)
 mf 84,32,48,240
 ds_read_b128 v[28:31],v2 offset:17600
 mf 100,32,52,244
 mf 84,36,56,84
 ds_read_b128 v[32:35],v2 offset:17664
 mf 100,36,60,100
 s_waitcnt lgkmcnt(5)
 mf 84,40,64,84
 ds_read_b128 v[36:39],v2 offset:17728
 mf 100,40,68,100
 mf 84,44,72,84
 ds_read_b128 v[40:43],v2 offset:17792
 mf 100,44,76,100
 s_waitcnt lgkmcnt(5)
 mf 88,16,48,240
 ds_read_b128 v[44:47],v2 offset:17856
 mf 104,16,52,244
 mf 88,20,56,88
 mf 104,20,60,104
 s_waitcnt lgkmcnt(4)
 mf 88,24,64,88
 mf 104,24,68,104
 mf 88,28,72,88
 mf 104,28,76,104
 s_waitcnt lgkmcnt(2)
 mf 92,32,48,240
 mf 108,32,52,244
 mf 92,36,56,92
 mf 108,36,60,108
 s_waitcnt lgkmcnt(0)
 mf 92,40,64,92
 mf 108,40,68,108
 mf 92,44,72,92
 mf 108,44,76,108
 v_max3_f32 v10,v80,v81,v82
 v_max3_f32 v11,v96,v97,v98
 v_max3_f32 v10,v10,v83,v84
 v_max3_f32 v11,v11,v99,v100
 v_max3_f32 v10,v10,v85,v86
 v_max3_f32 v11,v11,v101,v102
 v_max3_f32 v10,v10,v87,v88
 v_max3_f32 v11,v11,v103,v104
 v_max3_f32 v10,v10,v89,v90
 s_waitcnt vmcnt(0)
 s_mov_b32 s39,0
 s_barrier
 ds_read_b128 v[16:19],v2
 ds_read_b128 v[20:23],v2 offset:64
 ds_read_b128 v[24:27],v2 offset:128
 ds_read_b128 v[28:31],v2 offset:192
 ds_read_b128 v[32:35],v2 offset:256
 ds_read_b128 v[36:39],v2 offset:320
 ds_read_b128 v[40:43],v2 offset:384
 v_max3_f32 v11,v11,v105,v106
 v_max3_f32 v10,v10,v91,v92
 v_max3_f32 v11,v11,v107,v108
 v_max3_f32 v10,v10,v93,v94
 v_max3_f32 v11,v11,v109,v110
 v_max_f32 v12,v10,v95
 v_max_f32 v13,v11,v111
 v_max_f32_e64 v12,|v12|,|v13|
 v_cmp_nge_f32 vcc,s4,v12
 s_cbranch_vccnz L_resc0first_y
L_ret0first_y:
 s_waitcnt lgkmcnt(5)
 mf 112,16,48,240
 ds_read_b128 v[44:47],v2 offset:448
 mf 128,16,52,244
 mf 112,20,56,112
 ds_read_b128 v[16:19],v2 offset:512
 mf 128,20,60,128
 s_waitcnt lgkmcnt(5)
 mf 112,24,64,112
 ds_read_b128 v[20:23],v2 offset:576
 v_exp_f32 v80,v80
 mf 128,24,68,128
 mf 112,28,72,112
 ds_read_b128 v[24:27],v2 offset:640
 v_exp_f32 v81,v81
 mf 128,28,76,128
 s_waitcnt lgkmcnt(5)
 mf 116,32,48,240
 ds_read_b128 v[28:31],v2 offset:704
 v_exp_f32 v82,v82
 mf 132,32,52,244
 mf 116,36,56,116
 ds_read_b128 v[32:35],v2 offset:768
 v_exp_f32 v83,v83
 mf 132,36,60,132
 s_waitcnt lgkmcnt(5)
 mf 116,40,64,116
 ds_read_b128 v[36:39],v2 offset:832
 v_exp_f32 v84,v84
 mf 132,40,68,132
 mf 116,44,72,116
 ds_read_b128 v[40:43],v2 offset:896
 v_exp_f32 v85,v85
 mf 132,44,76,132
 s_waitcnt lgkmcnt(5)
 mf 120,16,48,240
 ds_read_b128 v[44:47],v2 offset:960
 v_exp_f32 v86,v86
 mf 136,16,52,244
 mf 120,20,56,120
 v_exp_f32 v87,v87
 mf 136,20,60,136
 cv 80,80,81
 s_waitcnt lgkmcnt(4)
 mf 120,24,64,120
 cv 81,82,83
 mf 136,24,68,136
 cv 82,84,85
 mf 120,28,72,120
 cv 83,86,87
 mf 136,28,76,136
 s_waitcnt lgkmcnt(0)
 s_branch L_aloop1_y
L_aloop_y:
 s_barrier
 ds_read_b128 v[16:19],v2
 ds_read_b128 v[20:23],v2 offset:64
 ds_read_b128 v[24:27],v2 offset:128
 mf 160,32,120,160
 ds_read_b128 v[28:31],v2 offset:192
 v_max3_f32 v11,v11,v105,v106
 v_max3_f32 v10,v10,v91,v92
 v_max3_f32 v11,v11,v107,v108
 v_max3_f32 v10,v10,v93,v94
 v_max3_f32 v11,v11,v109,v110
 mf 192,32,136,192
 v_max_f32 v12,v10,v95
 v_max_f32 v13,v11,v111
 v_max_f32_e64 v12,|v12|,|v13|
 v_cmp_nge_f32 vcc,s4,v12
 s_cbranch_vccnz L_resc0_y
L_ret0_y:
 mf 164,36,120,164
 ds_read_b128 v[32:35],v2 offset:256
 v_exp_f32 v80,v80
 v_exp_f32 v81,v81
 mf 196,36,136,196
 v_exp_f32 v82,v82
 v_exp_f32 v83,v83
 mf 168,40,120,168
 ds_read_b128 v[36:39],v2 offset:320
 v_exp_f32 v84,v84
 v_exp_f32 v85,v85
 mf 200,40,136,200
 v_exp_f32 v86,v86
 v_exp_f32 v87,v87
 cv 80,80,81
 mf 172,44,120,172
 ds_read_b128 v[40:43],v2 offset:384
 cv 81,82,83
 cv 82,84,85
 cv 83,86,87
 mf 204,44,136,204
 v_rcp_f32 v10,v248
 v_rcp_f32 v12,v252
 v_mul_f32 v144,v10,v144
 s_waitcnt lgkmcnt(5)
 mf 112,16,48,240
 ds_read_b128 v[44:47],v2 offset:448
 v_mul_f32 v145,v10,v145
 v_mul_f32 v146,v10,v146
 v_mul_f32 v147,v10,v147
 v_mul_f32 v148,v10,v148
 v_mul_f32 v149,v10,v149
 mf 128,16,52,244
 v_mul_f32 v150,v10,v150
 v_mul_f32 v151,v10,v151
 cv 144,144,145
 cv 145,146,147
 cv 146,148,149
 mf 112,20,56,112
 ds_read_b128 v[16:19],v2 offset:512
 cv 147,150,151
 ds_write_b128 v4,v[144:147]
 v_mul_f32 v176,v12,v176
 mf 128,20,60,128
 v_mul_f32 v177,v12,v177
 v_mul_f32 v178,v12,v178
 v_mul_f32 v179,v12,v179
 v_mul_f32 v180,v12,v180
 v_mul_f32 v181,v12,v181
 s_waitcnt lgkmcnt(6)
 mf 112,24,64,112
 ds_read_b128 v[20:23],v2 offset:576
 v_mul_f32 v182,v12,v182
 v_mul_f32 v183,v12,v183
 cv 176,176,177
 cv 177,178,179
 cv 178,180,181
 mf 128,24,68,128
 cv 179,182,183
 ds_write_b128 v5,v[176:179]
 v_mul_f32 v152,v10,v152
 mf 112,28,72,112
 ds_read_b128 v[24:27],v2 offset:640
 v_mul_f32 v153,v10,v153
 v_mul_f32 v154,v10,v154
 v_mul_f32 v155,v10,v155
 v_mul_f32 v156,v10,v156
 v_mul_f32 v157,v10,v157
 mf 128,28,76,128
 v_mul_f32 v158,v10,v158
 v_mul_f32 v159,v10,v159
 cv 152,152,153
 cv 153,154,155
 cv 154,156,157
 s_waitcnt lgkmcnt(7)
 mf 116,32,48,240
 ds_read_b128 v[28:31],v2 offset:704
 cv 155,158,159
 ds_write_b128 v4,v[152:155] offset:7168
 v_mul_f32 v184,v12,v184
 mf 132,32,52,244
 v_mul_f32 v185,v12,v185
 v_mul_f32 v186,v12,v186
 v_mul_f32 v187,v12,v187
 v_mul_f32 v188,v12,v188
 v_mul_f32 v189,v12,v189
 mf 116,36,56,116
 ds_read_b128 v[32:35],v2 offset:768
 v_mul_f32 v190,v12,v190
 v_mul_f32 v191,v12,v191
 cv 184,184,185
 cv 185,186,187
 cv 186,188,189
 mf 132,36,60,132
 cv 187,190,191
 ds_write_b128 v5,v[184:187] offset:7168
 v_mul_f32 v160,v10,v160
 s_waitcnt lgkmcnt(9)
 mf 116,40,64,116
 ds_read_b128 v[36:39],v2 offset:832
 v_mul_f32 v161,v10,v161
 v_mul_f32 v162,v10,v162
 v_mul_f32 v163,v10,v163
 v_mul_f32 v164,v10,v164
 v_mul_f32 v165,v10,v165
 mf 132,40,68,132
 v_mul_f32 v166,v10,v166
 v_mul_f32 v167,v10,v167
 cv 160,160,161
 cv 161,162,163
 cv 162,164,165
 mf 116,44,72,116
 ds_read_b128 v[40:43],v2 offset:896
 cv 163,166,167
 ds_write_b128 v4,v[160:163] offset:14336
 v_mul_f32 v192,v12,v192
 mf 132,44,76,132
 v_mul_f32 v193,v12,v193
 v_mul_f32 v194,v12,v194
 v_mul_f32 v195,v12,v195
 v_mul_f32 v196,v12,v196
 v_mul_f32 v197,v12,v197
 s_waitcnt lgkmcnt(9)
 mf 120,16,48,240
 ds_read_b128 v[44:47],v2 offset:960
 v_mul_f32 v198,v12,v198
 v_mul_f32 v199,v12,v199
 cv 192,192,193
 cv 193,194,195
 cv 194,196,197
 mf 136,16,52,244
 cv 195,198,199
 ds_write_b128 v5,v[192:195] offset:14336
 v_mul_f32 v168,v10,v168
 mf 120,20,56,120
 v_mul_f32 v169,v10,v169
 v_mul_f32 v170,v10,v170
 v_mul_f32 v171,v10,v171
 v_mul_f32 v172,v10,v172
 v_mul_f32 v173,v10,v173
 mf 136,20,60,136
 v_mul_f32 v174,v10,v174
 v_mul_f32 v175,v10,v175
 cv 168,168,169
 cv 169,170,171
 cv 170,172,173
 s_waitcnt lgkmcnt(8)
 mf 120,24,64,120
 cv 171,174,175
 ds_write_b128 v4,v[168:171] offset:21504
 v_mul_f32 v200,v12,v200
 mf 136,24,68,136
 v_mul_f32 v201,v12,v201
 v_mul_f32 v202,v12,v202
 v_mul_f32 v203,v12,v203
 v_mul_f32 v204,v12,v204
 v_mul_f32 v205,v12,v205
 mf 120,28,72,120
 v_mul_f32 v206,v12,v206
 v_mul_f32 v207,v12,v207
 cv 200,200,201
 cv 201,202,203
 cv 202,204,205
 mf 136,28,76,136
 cv 203,206,207
 ds_write_b128 v5,v[200:203] offset:21504
 s_waitcnt lgkmcnt(0)
L_aloop1_y:
 s_barrier
 tr 16,3,33792
 tr 18,3,34048
 tr 20,3,33824
 tr 22,3,34080
 tr 24,3,33856
 tr 26,3,34112
 mf 124,32,48,240
 tr 28,3,33888
 tr 30,3,34144
 v_exp_f32 v96,v96
 mf 140,32,52,244
 v_exp_f32 v97,v97
 mf 124,36,56,124
 tr 32,3,33920
 tr 34,3,34176
 v_exp_f32 v98,v98
 mf 140,36,60,140
 v_exp_f32 v99,v99
 mf 124,40,64,124
 tr 36,3,33952
 tr 38,3,34208
 v_exp_f32 v100,v100
 v_exp_f32 v101,v101
 mf 140,40,68,140
 v_exp_f32 v102,v102
 mf 124,44,72,124
 tr 40,3,33984
 tr 42,3,34240
 v_exp_f32 v103,v103
 cv 96,96,97
 mf 140,44,76,140
 cv 97,98,99
 cv 98,100,101
 cv 99,102,103
 s_waitcnt lgkmcnt(10)
 mz 144,16,80
 tr 44,3,34016
 tr 46,3,34272
 v_exp_f32 v88,v88
 mz 176,16,96
 v_exp_f32 v89,v89
 mz 248,6,80
 v_exp_f32 v90,v90
 mz 148,20,80
 tr 16,3,34304
 tr 18,3,34560
 v_exp_f32 v91,v91
 mz 180,20,96
 v_exp_f32 v92,v92
 mz 252,6,96
 v_exp_f32 v93,v93
 s_waitcnt lgkmcnt(10)
 mz 152,24,80
 tr 20,3,34336
 tr 22,3,34592
 v_exp_f32 v94,v94
 mz 184,24,96
 v_exp_f32 v95,v95
 mz 156,28,80
 tr 24,3,34368
 tr 26,3,34624
 cv 88,88,89
 cv 89,90,91
 mz 188,28,96
 cv 90,92,93
 cv 91,94,95
 s_waitcnt lgkmcnt(10)
 mz 160,32,80
 tr 28,3,34400
 tr 30,3,34656
 v_exp_f32 v104,v104
 mz 192,32,96
 v_exp_f32 v105,v105
 mz 164,36,80
 tr 32,3,34432
 tr 34,3,34688
 v_exp_f32 v106,v106
 mz 196,36,96
 v_exp_f32 v107,v107
 s_waitcnt lgkmcnt(10)
 mz 168,40,80
 tr 36,3,34464
 tr 38,3,34720
 v_exp_f32 v108,v108
 v_exp_f32 v109,v109
 mz 200,40,96
 v_exp_f32 v110,v110
 mz 172,44,80
 tr 40,3,34496
 tr 42,3,34752
 v_exp_f32 v111,v111
 cv 104,104,105
 mz 204,44,96
 cv 105,106,107
 cv 106,108,109
 cv 107,110,111
 s_waitcnt lgkmcnt(10)
 mf 144,16,88,144
 tr 44,3,34528
 tr 46,3,34784
 v_max3_f32 v10,v112,v113,v114
 mf 176,16,104,176
 v_max3_f32 v11,v128,v129,v130
 mf 248,6,88,248
 v_max3_f32 v10,v10,v115,v116
 mf 148,20,88,148
 v_max3_f32 v11,v11,v131,v132
 mf 180,20,104,180
 v_max3_f32 v10,v10,v117,v118
 mf 252,6,104,252
 v_max3_f32 v11,v11,v133,v134
 s_waitcnt lgkmcnt(8)
 mf 152,24,88,152
 v_max3_f32 v10,v10,v119,v120
 mf 184,24,104,184
 mf 156,28,88,156
 v_max3_f32 v11,v11,v135,v136
 mf 188,28,104,188
 s_cmp_lg_u32 s39,1
 s_waitcnt lgkmcnt(0)
 s_cbranch_scc1 L_nokeep_y
 ds_read_b128 v[208:211],v4
 ds_read_b128 v[212:215],v5
 ds_read_b128 v[216:219],v4 offset:7168
 ds_read_b128 v[220:223],v5 offset:7168
 ds_read_b128 v[224:227],v4 offset:14336
 ds_read_b128 v[228:231],v5 offset:14336
 ds_read_b128 v[232:235],v4 offset:21504
 ds_read_b128 v[236:239],v5 offset:21504
 s_waitcnt lgkmcnt(0)
L_nokeep_y:
 s_barrier
 ds_read_b128 v[16:19],v2 offset:16896
 ds_read_b128 v[20:23],v2 offset:16960
 ds_read_b128 v[24:27],v2 offset:17024
 mf 160,32,88,160
 ds_read_b128 v[28:31],v2 offset:17088
 v_max3_f32 v10,v10,v121,v122
 v_max3_f32 v11,v11,v137,v138
 mf 192,32,104,192
 v_max3_f32 v10,v10,v123,v124
 v_max3_f32 v11,v11,v139,v140
 mf 164,36,88,164
 ds_read_b128 v[32:35],v2 offset:17152
 v_max3_f32 v10,v10,v125,v126
 v_max3_f32 v11,v11,v141,v142
 mf 196,36,104,196
 v_max3_f32 v12,v10,v127,v143
 v_max_f32 v12,v12,v11
 mf 168,40,88,168
 ds_read_b128 v[36:39],v2 offset:17216
 v_cmp_nge_f32 vcc,s4,v12
 mf 200,40,104,200
 mf 172,44,88,172
 ds_read_b128 v[40:43],v2 offset:17280
 mf 204,44,104,204
 s_cbranch_vccnz L_resc1_y
L_ret1_y:
 v_exp_f32 v112,v112
 s_waitcnt lgkmcnt(5)
 mf 80,16,48,240
 ds_read_b128 v[44:47],v2 offset:17344
 v_exp_f32 v113,v113
 mf 96,16,52,244
 v_exp_f32 v114,v114
 mf 80,20,56,80
 ds_read_b128 v[16:19],v2 offset:17408
 v_exp_f32 v115,v115
 mf 96,20,60,96
 v_exp_f32 v116,v116
 s_waitcnt lgkmcnt(5)
 mf 80,24,64,80
 ds_read_b128 v[20:23],v2 offset:17472
 v_exp_f32 v117,v117
 mf 96,24,68,96
 v_exp_f32 v118,v118
 mf 80,28,72,80
 ds_read_b128 v[24:27],v2 offset:17536
 v_exp_f32 v119,v119
 cv 112,112,113
 mf 96,28,76,96
 cv 113,114,115
 cv 114,116,117
 cv 115,118,119
 s_waitcnt lgkmcnt(5)
 mf 84,32,48,240
 ds_read_b128 v[28:31],v2 offset:17600
 v_exp_f32 v128,v128
 mf 100,32,52,244
 v_exp_f32 v129,v129
 mf 84,36,56,84
 ds_read_b128 v[32:35],v2 offset:17664
 v_exp_f32 v130,v130
 mf 100,36,60,100
 v_exp_f32 v131,v131
 s_waitcnt lgkmcnt(5)
 mf 84,40,64,84
 ds_read_b128 v[36:39],v2 offset:17728
 v_exp_f32 v132,v132
 mf 100,40,68,100
 v_exp_f32 v133,v133
 mf 84,44,72,84
 ds_read_b128 v[40:43],v2 offset:17792
 v_exp_f32 v134,v134
 mf 100,44,76,100
 v_exp_f32 v135,v135
 cv 128,128,129
 s_waitcnt lgkmcnt(5)
 mf 88,16,48,240
 ds_read_b128 v[44:47],v2 offset:17856
 cv 129,130,131
 cv 130,132,133
 cv 131,134,135
 mf 104,16,52,244
 v_exp_f32 v120,v120
 mf 88,20,56,88
 v_exp_f32 v121,v121
 v_exp_f32 v122,v122
 mf 104,20,60,104
 v_exp_f32 v123,v123
 s_waitcnt lgkmcnt(4)
 mf 88,24,64,88
 v_exp_f32 v124,v124
 v_exp_f32 v125,v125
 mf 104,24,68,104
 v_exp_f32 v126,v126
 mf 88,28,72,88
 v_exp_f32 v127,v127
 cv 120,120,121
 mf 104,28,76,104
 cv 121,122,123
 cv 122,124,125
 cv 123,126,127
 s_waitcnt lgkmcnt(0)
 s_barrier
 tr 16,3,50688
 tr 18,3,50944
 tr 20,3,50720
 tr 22,3,50976
 tr 24,3,50752
 tr 26,3,51008
 mf 92,32,48,240
 tr 28,3,50784
 tr 30,3,51040
 mf 108,32,52,244
 mf 92,36,56,92
 tr 32,3,50816
 tr 34,3,51072
 mf 108,36,60,108
 mf 92,40,64,92
 tr 36,3,50848
 tr 38,3,51104
 mf 108,40,68,108
 mf 92,44,72,92
 tr 40,3,50880
 tr 42,3,51136
 v_exp_f32 v136,v136
 mf 108,44,76,108
 s_waitcnt lgkmcnt(10)
 mf 144,16,112,144
 tr 44,3,50912
 tr 46,3,51168
 v_exp_f32 v137,v137
 mf 176,16,128,176
 mf 248,6,112,248
 v_exp_f32 v138,v138
 mf 148,20,112,148
 tr 16,3,51200
 tr 18,3,51456
 mf 180,20,128,180
 v_exp_f32 v139,v139
 mf 252,6,128,252
 s_waitcnt lgkmcnt(10)
 mf 152,24,112,152
 tr 20,3,51232
 tr 22,3,51488
 v_exp_f32 v140,v140
 mf 184,24,128,184
 mf 156,28,112,156
 tr 24,3,51264
 tr 26,3,51520
 v_exp_f32 v141,v141
 mf 188,28,128,188
 s_waitcnt lgkmcnt(10)
 mf 160,32,112,160
 tr 28,3,51296
 tr 30,3,51552
 v_exp_f32 v142,v142
 mf 192,32,128,192
 mf 164,36,112,164
 tr 32,3,51328
 tr 34,3,51584
 v_exp_f32 v143,v143
 mf 196,36,128,196
 cv 136,136,137
 s_waitcnt lgkmcnt(10)
 mf 168,40,112,168
 tr 36,3,51360
 tr 38,3,51616
 cv 137,138,139
 mf 200,40,128,200
 cv 138,140,141
 mf 172,44,112,172
 tr 40,3,51392
 tr 42,3,51648
 cv 139,142,143
 mf 204,44,128,204
 v_max3_f32 v10,v80,v81,v82
 s_waitcnt lgkmcnt(10)
 mf 144,16,120,144
 tr 44,3,51424
 tr 46,3,51680
 v_max3_f32 v11,v96,v97,v98
 mf 176,16,136,176
 v_max3_f32 v10,v10,v83,v84
 mf 248,6,120,248
 v_max3_f32 v11,v11,v99,v100
 mf 148,20,120,148
 v_max3_f32 v10,v10,v85,v86
 mf 180,20,136,180
 v_max3_f32 v11,v11,v101,v102
 mf 252,6,136,252
 s_waitcnt lgkmcnt(8)
 mf 152,24,120,152
 v_max3_f32 v10,v10,v87,v88
 mf 184,24,136,184
 mf 156,28,120,156
 v_max3_f32 v11,v11,v103,v104
 mf 188,28,136,188
 s_waitcnt lgkmcnt(0)
 s_barrier
 ds_read_b128 v[16:19],v2
 ds_read_b128 v[20:23],v2 offset:64
 ds_read_b128 v[24:27],v2 offset:128
 mf 160,32,120,160
 ds_read_b128 v[28:31],v2 offset:192
 v_max3_f32 v10,v10,v89,v90
 v_max3_f32 v11,v11,v105,v106
 mf 192,32,136,192
 v_max3_f32 v10,v10,v91,v92
 v_max3_f32 v11,v11,v107,v108
 mf 164,36,120,164
 ds_read_b128 v[32:35],v2 offset:256
 v_max3_f32 v10,v10,v93,v94
 v_max3_f32 v11,v11,v109,v110
 mf 196,36,136,196
 v_max3_f32 v12,v10,v95,v111
 v_max_f32 v12,v12,v11
 mf 168,40,120,168
 ds_read_b128 v[36:39],v2 offset:320
 v_cmp_nge_f32 vcc,s4,v12
 mf 200,40,136,200
 mf 172,44,120,172
 ds_read_b128 v[40:43],v2 offset:384
 mf 204,44,136,204
 s_cbranch_vccnz L_resc2_y
L_ret2_y:
 v_exp_f32 v80,v80
 s_waitcnt lgkmcnt(5)
 mf 112,16,48,240
 ds_read_b128 v[44:47],v2 offset:448
 v_exp_f32 v81,v81
 mf 128,16,52,244
 v_exp_f32 v82,v82
 mf 112,20,56,112
 ds_read_b128 v[16:19],v2 offset:512
 v_exp_f32 v83,v83
 mf 128,20,60,128
 v_exp_f32 v84,v84
 s_waitcnt lgkmcnt(5)
 mf 112,24,64,112
 ds_read_b128 v[20:23],v2 offset:576
 v_exp_f32 v85,v85
 mf 128,24,68,128
 v_exp_f32 v86,v86
 mf 112,28,72,112
 ds_read_b128 v[24:27],v2 offset:640
 v_exp_f32 v87,v87
 cv 80,80,81
 mf 128,28,76,128
 cv 81,82,83
 cv 82,84,85
 cv 83,86,87
 s_waitcnt lgkmcnt(5)
 mf 116,32,48,240
 ds_read_b128 v[28:31],v2 offset:704
 v_exp_f32 v96,v96
 mf 132,32,52,244
 v_exp_f32 v97,v97
 mf 116,36,56,116
 ds_read_b128 v[32:35],v2 offset:768
 v_exp_f32 v98,v98
 mf 132,36,60,132
 v_exp_f32 v99,v99
 s_waitcnt lgkmcnt(5)
 mf 116,40,64,116
 ds_read_b128 v[36:39],v2 offset:832
 v_exp_f32 v100,v100
 mf 132,40,68,132
 v_exp_f32 v101,v101
 mf 116,44,72,116
 ds_read_b128 v[40:43],v2 offset:896
 v_exp_f32 v102,v102
 mf 132,44,76,132
 v_exp_f32 v103,v103
 cv 96,96,97
 s_waitcnt lgkmcnt(5)
 mf 120,16,48,240
 ds_read_b128 v[44:47],v2 offset:960
 cv 97,98,99
 cv 98,100,101
 cv 99,102,103
 mf 136,16,52,244
 v_exp_f32 v88,v88
 mf 120,20,56,120
 v_exp_f32 v89,v89
 v_exp_f32 v90,v90
 mf 136,20,60,136
 v_exp_f32 v91,v91
 s_waitcnt lgkmcnt(4)
 mf 120,24,64,120
 v_exp_f32 v92,v92
 v_exp_f32 v93,v93
 mf 136,24,68,136
 v_exp_f32 v94,v94
 mf 120,28,72,120
 v_exp_f32 v95,v95
 cv 88,88,89
 mf 136,28,76,136
 cv 89,90,91
 cv 90,92,93
 cv 91,94,95
 s_waitcnt lgkmcnt(0)
 s_barrier
 tr 16,3,33792
 tr 18,3,34048
 tr 20,3,33824
 tr 22,3,34080
 tr 24,3,33856
 tr 26,3,34112
 mf 124,32,48,240
 tr 28,3,33888
 tr 30,3,34144
 mf 140,32,52,244
 mf 124,36,56,124
 tr 32,3,33920
 tr 34,3,34176
 mf 140,36,60,140
 mf 124,40,64,124
 tr 36,3,33952
 tr 38,3,34208
 mf 140,40,68,140
 mf 124,44,72,124
 tr 40,3,33984
 tr 42,3,34240
 v_exp_f32 v104,v104
 mf 140,44,76,140
 s_waitcnt lgkmcnt(10)
 mf 144,16,80,144
 tr 44,3,34016
 tr 46,3,34272
 v_exp_f32 v105,v105
 mf 176,16,96,176
 mf 248,6,80,248
 v_exp_f32 v106,v106
 mf 148,20,80,148
 tr 16,3,34304
 tr 18,3,34560
 mf 180,20,96,180
 v_exp_f32 v107,v107
 mf 252,6,96,252
 s_waitcnt lgkmcnt(10)
 mf 152,24,80,152
 tr 20,3,34336
 tr 22,3,34592
 v_exp_f32 v108,v108
 mf 184,24,96,184
 mf 156,28,80,156
 tr 24,3,34368
 tr 26,3,34624
 v_exp_f32 v109,v109
 mf 188,28,96,188
 s_waitcnt lgkmcnt(10)
 mf 160,32,80,160
 tr 28,3,34400
 tr 30,3,34656
 v_exp_f32 v110,v110
 mf 192,32,96,192
 mf 164,36,80,164
 tr 32,3,34432
 tr 34,3,34688
 v_exp_f32 v111,v111
 mf 196,36,96,196
 cv 104,104,105
 s_waitcnt lgkmcnt(10)
 mf 168,40,80,168
 tr 36,3,34464
 tr 38,3,34720
 cv 105,106,107
 mf 200,40,96,200
 cv 106,108,109
 mf 172,44,80,172
 tr 40,3,34496
 tr 42,3,34752
 cv 107,110,111
 mf 204,44,96,204
 v_max3_f32 v10,v112,v113,v114
 s_waitcnt lgkmcnt(10)
 mf 144,16,88,144
 tr 44,3,34528
 tr 46,3,34784
 v_max3_f32 v11,v128,v129,v130
 mf 176,16,104,176
 v_max3_f32 v10,v10,v115,v116
 mf 248,6,88,248
 v_max3_f32 v11,v11,v131,v132
 mf 148,20,88,148
 v_max3_f32 v10,v10,v117,v118
 mf 180,20,104,180
 v_max3_f32 v11,v11,v133,v134
 mf 252,6,104,252
 s_waitcnt lgkmcnt(8)
 mf 152,24,88,152
 v_max3_f32 v10,v10,v119,v120
 mf 184,24,104,184
 mf 156,28,88,156
 v_max3_f32 v11,v11,v135,v136
 mf 188,28,104,188
 s_waitcnt lgkmcnt(0)
 s_barrier
 ds_read_b128 v[16:19],v2 offset:16896
 ds_read_b128 v[20:23],v2 offset:16960
 ds_read_b128 v[24:27],v2 offset:17024
 mf 160,32,88,160
 ds_read_b128 v[28:31],v2 offset:17088
 v_max3_f32 v10,v10,v121,v122
 v_max3_f32 v11,v11,v137,v138
 mf 192,32,104,192
 v_max3_f32 v10,v10,v123,v124
 v_max3_f32 v11,v11,v139,v140
 mf 164,36,88,164
 ds_read_b128 v[32:35],v2 offset:17152
 v_max3_f32 v10,v10,v125,v126
 v_max3_f32 v11,v11,v141,v142
 mf 196,36,104,196
 v_max3_f32 v12,v10,v127,v143
 v_max_f32 v12,v12,v11
 mf 168,40,88,168
 ds_read_b128 v[36:39],v2 offset:17216
 v_cmp_nge_f32 vcc,s4,v12
 mf 200,40,104,200
 mf 172,44,88,172
 ds_read_b128 v[40:43],v2 offset:17280
 mf 204,44,104,204
 s_cbranch_vccnz L_resc3_y
L_ret3_y:
 v_exp_f32 v112,v112
 s_waitcnt lgkmcnt(5)
 mf 80,16,48,240
 ds_read_b128 v[44:47],v2 offset:17344
 v_exp_f32 v113,v113
 mf 96,16,52,244
 v_exp_f32 v114,v114
 mf 80,20,56,80
 ds_read_b128 v[16:19],v2 offset:17408
 v_exp_f32 v115,v115
 mf 96,20,60,96
 v_exp_f32 v116,v116
 s_waitcnt lgkmcnt(5)
 mf 80,24,64,80
 ds_read_b128 v[20:23],v2 offset:17472
 v_exp_f32 v117,v117
 mf 96,24,68,96
 v_exp_f32 v118,v118
 mf 80,28,72,80
 ds_read_b128 v[24:27],v2 offset:17536
 v_exp_f32 v119,v119
 cv 112,112,113
 mf 96,28,76,96
 cv 113,114,115
 cv 114,116,117
 cv 115,118,119
 s_waitcnt lgkmcnt(5)
 mf 84,32,48,240
 ds_read_b128 v[28:31],v2 offset:17600
 v_exp_f32 v128,v128
 mf 100,32,52,244
 v_exp_f32 v129,v129
 mf 84,36,56,84
 ds_read_b128 v[32:35],v2 offset:17664
 v_exp_f32 v130,v130
 mf 100,36,60,100
 v_exp_f32 v131,v131
 s_waitcnt lgkmcnt(5)
 mf 84,40,64,84
 ds_read_b128 v[36:39],v2 offset:17728
 v_exp_f32 v132,v132
 mf 100,40,68,100
 v_exp_f32 v133,v133
 mf 84,44,72,84
 ds_read_b128 v[40:43],v2 offset:17792
 v_exp_f32 v134,v134
 mf 100,44,76,100
 v_exp_f32 v135,v135
 cv 128,128,129
 s_waitcnt lgkmcnt(5)
 mf 88,16,48,240
 ds_read_b128 v[44:47],v2 offset:17856
 cv 129,130,131
 cv 130,132,133
 cv 131,134,135
 mf 104,16,52,244
 v_exp_f32 v120,v120
 mf 88,20,56,88
 v_exp_f32 v121,v121
 v_exp_f32 v122,v122
 mf 104,20,60,104
 v_exp_f32 v123,v123
 s_waitcnt lgkmcnt(4)
 mf 88,24,64,88
 v_exp_f32 v124,v124
 v_exp_f32 v125,v125
 mf 104,24,68,104
 v_exp_f32 v126,v126
 mf 88,28,72,88
 v_exp_f32 v127,v127
 cv 120,120,121
 mf 104,28,76,104
 cv 121,122,123
 cv 122,124,125
 cv 123,126,127
 s_waitcnt lgkmcnt(0)
 s_barrier
 tr 16,3,50688
 tr 18,3,50944
 tr 20,3,50720
 tr 22,3,50976
 tr 24,3,50752
 tr 26,3,51008
 mf 92,32,48,240
 tr 28,3,50784
 tr 30,3,51040
 mf 108,32,52,244
 mf 92,36,56,92
 tr 32,3,50816
 tr 34,3,51072
 mf 108,36,60,108
 mf 92,40,64,92
 tr 36,3,50848
 tr 38,3,51104
 mf 108,40,68,108
 mf 92,44,72,92
 tr 40,3,50880
 tr 42,3,51136
 v_exp_f32 v136,v136
 mf 108,44,76,108
 s_waitcnt lgkmcnt(10)
 mf 144,16,112,144
 tr 44,3,50912
 tr 46,3,51168
 v_exp_f32 v137,v137
 mf 176,16,128,176
 mf 248,6,112,248
 v_exp_f32 v138,v138
 mf 148,20,112,148
 tr 16,3,51200
 tr 18,3,51456
 mf 180,20,128,180
 v_exp_f32 v139,v139
 mf 252,6,128,252
 s_waitcnt lgkmcnt(10)
 mf 152,24,112,152
 tr 20,3,51232
 tr 22,3,51488
 v_exp_f32 v140,v140
 mf 184,24,128,184
 mf 156,28,112,156
 tr 24,3,51264
 tr 26,3,51520
 v_exp_f32 v141,v141
 mf 188,28,128,188
 s_waitcnt lgkmcnt(10)
 mf 160,32,112,160
 tr 28,3,51296
 tr 30,3,51552
 v_exp_f32 v142,v142
 mf 192,32,128,192
 mf 164,36,112,164
 tr 32,3,51328
 tr 34,3,51584
 v_exp_f32 v143,v143
 mf 196,36,128,196
 cv 136,136,137
 s_waitcnt lgkmcnt(10)
 mf 168,40,112,168
 tr 36,3,51360
 tr 38,3,51616
 cv 137,138,139
 mf 200,40,128,200
 cv 138,140,141
 mf 172,44,112,172
 tr 40,3,51392
 tr 42,3,51648
 cv 139,142,143
 mf 204,44,128,204
 v_max3_f32 v10,v80,v81,v82
 s_waitcnt lgkmcnt(10)
 mf 144,16,120,144
 tr 44,3,51424
 tr 46,3,51680
 v_max3_f32 v11,v96,v97,v98
 mf 176,16,136,176
 v_max3_f32 v10,v10,v83,v84
 mf 248,6,120,248
 v_max3_f32 v11,v11,v99,v100
 mf 148,20,120,148
 v_max3_f32 v10,v10,v85,v86
 mf 180,20,136,180
 v_max3_f32 v11,v11,v101,v102
 mf 252,6,136,252
 s_waitcnt lgkmcnt(8)
 mf 152,24,120,152
 v_max3_f32 v10,v10,v87,v88
 mf 184,24,136,184
 mf 156,28,120,156
 v_max3_f32 v11,v11,v103,v104
 mf 188,28,136,188
 s_waitcnt lgkmcnt(0)
 s_barrier
 ds_read_b128 v[16:19],v2
 ds_read_b128 v[20:23],v2 offset:64
 ds_read_b128 v[24:27],v2 offset:128
 mf 160,32,120,160
 ds_read_b128 v[28:31],v2 offset:192
 v_max3_f32 v10,v10,v89,v90
 v_max3_f32 v11,v11,v105,v106
 mf 192,32,136,192
 v_max3_f32 v10,v10,v91,v92
 v_max3_f32 v11,v11,v107,v108
 mf 164,36,120,164
 ds_read_b128 v[32:35],v2 offset:256
 v_max3_f32 v10,v10,v93,v94
 v_max3_f32 v11,v11,v109,v110
 mf 196,36,136,196
 v_max3_f32 v12,v10,v95,v111
 v_max_f32 v12,v12,v11
 mf 168,40,120,168
 ds_read_b128 v[36:39],v2 offset:320
 v_cmp_nge_f32 vcc,s4,v12
 mf 200,40,136,200
 mf 172,44,120,172
 ds_read_b128 v[40:43],v2 offset:384
 mf 204,44,136,204
 s_cbranch_vccnz L_resc4_y
L_ret4_y:
 v_exp_f32 v80,v80
 s_waitcnt lgkmcnt(5)
 mf 112,16,48,240
 ds_read_b128 v[44:47],v2 offset:448
 v_exp_f32 v81,v81
 mf 128,16,52,244
 v_exp_f32 v82,v82
 mf 112,20,56,112
 ds_read_b128 v[16:19],v2 offset:512
 v_exp_f32 v83,v83
 mf 128,20,60,128
 v_exp_f32 v84,v84
 s_waitcnt lgkmcnt(5)
 mf 112,24,64,112
 ds_read_b128 v[20:23],v2 offset:576
 v_exp_f32 v85,v85
 mf 128,24,68,128
 v_exp_f32 v86,v86
 mf 112,28,72,112
 ds_read_b128 v[24:27],v2 offset:640
 v_exp_f32 v87,v87
 cv 80,80,81
 mf 128,28,76,128
 cv 81,82,83
 cv 82,84,85
 cv 83,86,87
 s_waitcnt lgkmcnt(5)
 mf 116,32,48,240
 ds_read_b128 v[28:31],v2 offset:704
 v_exp_f32 v96,v96
 mf 132,32,52,244
 v_exp_f32 v97,v97
 mf 116,36,56,116
 ds_read_b128 v[32:35],v2 offset:768
 v_exp_f32 v98,v98
 mf 132,36,60,132
 v_exp_f32 v99,v99
 s_waitcnt lgkmcnt(5)
 mf 116,40,64,116
 ds_read_b128 v[36:39],v2 offset:832
 v_exp_f32 v100,v100
 mf 132,40,68,132
 v_exp_f32 v101,v101
 mf 116,44,72,116
 ds_read_b128 v[40:43],v2 offset:896
 v_exp_f32 v102,v102
 mf 132,44,76,132
 v_exp_f32 v103,v103
 cv 96,96,97
 s_waitcnt lgkmcnt(5)
 mf 120,16,48,240
 ds_read_b128 v[44:47],v2 offset:960
 cv 97,98,99
 cv 98,100,101
 cv 99,102,103
 mf 136,16,52,244
 v_exp_f32 v88,v88
 mf 120,20,56,120
 v_exp_f32 v89,v89
 v_exp_f32 v90,v90
 mf 136,20,60,136
 v_exp_f32 v91,v91
 s_waitcnt lgkmcnt(4)
 mf 120,24,64,120
 v_exp_f32 v92,v92
 v_exp_f32 v93,v93
 mf 136,24,68,136
 v_exp_f32 v94,v94
 mf 120,28,72,120
 v_exp_f32 v95,v95
 cv 88,88,89
 mf 136,28,76,136
 cv 89,90,91
 cv 90,92,93
 cv 91,94,95
 s_waitcnt lgkmcnt(0)
 s_barrier
 tr 16,3,33792
 tr 18,3,34048
 tr 20,3,33824
 tr 22,3,34080
 tr 24,3,33856
 tr 26,3,34112
 mf 124,32,48,240
 tr 28,3,33888
 tr 30,3,34144
 mf 140,32,52,244
 mf 124,36,56,124
 tr 32,3,33920
 tr 34,3,34176
 mf 140,36,60,140
 mf 124,40,64,124
 tr 36,3,33952
 tr 38,3,34208
 mf 140,40,68,140
 mf 124,44,72,124
 tr 40,3,33984
 tr 42,3,34240
 v_exp_f32 v104,v104
 mf 140,44,76,140
 s_waitcnt lgkmcnt(10)
 mf 144,16,80,144
 tr 44,3,34016
 tr 46,3,34272
 v_exp_f32 v105,v105
 mf 176,16,96,176
 mf 248,6,80,248
 v_exp_f32 v106,v106
 mf 148,20,80,148
 tr 16,3,34304
 tr 18,3,34560
 mf 180,20,96,180
 v_exp_f32 v107,v107
 mf 252,6,96,252
 s_waitcnt lgkmcnt(10)
 mf 152,24,80,152
 tr 20,3,34336
 tr 22,3,34592
 v_exp_f32 v108,v108
 mf 184,24,96,184
 mf 156,28,80,156
 tr 24,3,34368
 tr 26,3,34624
 v_exp_f32 v109,v109
 mf 188,28,96,188
 s_waitcnt lgkmcnt(10)
 mf 160,32,80,160
 tr 28,3,34400
 tr 30,3,34656
 v_exp_f32 v110,v110
 mf 192,32,96,192
 mf 164,36,80,164
 tr 32,3,34432
 tr 34,3,34688
 v_exp_f32 v111,v111
 mf 196,36,96,196
 cv 104,104,105
 s_waitcnt lgkmcnt(10)
 mf 168,40,80,168
 tr 36,3,34464
 tr 38,3,34720
 cv 105,106,107
 mf 200,40,96,200
 cv 106,108,109
 mf 172,44,80,172
 tr 40,3,34496
 tr 42,3,34752
 cv 107,110,111
 mf 204,44,96,204
 v_max3_f32 v10,v112,v113,v114
 s_waitcnt lgkmcnt(10)
 mf 144,16,88,144
 tr 44,3,34528
 tr 46,3,34784
 v_max3_f32 v11,v128,v129,v130
 mf 176,16,104,176
 v_max3_f32 v10,v10,v115,v116
 mf 248,6,88,248
 v_max3_f32 v11,v11,v131,v132
 mf 148,20,88,148
 v_max3_f32 v10,v10,v117,v118
 mf 180,20,104,180
 v_max3_f32 v11,v11,v133,v134
 mf 252,6,104,252
 s_waitcnt lgkmcnt(8)
 mf 152,24,88,152
 v_max3_f32 v10,v10,v119,v120
 mf 184,24,104,184
 mf 156,28,88,156
 v_max3_f32 v11,v11,v135,v136
 mf 188,28,104,188
 s_waitcnt lgkmcnt(0)
 s_barrier
 ds_read_b128 v[16:19],v2 offset:16896
 ds_read_b128 v[20:23],v2 offset:16960
 ds_read_b128 v[24:27],v2 offset:17024
 mf 160,32,88,160
 ds_read_b128 v[28:31],v2 offset:17088
 v_max3_f32 v10,v10,v121,v122
 v_max3_f32 v11,v11,v137,v138
 mf 192,32,104,192
 v_max3_f32 v10,v10,v123,v124
 v_max3_f32 v11,v11,v139,v140
 mf 164,36,88,164
 ds_read_b128 v[32:35],v2 offset:17152
 v_max3_f32 v10,v10,v125,v126
 v_max3_f32 v11,v11,v141,v142
 mf 196,36,104,196
 v_max3_f32 v12,v10,v127,v143
 v_max_f32 v12,v12,v11
 mf 168,40,88,168
 ds_read_b128 v[36:39],v2 offset:17216
 v_cmp_nge_f32 vcc,s4,v12
 mf 200,40,104,200
 mf 172,44,88,172
 ds_read_b128 v[40:43],v2 offset:17280
 mf 204,44,104,204
 s_cbranch_vccnz L_resc5_y
L_ret5_y:
 v_exp_f32 v112,v112
 s_waitcnt lgkmcnt(5)
 mf 80,16,48,240
 ds_read_b128 v[44:47],v2 offset:17344
 v_exp_f32 v113,v113
 mf 96,16,52,244
 v_exp_f32 v114,v114
 mf 80,20,56,80
 ds_read_b128 v[16:19],v2 offset:17408
 v_exp_f32 v115,v115
 mf 96,20,60,96
 v_exp_f32 v116,v116
 s_waitcnt lgkmcnt(5)
 mf 80,24,64,80
 ds_read_b128 v[20:23],v2 offset:17472
 v_exp_f32 v117,v117
 mf 96,24,68,96
 v_exp_f32 v118,v118
 mf 80,28,72,80
 ds_read_b128 v[24:27],v2 offset:17536
 v_exp_f32 v119,v119
 cv 112,112,113
 mf 96,28,76,96
 cv 113,114,115
 cv 114,116,117
 cv 115,118,119
 s_waitcnt lgkmcnt(5)
 mf 84,32,48,240
 ds_read_b128 v[28:31],v2 offset:17600
 v_exp_f32 v128,v128
 mf 100,32,52,244
 v_exp_f32 v129,v129
 mf 84,36,56,84
 ds_read_b128 v[32:35],v2 offset:17664
 v_exp_f32 v130,v130
 mf 100,36,60,100
 v_exp_f32 v131,v131
 s_waitcnt lgkmcnt(5)
 mf 84,40,64,84
 ds_read_b128 v[36:39],v2 offset:17728
 v_exp_f32 v132,v132
 mf 100,40,68,100
 v_exp_f32 v133,v133
 mf 84,44,72,84
 ds_read_b128 v[40:43],v2 offset:17792
 v_exp_f32 v134,v134
 mf 100,44,76,100
 v_exp_f32 v135,v135
 cv 128,128,129
 s_waitcnt lgkmcnt(5)
 mf 88,16,48,240
 ds_read_b128 v[44:47],v2 offset:17856
 cv 129,130,131
 cv 130,132,133
 cv 131,134,135
 mf 104,16,52,244
 v_exp_f32 v120,v120
 mf 88,20,56,88
 v_exp_f32 v121,v121
 v_exp_f32 v122,v122
 mf 104,20,60,104
 v_exp_f32 v123,v123
 s_waitcnt lgkmcnt(4)
 mf 88,24,64,88
 v_exp_f32 v124,v124
 v_exp_f32 v125,v125
 mf 104,24,68,104
 v_exp_f32 v126,v126
 mf 88,28,72,88
 v_exp_f32 v127,v127
 cv 120,120,121
 mf 104,28,76,104
 cv 121,122,123
 cv 122,124,125
 cv 123,126,127
 s_waitcnt lgkmcnt(0)
 s_barrier
 tr 16,3,50688
 tr 18,3,50944
 tr 20,3,50720
 tr 22,3,50976
 tr 24,3,50752
 tr 26,3,51008
 mf 92,32,48,240
 tr 28,3,50784
 tr 30,3,51040
 mf 108,32,52,244
 mf 92,36,56,92
 tr 32,3,50816
 tr 34,3,51072
 mf 108,36,60,108
 mf 92,40,64,92
 tr 36,3,50848
 tr 38,3,51104
 mf 108,40,68,108
 mf 92,44,72,92
 tr 40,3,50880
 tr 42,3,51136
 v_exp_f32 v136,v136
 mf 108,44,76,108
 s_waitcnt lgkmcnt(10)
 mf 144,16,112,144
 tr 44,3,50912
 tr 46,3,51168
 v_exp_f32 v137,v137
 mf 176,16,128,176
 mf 248,6,112,248
 v_exp_f32 v138,v138
 mf 148,20,112,148
 tr 16,3,51200
 tr 18,3,51456
 mf 180,20,128,180
 v_exp_f32 v139,v139
 mf 252,6,128,252
 s_waitcnt lgkmcnt(10)
 mf 152,24,112,152
 tr 20,3,51232
 tr 22,3,51488
 v_exp_f32 v140,v140
 mf 184,24,128,184
 mf 156,28,112,156
 tr 24,3,51264
 tr 26,3,51520
 v_exp_f32 v141,v141
 mf 188,28,128,188
 s_waitcnt lgkmcnt(10)
 mf 160,32,112,160
 tr 28,3,51296
 tr 30,3,51552
 v_exp_f32 v142,v142
 mf 192,32,128,192
 mf 164,36,112,164
 tr 32,3,51328
 tr 34,3,51584
 v_exp_f32 v143,v143
 mf 196,36,128,196
 cv 136,136,137
 s_waitcnt lgkmcnt(10)
 mf 168,40,112,168
 tr 36,3,51360
 tr 38,3,51616
 cv 137,138,139
 mf 200,40,128,200
 cv 138,140,141
 mf 172,44,112,172
 tr 40,3,51392
 tr 42,3,51648
 cv 139,142,143
 mf 204,44,128,204
 v_max3_f32 v10,v80,v81,v82
 s_waitcnt lgkmcnt(10)
 mf 144,16,120,144
 tr 44,3,51424
 tr 46,3,51680
 v_max3_f32 v11,v96,v97,v98
 mf 176,16,136,176
 v_max3_f32 v10,v10,v83,v84
 mf 248,6,120,248
 v_max3_f32 v11,v11,v99,v100
 mf 148,20,120,148
 v_max3_f32 v10,v10,v85,v86
 mf 180,20,136,180
 v_max3_f32 v11,v11,v101,v102
 mf 252,6,136,252
 s_waitcnt lgkmcnt(8)
 mf 152,24,120,152
 v_max3_f32 v10,v10,v87,v88
 mf 184,24,136,184
 mf 156,28,120,156
 v_max3_f32 v11,v11,v103,v104
 mf 188,28,136,188
 s_waitcnt lgkmcnt(0)
 s_barrier
 ds_read_b128 v[16:19],v2
 ds_read_b128 v[20:23],v2 offset:64
 ds_read_b128 v[24:27],v2 offset:128
 mf 160,32,120,160
 ds_read_b128 v[28:31],v2 offset:192
 v_max3_f32 v10,v10,v89,v90
 v_max3_f32 v11,v11,v105,v106
 mf 192,32,136,192
 v_max3_f32 v10,v10,v91,v92
 v_max3_f32 v11,v11,v107,v108
 mf 164,36,120,164
 ds_read_b128 v[32:35],v2 offset:256
 v_max3_f32 v10,v10,v93,v94
 v_max3_f32 v11,v11,v109,v110
 mf 196,36,136,196
 v_max3_f32 v12,v10,v95,v111
 v_max_f32 v12,v12,v11
 mf 168,40,120,168
 ds_read_b128 v[36:39],v2 offset:320
 v_cmp_nge_f32 vcc,s4,v12
 mf 200,40,136,200
 mf 172,44,120,172
 ds_read_b128 v[40:43],v2 offset:384
 mf 204,44,136,204
 s_cbranch_vccnz L_resc6_y
L_ret6_y:
 v_exp_f32 v80,v80
 s_waitcnt lgkmcnt(5)
 mf 112,16,48,240
 ds_read_b128 v[44:47],v2 offset:448
 v_exp_f32 v81,v81
 mf 128,16,52,244
 v_exp_f32 v82,v82
 mf 112,20,56,112
 ds_read_b128 v[16:19],v2 offset:512
 v_exp_f32 v83,v83
 mf 128,20,60,128
 v_exp_f32 v84,v84
 s_waitcnt lgkmcnt(5)
 mf 112,24,64,112
 ds_read_b128 v[20:23],v2 offset:576
 v_exp_f32 v85,v85
 mf 128,24,68,128
 v_exp_f32 v86,v86
 mf 112,28,72,112
 ds_read_b128 v[24:27],v2 offset:640
 v_exp_f32 v87,v87
 cv 80,80,81
 mf 128,28,76,128
 cv 81,82,83
 cv 82,84,85
 cv 83,86,87
 s_waitcnt lgkmcnt(5)
 mf 116,32,48,240
 ds_read_b128 v[28:31],v2 offset:704
 v_exp_f32 v96,v96
 mf 132,32,52,244
 v_exp_f32 v97,v97
 mf 116,36,56,116
 ds_read_b128 v[32:35],v2 offset:768
 v_exp_f32 v98,v98
 mf 132,36,60,132
 v_exp_f32 v99,v99
 s_waitcnt lgkmcnt(5)
 mf 116,40,64,116
 ds_read_b128 v[36:39],v2 offset:832
 v_exp_f32 v100,v100
 mf 132,40,68,132
 v_exp_f32 v101,v101
 mf 116,44,72,116
 ds_read_b128 v[40:43],v2 offset:896
 v_exp_f32 v102,v102
 mf 132,44,76,132
 v_exp_f32 v103,v103
 cv 96,96,97
 s_waitcnt lgkmcnt(5)
 mf 120,16,48,240
 ds_read_b128 v[44:47],v2 offset:960
 cv 97,98,99
 cv 98,100,101
 cv 99,102,103
 mf 136,16,52,244
 v_exp_f32 v88,v88
 mf 120,20,56,120
 v_exp_f32 v89,v89
 v_exp_f32 v90,v90
 mf 136,20,60,136
 v_exp_f32 v91,v91
 s_waitcnt lgkmcnt(4)
 mf 120,24,64,120
 v_exp_f32 v92,v92
 v_exp_f32 v93,v93
 mf 136,24,68,136
 v_exp_f32 v94,v94
 mf 120,28,72,120
 v_exp_f32 v95,v95
 cv 88,88,89
 mf 136,28,76,136
 cv 89,90,91
 cv 90,92,93
 cv 91,94,95
 s_waitcnt lgkmcnt(0)
 s_barrier
 tr 16,3,33792
 tr 18,3,34048
 tr 20,3,33824
 tr 22,3,34080
 tr 24,3,33856
 tr 26,3,34112
 mf 124,32,48,240
 tr 28,3,33888
 tr 30,3,34144
 v_exp_f32 v104,v104
 mf 140,32,52,244
 v_exp_f32 v105,v105
 mf 124,36,56,124
 tr 32,3,33920
 tr 34,3,34176
 v_exp_f32 v106,v106
 mf 140,36,60,140
 v_exp_f32 v107,v107
 mf 124,40,64,124
 tr 36,3,33952
 tr 38,3,34208
 v_exp_f32 v108,v108
 mf 140,40,68,140
 v_exp_f32 v109,v109
 mf 124,44,72,124
 tr 40,3,33984
 tr 42,3,34240
 v_exp_f32 v110,v110
 mf 140,44,76,140
 v_exp_f32 v111,v111
 s_waitcnt lgkmcnt(10)
 mf 144,16,80,144
 tr 44,3,34016
 tr 46,3,34272
 cv 104,104,105
 mf 176,16,96,176
 cv 105,106,107
 mf 248,6,80,248
 cv 106,108,109
 mf 148,20,80,148
 tr 16,3,34304
 tr 18,3,34560
 cv 107,110,111
 mf 180,20,96,180
 v_max3_f32 v10,v112,v113,v114
 mf 252,6,96,252
 v_max3_f32 v11,v128,v129,v130
 s_waitcnt lgkmcnt(10)
 mf 152,24,80,152
 tr 20,3,34336
 tr 22,3,34592
 v_max3_f32 v10,v10,v115,v116
 mf 184,24,96,184
 v_max3_f32 v11,v11,v131,v132
 mf 156,28,80,156
 tr 24,3,34368
 tr 26,3,34624
 v_max3_f32 v10,v10,v117,v118
 mf 188,28,96,188
 v_max3_f32 v11,v11,v133,v134
 s_waitcnt lgkmcnt(10)
 mf 160,32,80,160
 tr 28,3,34400
 tr 30,3,34656
 v_max3_f32 v10,v10,v119,v120
 mf 192,32,96,192
 v_max3_f32 v11,v11,v135,v136
 mf 164,36,80,164
 tr 32,3,34432
 tr 34,3,34688
 ds_read_b128 v[48:51],v4
 mf 196,36,96,196
 s_waitcnt lgkmcnt(11)
 mf 168,40,80,168
 tr 36,3,34464
 tr 38,3,34720
 ds_read_b128 v[52:55],v5
 mf 200,40,96,200
 mf 172,44,80,172
 tr 40,3,34496
 tr 42,3,34752
 ds_read_b128 v[56:59],v4 offset:7168
 mf 204,44,96,204
 s_waitcnt lgkmcnt(13)
 mf 144,16,88,144
 tr 44,3,34528
 tr 46,3,34784
 ds_read_b128 v[60:63],v5 offset:7168
 mf 176,16,104,176
 mf 248,6,88,248
 ds_read_b128 v[64:67],v4 offset:14336
 mf 148,20,88,148
 mf 180,20,104,180
 ds_read_b128 v[68:71],v5 offset:14336
 mf 252,6,104,252
 s_waitcnt lgkmcnt(14)
 mf 152,24,88,152
 ds_read_b128 v[72:75],v4 offset:21504
 mf 184,24,104,184
 mf 156,28,88,156
 ds_read_b128 v[76:79],v5 offset:21504
 mf 188,28,104,188
 s_cmp_eq_u32 s39,3
 s_waitcnt lgkmcnt(0)
 s_cbranch_scc1 L_alast_y
 s_barrier
 ds_read_b128 v[16:19],v2 offset:16896
 ds_read_b128 v[20:23],v2 offset:16960
 ds_read_b128 v[24:27],v2 offset:17024
 mf 160,32,88,160
 ds_read_b128 v[28:31],v2 offset:17088
 v_max3_f32 v10,v10,v121,v122
 v_max3_f32 v11,v11,v137,v138
 mf 192,32,104,192
 v_max3_f32 v10,v10,v123,v124
 v_max3_f32 v11,v11,v139,v140
 mf 164,36,88,164
 ds_read_b128 v[32:35],v2 offset:17152
 v_max3_f32 v10,v10,v125,v126
 v_max3_f32 v11,v11,v141,v142
 mf 196,36,104,196
 v_max3_f32 v12,v10,v127,v143
 v_max_f32 v12,v12,v11
 mf 168,40,88,168
 ds_read_b128 v[36:39],v2 offset:17216
 v_cmp_nge_f32 vcc,s4,v12
 mf 200,40,104,200
 mf 172,44,88,172
 ds_read_b128 v[40:43],v2 offset:17280
 mf 204,44,104,204
 s_cbranch_vccnz L_resc7_y
L_ret7_y:
 v_exp_f32 v112,v112
 s_waitcnt lgkmcnt(5)
 mf 80,16,48,240
 ds_read_b128 v[44:47],v2 offset:17344
 v_exp_f32 v113,v113
 mf 96,16,52,244
 v_exp_f32 v114,v114
 mf 80,20,56,80
 ds_read_b128 v[16:19],v2 offset:17408
 v_exp_f32 v115,v115
 mf 96,20,60,96
 v_exp_f32 v116,v116
 s_waitcnt lgkmcnt(5)
 mf 80,24,64,80
 ds_read_b128 v[20:23],v2 offset:17472
 v_exp_f32 v117,v117
 mf 96,24,68,96
 v_exp_f32 v118,v118
 mf 80,28,72,80
 ds_read_b128 v[24:27],v2 offset:17536
 v_exp_f32 v119,v119
 cv 112,112,113
 mf 96,28,76,96
 cv 113,114,115
 cv 114,116,117
 cv 115,118,119
 s_waitcnt lgkmcnt(5)
 mf 84,32,48,240
 ds_read_b128 v[28:31],v2 offset:17600
 v_exp_f32 v128,v128
 mf 100,32,52,244
 v_exp_f32 v129,v129
 mf 84,36,56,84
 ds_read_b128 v[32:35],v2 offset:17664
 v_exp_f32 v130,v130
 mf 100,36,60,100
 v_exp_f32 v131,v131
 s_waitcnt lgkmcnt(5)
 mf 84,40,64,84
 ds_read_b128 v[36:39],v2 offset:17728
 v_exp_f32 v132,v132
 mf 100,40,68,100
 v_exp_f32 v133,v133
 mf 84,44,72,84
 ds_read_b128 v[40:43],v2 offset:17792
 v_exp_f32 v134,v134
 mf 100,44,76,100
 v_exp_f32 v135,v135
 cv 128,128,129
 s_waitcnt lgkmcnt(5)
 mf 88,16,48,240
 ds_read_b128 v[44:47],v2 offset:17856
 cv 129,130,131
 cv 130,132,133
 cv 131,134,135
 mf 104,16,52,244
 v_exp_f32 v120,v120
 mf 88,20,56,88
 v_exp_f32 v121,v121
 v_exp_f32 v122,v122
 mf 104,20,60,104
 v_exp_f32 v123,v123
 s_waitcnt lgkmcnt(4)
 mf 88,24,64,88
 v_exp_f32 v124,v124
 v_exp_f32 v125,v125
 mf 104,24,68,104
 v_exp_f32 v126,v126
 mf 88,28,72,88
 v_exp_f32 v127,v127
 cv 120,120,121
 mf 104,28,76,104
 cv 121,122,123
 cv 122,124,125
 cv 123,126,127
 s_waitcnt lgkmcnt(0)
 s_barrier
 tr 16,3,50688
 tr 18,3,50944
 tr 20,3,50720
 tr 22,3,50976
 tr 24,3,50752
 tr 26,3,51008
 mf 92,32,48,240
 tr 28,3,50784
 tr 30,3,51040
 mf 108,32,52,244
 mf 92,36,56,92
 tr 32,3,50816
 tr 34,3,51072
 mf 108,36,60,108
 mf 92,40,64,92
 tr 36,3,50848
 tr 38,3,51104
 mf 108,40,68,108
 mf 92,44,72,92
 tr 40,3,50880
 tr 42,3,51136
 v_exp_f32 v136,v136
 mf 108,44,76,108
 s_waitcnt lgkmcnt(10)
 mf 144,16,112,144
 tr 44,3,50912
 tr 46,3,51168
 v_exp_f32 v137,v137
 mf 176,16,128,176
 mf 248,6,112,248
 v_exp_f32 v138,v138
 mf 148,20,112,148
 tr 16,3,51200
 tr 18,3,51456
 mf 180,20,128,180
 v_exp_f32 v139,v139
 mf 252,6,128,252
 s_waitcnt lgkmcnt(10)
 mf 152,24,112,152
 tr 20,3,51232
 tr 22,3,51488
 v_exp_f32 v140,v140
 mf 184,24,128,184
 mf 156,28,112,156
 tr 24,3,51264
 tr 26,3,51520
 v_exp_f32 v141,v141
 mf 188,28,128,188
 s_waitcnt lgkmcnt(10)
 mf 160,32,112,160
 tr 28,3,51296
 tr 30,3,51552
 v_exp_f32 v142,v142
 mf 192,32,128,192
 mf 164,36,112,164
 tr 32,3,51328
 tr 34,3,51584
 v_exp_f32 v143,v143
 mf 196,36,128,196
 cv 136,136,137
 s_waitcnt lgkmcnt(10)
 mf 168,40,112,168
 tr 36,3,51360
 tr 38,3,51616
 cv 137,138,139
 mf 200,40,128,200
 cv 138,140,141
 mf 172,44,112,172
 tr 40,3,51392
 tr 42,3,51648
 cv 139,142,143
 mf 204,44,128,204
 v_max3_f32 v10,v80,v81,v82
 s_waitcnt lgkmcnt(10)
 mf 144,16,120,144
 tr 44,3,51424
 tr 46,3,51680
 v_max3_f32 v11,v96,v97,v98
 mf 176,16,136,176
 v_max3_f32 v10,v10,v83,v84
 mf 248,6,120,248
 v_max3_f32 v11,v11,v99,v100
 mf 148,20,120,148
 v_max3_f32 v10,v10,v85,v86
 mf 180,20,136,180
 v_max3_f32 v11,v11,v101,v102
 mf 252,6,136,252
 v_max3_f32 v10,v10,v87,v88
 s_waitcnt lgkmcnt(8)
 mf 152,24,120,152
 v_max3_f32 v11,v11,v103,v104
 mf 184,24,136,184
 mf 156,28,120,156
 v_max3_f32 v10,v10,v89,v90
 mf 188,28,136,188
 s_add_u32 s39,s39,1
 s_waitcnt lgkmcnt(0)
 s_branch L_aloop_y
L_alast_y:
 s_barrier
 tr 16,3,50688
 tr 18,3,50944
 tr 20,3,50720
 tr 22,3,50976
 tr 24,3,50752
 tr 26,3,51008
 mf 160,32,88,160
 tr 28,3,50784
 tr 30,3,51040
 v_max3_f32 v10,v10,v121,v122
 v_max3_f32 v11,v11,v137,v138
 v_max3_f32 v10,v10,v123,v124
 v_max3_f32 v11,v11,v139,v140
 v_max3_f32 v10,v10,v125,v126
 v_max3_f32 v11,v11,v141,v142
 mf 192,32,104,192
 v_max3_f32 v12,v10,v127,v143
 v_max_f32 v12,v12,v11
 v_cmp_nge_f32 vcc,s4,v12
 mf 164,36,88,164
 tr 32,3,50816
 tr 34,3,51072
 mf 196,36,104,196
 mf 168,40,88,168
 tr 36,3,50848
 tr 38,3,51104
 mf 200,40,104,200
 mf 172,44,88,172
 tr 40,3,50880
 tr 42,3,51136
 mf 204,44,104,204
 s_cbranch_vccnz L_resc7last_y
L_ret7last_y:
 v_exp_f32 v112,v112
 v_exp_f32 v113,v113
 v_exp_f32 v114,v114
 v_exp_f32 v115,v115
 v_exp_f32 v116,v116
 v_exp_f32 v117,v117
 v_exp_f32 v118,v118
 v_exp_f32 v119,v119
 cv 112,112,113
 cv 113,114,115
 cv 114,116,117
 cv 115,118,119
 v_exp_f32 v128,v128
 v_exp_f32 v129,v129
 v_exp_f32 v130,v130
 v_exp_f32 v131,v131
 v_exp_f32 v132,v132
 v_exp_f32 v133,v133
 v_exp_f32 v134,v134
 v_exp_f32 v135,v135
 cv 128,128,129
 cv 129,130,131
 cv 130,132,133
 cv 131,134,135
 s_waitcnt lgkmcnt(10)
 mf 144,16,112,144
 tr 44,3,50912
 tr 46,3,51168
 v_exp_f32 v120,v120
 mf 176,16,128,176
 v_exp_f32 v121,v121
 mf 248,6,112,248
 v_exp_f32 v122,v122
 mf 148,20,112,148
 tr 16,3,51200
 tr 18,3,51456
 v_exp_f32 v123,v123
 mf 180,20,128,180
 v_exp_f32 v124,v124
 mf 252,6,128,252
 v_exp_f32 v125,v125
 s_waitcnt lgkmcnt(10)
 mf 152,24,112,152
 tr 20,3,51232
 tr 22,3,51488
 v_exp_f32 v126,v126
 mf 184,24,128,184
 v_exp_f32 v127,v127
 mf 156,28,112,156
 tr 24,3,51264
 tr 26,3,51520
 cv 120,120,121
 cv 121,122,123
 mf 188,28,128,188
 cv 122,124,125
 cv 123,126,127
 s_waitcnt lgkmcnt(10)
 mf 160,32,112,160
 tr 28,3,51296
 tr 30,3,51552
 v_exp_f32 v136,v136
 mf 192,32,128,192
 v_exp_f32 v137,v137
 mf 164,36,112,164
 tr 32,3,51328
 tr 34,3,51584
 v_exp_f32 v138,v138
 mf 196,36,128,196
 v_exp_f32 v139,v139
 s_waitcnt lgkmcnt(10)
 mf 168,40,112,168
 tr 36,3,51360
 tr 38,3,51616
 v_exp_f32 v140,v140
 v_exp_f32 v141,v141
 mf 200,40,128,200
 v_exp_f32 v142,v142
 mf 172,44,112,172
 tr 40,3,51392
 tr 42,3,51648
 v_exp_f32 v143,v143
 cv 136,136,137
 mf 204,44,128,204
 cv 137,138,139
 cv 138,140,141
 cv 139,142,143
 s_waitcnt lgkmcnt(10)
 mf 144,16,120,144
 tr 44,3,51424
 tr 46,3,51680
 mf 176,16,136,176
 mf 248,6,120,248
 mf 148,20,120,148
 mf 180,20,136,180
 mf 252,6,136,252
 s_waitcnt lgkmcnt(8)
 mf 152,24,120,152
 mf 184,24,136,184
 mf 156,28,120,156
 mf 188,28,136,188
 s_lshl_b32 s42,s54,2
 v_mov_b32 v9,0
 buffer_load_dword v9,v9,s[64:67],s42 offen sc1
 s_waitcnt lgkmcnt(0)
 s_barrier
 mf 160,32,120,160
 ds_read_b128 v[80:83],v4
 ds_read_b128 v[84:87],v5
 ds_read_b128 v[88:91],v4 offset:7168
 ds_read_b128 v[92:95],v5 offset:7168
 ds_read_b128 v[96:99],v4 offset:14336
 ds_read_b128 v[100:103],v5 offset:14336
 ds_read_b128 v[104:107],v4 offset:21504
 ds_read_b128 v[108:111],v5 offset:21504
 v_mbcnt_lo_u32_b32 v13,-1,0
 v_mbcnt_hi_u32_b32 v13,-1,v13
 v_bfe_u32 v11,v13,3,2
 mf 192,32,136,192
 v_mul_u32_u24 v2,1056,v11
 v_lshrrev_b32 v11,5,v13
 v_lshl_add_u32 v2,v11,8,v2
 v_bfe_u32 v11,v13,2,1
 v_lshl_add_u32 v2,v11,7,v2
 v_and_b32 v11,3,v13
 v_lshl_add_u32 v2,v11,3,v2
 mf 164,36,120,164
 mf 196,36,136,196
 mf 168,40,120,168
 mf 200,40,136,200
 mf 172,44,120,172
 mf 204,44,136,204
 v_rcp_f32 v10,v248
 v_rcp_f32 v12,v252
 v_mul_f32 v144,v10,v144
 v_mul_f32 v145,v10,v145
 v_mul_f32 v146,v10,v146
 v_mul_f32 v147,v10,v147
 v_mul_f32 v148,v10,v148
 v_mul_f32 v149,v10,v149
 v_mul_f32 v150,v10,v150
 v_mul_f32 v151,v10,v151
 cv 144,144,145
 cv 145,146,147
 cv 146,148,149
 cv 147,150,151
 ds_write_b128 v4,v[144:147]
 v_mul_f32 v176,v12,v176
 v_mul_f32 v177,v12,v177
 v_mul_f32 v178,v12,v178
 v_mul_f32 v179,v12,v179
 v_mul_f32 v180,v12,v180
 v_mul_f32 v181,v12,v181
 v_mul_f32 v182,v12,v182
 v_mul_f32 v183,v12,v183
 cv 176,176,177
 cv 177,178,179
 cv 178,180,181
 cv 179,182,183
 ds_write_b128 v5,v[176:179]
 v_mul_f32 v152,v10,v152
 v_mul_f32 v153,v10,v153
 v_mul_f32 v154,v10,v154
 v_mul_f32 v155,v10,v155
 v_mul_f32 v156,v10,v156
 v_mul_f32 v157,v10,v157
 v_mul_f32 v158,v10,v158
 v_mul_f32 v159,v10,v159
 cv 152,152,153
 cv 153,154,155
 cv 154,156,157
 cv 155,158,159
 ds_write_b128 v4,v[152:155] offset:7168
 v_mul_f32 v184,v12,v184
 v_mul_f32 v185,v12,v185
 v_mul_f32 v186,v12,v186
 v_mul_f32 v187,v12,v187
 v_mul_f32 v188,v12,v188
 v_mul_f32 v189,v12,v189
 v_mul_f32 v190,v12,v190
 v_mul_f32 v191,v12,v191
 cv 184,184,185
 cv 185,186,187
 cv 186,188,189
 cv 187,190,191
 ds_write_b128 v5,v[184:187] offset:7168
 v_mul_f32 v160,v10,v160
 v_mul_f32 v161,v10,v161
 v_mul_f32 v162,v10,v162
 v_mul_f32 v163,v10,v163
 v_mul_f32 v164,v10,v164
 v_mul_f32 v165,v10,v165
 v_mul_f32 v166,v10,v166
 v_mul_f32 v167,v10,v167
 cv 160,160,161
 cv 161,162,163
 cv 162,164,165
 cv 163,166,167
 ds_write_b128 v4,v[160:163] offset:14336
 v_mul_f32 v192,v12,v192
 v_mul_f32 v193,v12,v193
 v_mul_f32 v194,v12,v194
 v_mul_f32 v195,v12,v195
 v_mul_f32 v196,v12,v196
 v_mul_f32 v197,v12,v197
 v_mul_f32 v198,v12,v198
 v_mul_f32 v199,v12,v199
 cv 192,192,193
 cv 193,194,195
 cv 194,196,197
 cv 195,198,199
 ds_write_b128 v5,v[192:195] offset:14336
 v_mul_f32 v168,v10,v168
 v_mul_f32 v169,v10,v169
 v_mul_f32 v170,v10,v170
 v_mul_f32 v171,v10,v171
 v_mul_f32 v172,v10,v172
 v_mul_f32 v173,v10,v173
 v_mul_f32 v174,v10,v174
 v_mul_f32 v175,v10,v175
 cv 168,168,169
 cv 169,170,171
 cv 170,172,173
 cv 171,174,175
 ds_write_b128 v4,v[168:171] offset:21504
 v_mul_f32 v200,v12,v200
 v_mul_f32 v201,v12,v201
 v_mul_f32 v202,v12,v202
 v_mul_f32 v203,v12,v203
 v_mul_f32 v204,v12,v204
 v_mul_f32 v205,v12,v205
 v_mul_f32 v206,v12,v206
 v_mul_f32 v207,v12,v207
 cv 200,200,201
 cv 201,202,203
 cv 202,204,205
 cv 203,206,207
 ds_write_b128 v5,v[200:203] offset:21504
 s_setprio 0
 s_waitcnt lgkmcnt(0)
 s_barrier
 ds_read_b64_tr_b16 v[16:17],v2
 tr 18,2,512
 tr 20,2,32
 tr 22,2,544
 tr 24,2,64
 tr 26,2,576
 tr 28,2,96
 tr 30,2,608
 tr 148,2,4224
 tr 150,2,4736
 tr 156,2,4256
 tr 158,2,4768
 tr 164,2,4288
 tr 166,2,4800
 s_waitcnt lgkmcnt(10)
 mz 112,16,208
 tr 172,2,4320
 tr 174,2,4832
 mz 128,16,212
 mz 116,20,208
 tr 16,2,8448
 tr 18,2,8960
 mz 132,20,212
 s_waitcnt lgkmcnt(10)
 mz 120,24,208
 tr 20,2,8480
 tr 22,2,8992
 mz 136,24,212
 mz 124,28,208
 tr 24,2,8512
 tr 26,2,9024
 mz 140,28,212
 s_waitcnt lgkmcnt(10)
 mf 112,148,216,112
 tr 28,2,8544
 tr 30,2,9056
 mf 128,148,220,128
 mf 116,156,216,116
 tr 148,2,12672
 tr 150,2,13184
 mf 132,156,220,132
 s_waitcnt lgkmcnt(10)
 mf 120,164,216,120
 tr 156,2,12704
 tr 158,2,13216
 mf 136,164,220,136
 mf 124,172,216,124
 tr 164,2,12736
 tr 166,2,13248
 mf 140,172,220,140
 s_waitcnt lgkmcnt(10)
 mf 112,16,224,112
 tr 172,2,12768
 tr 174,2,13280
 mf 128,16,228,128
 mf 116,20,224,116
 mf 132,20,228,132
 s_waitcnt lgkmcnt(8)
 mf 120,24,224,120
 mf 136,24,228,136
 mf 124,28,224,124
 mf 140,28,228,140
 s_waitcnt vmcnt(0)
 s_waitcnt lgkmcnt(0)
L_rdy_y:
 v_readfirstlane_b32 s55,v9
 s_add_u32 s100,s100,1
 s_cmp_gt_u32 s100,0x40000
 s_cbranch_scc1 L_rdyok_y
 s_cmp_ge_u32 s55,8
 s_cbranch_scc1 L_rdyok_y
 v_mov_b32 v9,0
 buffer_load_dword v9,v9,s[64:67],s42 offen sc1
 s_waitcnt vmcnt(0)
 s_branch L_rdy_y
L_rdyok_y:
 s_barrier
 tr 16,2,16896
 tr 18,2,17408
 tr 20,2,16928
 tr 22,2,17440
 tr 24,2,16960
 tr 26,2,17472
 mf 112,148,232,112
 tr 28,2,16992
 tr 30,2,17504
 mf 128,148,236,128
 mf 116,156,232,116
 tr 148,2,21120
 tr 150,2,21632
 mf 132,156,236,132
 mf 120,164,232,120
 tr 156,2,21152
 tr 158,2,21664
 mf 136,164,236,136
 mf 124,172,232,124
 tr 164,2,21184
 tr 166,2,21696
 mf 140,172,236,140
 s_waitcnt lgkmcnt(10)
 mf 112,16,48,112
 tr 172,2,21216
 tr 174,2,21728
 mf 128,16,52,128
 mf 116,20,48,116
 tr 16,2,25344
 tr 18,2,25856
 mf 132,20,52,132
 s_waitcnt lgkmcnt(10)
 mf 120,24,48,120
 tr 20,2,25376
 tr 22,2,25888
 v_mbcnt_lo_u32_b32 v10,-1,0
 mf 136,24,52,136
 mf 124,28,48,124
 tr 24,2,25408
 tr 26,2,25920
 v_mbcnt_hi_u32_b32 v10,-1,v10
 mf 140,28,52,140
 s_lshl_b32 s47,s37,2
 s_add_u32 s47,s47,s33
 s_lshl_b32 s47,s47,2
 s_waitcnt lgkmcnt(10)
 mf 112,148,56,112
 tr 28,2,25440
 tr 30,2,25952
 v_cmp_eq_u32 vcc,0,v10
 mf 128,148,60,128
 mf 116,156,56,116
 tr 148,2,29568
 tr 150,2,30080
 v_mov_b32 v10,s47
 mf 132,156,60,132
 s_waitcnt lgkmcnt(10)
 mf 120,164,56,120
 tr 156,2,29600
 tr 158,2,30112
 v_mov_b32 v7,0x40000000
 mf 136,164,60,136
 mf 124,172,56,124
 tr 164,2,29632
 tr 166,2,30144
 v_cndmask_b32 v7,v7,v10,vcc
 mf 140,172,60,140
 s_lshl_b32 s40,s33,12
 s_waitcnt lgkmcnt(10)
 mf 112,16,64,112
 tr 172,2,29664
 tr 174,2,30176
 v_lshlrev_b32 v3,4,v13
 mf 128,16,68,128
 mf 116,20,64,116
 v_add_u32 v3,s40,v3
 mf 132,20,68,132
 s_mov_b32 s40,0
 s_cmp_eq_u32 s33,3
 s_cselect_b32 s40,0x40000000,s40
 s_waitcnt lgkmcnt(8)
 mf 120,24,64,120
 v_add_u32 v6,s40,v3
 mf 136,24,68,136
 mf 124,28,64,124
 v_add_u32 v8,67584,v2
 mf 140,28,68,140
 s_waitcnt lgkmcnt(0)
 s_barrier
 tr 16,2,33792
 tr 18,2,34304
 tr 20,2,33824
 tr 22,2,34336
 tr 24,2,33856
 tr 26,2,34368
 mf 112,148,72,112
 tr 28,2,33888
 tr 30,2,34400
 mf 128,148,76,128
 mf 116,156,72,116
 tr 148,2,38016
 tr 150,2,38528
 mf 132,156,76,132
 mf 120,164,72,120
 tr 156,2,38048
 tr 158,2,38560
 mf 136,164,76,136
 mf 124,172,72,124
 tr 164,2,38080
 tr 166,2,38592
 mf 140,172,76,140
 s_waitcnt lgkmcnt(10)
 mf 112,16,80,112
 tr 172,2,38112
 tr 174,2,38624
 mf 128,16,84,128
 mf 116,20,80,116
 tr 16,2,42240
 tr 18,2,42752
 mf 132,20,84,132
 s_waitcnt lgkmcnt(10)
 mf 120,24,80,120
 tr 20,2,42272
 tr 22,2,42784
 mf 136,24,84,136
 mf 124,28,80,124
 tr 24,2,42304
 tr 26,2,42816
 mf 140,28,84,140
 s_waitcnt lgkmcnt(10)
 mf 112,148,88,112
 tr 28,2,42336
 tr 30,2,42848
 mf 128,148,92,128
 mf 116,156,88,116
 tr 148,2,46464
 tr 150,2,46976
 mf 132,156,92,132
 s_waitcnt lgkmcnt(10)
 mf 120,164,88,120
 tr 156,2,46496
 tr 158,2,47008
 mf 136,164,92,136
 mf 124,172,88,124
 tr 164,2,46528
 tr 166,2,47040
 mf 140,172,92,140
 s_waitcnt lgkmcnt(10)
 mf 112,16,96,112
 tr 172,2,46560
 tr 174,2,47072
 mf 128,16,100,128
 mf 116,20,96,116
 mf 132,20,100,132
 s_waitcnt lgkmcnt(8)
 mf 120,24,96,120
 mf 136,24,100,136
 mf 124,28,96,124
 mf 140,28,100,140
 s_waitcnt lgkmcnt(0)
 s_barrier
 tr 16,2,50688
 tr 18,2,51200
 tr 20,2,50720
 tr 22,2,51232
 tr 24,2,50752
 tr 26,2,51264
 mf 112,148,104,112
 tr 28,2,50784
 tr 30,2,51296
 mf 128,148,108,128
 mf 116,156,104,116
 tr 148,2,54912
 tr 150,2,55424
 mf 132,156,108,132
 mf 120,164,104,120
 tr 156,2,54944
 tr 158,2,55456
 mf 136,164,108,136
 mf 124,172,104,124
 tr 164,2,54976
 tr 166,2,55488
 mf 140,172,108,140
 s_waitcnt lgkmcnt(10)
 mf 112,16,144,112
 tr 172,2,55008
 tr 174,2,55520
 mf 128,16,176,128
 mf 116,20,144,116
 tr 16,2,59136
 tr 18,2,59648
 mf 132,20,176,132
 s_waitcnt lgkmcnt(10)
 mf 120,24,144,120
 tr 20,2,59168
 tr 22,2,59680
 mf 136,24,176,136
 mf 124,28,144,124
 tr 24,2,59200
 tr 26,2,59712
 mf 140,28,176,140
 s_waitcnt lgkmcnt(10)
 mf 112,148,152,112
 tr 28,2,59232
 tr 30,2,59744
 mf 128,148,184,128
 mf 116,156,152,116
 tr 148,2,63360
 tr 150,2,63872
 mf 132,156,184,132
 s_waitcnt lgkmcnt(10)
 mf 120,164,152,120
 tr 156,2,63392
 tr 158,2,63904
 mf 136,164,184,136
 mf 124,172,152,124
 tr 164,2,63424
 tr 166,2,63936
 mf 140,172,184,140
 s_waitcnt lgkmcnt(10)
 mf 112,16,160,112
 tr 172,2,63456
 tr 174,2,63968
 mf 128,16,192,128
 mf 116,20,160,116
 mf 132,20,192,132
 s_waitcnt lgkmcnt(8)
 mf 120,24,160,120
 mf 136,24,192,136
 mf 124,28,160,124
 mf 140,28,192,140
 s_waitcnt lgkmcnt(0)
 s_barrier
 ds_read_b64_tr_b16 v[16:17],v2
 tr 18,2,512
 tr 20,2,32
 tr 22,2,544
 tr 24,2,64
 tr 26,2,576
 mf 112,148,168,112
 tr 28,2,96
 tr 30,2,608
 mf 128,148,200,128
 mf 116,156,168,116
 tr 148,2,4224
 tr 150,2,4736
 mf 132,156,200,132
 mf 120,164,168,120
 tr 156,2,4256
 tr 158,2,4768
 mf 136,164,200,136
 mf 124,172,168,124
 tr 164,2,4288
 tr 166,2,4800
 mf 140,172,200,140
 s_waitcnt lgkmcnt(10)
 mz 32,16,208
 tr 172,2,4320
 tr 174,2,4832
 mz 240,16,212
 cv 112,112,113
 cv 113,114,115
 mz 36,20,208
 tr 16,2,8448
 tr 18,2,8960
 cv 114,116,117
 cv 115,118,119
 mz 244,20,212
 ds_write_b128 v4,v[112:115]
 s_waitcnt lgkmcnt(11)
 mz 40,24,208
 tr 20,2,8480
 tr 22,2,8992
 cv 120,120,121
 cv 121,122,123
 mz 248,24,212
 cv 122,124,125
 cv 123,126,127
 mz 44,28,208
 tr 24,2,8512
 tr 26,2,9024
 ds_write_b128 v4,v[120:123] offset:7168
 mz 252,28,212
 cv 128,128,129
 cv 129,130,131
 s_waitcnt lgkmcnt(12)
 mf 32,148,216,32
 tr 28,2,8544
 tr 30,2,9056
 cv 130,132,133
 cv 131,134,135
 mf 240,148,220,240
 mf 36,156,216,36
 tr 148,2,12672
 tr 150,2,13184
 ds_write_b128 v5,v[128:131]
 mf 244,156,220,244
 cv 136,136,137
 s_waitcnt lgkmcnt(13)
 mf 40,164,216,40
 tr 156,2,12704
 tr 158,2,13216
 cv 137,138,139
 cv 138,140,141
 mf 248,164,220,248
 cv 139,142,143
 mf 44,172,216,44
 tr 164,2,12736
 tr 166,2,13248
 ds_write_b128 v5,v[136:139] offset:7168
 mf 252,172,220,252
 s_waitcnt lgkmcnt(13)
 mf 32,16,224,32
 tr 172,2,12768
 tr 174,2,13280
 mf 240,16,228,240
 mf 36,20,224,36
 mf 244,20,228,244
 s_waitcnt lgkmcnt(10)
 mf 40,24,224,40
 mf 248,24,228,248
 mf 44,28,224,44
 mf 252,28,228,252
 s_waitcnt lgkmcnt(0)
 s_barrier
 tr 16,2,16896
 tr 18,2,17408
 tr 20,2,16928
 tr 22,2,17440
 tr 24,2,16960
 tr 26,2,17472
 mf 32,148,232,32
 tr 28,2,16992
 tr 30,2,17504
 mf 240,148,236,240
 mf 36,156,232,36
 tr 148,2,21120
 tr 150,2,21632
 mf 244,156,236,244
 mf 40,164,232,40
 tr 156,2,21152
 tr 158,2,21664
 mf 248,164,236,248
 mf 44,172,232,44
 tr 164,2,21184
 tr 166,2,21696
 mf 252,172,236,252
 s_waitcnt lgkmcnt(10)
 mf 32,16,48,32
 tr 172,2,21216
 tr 174,2,21728
 mf 240,16,52,240
 mf 36,20,48,36
 tr 16,2,25344
 tr 18,2,25856
 mf 244,20,52,244
 s_waitcnt lgkmcnt(10)
 mf 40,24,48,40
 tr 20,2,25376
 tr 22,2,25888
 mf 248,24,52,248
 mf 44,28,48,44
 tr 24,2,25408
 tr 26,2,25920
 mf 252,28,52,252
 s_waitcnt lgkmcnt(10)
 mf 32,148,56,32
 tr 28,2,25440
 tr 30,2,25952
 mf 240,148,60,240
 mf 36,156,56,36
 tr 148,2,29568
 tr 150,2,30080
 mf 244,156,60,244
 s_waitcnt lgkmcnt(10)
 mf 40,164,56,40
 tr 156,2,29600
 tr 158,2,30112
 mf 248,164,60,248
 mf 44,172,56,44
 tr 164,2,29632
 tr 166,2,30144
 mf 252,172,60,252
 s_waitcnt lgkmcnt(10)
 mf 32,16,64,32
 tr 172,2,29664
 tr 174,2,30176
 mf 240,16,68,240
 mf 36,20,64,36
 mf 244,20,68,244
 s_waitcnt lgkmcnt(8)
 mf 40,24,64,40
 mf 248,24,68,248
 mf 44,28,64,44
 mf 252,28,68,252
 tr 16,2,33792
 tr 18,2,34304
 tr 20,2,33824
 tr 22,2,34336
 tr 24,2,33856
 tr 26,2,34368
 s_waitcnt lgkmcnt(10)
 mf 32,148,72,32
 tr 28,2,33888
 tr 30,2,34400
 mf 240,148,76,240
 mf 36,156,72,36
 tr 148,2,38016
 tr 150,2,38528
 mf 244,156,76,244
 s_waitcnt lgkmcnt(10)
 mf 40,164,72,40
 tr 156,2,38048
 tr 158,2,38560
 mf 248,164,76,248
 mf 44,172,72,44
 tr 164,2,38080
 tr 166,2,38592
 mf 252,172,76,252
 s_waitcnt lgkmcnt(10)
 mf 32,16,80,32
 tr 172,2,38112
 tr 174,2,38624
 mf 240,16,84,240
 mf 36,20,80,36
 tr 16,2,42240
 tr 18,2,42752
 mf 244,20,84,244
 s_waitcnt lgkmcnt(10)
 mf 40,24,80,40
 tr 20,2,42272
 tr 22,2,42784
 mf 248,24,84,248
 mf 44,28,80,44
 tr 24,2,42304
 tr 26,2,42816
 mf 252,28,84,252
 s_waitcnt lgkmcnt(10)
 mf 32,148,88,32
 tr 28,2,42336
 tr 30,2,42848
 mf 240,148,92,240
 mf 36,156,88,36
 tr 148,2,46464
 tr 150,2,46976
 mf 244,156,92,244
 s_waitcnt lgkmcnt(10)
 mf 40,164,88,40
 tr 156,2,46496
 tr 158,2,47008
 mf 248,164,92,248
 mf 44,172,88,44
 tr 164,2,46528
 tr 166,2,47040
 mf 252,172,92,252
 s_waitcnt lgkmcnt(10)
 mf 32,16,96,32
 tr 172,2,46560
 tr 174,2,47072
 mf 240,16,100,240
 mf 36,20,96,36
 mf 244,20,100,244
 s_waitcnt lgkmcnt(8)
 mf 40,24,96,40
 mf 248,24,100,248
 mf 44,28,96,44
 mf 252,28,100,252
 tr 16,2,50688
 tr 18,2,51200
 tr 20,2,50720
 tr 22,2,51232
 tr 24,2,50752
 tr 26,2,51264
 s_waitcnt lgkmcnt(10)
 mf 32,148,104,32
 tr 28,2,50784
 tr 30,2,51296
 mf 240,148,108,240
 mf 36,156,104,36
 tr 148,2,54912
 tr 150,2,55424
 mf 244,156,108,244
 s_waitcnt lgkmcnt(10)
 mf 40,164,104,40
 tr 156,2,54944
 tr 158,2,55456
 mf 248,164,108,248
 mf 44,172,104,44
 tr 164,2,54976
 tr 166,2,55488
 mf 252,172,108,252
 s_waitcnt lgkmcnt(10)
 mf 32,16,144,32
 tr 172,2,55008
 tr 174,2,55520
 mf 240,16,176,240
 mf 36,20,144,36
 tr 16,2,59136
 tr 18,2,59648
 mf 244,20,176,244
 s_waitcnt lgkmcnt(10)
 mf 40,24,144,40
 tr 20,2,59168
 tr 22,2,59680
 mf 248,24,176,248
 mf 44,28,144,44
 tr 24,2,59200
 tr 26,2,59712
 mf 252,28,176,252
 s_waitcnt lgkmcnt(10)
 mf 32,148,152,32
 tr 28,2,59232
 tr 30,2,59744
 mf 240,148,184,240
 mf 36,156,152,36
 tr 148,2,63360
 tr 150,2,63872
 mf 244,156,184,244
 s_waitcnt lgkmcnt(10)
 mf 40,164,152,40
 tr 156,2,63392
 tr 158,2,63904
 mf 248,164,184,248
 mf 44,172,152,44
 tr 164,2,63424
 tr 166,2,63936
 mf 252,172,184,252
 s_waitcnt lgkmcnt(10)
 mf 32,16,160,32
 tr 172,2,63456
 tr 174,2,63968
 mf 240,16,192,240
 mf 36,20,160,36
 mf 244,20,192,244
 s_waitcnt lgkmcnt(8)
 mf 40,24,160,40
 mf 248,24,192,248
 mf 44,28,160,44
 mf 252,28,192,252
 s_waitcnt lgkmcnt(4)
 mf 32,148,168,32
 mf 240,148,200,240
 mf 36,156,168,36
 mf 244,156,200,244
 s_waitcnt lgkmcnt(0)
 mf 40,164,168,40
 mf 248,164,200,248
 mf 44,172,168,44
 mf 252,172,200,252
 cv 32,32,33
 cv 33,34,35
 cv 34,36,37
 cv 35,38,39
 ds_write_b128 v4,v[32:35] offset:14336
 cv 40,40,41
 cv 41,42,43
 cv 42,44,45
 cv 43,46,47
 ds_write_b128 v4,v[40:43] offset:21504
 cv 240,240,241
 cv 241,242,243
 cv 242,244,245
 cv 243,246,247
 ds_write_b128 v5,v[240:243] offset:14336
 cv 248,248,249
 cv 249,250,251
 cv 250,252,253
 cv 251,254,255
 ds_write_b128 v5,v[248:251] offset:21504
 s_waitcnt lgkmcnt(0)
 s_barrier
 ds_read_b64_tr_b16 v[16:17],v8
 tr 18,8,512
 tr 20,8,32
 tr 22,8,544
 tr 24,8,64
 tr 26,8,576
 tr 28,8,96
 tr 30,8,608
 tr 148,8,4224
 tr 150,8,4736
 tr 156,8,4256
 tr 158,8,4768
 tr 164,8,4288
 tr 166,8,4800
 s_waitcnt lgkmcnt(10)
 mz 112,16,208
 tr 172,8,4320
 tr 174,8,4832
 mz 128,16,212
 mz 116,20,208
 tr 16,8,8448
 tr 18,8,8960
 mz 132,20,212
 s_waitcnt lgkmcnt(10)
 mz 120,24,208
 tr 20,8,8480
 tr 22,8,8992
 mz 136,24,212
 mz 124,28,208
 tr 24,8,8512
 tr 26,8,9024
 mz 140,28,212
 s_waitcnt lgkmcnt(10)
 mf 112,148,216,112
 tr 28,8,8544
 tr 30,8,9056
 mf 128,148,220,128
 mf 116,156,216,116
 tr 148,8,12672
 tr 150,8,13184
 mf 132,156,220,132
 s_waitcnt lgkmcnt(10)
 mf 120,164,216,120
 tr 156,8,12704
 tr 158,8,13216
 mf 136,164,220,136
 mf 124,172,216,124
 tr 164,8,12736
 tr 166,8,13248
 mf 140,172,220,140
 s_waitcnt lgkmcnt(10)
 mf 112,16,224,112
 tr 172,8,12768
 tr 174,8,13280
 mf 128,16,228,128
 mf 116,20,224,116
 mf 132,20,228,132
 s_waitcnt lgkmcnt(8)
 mf 120,24,224,120
 mf 136,24,228,136
 mf 124,28,224,124
 mf 140,28,228,140
 tr 16,8,16896
 tr 18,8,17408
 tr 20,8,16928
 tr 22,8,17440
 tr 24,8,16960
 tr 26,8,17472
 s_waitcnt lgkmcnt(10)
 mf 112,148,232,112
 tr 28,8,16992
 tr 30,8,17504
 mf 128,148,236,128
 mf 116,156,232,116
 tr 148,8,21120
 tr 150,8,21632
 mf 132,156,236,132
 s_waitcnt lgkmcnt(10)
 mf 120,164,232,120
 tr 156,8,21152
 tr 158,8,21664
 mf 136,164,236,136
 mf 124,172,232,124
 tr 164,8,21184
 tr 166,8,21696
 mf 140,172,236,140
 s_waitcnt lgkmcnt(10)
 mf 112,16,48,112
 tr 172,8,21216
 tr 174,8,21728
 mf 128,16,52,128
 mf 116,20,48,116
 tr 16,8,25344
 tr 18,8,25856
 mf 132,20,52,132
 s_waitcnt lgkmcnt(10)
 mf 120,24,48,120
 tr 20,8,25376
 tr 22,8,25888
 mf 136,24,52,136
 mf 124,28,48,124
 tr 24,8,25408
 tr 26,8,25920
 mf 140,28,52,140
 s_waitcnt lgkmcnt(10)
 mf 112,148,56,112
 tr 28,8,25440
 tr 30,8,25952
 mf 128,148,60,128
 mf 116,156,56,116
 tr 148,8,29568
 tr 150,8,30080
 mf 132,156,60,132
 s_waitcnt lgkmcnt(10)
 mf 120,164,56,120
 tr 156,8,29600
 tr 158,8,30112
 mf 136,164,60,136
 mf 124,172,56,124
 tr 164,8,29632
 tr 166,8,30144
 mf 140,172,60,140
 s_waitcnt lgkmcnt(10)
 mf 112,16,64,112
 tr 172,8,29664
 tr 174,8,30176
 mf 128,16,68,128
 mf 116,20,64,116
 mf 132,20,68,132
 s_waitcnt lgkmcnt(8)
 mf 120,24,64,120
 mf 136,24,68,136
 mf 124,28,64,124
 mf 140,28,68,140
 tr 16,8,33792
 tr 18,8,34304
 tr 20,8,33824
 tr 22,8,34336
 tr 24,8,33856
 tr 26,8,34368
 s_waitcnt lgkmcnt(10)
 mf 112,148,72,112
 tr 28,8,33888
 tr 30,8,34400
 mf 128,148,76,128
 mf 116,156,72,116
 tr 148,8,38016
 tr 150,8,38528
 mf 132,156,76,132
 s_waitcnt lgkmcnt(10)
 mf 120,164,72,120
 tr 156,8,38048
 tr 158,8,38560
 mf 136,164,76,136
 mf 124,172,72,124
 tr 164,8,38080
 tr 166,8,38592
 mf 140,172,76,140
 s_waitcnt lgkmcnt(10)
 mf 112,16,80,112
 tr 172,8,38112
 tr 174,8,38624
 mf 128,16,84,128
 mf 116,20,80,116
 tr 16,8,42240
 tr 18,8,42752
 mf 132,20,84,132
 s_waitcnt lgkmcnt(10)
 mf 120,24,80,120
 tr 20,8,42272
 tr 22,8,42784
 mf 136,24,84,136
 mf 124,28,80,124
 tr 24,8,42304
 tr 26,8,42816
 mf 140,28,84,140
 s_waitcnt lgkmcnt(10)
 mf 112,148,88,112
 tr 28,8,42336
 tr 30,8,42848
 mf 128,148,92,128
 mf 116,156,88,116
 tr 148,8,46464
 tr 150,8,46976
 mf 132,156,92,132
 s_waitcnt lgkmcnt(10)
 mf 120,164,88,120
 tr 156,8,46496
 tr 158,8,47008
 mf 136,164,92,136
 mf 124,172,88,124
 tr 164,8,46528
 tr 166,8,47040
 mf 140,172,92,140
 s_waitcnt lgkmcnt(10)
 mf 112,16,96,112
 tr 172,8,46560
 tr 174,8,47072
 mf 128,16,100,128
 mf 116,20,96,116
 mf 132,20,100,132
 s_waitcnt lgkmcnt(8)
 mf 120,24,96,120
 mf 136,24,100,136
 mf 124,28,96,124
 mf 140,28,100,140
 ds_read_b64_tr_b16 v[16:17],v2
 tr 18,2,512
 tr 20,2,32
 tr 22,2,544
 tr 24,2,64
 tr 26,2,576
 s_waitcnt lgkmcnt(10)
 mf 112,148,104,112
 tr 28,2,96
 tr 30,2,608
 mf 128,148,108,128
 mf 116,156,104,116
 tr 148,2,4224
 tr 150,2,4736
 mf 132,156,108,132
 s_waitcnt lgkmcnt(10)
 mf 120,164,104,120
 tr 156,2,4256
 tr 158,2,4768
 mf 136,164,108,136
 mf 124,172,104,124
 tr 164,2,4288
 tr 166,2,4800
 mf 140,172,108,140
 s_waitcnt lgkmcnt(10)
 mf 112,16,144,112
 tr 172,2,4320
 tr 174,2,4832
 mf 128,16,176,128
 mf 116,20,144,116
 tr 16,2,8448
 tr 18,2,8960
 mf 132,20,176,132
 s_waitcnt lgkmcnt(10)
 mf 120,24,144,120
 tr 20,2,8480
 tr 22,2,8992
 mf 136,24,176,136
 mf 124,28,144,124
 tr 24,2,8512
 tr 26,2,9024
 mf 140,28,176,140
 s_waitcnt lgkmcnt(10)
 mf 112,148,152,112
 tr 28,2,8544
 tr 30,2,9056
 mf 128,148,184,128
 mf 116,156,152,116
 tr 148,2,12672
 tr 150,2,13184
 mf 132,156,184,132
 s_waitcnt lgkmcnt(10)
 mf 120,164,152,120
 tr 156,2,12704
 tr 158,2,13216
 mf 136,164,184,136
 mf 124,172,152,124
 tr 164,2,12736
 tr 166,2,13248
 mf 140,172,184,140
 s_waitcnt lgkmcnt(10)
 mf 112,16,160,112
 tr 172,2,12768
 tr 174,2,13280
 mf 128,16,192,128
 mf 116,20,160,116
 mf 132,20,192,132
 s_waitcnt lgkmcnt(8)
 mf 120,24,160,120
 mf 136,24,192,136
 mf 124,28,160,124
 mf 140,28,192,140
 s_waitcnt lgkmcnt(4)
 mf 112,148,168,112
 mf 128,148,200,128
 mf 116,156,168,116
 mf 132,156,200,132
 s_waitcnt lgkmcnt(0)
 mf 120,164,168,120
 mf 136,164,200,136
 mf 124,172,168,124
 mf 140,172,200,140
 cv 112,112,113
 cv 113,114,115
 cv 114,116,117
 cv 115,118,119
 ds_write_b128 v4,v[112:115]
 cv 120,120,121
 cv 121,122,123
 cv 122,124,125
 cv 123,126,127
 ds_write_b128 v4,v[120:123] offset:7168
 cv 128,128,129
 cv 129,130,131
 cv 130,132,133
 cv 131,134,135
 ds_write_b128 v5,v[128:131]
 cv 136,136,137
 cv 137,138,139
 cv 138,140,141
 cv 139,142,143
 ds_write_b128 v5,v[136:139] offset:7168
 s_waitcnt lgkmcnt(0)
 s_barrier
 s_endpgm
L_resc0first_y:
 s_nop 7
 v_max_f32 v10,v10,v95
 v_max_f32 v11,v11,v111
 v_mov_b32 v12,v10
 v_mov_b32 v13,v11
 s_nop 0
 v_permlane16_swap_b32 v10,v12
 v_permlane16_swap_b32 v11,v13
 v_max_f32 v10,v10,v12
 v_max_f32 v11,v11,v13
 v_mov_b32 v12,v10
 v_mov_b32 v13,v11
 s_nop 0
 v_permlane32_swap_b32 v10,v12
 v_permlane32_swap_b32 v11,v13
 v_max_f32 v10,v10,v12
 v_max_f32 v11,v11,v13
 v_sub_f32 v80,v80,v10
 v_sub_f32 v81,v81,v10
 v_sub_f32 v82,v82,v10
 v_sub_f32 v83,v83,v10
 v_sub_f32 v84,v84,v10
 v_sub_f32 v85,v85,v10
 v_sub_f32 v86,v86,v10
 v_sub_f32 v87,v87,v10
 v_sub_f32 v88,v88,v10
 v_sub_f32 v89,v89,v10
 v_sub_f32 v90,v90,v10
 v_sub_f32 v91,v91,v10
 v_sub_f32 v92,v92,v10
 v_sub_f32 v93,v93,v10
 v_sub_f32 v94,v94,v10
 v_sub_f32 v95,v95,v10
 v_sub_f32 v240,v240,v10
 v_sub_f32 v241,v241,v10
 v_sub_f32 v242,v242,v10
 v_sub_f32 v243,v243,v10
 v_sub_f32 v96,v96,v11
 v_sub_f32 v97,v97,v11
 v_sub_f32 v98,v98,v11
 v_sub_f32 v99,v99,v11
 v_sub_f32 v100,v100,v11
 v_sub_f32 v101,v101,v11
 v_sub_f32 v102,v102,v11
 v_sub_f32 v103,v103,v11
 v_sub_f32 v104,v104,v11
 v_sub_f32 v105,v105,v11
 v_sub_f32 v106,v106,v11
 v_sub_f32 v107,v107,v11
 v_sub_f32 v108,v108,v11
 v_sub_f32 v109,v109,v11
 v_sub_f32 v110,v110,v11
 v_sub_f32 v111,v111,v11
 v_sub_f32 v244,v244,v11
 v_sub_f32 v245,v245,v11
 v_sub_f32 v246,v246,v11
 v_sub_f32 v247,v247,v11
 s_nop 1
 s_branch L_ret0first_y
L_resc0_y:
 s_nop 7
 v_max_f32 v10,v10,v95
 v_max_f32 v11,v11,v111
 v_mov_b32 v12,v10
 v_mov_b32 v13,v11
 s_nop 0
 v_permlane16_swap_b32 v10,v12
 v_permlane16_swap_b32 v11,v13
 v_max_f32 v10,v10,v12
 v_max_f32 v11,v11,v13
 v_mov_b32 v12,v10
 v_mov_b32 v13,v11
 s_nop 0
 v_permlane32_swap_b32 v10,v12
 v_permlane32_swap_b32 v11,v13
 v_max_f32 v10,v10,v12
 v_max_f32 v11,v11,v13
 v_sub_f32 v80,v80,v10
 v_sub_f32 v81,v81,v10
 v_sub_f32 v82,v82,v10
 v_sub_f32 v83,v83,v10
 v_sub_f32 v84,v84,v10
 v_sub_f32 v85,v85,v10
 v_sub_f32 v86,v86,v10
 v_sub_f32 v87,v87,v10
 v_sub_f32 v88,v88,v10
 v_sub_f32 v89,v89,v10
 v_sub_f32 v90,v90,v10
 v_sub_f32 v91,v91,v10
 v_sub_f32 v92,v92,v10
 v_sub_f32 v93,v93,v10
 v_sub_f32 v94,v94,v10
 v_sub_f32 v95,v95,v10
 v_sub_f32 v240,v240,v10
 v_sub_f32 v241,v241,v10
 v_sub_f32 v242,v242,v10
 v_sub_f32 v243,v243,v10
 v_sub_f32 v96,v96,v11
 v_sub_f32 v97,v97,v11
 v_sub_f32 v98,v98,v11
 v_sub_f32 v99,v99,v11
 v_sub_f32 v100,v100,v11
 v_sub_f32 v101,v101,v11
 v_sub_f32 v102,v102,v11
 v_sub_f32 v103,v103,v11
 v_sub_f32 v104,v104,v11
 v_sub_f32 v105,v105,v11
 v_sub_f32 v106,v106,v11
 v_sub_f32 v107,v107,v11
 v_sub_f32 v108,v108,v11
 v_sub_f32 v109,v109,v11
 v_sub_f32 v110,v110,v11
 v_sub_f32 v111,v111,v11
 v_sub_f32 v244,v244,v11
 v_sub_f32 v245,v245,v11
 v_sub_f32 v246,v246,v11
 v_sub_f32 v247,v247,v11
 s_nop 1
 s_branch L_ret0_y
L_resc1_y:
 s_nop 7
 v_max3_f32 v10,v10,v127,0
 v_max3_f32 v11,v11,v143,0
 v_mov_b32 v12,v10
 v_mov_b32 v13,v11
 s_nop 0
 v_permlane16_swap_b32 v10,v12
 v_permlane16_swap_b32 v11,v13
 v_max_f32 v10,v10,v12
 v_max_f32 v11,v11,v13
 v_mov_b32 v12,v10
 v_mov_b32 v13,v11
 s_nop 0
 v_permlane32_swap_b32 v10,v12
 v_permlane32_swap_b32 v11,v13
 v_max_f32 v10,v10,v12
 v_max_f32 v11,v11,v13
 v_sub_f32 v12,0,v10
 v_sub_f32 v13,0,v11
 v_exp_f32 v12,v12
 v_exp_f32 v13,v13
 v_sub_f32 v112,v112,v10
 v_sub_f32 v113,v113,v10
 v_sub_f32 v114,v114,v10
 v_sub_f32 v115,v115,v10
 v_sub_f32 v116,v116,v10
 v_sub_f32 v117,v117,v10
 v_sub_f32 v118,v118,v10
 v_sub_f32 v119,v119,v10
 v_sub_f32 v120,v120,v10
 v_sub_f32 v121,v121,v10
 v_sub_f32 v122,v122,v10
 v_sub_f32 v123,v123,v10
 v_sub_f32 v124,v124,v10
 v_sub_f32 v125,v125,v10
 v_sub_f32 v126,v126,v10
 v_sub_f32 v127,v127,v10
 v_sub_f32 v240,v240,v10
 v_sub_f32 v241,v241,v10
 v_sub_f32 v242,v242,v10
 v_sub_f32 v243,v243,v10
 v_mul_f32 v144,v12,v144
 v_mul_f32 v145,v12,v145
 v_mul_f32 v146,v12,v146
 v_mul_f32 v147,v12,v147
 v_mul_f32 v148,v12,v148
 v_mul_f32 v149,v12,v149
 v_mul_f32 v150,v12,v150
 v_mul_f32 v151,v12,v151
 v_mul_f32 v152,v12,v152
 v_mul_f32 v153,v12,v153
 v_mul_f32 v154,v12,v154
 v_mul_f32 v155,v12,v155
 v_mul_f32 v156,v12,v156
 v_mul_f32 v157,v12,v157
 v_mul_f32 v158,v12,v158
 v_mul_f32 v159,v12,v159
 v_mul_f32 v160,v12,v160
 v_mul_f32 v161,v12,v161
 v_mul_f32 v162,v12,v162
 v_mul_f32 v163,v12,v163
 v_mul_f32 v164,v12,v164
 v_mul_f32 v165,v12,v165
 v_mul_f32 v166,v12,v166
 v_mul_f32 v167,v12,v167
 v_mul_f32 v168,v12,v168
 v_mul_f32 v169,v12,v169
 v_mul_f32 v170,v12,v170
 v_mul_f32 v171,v12,v171
 v_mul_f32 v172,v12,v172
 v_mul_f32 v173,v12,v173
 v_mul_f32 v174,v12,v174
 v_mul_f32 v175,v12,v175
 v_mul_f32 v248,v12,v248
 v_sub_f32 v128,v128,v11
 v_sub_f32 v129,v129,v11
 v_sub_f32 v130,v130,v11
 v_sub_f32 v131,v131,v11
 v_sub_f32 v132,v132,v11
 v_sub_f32 v133,v133,v11
 v_sub_f32 v134,v134,v11
 v_sub_f32 v135,v135,v11
 v_sub_f32 v136,v136,v11
 v_sub_f32 v137,v137,v11
 v_sub_f32 v138,v138,v11
 v_sub_f32 v139,v139,v11
 v_sub_f32 v140,v140,v11
 v_sub_f32 v141,v141,v11
 v_sub_f32 v142,v142,v11
 v_sub_f32 v143,v143,v11
 v_sub_f32 v244,v244,v11
 v_sub_f32 v245,v245,v11
 v_sub_f32 v246,v246,v11
 v_sub_f32 v247,v247,v11
 v_mul_f32 v176,v13,v176
 v_mul_f32 v177,v13,v177
 v_mul_f32 v178,v13,v178
 v_mul_f32 v179,v13,v179
 v_mul_f32 v180,v13,v180
 v_mul_f32 v181,v13,v181
 v_mul_f32 v182,v13,v182
 v_mul_f32 v183,v13,v183
 v_mul_f32 v184,v13,v184
 v_mul_f32 v185,v13,v185
 v_mul_f32 v186,v13,v186
 v_mul_f32 v187,v13,v187
 v_mul_f32 v188,v13,v188
 v_mul_f32 v189,v13,v189
 v_mul_f32 v190,v13,v190
 v_mul_f32 v191,v13,v191
 v_mul_f32 v192,v13,v192
 v_mul_f32 v193,v13,v193
 v_mul_f32 v194,v13,v194
 v_mul_f32 v195,v13,v195
 v_mul_f32 v196,v13,v196
 v_mul_f32 v197,v13,v197
 v_mul_f32 v198,v13,v198
 v_mul_f32 v199,v13,v199
 v_mul_f32 v200,v13,v200
 v_mul_f32 v201,v13,v201
 v_mul_f32 v202,v13,v202
 v_mul_f32 v203,v13,v203
 v_mul_f32 v204,v13,v204
 v_mul_f32 v205,v13,v205
 v_mul_f32 v206,v13,v206
 v_mul_f32 v207,v13,v207
 v_mul_f32 v252,v13,v252
 s_nop 1
 s_branch L_ret1_y
L_resc2_y:
 s_nop 7
 v_max3_f32 v10,v10,v95,0
 v_max3_f32 v11,v11,v111,0
 v_mov_b32 v12,v10
 v_mov_b32 v13,v11
 s_nop 0
 v_permlane16_swap_b32 v10,v12
 v_permlane16_swap_b32 v11,v13
 v_max_f32 v10,v10,v12
 v_max_f32 v11,v11,v13
 v_mov_b32 v12,v10
 v_mov_b32 v13,v11
 s_nop 0
 v_permlane32_swap_b32 v10,v12
 v_permlane32_swap_b32 v11,v13
 v_max_f32 v10,v10,v12
 v_max_f32 v11,v11,v13
 v_sub_f32 v12,0,v10
 v_sub_f32 v13,0,v11
 v_exp_f32 v12,v12
 v_exp_f32 v13,v13
 v_sub_f32 v80,v80,v10
 v_sub_f32 v81,v81,v10
 v_sub_f32 v82,v82,v10
 v_sub_f32 v83,v83,v10
 v_sub_f32 v84,v84,v10
 v_sub_f32 v85,v85,v10
 v_sub_f32 v86,v86,v10
 v_sub_f32 v87,v87,v10
 v_sub_f32 v88,v88,v10
 v_sub_f32 v89,v89,v10
 v_sub_f32 v90,v90,v10
 v_sub_f32 v91,v91,v10
 v_sub_f32 v92,v92,v10
 v_sub_f32 v93,v93,v10
 v_sub_f32 v94,v94,v10
 v_sub_f32 v95,v95,v10
 v_sub_f32 v240,v240,v10
 v_sub_f32 v241,v241,v10
 v_sub_f32 v242,v242,v10
 v_sub_f32 v243,v243,v10
 v_mul_f32 v144,v12,v144
 v_mul_f32 v145,v12,v145
 v_mul_f32 v146,v12,v146
 v_mul_f32 v147,v12,v147
 v_mul_f32 v148,v12,v148
 v_mul_f32 v149,v12,v149
 v_mul_f32 v150,v12,v150
 v_mul_f32 v151,v12,v151
 v_mul_f32 v152,v12,v152
 v_mul_f32 v153,v12,v153
 v_mul_f32 v154,v12,v154
 v_mul_f32 v155,v12,v155
 v_mul_f32 v156,v12,v156
 v_mul_f32 v157,v12,v157
 v_mul_f32 v158,v12,v158
 v_mul_f32 v159,v12,v159
 v_mul_f32 v160,v12,v160
 v_mul_f32 v161,v12,v161
 v_mul_f32 v162,v12,v162
 v_mul_f32 v163,v12,v163
 v_mul_f32 v164,v12,v164
 v_mul_f32 v165,v12,v165
 v_mul_f32 v166,v12,v166
 v_mul_f32 v167,v12,v167
 v_mul_f32 v168,v12,v168
 v_mul_f32 v169,v12,v169
 v_mul_f32 v170,v12,v170
 v_mul_f32 v171,v12,v171
 v_mul_f32 v172,v12,v172
 v_mul_f32 v173,v12,v173
 v_mul_f32 v174,v12,v174
 v_mul_f32 v175,v12,v175
 v_mul_f32 v248,v12,v248
 v_sub_f32 v96,v96,v11
 v_sub_f32 v97,v97,v11
 v_sub_f32 v98,v98,v11
 v_sub_f32 v99,v99,v11
 v_sub_f32 v100,v100,v11
 v_sub_f32 v101,v101,v11
 v_sub_f32 v102,v102,v11
 v_sub_f32 v103,v103,v11
 v_sub_f32 v104,v104,v11
 v_sub_f32 v105,v105,v11
 v_sub_f32 v106,v106,v11
 v_sub_f32 v107,v107,v11
 v_sub_f32 v108,v108,v11
 v_sub_f32 v109,v109,v11
 v_sub_f32 v110,v110,v11
 v_sub_f32 v111,v111,v11
 v_sub_f32 v244,v244,v11
 v_sub_f32 v245,v245,v11
 v_sub_f32 v246,v246,v11
 v_sub_f32 v247,v247,v11
 v_mul_f32 v176,v13,v176
 v_mul_f32 v177,v13,v177
 v_mul_f32 v178,v13,v178
 v_mul_f32 v179,v13,v179
 v_mul_f32 v180,v13,v180
 v_mul_f32 v181,v13,v181
 v_mul_f32 v182,v13,v182
 v_mul_f32 v183,v13,v183
 v_mul_f32 v184,v13,v184
 v_mul_f32 v185,v13,v185
 v_mul_f32 v186,v13,v186
 v_mul_f32 v187,v13,v187
 v_mul_f32 v188,v13,v188
 v_mul_f32 v189,v13,v189
 v_mul_f32 v190,v13,v190
 v_mul_f32 v191,v13,v191
 v_mul_f32 v192,v13,v192
 v_mul_f32 v193,v13,v193
 v_mul_f32 v194,v13,v194
 v_mul_f32 v195,v13,v195
 v_mul_f32 v196,v13,v196
 v_mul_f32 v197,v13,v197
 v_mul_f32 v198,v13,v198
 v_mul_f32 v199,v13,v199
 v_mul_f32 v200,v13,v200
 v_mul_f32 v201,v13,v201
 v_mul_f32 v202,v13,v202
 v_mul_f32 v203,v13,v203
 v_mul_f32 v204,v13,v204
 v_mul_f32 v205,v13,v205
 v_mul_f32 v206,v13,v206
 v_mul_f32 v207,v13,v207
 v_mul_f32 v252,v13,v252
 s_nop 1
 s_branch L_ret2_y
L_resc3_y:
 s_nop 7
 v_max3_f32 v10,v10,v127,0
 v_max3_f32 v11,v11,v143,0
 v_mov_b32 v12,v10
 v_mov_b32 v13,v11
 s_nop 0
 v_permlane16_swap_b32 v10,v12
 v_permlane16_swap_b32 v11,v13
 v_max_f32 v10,v10,v12
 v_max_f32 v11,v11,v13
 v_mov_b32 v12,v10
 v_mov_b32 v13,v11
 s_nop 0
 v_permlane32_swap_b32 v10,v12
 v_permlane32_swap_b32 v11,v13
 v_max_f32 v10,v10,v12
 v_max_f32 v11,v11,v13
 v_sub_f32 v12,0,v10
 v_sub_f32 v13,0,v11
 v_exp_f32 v12,v12
 v_exp_f32 v13,v13
 v_sub_f32 v112,v112,v10
 v_sub_f32 v113,v113,v10
 v_sub_f32 v114,v114,v10
 v_sub_f32 v115,v115,v10
 v_sub_f32 v116,v116,v10
 v_sub_f32 v117,v117,v10
 v_sub_f32 v118,v118,v10
 v_sub_f32 v119,v119,v10
 v_sub_f32 v120,v120,v10
 v_sub_f32 v121,v121,v10
 v_sub_f32 v122,v122,v10
 v_sub_f32 v123,v123,v10
 v_sub_f32 v124,v124,v10
 v_sub_f32 v125,v125,v10
 v_sub_f32 v126,v126,v10
 v_sub_f32 v127,v127,v10
 v_sub_f32 v240,v240,v10
 v_sub_f32 v241,v241,v10
 v_sub_f32 v242,v242,v10
 v_sub_f32 v243,v243,v10
 v_mul_f32 v144,v12,v144
 v_mul_f32 v145,v12,v145
 v_mul_f32 v146,v12,v146
 v_mul_f32 v147,v12,v147
 v_mul_f32 v148,v12,v148
 v_mul_f32 v149,v12,v149
 v_mul_f32 v150,v12,v150
 v_mul_f32 v151,v12,v151
 v_mul_f32 v152,v12,v152
 v_mul_f32 v153,v12,v153
 v_mul_f32 v154,v12,v154
 v_mul_f32 v155,v12,v155
 v_mul_f32 v156,v12,v156
 v_mul_f32 v157,v12,v157
 v_mul_f32 v158,v12,v158
 v_mul_f32 v159,v12,v159
 v_mul_f32 v160,v12,v160
 v_mul_f32 v161,v12,v161
 v_mul_f32 v162,v12,v162
 v_mul_f32 v163,v12,v163
 v_mul_f32 v164,v12,v164
 v_mul_f32 v165,v12,v165
 v_mul_f32 v166,v12,v166
 v_mul_f32 v167,v12,v167
 v_mul_f32 v168,v12,v168
 v_mul_f32 v169,v12,v169
 v_mul_f32 v170,v12,v170
 v_mul_f32 v171,v12,v171
 v_mul_f32 v172,v12,v172
 v_mul_f32 v173,v12,v173
 v_mul_f32 v174,v12,v174
 v_mul_f32 v175,v12,v175
 v_mul_f32 v248,v12,v248
 v_sub_f32 v128,v128,v11
 v_sub_f32 v129,v129,v11
 v_sub_f32 v130,v130,v11
 v_sub_f32 v131,v131,v11
 v_sub_f32 v132,v132,v11
 v_sub_f32 v133,v133,v11
 v_sub_f32 v134,v134,v11
 v_sub_f32 v135,v135,v11
 v_sub_f32 v136,v136,v11
 v_sub_f32 v137,v137,v11
 v_sub_f32 v138,v138,v11
 v_sub_f32 v139,v139,v11
 v_sub_f32 v140,v140,v11
 v_sub_f32 v141,v141,v11
 v_sub_f32 v142,v142,v11
 v_sub_f32 v143,v143,v11
 v_sub_f32 v244,v244,v11
 v_sub_f32 v245,v245,v11
 v_sub_f32 v246,v246,v11
 v_sub_f32 v247,v247,v11
 v_mul_f32 v176,v13,v176
 v_mul_f32 v177,v13,v177
 v_mul_f32 v178,v13,v178
 v_mul_f32 v179,v13,v179
 v_mul_f32 v180,v13,v180
 v_mul_f32 v181,v13,v181
 v_mul_f32 v182,v13,v182
 v_mul_f32 v183,v13,v183
 v_mul_f32 v184,v13,v184
 v_mul_f32 v185,v13,v185
 v_mul_f32 v186,v13,v186
 v_mul_f32 v187,v13,v187
 v_mul_f32 v188,v13,v188
 v_mul_f32 v189,v13,v189
 v_mul_f32 v190,v13,v190
 v_mul_f32 v191,v13,v191
 v_mul_f32 v192,v13,v192
 v_mul_f32 v193,v13,v193
 v_mul_f32 v194,v13,v194
 v_mul_f32 v195,v13,v195
 v_mul_f32 v196,v13,v196
 v_mul_f32 v197,v13,v197
 v_mul_f32 v198,v13,v198
 v_mul_f32 v199,v13,v199
 v_mul_f32 v200,v13,v200
 v_mul_f32 v201,v13,v201
 v_mul_f32 v202,v13,v202
 v_mul_f32 v203,v13,v203
 v_mul_f32 v204,v13,v204
 v_mul_f32 v205,v13,v205
 v_mul_f32 v206,v13,v206
 v_mul_f32 v207,v13,v207
 v_mul_f32 v252,v13,v252
 s_nop 1
 s_branch L_ret3_y
L_resc4_y:
 s_nop 7
 v_max3_f32 v10,v10,v95,0
 v_max3_f32 v11,v11,v111,0
 v_mov_b32 v12,v10
 v_mov_b32 v13,v11
 s_nop 0
 v_permlane16_swap_b32 v10,v12
 v_permlane16_swap_b32 v11,v13
 v_max_f32 v10,v10,v12
 v_max_f32 v11,v11,v13
 v_mov_b32 v12,v10
 v_mov_b32 v13,v11
 s_nop 0
 v_permlane32_swap_b32 v10,v12
 v_permlane32_swap_b32 v11,v13
 v_max_f32 v10,v10,v12
 v_max_f32 v11,v11,v13
 v_sub_f32 v12,0,v10
 v_sub_f32 v13,0,v11
 v_exp_f32 v12,v12
 v_exp_f32 v13,v13
 v_sub_f32 v80,v80,v10
 v_sub_f32 v81,v81,v10
 v_sub_f32 v82,v82,v10
 v_sub_f32 v83,v83,v10
 v_sub_f32 v84,v84,v10
 v_sub_f32 v85,v85,v10
 v_sub_f32 v86,v86,v10
 v_sub_f32 v87,v87,v10
 v_sub_f32 v88,v88,v10
 v_sub_f32 v89,v89,v10
 v_sub_f32 v90,v90,v10
 v_sub_f32 v91,v91,v10
 v_sub_f32 v92,v92,v10
 v_sub_f32 v93,v93,v10
 v_sub_f32 v94,v94,v10
 v_sub_f32 v95,v95,v10
 v_sub_f32 v240,v240,v10
 v_sub_f32 v241,v241,v10
 v_sub_f32 v242,v242,v10
 v_sub_f32 v243,v243,v10
 v_mul_f32 v144,v12,v144
 v_mul_f32 v145,v12,v145
 v_mul_f32 v146,v12,v146
 v_mul_f32 v147,v12,v147
 v_mul_f32 v148,v12,v148
 v_mul_f32 v149,v12,v149
 v_mul_f32 v150,v12,v150
 v_mul_f32 v151,v12,v151
 v_mul_f32 v152,v12,v152
 v_mul_f32 v153,v12,v153
 v_mul_f32 v154,v12,v154
 v_mul_f32 v155,v12,v155
 v_mul_f32 v156,v12,v156
 v_mul_f32 v157,v12,v157
 v_mul_f32 v158,v12,v158
 v_mul_f32 v159,v12,v159
 v_mul_f32 v160,v12,v160
 v_mul_f32 v161,v12,v161
 v_mul_f32 v162,v12,v162
 v_mul_f32 v163,v12,v163
 v_mul_f32 v164,v12,v164
 v_mul_f32 v165,v12,v165
 v_mul_f32 v166,v12,v166
 v_mul_f32 v167,v12,v167
 v_mul_f32 v168,v12,v168
 v_mul_f32 v169,v12,v169
 v_mul_f32 v170,v12,v170
 v_mul_f32 v171,v12,v171
 v_mul_f32 v172,v12,v172
 v_mul_f32 v173,v12,v173
 v_mul_f32 v174,v12,v174
 v_mul_f32 v175,v12,v175
 v_mul_f32 v248,v12,v248
 v_sub_f32 v96,v96,v11
 v_sub_f32 v97,v97,v11
 v_sub_f32 v98,v98,v11
 v_sub_f32 v99,v99,v11
 v_sub_f32 v100,v100,v11
 v_sub_f32 v101,v101,v11
 v_sub_f32 v102,v102,v11
 v_sub_f32 v103,v103,v11
 v_sub_f32 v104,v104,v11
 v_sub_f32 v105,v105,v11
 v_sub_f32 v106,v106,v11
 v_sub_f32 v107,v107,v11
 v_sub_f32 v108,v108,v11
 v_sub_f32 v109,v109,v11
 v_sub_f32 v110,v110,v11
 v_sub_f32 v111,v111,v11
 v_sub_f32 v244,v244,v11
 v_sub_f32 v245,v245,v11
 v_sub_f32 v246,v246,v11
 v_sub_f32 v247,v247,v11
 v_mul_f32 v176,v13,v176
 v_mul_f32 v177,v13,v177
 v_mul_f32 v178,v13,v178
 v_mul_f32 v179,v13,v179
 v_mul_f32 v180,v13,v180
 v_mul_f32 v181,v13,v181
 v_mul_f32 v182,v13,v182
 v_mul_f32 v183,v13,v183
 v_mul_f32 v184,v13,v184
 v_mul_f32 v185,v13,v185
 v_mul_f32 v186,v13,v186
 v_mul_f32 v187,v13,v187
 v_mul_f32 v188,v13,v188
 v_mul_f32 v189,v13,v189
 v_mul_f32 v190,v13,v190
 v_mul_f32 v191,v13,v191
 v_mul_f32 v192,v13,v192
 v_mul_f32 v193,v13,v193
 v_mul_f32 v194,v13,v194
 v_mul_f32 v195,v13,v195
 v_mul_f32 v196,v13,v196
 v_mul_f32 v197,v13,v197
 v_mul_f32 v198,v13,v198
 v_mul_f32 v199,v13,v199
 v_mul_f32 v200,v13,v200
 v_mul_f32 v201,v13,v201
 v_mul_f32 v202,v13,v202
 v_mul_f32 v203,v13,v203
 v_mul_f32 v204,v13,v204
 v_mul_f32 v205,v13,v205
 v_mul_f32 v206,v13,v206
 v_mul_f32 v207,v13,v207
 v_mul_f32 v252,v13,v252
 s_nop 1
 s_branch L_ret4_y
L_resc5_y:
 s_nop 7
 v_max3_f32 v10,v10,v127,0
 v_max3_f32 v11,v11,v143,0
 v_mov_b32 v12,v10
 v_mov_b32 v13,v11
 s_nop 0
 v_permlane16_swap_b32 v10,v12
 v_permlane16_swap_b32 v11,v13
 v_max_f32 v10,v10,v12
 v_max_f32 v11,v11,v13
 v_mov_b32 v12,v10
 v_mov_b32 v13,v11
 s_nop 0
 v_permlane32_swap_b32 v10,v12
 v_permlane32_swap_b32 v11,v13
 v_max_f32 v10,v10,v12
 v_max_f32 v11,v11,v13
 v_sub_f32 v12,0,v10
 v_sub_f32 v13,0,v11
 v_exp_f32 v12,v12
 v_exp_f32 v13,v13
 v_sub_f32 v112,v112,v10
 v_sub_f32 v113,v113,v10
 v_sub_f32 v114,v114,v10
 v_sub_f32 v115,v115,v10
 v_sub_f32 v116,v116,v10
 v_sub_f32 v117,v117,v10
 v_sub_f32 v118,v118,v10
 v_sub_f32 v119,v119,v10
 v_sub_f32 v120,v120,v10
 v_sub_f32 v121,v121,v10
 v_sub_f32 v122,v122,v10
 v_sub_f32 v123,v123,v10
 v_sub_f32 v124,v124,v10
 v_sub_f32 v125,v125,v10
 v_sub_f32 v126,v126,v10
 v_sub_f32 v127,v127,v10
 v_sub_f32 v240,v240,v10
 v_sub_f32 v241,v241,v10
 v_sub_f32 v242,v242,v10
 v_sub_f32 v243,v243,v10
 v_mul_f32 v144,v12,v144
 v_mul_f32 v145,v12,v145
 v_mul_f32 v146,v12,v146
 v_mul_f32 v147,v12,v147
 v_mul_f32 v148,v12,v148
 v_mul_f32 v149,v12,v149
 v_mul_f32 v150,v12,v150
 v_mul_f32 v151,v12,v151
 v_mul_f32 v152,v12,v152
 v_mul_f32 v153,v12,v153
 v_mul_f32 v154,v12,v154
 v_mul_f32 v155,v12,v155
 v_mul_f32 v156,v12,v156
 v_mul_f32 v157,v12,v157
 v_mul_f32 v158,v12,v158
 v_mul_f32 v159,v12,v159
 v_mul_f32 v160,v12,v160
 v_mul_f32 v161,v12,v161
 v_mul_f32 v162,v12,v162
 v_mul_f32 v163,v12,v163
 v_mul_f32 v164,v12,v164
 v_mul_f32 v165,v12,v165
 v_mul_f32 v166,v12,v166
 v_mul_f32 v167,v12,v167
 v_mul_f32 v168,v12,v168
 v_mul_f32 v169,v12,v169
 v_mul_f32 v170,v12,v170
 v_mul_f32 v171,v12,v171
 v_mul_f32 v172,v12,v172
 v_mul_f32 v173,v12,v173
 v_mul_f32 v174,v12,v174
 v_mul_f32 v175,v12,v175
 v_mul_f32 v248,v12,v248
 v_sub_f32 v128,v128,v11
 v_sub_f32 v129,v129,v11
 v_sub_f32 v130,v130,v11
 v_sub_f32 v131,v131,v11
 v_sub_f32 v132,v132,v11
 v_sub_f32 v133,v133,v11
 v_sub_f32 v134,v134,v11
 v_sub_f32 v135,v135,v11
 v_sub_f32 v136,v136,v11
 v_sub_f32 v137,v137,v11
 v_sub_f32 v138,v138,v11
 v_sub_f32 v139,v139,v11
 v_sub_f32 v140,v140,v11
 v_sub_f32 v141,v141,v11
 v_sub_f32 v142,v142,v11
 v_sub_f32 v143,v143,v11
 v_sub_f32 v244,v244,v11
 v_sub_f32 v245,v245,v11
 v_sub_f32 v246,v246,v11
 v_sub_f32 v247,v247,v11
 v_mul_f32 v176,v13,v176
 v_mul_f32 v177,v13,v177
 v_mul_f32 v178,v13,v178
 v_mul_f32 v179,v13,v179
 v_mul_f32 v180,v13,v180
 v_mul_f32 v181,v13,v181
 v_mul_f32 v182,v13,v182
 v_mul_f32 v183,v13,v183
 v_mul_f32 v184,v13,v184
 v_mul_f32 v185,v13,v185
 v_mul_f32 v186,v13,v186
 v_mul_f32 v187,v13,v187
 v_mul_f32 v188,v13,v188
 v_mul_f32 v189,v13,v189
 v_mul_f32 v190,v13,v190
 v_mul_f32 v191,v13,v191
 v_mul_f32 v192,v13,v192
 v_mul_f32 v193,v13,v193
 v_mul_f32 v194,v13,v194
 v_mul_f32 v195,v13,v195
 v_mul_f32 v196,v13,v196
 v_mul_f32 v197,v13,v197
 v_mul_f32 v198,v13,v198
 v_mul_f32 v199,v13,v199
 v_mul_f32 v200,v13,v200
 v_mul_f32 v201,v13,v201
 v_mul_f32 v202,v13,v202
 v_mul_f32 v203,v13,v203
 v_mul_f32 v204,v13,v204
 v_mul_f32 v205,v13,v205
 v_mul_f32 v206,v13,v206
 v_mul_f32 v207,v13,v207
 v_mul_f32 v252,v13,v252
 s_nop 1
 s_branch L_ret5_y
L_resc6_y:
 s_nop 7
 v_max3_f32 v10,v10,v95,0
 v_max3_f32 v11,v11,v111,0
 v_mov_b32 v12,v10
 v_mov_b32 v13,v11
 s_nop 0
 v_permlane16_swap_b32 v10,v12
 v_permlane16_swap_b32 v11,v13
 v_max_f32 v10,v10,v12
 v_max_f32 v11,v11,v13
 v_mov_b32 v12,v10
 v_mov_b32 v13,v11
 s_nop 0
 v_permlane32_swap_b32 v10,v12
 v_permlane32_swap_b32 v11,v13
 v_max_f32 v10,v10,v12
 v_max_f32 v11,v11,v13
 v_sub_f32 v12,0,v10
 v_sub_f32 v13,0,v11
 v_exp_f32 v12,v12
 v_exp_f32 v13,v13
 v_sub_f32 v80,v80,v10
 v_sub_f32 v81,v81,v10
 v_sub_f32 v82,v82,v10
 v_sub_f32 v83,v83,v10
 v_sub_f32 v84,v84,v10
 v_sub_f32 v85,v85,v10
 v_sub_f32 v86,v86,v10
 v_sub_f32 v87,v87,v10
 v_sub_f32 v88,v88,v10
 v_sub_f32 v89,v89,v10
 v_sub_f32 v90,v90,v10
 v_sub_f32 v91,v91,v10
 v_sub_f32 v92,v92,v10
 v_sub_f32 v93,v93,v10
 v_sub_f32 v94,v94,v10
 v_sub_f32 v95,v95,v10
 v_sub_f32 v240,v240,v10
 v_sub_f32 v241,v241,v10
 v_sub_f32 v242,v242,v10
 v_sub_f32 v243,v243,v10
 v_mul_f32 v144,v12,v144
 v_mul_f32 v145,v12,v145
 v_mul_f32 v146,v12,v146
 v_mul_f32 v147,v12,v147
 v_mul_f32 v148,v12,v148
 v_mul_f32 v149,v12,v149
 v_mul_f32 v150,v12,v150
 v_mul_f32 v151,v12,v151
 v_mul_f32 v152,v12,v152
 v_mul_f32 v153,v12,v153
 v_mul_f32 v154,v12,v154
 v_mul_f32 v155,v12,v155
 v_mul_f32 v156,v12,v156
 v_mul_f32 v157,v12,v157
 v_mul_f32 v158,v12,v158
 v_mul_f32 v159,v12,v159
 v_mul_f32 v160,v12,v160
 v_mul_f32 v161,v12,v161
 v_mul_f32 v162,v12,v162
 v_mul_f32 v163,v12,v163
 v_mul_f32 v164,v12,v164
 v_mul_f32 v165,v12,v165
 v_mul_f32 v166,v12,v166
 v_mul_f32 v167,v12,v167
 v_mul_f32 v168,v12,v168
 v_mul_f32 v169,v12,v169
 v_mul_f32 v170,v12,v170
 v_mul_f32 v171,v12,v171
 v_mul_f32 v172,v12,v172
 v_mul_f32 v173,v12,v173
 v_mul_f32 v174,v12,v174
 v_mul_f32 v175,v12,v175
 v_mul_f32 v248,v12,v248
 v_sub_f32 v96,v96,v11
 v_sub_f32 v97,v97,v11
 v_sub_f32 v98,v98,v11
 v_sub_f32 v99,v99,v11
 v_sub_f32 v100,v100,v11
 v_sub_f32 v101,v101,v11
 v_sub_f32 v102,v102,v11
 v_sub_f32 v103,v103,v11
 v_sub_f32 v104,v104,v11
 v_sub_f32 v105,v105,v11
 v_sub_f32 v106,v106,v11
 v_sub_f32 v107,v107,v11
 v_sub_f32 v108,v108,v11
 v_sub_f32 v109,v109,v11
 v_sub_f32 v110,v110,v11
 v_sub_f32 v111,v111,v11
 v_sub_f32 v244,v244,v11
 v_sub_f32 v245,v245,v11
 v_sub_f32 v246,v246,v11
 v_sub_f32 v247,v247,v11
 v_mul_f32 v176,v13,v176
 v_mul_f32 v177,v13,v177
 v_mul_f32 v178,v13,v178
 v_mul_f32 v179,v13,v179
 v_mul_f32 v180,v13,v180
 v_mul_f32 v181,v13,v181
 v_mul_f32 v182,v13,v182
 v_mul_f32 v183,v13,v183
 v_mul_f32 v184,v13,v184
 v_mul_f32 v185,v13,v185
 v_mul_f32 v186,v13,v186
 v_mul_f32 v187,v13,v187
 v_mul_f32 v188,v13,v188
 v_mul_f32 v189,v13,v189
 v_mul_f32 v190,v13,v190
 v_mul_f32 v191,v13,v191
 v_mul_f32 v192,v13,v192
 v_mul_f32 v193,v13,v193
 v_mul_f32 v194,v13,v194
 v_mul_f32 v195,v13,v195
 v_mul_f32 v196,v13,v196
 v_mul_f32 v197,v13,v197
 v_mul_f32 v198,v13,v198
 v_mul_f32 v199,v13,v199
 v_mul_f32 v200,v13,v200
 v_mul_f32 v201,v13,v201
 v_mul_f32 v202,v13,v202
 v_mul_f32 v203,v13,v203
 v_mul_f32 v204,v13,v204
 v_mul_f32 v205,v13,v205
 v_mul_f32 v206,v13,v206
 v_mul_f32 v207,v13,v207
 v_mul_f32 v252,v13,v252
 s_nop 1
 s_branch L_ret6_y
L_resc7_y:
 s_nop 7
 v_max3_f32 v10,v10,v127,0
 v_max3_f32 v11,v11,v143,0
 v_mov_b32 v12,v10
 v_mov_b32 v13,v11
 s_nop 0
 v_permlane16_swap_b32 v10,v12
 v_permlane16_swap_b32 v11,v13
 v_max_f32 v10,v10,v12
 v_max_f32 v11,v11,v13
 v_mov_b32 v12,v10
 v_mov_b32 v13,v11
 s_nop 0
 v_permlane32_swap_b32 v10,v12
 v_permlane32_swap_b32 v11,v13
 v_max_f32 v10,v10,v12
 v_max_f32 v11,v11,v13
 v_sub_f32 v12,0,v10
 v_sub_f32 v13,0,v11
 v_exp_f32 v12,v12
 v_exp_f32 v13,v13
 v_sub_f32 v112,v112,v10
 v_sub_f32 v113,v113,v10
 v_sub_f32 v114,v114,v10
 v_sub_f32 v115,v115,v10
 v_sub_f32 v116,v116,v10
 v_sub_f32 v117,v117,v10
 v_sub_f32 v118,v118,v10
 v_sub_f32 v119,v119,v10
 v_sub_f32 v120,v120,v10
 v_sub_f32 v121,v121,v10
 v_sub_f32 v122,v122,v10
 v_sub_f32 v123,v123,v10
 v_sub_f32 v124,v124,v10
 v_sub_f32 v125,v125,v10
 v_sub_f32 v126,v126,v10
 v_sub_f32 v127,v127,v10
 v_sub_f32 v240,v240,v10
 v_sub_f32 v241,v241,v10
 v_sub_f32 v242,v242,v10
 v_sub_f32 v243,v243,v10
 v_mul_f32 v144,v12,v144
 v_mul_f32 v145,v12,v145
 v_mul_f32 v146,v12,v146
 v_mul_f32 v147,v12,v147
 v_mul_f32 v148,v12,v148
 v_mul_f32 v149,v12,v149
 v_mul_f32 v150,v12,v150
 v_mul_f32 v151,v12,v151
 v_mul_f32 v152,v12,v152
 v_mul_f32 v153,v12,v153
 v_mul_f32 v154,v12,v154
 v_mul_f32 v155,v12,v155
 v_mul_f32 v156,v12,v156
 v_mul_f32 v157,v12,v157
 v_mul_f32 v158,v12,v158
 v_mul_f32 v159,v12,v159
 v_mul_f32 v160,v12,v160
 v_mul_f32 v161,v12,v161
 v_mul_f32 v162,v12,v162
 v_mul_f32 v163,v12,v163
 v_mul_f32 v164,v12,v164
 v_mul_f32 v165,v12,v165
 v_mul_f32 v166,v12,v166
 v_mul_f32 v167,v12,v167
 v_mul_f32 v168,v12,v168
 v_mul_f32 v169,v12,v169
 v_mul_f32 v170,v12,v170
 v_mul_f32 v171,v12,v171
 v_mul_f32 v172,v12,v172
 v_mul_f32 v173,v12,v173
 v_mul_f32 v174,v12,v174
 v_mul_f32 v175,v12,v175
 v_mul_f32 v248,v12,v248
 v_sub_f32 v128,v128,v11
 v_sub_f32 v129,v129,v11
 v_sub_f32 v130,v130,v11
 v_sub_f32 v131,v131,v11
 v_sub_f32 v132,v132,v11
 v_sub_f32 v133,v133,v11
 v_sub_f32 v134,v134,v11
 v_sub_f32 v135,v135,v11
 v_sub_f32 v136,v136,v11
 v_sub_f32 v137,v137,v11
 v_sub_f32 v138,v138,v11
 v_sub_f32 v139,v139,v11
 v_sub_f32 v140,v140,v11
 v_sub_f32 v141,v141,v11
 v_sub_f32 v142,v142,v11
 v_sub_f32 v143,v143,v11
 v_sub_f32 v244,v244,v11
 v_sub_f32 v245,v245,v11
 v_sub_f32 v246,v246,v11
 v_sub_f32 v247,v247,v11
 v_mul_f32 v176,v13,v176
 v_mul_f32 v177,v13,v177
 v_mul_f32 v178,v13,v178
 v_mul_f32 v179,v13,v179
 v_mul_f32 v180,v13,v180
 v_mul_f32 v181,v13,v181
 v_mul_f32 v182,v13,v182
 v_mul_f32 v183,v13,v183
 v_mul_f32 v184,v13,v184
 v_mul_f32 v185,v13,v185
 v_mul_f32 v186,v13,v186
 v_mul_f32 v187,v13,v187
 v_mul_f32 v188,v13,v188
 v_mul_f32 v189,v13,v189
 v_mul_f32 v190,v13,v190
 v_mul_f32 v191,v13,v191
 v_mul_f32 v192,v13,v192
 v_mul_f32 v193,v13,v193
 v_mul_f32 v194,v13,v194
 v_mul_f32 v195,v13,v195
 v_mul_f32 v196,v13,v196
 v_mul_f32 v197,v13,v197
 v_mul_f32 v198,v13,v198
 v_mul_f32 v199,v13,v199
 v_mul_f32 v200,v13,v200
 v_mul_f32 v201,v13,v201
 v_mul_f32 v202,v13,v202
 v_mul_f32 v203,v13,v203
 v_mul_f32 v204,v13,v204
 v_mul_f32 v205,v13,v205
 v_mul_f32 v206,v13,v206
 v_mul_f32 v207,v13,v207
 v_mul_f32 v252,v13,v252
 s_nop 1
 s_branch L_ret7_y
L_resc7last_y:
 s_nop 7
 v_max3_f32 v10,v10,v127,0
 v_max3_f32 v11,v11,v143,0
 v_mov_b32 v12,v10
 v_mov_b32 v13,v11
 s_nop 0
 v_permlane16_swap_b32 v10,v12
 v_permlane16_swap_b32 v11,v13
 v_max_f32 v10,v10,v12
 v_max_f32 v11,v11,v13
 v_mov_b32 v12,v10
 v_mov_b32 v13,v11
 s_nop 0
 v_permlane32_swap_b32 v10,v12
 v_permlane32_swap_b32 v11,v13
 v_max_f32 v10,v10,v12
 v_max_f32 v11,v11,v13
 v_sub_f32 v12,0,v10
 v_sub_f32 v13,0,v11
 v_exp_f32 v12,v12
 v_exp_f32 v13,v13
 v_sub_f32 v112,v112,v10
 v_sub_f32 v113,v113,v10
 v_sub_f32 v114,v114,v10
 v_sub_f32 v115,v115,v10
 v_sub_f32 v116,v116,v10
 v_sub_f32 v117,v117,v10
 v_sub_f32 v118,v118,v10
 v_sub_f32 v119,v119,v10
 v_sub_f32 v120,v120,v10
 v_sub_f32 v121,v121,v10
 v_sub_f32 v122,v122,v10
 v_sub_f32 v123,v123,v10
 v_sub_f32 v124,v124,v10
 v_sub_f32 v125,v125,v10
 v_sub_f32 v126,v126,v10
 v_sub_f32 v127,v127,v10
 v_sub_f32 v240,v240,v10
 v_sub_f32 v241,v241,v10
 v_sub_f32 v242,v242,v10
 v_sub_f32 v243,v243,v10
 v_mul_f32 v144,v12,v144
 v_mul_f32 v145,v12,v145
 v_mul_f32 v146,v12,v146
 v_mul_f32 v147,v12,v147
 v_mul_f32 v148,v12,v148
 v_mul_f32 v149,v12,v149
 v_mul_f32 v150,v12,v150
 v_mul_f32 v151,v12,v151
 v_mul_f32 v152,v12,v152
 v_mul_f32 v153,v12,v153
 v_mul_f32 v154,v12,v154
 v_mul_f32 v155,v12,v155
 v_mul_f32 v156,v12,v156
 v_mul_f32 v157,v12,v157
 v_mul_f32 v158,v12,v158
 v_mul_f32 v159,v12,v159
 v_mul_f32 v160,v12,v160
 v_mul_f32 v161,v12,v161
 v_mul_f32 v162,v12,v162
 v_mul_f32 v163,v12,v163
 v_mul_f32 v164,v12,v164
 v_mul_f32 v165,v12,v165
 v_mul_f32 v166,v12,v166
 v_mul_f32 v167,v12,v167
 v_mul_f32 v168,v12,v168
 v_mul_f32 v169,v12,v169
 v_mul_f32 v170,v12,v170
 v_mul_f32 v171,v12,v171
 v_mul_f32 v172,v12,v172
 v_mul_f32 v173,v12,v173
 v_mul_f32 v174,v12,v174
 v_mul_f32 v175,v12,v175
 v_mul_f32 v248,v12,v248
 v_sub_f32 v128,v128,v11
 v_sub_f32 v129,v129,v11
 v_sub_f32 v130,v130,v11
 v_sub_f32 v131,v131,v11
 v_sub_f32 v132,v132,v11
 v_sub_f32 v133,v133,v11
 v_sub_f32 v134,v134,v11
 v_sub_f32 v135,v135,v11
 v_sub_f32 v136,v136,v11
 v_sub_f32 v137,v137,v11
 v_sub_f32 v138,v138,v11
 v_sub_f32 v139,v139,v11
 v_sub_f32 v140,v140,v11
 v_sub_f32 v141,v141,v11
 v_sub_f32 v142,v142,v11
 v_sub_f32 v143,v143,v11
 v_sub_f32 v244,v244,v11
 v_sub_f32 v245,v245,v11
 v_sub_f32 v246,v246,v11
 v_sub_f32 v247,v247,v11
 v_mul_f32 v176,v13,v176
 v_mul_f32 v177,v13,v177
 v_mul_f32 v178,v13,v178
 v_mul_f32 v179,v13,v179
 v_mul_f32 v180,v13,v180
 v_mul_f32 v181,v13,v181
 v_mul_f32 v182,v13,v182
 v_mul_f32 v183,v13,v183
 v_mul_f32 v184,v13,v184
 v_mul_f32 v185,v13,v185
 v_mul_f32 v186,v13,v186
 v_mul_f32 v187,v13,v187
 v_mul_f32 v188,v13,v188
 v_mul_f32 v189,v13,v189
 v_mul_f32 v190,v13,v190
 v_mul_f32 v191,v13,v191
 v_mul_f32 v192,v13,v192
 v_mul_f32 v193,v13,v193
 v_mul_f32 v194,v13,v194
 v_mul_f32 v195,v13,v195
 v_mul_f32 v196,v13,v196
 v_mul_f32 v197,v13,v197
 v_mul_f32 v198,v13,v198
 v_mul_f32 v199,v13,v199
 v_mul_f32 v200,v13,v200
 v_mul_f32 v201,v13,v201
 v_mul_f32 v202,v13,v202
 v_mul_f32 v203,v13,v203
 v_mul_f32 v204,v13,v204
 v_mul_f32 v205,v13,v205
 v_mul_f32 v206,v13,v206
 v_mul_f32 v207,v13,v207
 v_mul_f32 v252,v13,v252
 s_nop 1
 s_branch L_ret7last_y
L_attn_ys:
 s_and_b32 s40,s33,1
 s_mul_i32 s40,s40,4096
 s_lshr_b32 s46,s33,1
 s_mul_i32 s46,s46,8192
 s_add_u32 s40,s40,s46
 v_add_u32 v14,s40,v14
 s_waitcnt vmcnt(4)
 s_barrier
 s_xor_b32 s40,s52,256
 s_add_u32 m0,s42,135168
 s_nop 0
 buffer_load_dwordx4 v20,s[24:27],s40 offen lds
 buffer_load_dwordx4 v21,s[24:27],s40 offen offset:1024 lds
 buffer_load_dwordx4 v22,s[24:27],s40 offen offset:2048 lds
 buffer_load_dwordx4 v23,s[24:27],s40 offen offset:3072 lds
 s_xor_b32 s46,s53,1048576
 s_add_u32 s46,s46,s44
 s_add_u32 m0,s41,101376
 s_add_u32 s40,s46,0
 buffer_load_dwordx4 v2,s[16:19],s40 offen lds
 s_add_u32 m0,s41,102432
 s_add_u32 s40,s46,16384
 buffer_load_dwordx4 v2,s[16:19],s40 offen lds
 s_add_u32 m0,s41,103488
 s_add_u32 s40,s46,65536
 buffer_load_dwordx4 v2,s[16:19],s40 offen lds
 s_add_u32 m0,s41,104544
 s_add_u32 s40,s46,81920
 buffer_load_dwordx4 v2,s[16:19],s40 offen lds
 s_waitcnt vmcnt(8)
 s_barrier
 s_xor_b32 s46,s53,1048576
 s_add_u32 s46,s46,s44
 s_add_u32 m0,s41,118272
 s_add_u32 s40,s46,128
 buffer_load_dwordx4 v2,s[16:19],s40 offen lds
 s_add_u32 m0,s41,119328
 s_add_u32 s40,s46,16512
 buffer_load_dwordx4 v2,s[16:19],s40 offen lds
 s_add_u32 m0,s41,120384
 s_add_u32 s40,s46,65664
 buffer_load_dwordx4 v2,s[16:19],s40 offen lds
 s_add_u32 m0,s41,121440
 s_add_u32 s40,s46,82048
 buffer_load_dwordx4 v2,s[16:19],s40 offen lds
 s_xor_b32 s46,s53,2097152
 s_add_u32 s46,s46,s44
 s_add_u32 m0,s41,67584
 s_add_u32 s40,s46,0
 buffer_load_dwordx4 v2,s[16:19],s40 offen lds
 s_add_u32 m0,s41,68640
 s_add_u32 s40,s46,16384
 buffer_load_dwordx4 v2,s[16:19],s40 offen lds
 s_add_u32 m0,s41,69696
 s_add_u32 s40,s46,65536
 buffer_load_dwordx4 v2,s[16:19],s40 offen lds
 s_add_u32 m0,s41,70752
 s_add_u32 s40,s46,81920
 buffer_load_dwordx4 v2,s[16:19],s40 offen lds
 s_waitcnt vmcnt(8)
 s_barrier
 s_xor_b32 s40,s52,512
 s_add_u32 m0,s42,33792
 s_nop 0
 buffer_load_dwordx4 v20,s[24:27],s40 offen lds
 buffer_load_dwordx4 v21,s[24:27],s40 offen offset:1024 lds
 buffer_load_dwordx4 v22,s[24:27],s40 offen offset:2048 lds
 buffer_load_dwordx4 v23,s[24:27],s40 offen offset:3072 lds
 s_xor_b32 s46,s53,3145728
 s_add_u32 s46,s46,s44
 s_add_u32 m0,s41,84480
 s_add_u32 s40,s46,0
 buffer_load_dwordx4 v2,s[16:19],s40 offen lds
 s_add_u32 m0,s41,85536
 s_add_u32 s40,s46,16384
 buffer_load_dwordx4 v2,s[16:19],s40 offen lds
 s_add_u32 m0,s41,86592
 s_add_u32 s40,s46,65536
 buffer_load_dwordx4 v2,s[16:19],s40 offen lds
 s_add_u32 m0,s41,87648
 s_add_u32 s40,s46,81920
 buffer_load_dwordx4 v2,s[16:19],s40 offen lds
 s_waitcnt vmcnt(12)
 s_barrier
 s_xor_b32 s40,s52,768
 s_add_u32 m0,s42,135168
 s_nop 0
 buffer_load_dwordx4 v20,s[24:27],s40 offen lds
 buffer_load_dwordx4 v21,s[24:27],s40 offen offset:1024 lds
 buffer_load_dwordx4 v22,s[24:27],s40 offen offset:2048 lds
 buffer_load_dwordx4 v23,s[24:27],s40 offen offset:3072 lds
 s_xor_b32 s46,s53,2097152
 s_add_u32 s46,s46,s44
 s_add_u32 m0,s41,101376
 s_add_u32 s40,s46,128
 buffer_load_dwordx4 v2,s[16:19],s40 offen lds
 s_add_u32 m0,s41,102432
 s_add_u32 s40,s46,16512
 buffer_load_dwordx4 v2,s[16:19],s40 offen lds
 s_add_u32 m0,s41,103488
 s_add_u32 s40,s46,65664
 buffer_load_dwordx4 v2,s[16:19],s40 offen lds
 s_add_u32 m0,s41,104544
 s_add_u32 s40,s46,82048
 buffer_load_dwordx4 v2,s[16:19],s40 offen lds
 s_mov_b32 s40,0
 s_add_u32 m0,s41,16896
 s_nop 0
 buffer_load_dwordx4 v14,s[8:11],s40 offen nt lds
 s_mov_b32 s40,1024
 s_add_u32 m0,s41,17952
 s_nop 0
 buffer_load_dwordx4 v14,s[8:11],s40 offen nt lds
 s_mov_b32 s40,2048
 s_add_u32 m0,s41,19008
 s_nop 0
 buffer_load_dwordx4 v14,s[8:11],s40 offen nt lds
 s_mov_b32 s40,3072
 s_add_u32 m0,s41,20064
 s_nop 0
 buffer_load_dwordx4 v14,s[8:11],s40 offen nt lds
 s_waitcnt vmcnt(16)
 s_barrier
 s_xor_b32 s46,s53,3145728
 s_add_u32 s46,s46,s44
 s_add_u32 m0,s41,118272
 s_add_u32 s40,s46,128
 buffer_load_dwordx4 v2,s[16:19],s40 offen lds
 s_add_u32 m0,s41,119328
 s_add_u32 s40,s46,16512
 buffer_load_dwordx4 v2,s[16:19],s40 offen lds
 s_add_u32 m0,s41,120384
 s_add_u32 s40,s46,65664
 buffer_load_dwordx4 v2,s[16:19],s40 offen lds
 s_add_u32 m0,s41,121440
 s_add_u32 s40,s46,82048
 buffer_load_dwordx4 v2,s[16:19],s40 offen lds
 s_waitcnt vmcnt(12)
 s_barrier
 v_mov_b32 v240,0
 v_mov_b32 v241,0
 v_mov_b32 v242,0
 v_mov_b32 v243,0
 v_mov_b32 v244,0
 v_mov_b32 v245,0
 v_mov_b32 v246,0
 v_mov_b32 v247,0
 s_waitcnt vmcnt(8)
 s_barrier
 s_mov_b32 s40,16384
 s_add_u32 m0,s41,0
 s_nop 0
 buffer_load_dwordx4 v14,s[8:11],s40 offen nt lds
 s_mov_b32 s40,17408
 s_add_u32 m0,s41,1056
 s_nop 0
 buffer_load_dwordx4 v14,s[8:11],s40 offen nt lds
 s_mov_b32 s40,18432
 s_add_u32 m0,s41,2112
 s_nop 0
 buffer_load_dwordx4 v14,s[8:11],s40 offen nt lds
 s_mov_b32 s40,19456
 s_add_u32 m0,s41,3168
 s_nop 0
 buffer_load_dwordx4 v14,s[8:11],s40 offen nt lds
 v_and_b32 v10,15,v1
 v_mul_u32_u24 v2,1056,v10
 v_and_b32 v10,48,v1
 v_add_u32 v2,v2,v10
 v_lshrrev_b32 v10,2,v1
 v_mul_u32_u24 v3,1056,v10
 v_and_b32 v10,3,v1
 v_lshl_add_u32 v3,v10,3,v3
 v_cmp_eq_u32 vcc,0,v10
 v_mov_b32 v11,0x3f803f80
 s_nop 0
 v_cndmask_b32 v6,0,v11,vcc
 v_cndmask_b32 v7,0,v11,vcc
 v_cndmask_b32 v8,0,v11,vcc
 v_cndmask_b32 v9,0,v11,vcc
 v_and_b32 v4,15,v1
 s_lshl_b32 s40,s33,5
 v_add_lshl_u32 v4,v4,s40,4
 v_lshrrev_b32 v10,4,v1
 v_mul_u32_u24 v10,1792,v10
 v_add_u32 v4,v4,v10
 v_add_u32 v4,135168,v4
 s_mov_b32 s40,256
 s_cmp_eq_u32 s33,3
 s_cselect_b32 s40,65536,s40
 v_add_u32 v5,s40,v4
 s_waitcnt vmcnt(4)
 s_barrier
 v_mov_b32 v10,16880
 v_mov_b32 v11,0
 ds_write_b32 v10,v11
 s_setprio 1
 s_waitcnt lgkmcnt(0)
 s_barrier
 ds_read_b128 v[48:51],v4
 ds_read_b128 v[56:59],v4 offset:7168
 ds_read_b128 v[64:67],v4 offset:14336
 ds_read_b128 v[72:75],v4 offset:21504
 ds_read_b128 v[16:19],v2 offset:16896
 ds_read_b128 v[20:23],v2 offset:16960
 ds_read_b128 v[24:27],v2 offset:17024
 ds_read_b128 v[28:31],v2 offset:17088
 ds_read_b128 v[32:35],v2 offset:17152
 ds_read_b128 v[36:39],v2 offset:17216
 ds_read_b128 v[40:43],v2 offset:17280
 s_waitcnt lgkmcnt(5)
 mf 80,16,48,240
 ds_read_b128 v[44:47],v2 offset:17344
 mf 80,20,56,80
 ds_read_b128 v[16:19],v2 offset:17408
 s_waitcnt lgkmcnt(5)
 mf 80,24,64,80
 ds_read_b128 v[20:23],v2 offset:17472
 mf 80,28,72,80
 ds_read_b128 v[24:27],v2 offset:17536
 s_waitcnt lgkmcnt(5)
 mf 84,32,48,240
 ds_read_b128 v[28:31],v2 offset:17600
 mf 84,36,56,84
 ds_read_b128 v[32:35],v2 offset:17664
 s_waitcnt lgkmcnt(5)
 mf 84,40,64,84
 ds_read_b128 v[36:39],v2 offset:17728
 mf 84,44,72,84
 ds_read_b128 v[40:43],v2 offset:17792
 s_waitcnt lgkmcnt(5)
 mf 88,16,48,240
 ds_read_b128 v[44:47],v2 offset:17856
 mf 88,20,56,88
 s_waitcnt lgkmcnt(4)
 mf 88,24,64,88
 mf 88,28,72,88
 s_waitcnt lgkmcnt(2)
 mf 92,32,48,240
 mf 92,36,56,92
 s_waitcnt lgkmcnt(0)
 mf 92,40,64,92
 mf 92,44,72,92
 v_max3_f32 v10,v80,v81,v82
 v_max3_f32 v10,v10,v83,v84
 v_max3_f32 v10,v10,v85,v86
 v_max3_f32 v10,v10,v87,v88
 v_max3_f32 v10,v10,v89,v90
 s_nop 2
 v_max3_f32 v10,v10,v91,v92
 s_waitcnt vmcnt(0)
 s_mov_b32 s39,0
 s_barrier
 ds_read_b128 v[16:19],v2
 ds_read_b128 v[20:23],v2 offset:64
 ds_read_b128 v[24:27],v2 offset:128
 ds_read_b128 v[28:31],v2 offset:192
 ds_read_b128 v[32:35],v2 offset:256
 ds_read_b128 v[36:39],v2 offset:320
 ds_read_b128 v[40:43],v2 offset:384
 v_max3_f32 v10,v10,v93,v94
 v_max_f32 v12,v10,v95
 v_max_f32_e64 v12,|v12|,|v12|
 v_cmp_nge_f32 vcc,s4,v12
 s_cbranch_vccnz L_resc0first_ys
L_ret0first_ys:
 s_waitcnt lgkmcnt(5)
 mf 112,16,48,240
 ds_read_b128 v[44:47],v2 offset:448
 v_exp_f32 v80,v80
 mf 112,20,56,112
 ds_read_b128 v[16:19],v2 offset:512
 v_exp_f32 v81,v81
 s_waitcnt lgkmcnt(5)
 mf 112,24,64,112
 ds_read_b128 v[20:23],v2 offset:576
 v_exp_f32 v82,v82
 mf 112,28,72,112
 ds_read_b128 v[24:27],v2 offset:640
 v_exp_f32 v83,v83
 s_waitcnt lgkmcnt(5)
 mf 116,32,48,240
 ds_read_b128 v[28:31],v2 offset:704
 v_exp_f32 v84,v84
 mf 116,36,56,116
 ds_read_b128 v[32:35],v2 offset:768
 v_exp_f32 v85,v85
 s_waitcnt lgkmcnt(5)
 mf 116,40,64,116
 ds_read_b128 v[36:39],v2 offset:832
 v_exp_f32 v86,v86
 mf 116,44,72,116
 ds_read_b128 v[40:43],v2 offset:896
 v_exp_f32 v87,v87
 s_waitcnt lgkmcnt(5)
 mf 120,16,48,240
 ds_read_b128 v[44:47],v2 offset:960
 cv 80,80,81
 mf 120,20,56,120
 cv 81,82,83
 s_waitcnt lgkmcnt(4)
 mf 120,24,64,120
 cv 82,84,85
 mf 120,28,72,120
 cv 83,86,87
 s_waitcnt lgkmcnt(0)
 s_branch L_aloop1_ys
L_aloop_ys:
 s_barrier
 ds_read_b128 v[16:19],v2
 ds_read_b128 v[20:23],v2 offset:64
 ds_read_b128 v[24:27],v2 offset:128
 mf 160,32,120,160
 ds_read_b128 v[28:31],v2 offset:192
 v_max3_f32 v10,v10,v93,v94
 v_max_f32 v12,v10,v95
 v_max_f32_e64 v12,|v12|,|v12|
 v_cmp_nge_f32 vcc,s4,v12
 s_cbranch_vccnz L_resc0_ys
L_ret0_ys:
 v_exp_f32 v80,v80
 mf 164,36,120,164
 ds_read_b128 v[32:35],v2 offset:256
 v_exp_f32 v81,v81
 v_exp_f32 v82,v82
 v_exp_f32 v83,v83
 mf 168,40,120,168
 ds_read_b128 v[36:39],v2 offset:320
 v_exp_f32 v84,v84
 v_exp_f32 v85,v85
 v_exp_f32 v86,v86
 mf 172,44,120,172
 ds_read_b128 v[40:43],v2 offset:384
 v_exp_f32 v87,v87
 cv 80,80,81
 cv 81,82,83
 cv 82,84,85
 s_waitcnt lgkmcnt(5)
 mf 112,16,48,240
 ds_read_b128 v[44:47],v2 offset:448
 cv 83,86,87
 v_rcp_f32 v10,v248
 s_nop 0
 v_mul_f32 v144,v10,v144
 v_mul_f32 v145,v10,v145
 mf 112,20,56,112
 ds_read_b128 v[16:19],v2 offset:512
 v_mul_f32 v146,v10,v146
 v_mul_f32 v147,v10,v147
 v_mul_f32 v148,v10,v148
 v_mul_f32 v149,v10,v149
 v_mul_f32 v150,v10,v150
 s_waitcnt lgkmcnt(5)
 mf 112,24,64,112
 ds_read_b128 v[20:23],v2 offset:576
 v_mul_f32 v151,v10,v151
 cv 144,144,145
 cv 145,146,147
 cv 146,148,149
 cv 147,150,151
 mf 112,28,72,112
 ds_read_b128 v[24:27],v2 offset:640
 ds_write_b128 v4,v[144:147]
 v_mul_f32 v152,v10,v152
 v_mul_f32 v153,v10,v153
 s_waitcnt lgkmcnt(6)
 mf 116,32,48,240
 ds_read_b128 v[28:31],v2 offset:704
 v_mul_f32 v154,v10,v154
 v_mul_f32 v155,v10,v155
 v_mul_f32 v156,v10,v156
 v_mul_f32 v157,v10,v157
 v_mul_f32 v158,v10,v158
 mf 116,36,56,116
 ds_read_b128 v[32:35],v2 offset:768
 v_mul_f32 v159,v10,v159
 cv 152,152,153
 cv 153,154,155
 cv 154,156,157
 cv 155,158,159
 s_waitcnt lgkmcnt(6)
 mf 116,40,64,116
 ds_read_b128 v[36:39],v2 offset:832
 ds_write_b128 v4,v[152:155] offset:7168
 v_mul_f32 v160,v10,v160
 v_mul_f32 v161,v10,v161
 v_mul_f32 v162,v10,v162
 mf 116,44,72,116
 ds_read_b128 v[40:43],v2 offset:896
 v_mul_f32 v163,v10,v163
 v_mul_f32 v164,v10,v164
 v_mul_f32 v165,v10,v165
 v_mul_f32 v166,v10,v166
 v_mul_f32 v167,v10,v167
 s_waitcnt lgkmcnt(7)
 mf 120,16,48,240
 ds_read_b128 v[44:47],v2 offset:960
 cv 160,160,161
 cv 161,162,163
 cv 162,164,165
 cv 163,166,167
 ds_write_b128 v4,v[160:163] offset:14336
 mf 120,20,56,120
 v_mul_f32 v168,v10,v168
 v_mul_f32 v169,v10,v169
 v_mul_f32 v170,v10,v170
 v_mul_f32 v171,v10,v171
 v_mul_f32 v172,v10,v172
 s_waitcnt lgkmcnt(6)
 mf 120,24,64,120
 v_mul_f32 v173,v10,v173
 v_mul_f32 v174,v10,v174
 v_mul_f32 v175,v10,v175
 cv 168,168,169
 cv 169,170,171
 mf 120,28,72,120
 cv 170,172,173
 cv 171,174,175
 ds_write_b128 v4,v[168:171] offset:21504
 s_waitcnt lgkmcnt(0)
L_aloop1_ys:
 s_barrier
 tr 16,3,33792
 tr 18,3,34048
 tr 20,3,33824
 tr 22,3,34080
 tr 24,3,33856
 tr 26,3,34112
 mf 124,32,48,240
 tr 28,3,33888
 tr 30,3,34144
 v_exp_f32 v88,v88
 mf 124,36,56,124
 tr 32,3,33920
 tr 34,3,34176
 v_exp_f32 v89,v89
 mf 124,40,64,124
 tr 36,3,33952
 tr 38,3,34208
 v_exp_f32 v90,v90
 mf 124,44,72,124
 tr 40,3,33984
 tr 42,3,34240
 v_exp_f32 v91,v91
 s_waitcnt lgkmcnt(10)
 mz 144,16,80
 tr 44,3,34016
 tr 46,3,34272
 v_exp_f32 v92,v92
 mz 248,6,80
 v_exp_f32 v93,v93
 mz 148,20,80
 tr 16,3,34304
 tr 18,3,34560
 v_exp_f32 v94,v94
 s_waitcnt lgkmcnt(10)
 mz 152,24,80
 tr 20,3,34336
 tr 22,3,34592
 v_exp_f32 v95,v95
 mz 156,28,80
 tr 24,3,34368
 tr 26,3,34624
 cv 88,88,89
 s_waitcnt lgkmcnt(10)
 mz 160,32,80
 tr 28,3,34400
 tr 30,3,34656
 cv 89,90,91
 mz 164,36,80
 tr 32,3,34432
 tr 34,3,34688
 cv 90,92,93
 s_waitcnt lgkmcnt(10)
 mz 168,40,80
 tr 36,3,34464
 tr 38,3,34720
 cv 91,94,95
 mz 172,44,80
 tr 40,3,34496
 tr 42,3,34752
 v_max3_f32 v10,v112,v113,v114
 s_waitcnt lgkmcnt(10)
 mf 144,16,88,144
 tr 44,3,34528
 tr 46,3,34784
 v_max3_f32 v10,v10,v115,v116
 mf 248,6,88,248
 v_max3_f32 v10,v10,v117,v118
 mf 148,20,88,148
 v_max3_f32 v10,v10,v119,v120
 s_waitcnt lgkmcnt(8)
 mf 152,24,88,152
 v_max3_f32 v10,v10,v121,v122
 mf 156,28,88,156
 s_cmp_lg_u32 s39,1
 s_waitcnt lgkmcnt(0)
 s_cbranch_scc1 L_nokeep_ys
 ds_read_b128 v[208:211],v4
 ds_read_b128 v[216:219],v4 offset:7168
 ds_read_b128 v[224:227],v4 offset:14336
 ds_read_b128 v[232:235],v4 offset:21504
 s_waitcnt lgkmcnt(0)
L_nokeep_ys:
 s_barrier
 ds_read_b128 v[16:19],v2 offset:16896
 ds_read_b128 v[20:23],v2 offset:16960
 ds_read_b128 v[24:27],v2 offset:17024
 mf 160,32,88,160
 ds_read_b128 v[28:31],v2 offset:17088
 v_max3_f32 v10,v10,v123,v124
 v_max3_f32 v10,v10,v125,v126
 v_max_f32 v12,v10,v127
 mf 164,36,88,164
 ds_read_b128 v[32:35],v2 offset:17152
 v_cmp_nge_f32 vcc,s4,v12
 mf 168,40,88,168
 ds_read_b128 v[36:39],v2 offset:17216
 mf 172,44,88,172
 ds_read_b128 v[40:43],v2 offset:17280
 s_cbranch_vccnz L_resc1_ys
L_ret1_ys:
 v_exp_f32 v112,v112
 v_exp_f32 v113,v113
 s_waitcnt lgkmcnt(5)
 mf 80,16,48,240
 ds_read_b128 v[44:47],v2 offset:17344
 v_exp_f32 v114,v114
 v_exp_f32 v115,v115
 mf 80,20,56,80
 ds_read_b128 v[16:19],v2 offset:17408
 v_exp_f32 v116,v116
 s_waitcnt lgkmcnt(5)
 mf 80,24,64,80
 ds_read_b128 v[20:23],v2 offset:17472
 v_exp_f32 v117,v117
 v_exp_f32 v118,v118
 mf 80,28,72,80
 ds_read_b128 v[24:27],v2 offset:17536
 v_exp_f32 v119,v119
 cv 112,112,113
 s_waitcnt lgkmcnt(5)
 mf 84,32,48,240
 ds_read_b128 v[28:31],v2 offset:17600
 cv 113,114,115
 cv 114,116,117
 cv 115,118,119
 mf 84,36,56,84
 ds_read_b128 v[32:35],v2 offset:17664
 v_exp_f32 v120,v120
 s_waitcnt lgkmcnt(5)
 mf 84,40,64,84
 ds_read_b128 v[36:39],v2 offset:17728
 v_exp_f32 v121,v121
 v_exp_f32 v122,v122
 mf 84,44,72,84
 ds_read_b128 v[40:43],v2 offset:17792
 v_exp_f32 v123,v123
 s_waitcnt lgkmcnt(5)
 mf 88,16,48,240
 ds_read_b128 v[44:47],v2 offset:17856
 v_exp_f32 v124,v124
 v_exp_f32 v125,v125
 mf 88,20,56,88
 v_exp_f32 v126,v126
 s_waitcnt lgkmcnt(4)
 mf 88,24,64,88
 v_exp_f32 v127,v127
 cv 120,120,121
 mf 88,28,72,88
 cv 121,122,123
 cv 122,124,125
 cv 123,126,127
 s_waitcnt lgkmcnt(0)
 s_barrier
 tr 16,3,50688
 tr 18,3,50944
 tr 20,3,50720
 tr 22,3,50976
 tr 24,3,50752
 tr 26,3,51008
 mf 92,32,48,240
 tr 28,3,50784
 tr 30,3,51040
 mf 92,36,56,92
 tr 32,3,50816
 tr 34,3,51072
 mf 92,40,64,92
 tr 36,3,50848
 tr 38,3,51104
 mf 92,44,72,92
 tr 40,3,50880
 tr 42,3,51136
 s_waitcnt lgkmcnt(10)
 mf 144,16,112,144
 tr 44,3,50912
 tr 46,3,51168
 mf 248,6,112,248
 v_max3_f32 v10,v80,v81,v82
 mf 148,20,112,148
 tr 16,3,51200
 tr 18,3,51456
 v_max3_f32 v10,v10,v83,v84
 v_max3_f32 v10,v10,v85,v86
 s_waitcnt lgkmcnt(10)
 mf 152,24,112,152
 tr 20,3,51232
 tr 22,3,51488
 v_max3_f32 v10,v10,v87,v88
 mf 156,28,112,156
 tr 24,3,51264
 tr 26,3,51520
 v_max3_f32 v10,v10,v89,v90
 v_mbcnt_lo_u32_b32 v1,-1,0
 s_waitcnt lgkmcnt(10)
 mf 160,32,112,160
 tr 28,3,51296
 tr 30,3,51552
 v_mbcnt_hi_u32_b32 v1,-1,v1
 s_add_u32 s47,s36,s39
 mf 164,36,112,164
 tr 32,3,51328
 tr 34,3,51584
 v_lshrrev_b32 v0,2,v1
 v_lshlrev_b32 v0,13,v0
 s_waitcnt lgkmcnt(10)
 mf 168,40,112,168
 tr 36,3,51360
 tr 38,3,51616
 v_and_b32 v1,3,v1
 mf 172,44,112,172
 tr 40,3,51392
 tr 42,3,51648
 v_lshl_add_u32 v0,v1,6,v0
 s_lshl_b32 s46,s35,18
 s_lshl_b32 s47,s47,8
 s_add_u32 s46,s46,s47
 s_add_u32 s46,s46,512
 s_cmp_lt_u32 s39,2
 s_cselect_b32 s46,s46,0
 s_waitcnt lgkmcnt(10)
 mf 144,16,120,144
 tr 44,3,51424
 tr 46,3,51680
 mf 248,6,120,248
 buffer_load_dword v176,v0,s[16:19],s46 offen
 mf 148,20,120,148
 s_add_u32 s46,s46,131072
 s_waitcnt lgkmcnt(8)
 mf 152,24,120,152
 buffer_load_dword v177,v0,s[16:19],s46 offen
 mf 156,28,120,156
 s_waitcnt lgkmcnt(0)
 s_barrier
 ds_read_b128 v[16:19],v2
 ds_read_b128 v[20:23],v2 offset:64
 ds_read_b128 v[24:27],v2 offset:128
 mf 160,32,120,160
 ds_read_b128 v[28:31],v2 offset:192
 v_max3_f32 v10,v10,v91,v92
 v_max3_f32 v10,v10,v93,v94
 v_max_f32 v12,v10,v95
 mf 164,36,120,164
 ds_read_b128 v[32:35],v2 offset:256
 v_cmp_nge_f32 vcc,s4,v12
 mf 168,40,120,168
 ds_read_b128 v[36:39],v2 offset:320
 mf 172,44,120,172
 ds_read_b128 v[40:43],v2 offset:384
 s_cbranch_vccnz L_resc2_ys
L_ret2_ys:
 v_exp_f32 v80,v80
 v_exp_f32 v81,v81
 s_waitcnt lgkmcnt(5)
 mf 112,16,48,240
 ds_read_b128 v[44:47],v2 offset:448
 v_exp_f32 v82,v82
 v_exp_f32 v83,v83
 mf 112,20,56,112
 ds_read_b128 v[16:19],v2 offset:512
 v_exp_f32 v84,v84
 s_waitcnt lgkmcnt(5)
 mf 112,24,64,112
 ds_read_b128 v[20:23],v2 offset:576
 v_exp_f32 v85,v85
 v_exp_f32 v86,v86
 mf 112,28,72,112
 ds_read_b128 v[24:27],v2 offset:640
 v_exp_f32 v87,v87
 cv 80,80,81
 s_waitcnt lgkmcnt(5)
 mf 116,32,48,240
 ds_read_b128 v[28:31],v2 offset:704
 cv 81,82,83
 cv 82,84,85
 cv 83,86,87
 mf 116,36,56,116
 ds_read_b128 v[32:35],v2 offset:768
 v_exp_f32 v88,v88
 s_waitcnt lgkmcnt(5)
 mf 116,40,64,116
 ds_read_b128 v[36:39],v2 offset:832
 v_exp_f32 v89,v89
 v_exp_f32 v90,v90
 mf 116,44,72,116
 ds_read_b128 v[40:43],v2 offset:896
 v_exp_f32 v91,v91
 s_waitcnt lgkmcnt(5)
 mf 120,16,48,240
 ds_read_b128 v[44:47],v2 offset:960
 v_exp_f32 v92,v92
 v_exp_f32 v93,v93
 mf 120,20,56,120
 v_exp_f32 v94,v94
 s_waitcnt lgkmcnt(4)
 mf 120,24,64,120
 v_exp_f32 v95,v95
 cv 88,88,89
 mf 120,28,72,120
 cv 89,90,91
 cv 90,92,93
 cv 91,94,95
 s_waitcnt lgkmcnt(0)
 s_barrier
 tr 16,3,33792
 tr 18,3,34048
 tr 20,3,33824
 tr 22,3,34080
 tr 24,3,33856
 tr 26,3,34112
 mf 124,32,48,240
 tr 28,3,33888
 tr 30,3,34144
 mf 124,36,56,124
 tr 32,3,33920
 tr 34,3,34176
 mf 124,40,64,124
 tr 36,3,33952
 tr 38,3,34208
 mf 124,44,72,124
 tr 40,3,33984
 tr 42,3,34240
 s_waitcnt lgkmcnt(10)
 mf 144,16,80,144
 tr 44,3,34016
 tr 46,3,34272
 mf 248,6,80,248
 mf 148,20,80,148
 tr 16,3,34304
 tr 18,3,34560
 s_waitcnt lgkmcnt(10)
 mf 152,24,80,152
 tr 20,3,34336
 tr 22,3,34592
 mf 156,28,80,156
 tr 24,3,34368
 tr 26,3,34624
 v_max3_f32 v10,v112,v113,v114
 s_waitcnt lgkmcnt(10)
 mf 160,32,80,160
 tr 28,3,34400
 tr 30,3,34656
 mf 164,36,80,164
 tr 32,3,34432
 tr 34,3,34688
 v_max3_f32 v10,v10,v115,v116
 s_waitcnt lgkmcnt(10)
 mf 168,40,80,168
 tr 36,3,34464
 tr 38,3,34720
 mf 172,44,80,172
 tr 40,3,34496
 tr 42,3,34752
 v_max3_f32 v10,v10,v117,v118
 s_waitcnt lgkmcnt(10)
 mf 144,16,88,144
 tr 44,3,34528
 tr 46,3,34784
 mf 248,6,88,248
 v_max3_f32 v10,v10,v119,v120
 mf 148,20,88,148
 s_waitcnt lgkmcnt(8)
 mf 152,24,88,152
 v_max3_f32 v10,v10,v121,v122
 mf 156,28,88,156
 s_waitcnt lgkmcnt(0)
 s_barrier
 ds_read_b128 v[16:19],v2 offset:16896
 ds_read_b128 v[20:23],v2 offset:16960
 ds_read_b128 v[24:27],v2 offset:17024
 mf 160,32,88,160
 ds_read_b128 v[28:31],v2 offset:17088
 v_max3_f32 v10,v10,v123,v124
 v_max3_f32 v10,v10,v125,v126
 v_max_f32 v12,v10,v127
 mf 164,36,88,164
 ds_read_b128 v[32:35],v2 offset:17152
 v_cmp_nge_f32 vcc,s4,v12
 mf 168,40,88,168
 ds_read_b128 v[36:39],v2 offset:17216
 mf 172,44,88,172
 ds_read_b128 v[40:43],v2 offset:17280
 s_cbranch_vccnz L_resc3_ys
L_ret3_ys:
 v_exp_f32 v112,v112
 v_exp_f32 v113,v113
 s_waitcnt lgkmcnt(5)
 mf 80,16,48,240
 ds_read_b128 v[44:47],v2 offset:17344
 v_exp_f32 v114,v114
 v_exp_f32 v115,v115
 mf 80,20,56,80
 ds_read_b128 v[16:19],v2 offset:17408
 v_exp_f32 v116,v116
 s_waitcnt lgkmcnt(5)
 mf 80,24,64,80
 ds_read_b128 v[20:23],v2 offset:17472
 v_exp_f32 v117,v117
 v_exp_f32 v118,v118
 mf 80,28,72,80
 ds_read_b128 v[24:27],v2 offset:17536
 v_exp_f32 v119,v119
 cv 112,112,113
 s_waitcnt lgkmcnt(5)
 mf 84,32,48,240
 ds_read_b128 v[28:31],v2 offset:17600
 cv 113,114,115
 cv 114,116,117
 cv 115,118,119
 mf 84,36,56,84
 ds_read_b128 v[32:35],v2 offset:17664
 v_exp_f32 v120,v120
 s_waitcnt lgkmcnt(5)
 mf 84,40,64,84
 ds_read_b128 v[36:39],v2 offset:17728
 v_exp_f32 v121,v121
 v_exp_f32 v122,v122
 mf 84,44,72,84
 ds_read_b128 v[40:43],v2 offset:17792
 v_exp_f32 v123,v123
 s_waitcnt lgkmcnt(5)
 mf 88,16,48,240
 ds_read_b128 v[44:47],v2 offset:17856
 v_exp_f32 v124,v124
 v_exp_f32 v125,v125
 mf 88,20,56,88
 v_exp_f32 v126,v126
 s_waitcnt lgkmcnt(4)
 mf 88,24,64,88
 v_exp_f32 v127,v127
 cv 120,120,121
 mf 88,28,72,88
 cv 121,122,123
 cv 122,124,125
 cv 123,126,127
 s_waitcnt lgkmcnt(0)
 s_barrier
 tr 16,3,50688
 tr 18,3,50944
 tr 20,3,50720
 tr 22,3,50976
 tr 24,3,50752
 tr 26,3,51008
 mf 92,32,48,240
 tr 28,3,50784
 tr 30,3,51040
 mf 92,36,56,92
 tr 32,3,50816
 tr 34,3,51072
 mf 92,40,64,92
 tr 36,3,50848
 tr 38,3,51104
 mf 92,44,72,92
 tr 40,3,50880
 tr 42,3,51136
 s_waitcnt lgkmcnt(10)
 mf 144,16,112,144
 tr 44,3,50912
 tr 46,3,51168
 mf 248,6,112,248
 v_max3_f32 v10,v80,v81,v82
 mf 148,20,112,148
 tr 16,3,51200
 tr 18,3,51456
 v_max3_f32 v10,v10,v83,v84
 s_waitcnt lgkmcnt(10)
 mf 152,24,112,152
 tr 20,3,51232
 tr 22,3,51488
 v_max3_f32 v10,v10,v85,v86
 mf 156,28,112,156
 tr 24,3,51264
 tr 26,3,51520
 v_max3_f32 v10,v10,v87,v88
 s_waitcnt lgkmcnt(10)
 mf 160,32,112,160
 tr 28,3,51296
 tr 30,3,51552
 v_max3_f32 v10,v10,v89,v90
 mf 164,36,112,164
 tr 32,3,51328
 tr 34,3,51584
 v_mbcnt_lo_u32_b32 v1,-1,0
 s_waitcnt lgkmcnt(10)
 mf 168,40,112,168
 tr 36,3,51360
 tr 38,3,51616
 v_mbcnt_hi_u32_b32 v1,-1,v1
 s_add_u32 s47,s36,s39
 mf 172,44,112,172
 tr 40,3,51392
 tr 42,3,51648
 v_lshlrev_b32 v0,6,v1
 s_lshl_b32 s46,s35,13
 s_lshl_b32 s47,s47,17
 s_add_u32 s46,s46,s47
 s_waitcnt lgkmcnt(10)
 mf 144,16,120,144
 tr 44,3,51424
 tr 46,3,51680
 mf 248,6,120,248
 buffer_load_dword v178,v0,s[20:23],s46 offen
 mf 148,20,120,148
 s_add_u32 s46,s46,4096
 s_waitcnt lgkmcnt(8)
 mf 152,24,120,152
 buffer_load_dword v179,v0,s[20:23],s46 offen
 mf 156,28,120,156
 s_waitcnt lgkmcnt(0)
 s_barrier
 ds_read_b128 v[16:19],v2
 ds_read_b128 v[20:23],v2 offset:64
 ds_read_b128 v[24:27],v2 offset:128
 mf 160,32,120,160
 ds_read_b128 v[28:31],v2 offset:192
 v_max3_f32 v10,v10,v91,v92
 v_max3_f32 v10,v10,v93,v94
 v_max_f32 v12,v10,v95
 mf 164,36,120,164
 ds_read_b128 v[32:35],v2 offset:256
 v_cmp_nge_f32 vcc,s4,v12
 mf 168,40,120,168
 ds_read_b128 v[36:39],v2 offset:320
 mf 172,44,120,172
 ds_read_b128 v[40:43],v2 offset:384
 s_cbranch_vccnz L_resc4_ys
L_ret4_ys:
 v_exp_f32 v80,v80
 v_exp_f32 v81,v81
 s_waitcnt lgkmcnt(5)
 mf 112,16,48,240
 ds_read_b128 v[44:47],v2 offset:448
 v_exp_f32 v82,v82
 v_exp_f32 v83,v83
 mf 112,20,56,112
 ds_read_b128 v[16:19],v2 offset:512
 v_exp_f32 v84,v84
 s_waitcnt lgkmcnt(5)
 mf 112,24,64,112
 ds_read_b128 v[20:23],v2 offset:576
 v_exp_f32 v85,v85
 v_exp_f32 v86,v86
 mf 112,28,72,112
 ds_read_b128 v[24:27],v2 offset:640
 v_exp_f32 v87,v87
 cv 80,80,81
 s_waitcnt lgkmcnt(5)
 mf 116,32,48,240
 ds_read_b128 v[28:31],v2 offset:704
 cv 81,82,83
 cv 82,84,85
 cv 83,86,87
 mf 116,36,56,116
 ds_read_b128 v[32:35],v2 offset:768
 v_exp_f32 v88,v88
 s_waitcnt lgkmcnt(5)
 mf 116,40,64,116
 ds_read_b128 v[36:39],v2 offset:832
 v_exp_f32 v89,v89
 v_exp_f32 v90,v90
 mf 116,44,72,116
 ds_read_b128 v[40:43],v2 offset:896
 v_exp_f32 v91,v91
 s_waitcnt lgkmcnt(5)
 mf 120,16,48,240
 ds_read_b128 v[44:47],v2 offset:960
 v_exp_f32 v92,v92
 v_exp_f32 v93,v93
 mf 120,20,56,120
 v_exp_f32 v94,v94
 s_waitcnt lgkmcnt(4)
 mf 120,24,64,120
 v_exp_f32 v95,v95
 cv 88,88,89
 mf 120,28,72,120
 cv 89,90,91
 cv 90,92,93
 cv 91,94,95
 s_waitcnt lgkmcnt(0)
 s_barrier
 tr 16,3,33792
 tr 18,3,34048
 tr 20,3,33824
 tr 22,3,34080
 tr 24,3,33856
 tr 26,3,34112
 mf 124,32,48,240
 tr 28,3,33888
 tr 30,3,34144
 mf 124,36,56,124
 tr 32,3,33920
 tr 34,3,34176
 mf 124,40,64,124
 tr 36,3,33952
 tr 38,3,34208
 mf 124,44,72,124
 tr 40,3,33984
 tr 42,3,34240
 s_waitcnt lgkmcnt(10)
 mf 144,16,80,144
 tr 44,3,34016
 tr 46,3,34272
 mf 248,6,80,248
 mf 148,20,80,148
 tr 16,3,34304
 tr 18,3,34560
 s_waitcnt lgkmcnt(10)
 mf 152,24,80,152
 tr 20,3,34336
 tr 22,3,34592
 mf 156,28,80,156
 tr 24,3,34368
 tr 26,3,34624
 v_max3_f32 v10,v112,v113,v114
 s_waitcnt lgkmcnt(10)
 mf 160,32,80,160
 tr 28,3,34400
 tr 30,3,34656
 mf 164,36,80,164
 tr 32,3,34432
 tr 34,3,34688
 v_max3_f32 v10,v10,v115,v116
 s_waitcnt lgkmcnt(10)
 mf 168,40,80,168
 tr 36,3,34464
 tr 38,3,34720
 mf 172,44,80,172
 tr 40,3,34496
 tr 42,3,34752
 v_max3_f32 v10,v10,v117,v118
 s_waitcnt lgkmcnt(10)
 mf 144,16,88,144
 tr 44,3,34528
 tr 46,3,34784
 mf 248,6,88,248
 v_max3_f32 v10,v10,v119,v120
 mf 148,20,88,148
 s_waitcnt lgkmcnt(8)
 mf 152,24,88,152
 v_max3_f32 v10,v10,v121,v122
 mf 156,28,88,156
 s_waitcnt lgkmcnt(0)
 s_barrier
 ds_read_b128 v[16:19],v2 offset:16896
 ds_read_b128 v[20:23],v2 offset:16960
 ds_read_b128 v[24:27],v2 offset:17024
 mf 160,32,88,160
 ds_read_b128 v[28:31],v2 offset:17088
 v_max3_f32 v10,v10,v123,v124
 v_max3_f32 v10,v10,v125,v126
 v_max_f32 v12,v10,v127
 mf 164,36,88,164
 ds_read_b128 v[32:35],v2 offset:17152
 v_cmp_nge_f32 vcc,s4,v12
 mf 168,40,88,168
 ds_read_b128 v[36:39],v2 offset:17216
 mf 172,44,88,172
 ds_read_b128 v[40:43],v2 offset:17280
 s_cbranch_vccnz L_resc5_ys
L_ret5_ys:
 v_exp_f32 v112,v112
 v_exp_f32 v113,v113
 s_waitcnt lgkmcnt(5)
 mf 80,16,48,240
 ds_read_b128 v[44:47],v2 offset:17344
 v_exp_f32 v114,v114
 v_exp_f32 v115,v115
 mf 80,20,56,80
 ds_read_b128 v[16:19],v2 offset:17408
 v_exp_f32 v116,v116
 s_waitcnt lgkmcnt(5)
 mf 80,24,64,80
 ds_read_b128 v[20:23],v2 offset:17472
 v_exp_f32 v117,v117
 v_exp_f32 v118,v118
 mf 80,28,72,80
 ds_read_b128 v[24:27],v2 offset:17536
 v_exp_f32 v119,v119
 cv 112,112,113
 s_waitcnt lgkmcnt(5)
 mf 84,32,48,240
 ds_read_b128 v[28:31],v2 offset:17600
 cv 113,114,115
 cv 114,116,117
 cv 115,118,119
 mf 84,36,56,84
 ds_read_b128 v[32:35],v2 offset:17664
 v_exp_f32 v120,v120
 s_waitcnt lgkmcnt(5)
 mf 84,40,64,84
 ds_read_b128 v[36:39],v2 offset:17728
 v_exp_f32 v121,v121
 v_exp_f32 v122,v122
 mf 84,44,72,84
 ds_read_b128 v[40:43],v2 offset:17792
 v_exp_f32 v123,v123
 s_waitcnt lgkmcnt(5)
 mf 88,16,48,240
 ds_read_b128 v[44:47],v2 offset:17856
 v_exp_f32 v124,v124
 v_exp_f32 v125,v125
 mf 88,20,56,88
 v_exp_f32 v126,v126
 s_waitcnt lgkmcnt(4)
 mf 88,24,64,88
 v_exp_f32 v127,v127
 cv 120,120,121
 mf 88,28,72,88
 cv 121,122,123
 cv 122,124,125
 cv 123,126,127
 s_waitcnt lgkmcnt(0)
 s_barrier
 tr 16,3,50688
 tr 18,3,50944
 tr 20,3,50720
 tr 22,3,50976
 tr 24,3,50752
 tr 26,3,51008
 mf 92,32,48,240
 tr 28,3,50784
 tr 30,3,51040
 mf 92,36,56,92
 tr 32,3,50816
 tr 34,3,51072
 mf 92,40,64,92
 tr 36,3,50848
 tr 38,3,51104
 mf 92,44,72,92
 tr 40,3,50880
 tr 42,3,51136
 s_waitcnt lgkmcnt(10)
 mf 144,16,112,144
 tr 44,3,50912
 tr 46,3,51168
 mf 248,6,112,248
 mf 148,20,112,148
 tr 16,3,51200
 tr 18,3,51456
 s_waitcnt lgkmcnt(10)
 mf 152,24,112,152
 tr 20,3,51232
 tr 22,3,51488
 mf 156,28,112,156
 tr 24,3,51264
 tr 26,3,51520
 v_max3_f32 v10,v80,v81,v82
 s_waitcnt lgkmcnt(10)
 mf 160,32,112,160
 tr 28,3,51296
 tr 30,3,51552
 mf 164,36,112,164
 tr 32,3,51328
 tr 34,3,51584
 v_max3_f32 v10,v10,v83,v84
 s_waitcnt lgkmcnt(10)
 mf 168,40,112,168
 tr 36,3,51360
 tr 38,3,51616
 mf 172,44,112,172
 tr 40,3,51392
 tr 42,3,51648
 v_max3_f32 v10,v10,v85,v86
 s_waitcnt lgkmcnt(10)
 mf 144,16,120,144
 tr 44,3,51424
 tr 46,3,51680
 mf 248,6,120,248
 v_max3_f32 v10,v10,v87,v88
 mf 148,20,120,148
 s_waitcnt lgkmcnt(8)
 mf 152,24,120,152
 v_max3_f32 v10,v10,v89,v90
 mf 156,28,120,156
 s_waitcnt lgkmcnt(0)
 s_barrier
 ds_read_b128 v[16:19],v2
 ds_read_b128 v[20:23],v2 offset:64
 ds_read_b128 v[24:27],v2 offset:128
 mf 160,32,120,160
 ds_read_b128 v[28:31],v2 offset:192
 v_max3_f32 v10,v10,v91,v92
 v_max3_f32 v10,v10,v93,v94
 v_max_f32 v12,v10,v95
 mf 164,36,120,164
 ds_read_b128 v[32:35],v2 offset:256
 v_cmp_nge_f32 vcc,s4,v12
 mf 168,40,120,168
 ds_read_b128 v[36:39],v2 offset:320
 mf 172,44,120,172
 ds_read_b128 v[40:43],v2 offset:384
 s_cbranch_vccnz L_resc6_ys
L_ret6_ys:
 v_exp_f32 v80,v80
 v_exp_f32 v81,v81
 s_waitcnt lgkmcnt(5)
 mf 112,16,48,240
 ds_read_b128 v[44:47],v2 offset:448
 v_exp_f32 v82,v82
 v_exp_f32 v83,v83
 mf 112,20,56,112
 ds_read_b128 v[16:19],v2 offset:512
 v_exp_f32 v84,v84
 s_waitcnt lgkmcnt(5)
 mf 112,24,64,112
 ds_read_b128 v[20:23],v2 offset:576
 v_exp_f32 v85,v85
 v_exp_f32 v86,v86
 mf 112,28,72,112
 ds_read_b128 v[24:27],v2 offset:640
 v_exp_f32 v87,v87
 cv 80,80,81
 s_waitcnt lgkmcnt(5)
 mf 116,32,48,240
 ds_read_b128 v[28:31],v2 offset:704
 cv 81,82,83
 cv 82,84,85
 cv 83,86,87
 mf 116,36,56,116
 ds_read_b128 v[32:35],v2 offset:768
 v_exp_f32 v88,v88
 s_waitcnt lgkmcnt(5)
 mf 116,40,64,116
 ds_read_b128 v[36:39],v2 offset:832
 v_exp_f32 v89,v89
 v_exp_f32 v90,v90
 mf 116,44,72,116
 ds_read_b128 v[40:43],v2 offset:896
 v_exp_f32 v91,v91
 s_waitcnt lgkmcnt(5)
 mf 120,16,48,240
 ds_read_b128 v[44:47],v2 offset:960
 v_exp_f32 v92,v92
 v_exp_f32 v93,v93
 mf 120,20,56,120
 v_exp_f32 v94,v94
 s_waitcnt lgkmcnt(4)
 mf 120,24,64,120
 v_exp_f32 v95,v95
 cv 88,88,89
 mf 120,28,72,120
 cv 89,90,91
 cv 90,92,93
 cv 91,94,95
 s_waitcnt lgkmcnt(0)
 s_barrier
 tr 16,3,33792
 tr 18,3,34048
 tr 20,3,33824
 tr 22,3,34080
 tr 24,3,33856
 tr 26,3,34112
 mf 124,32,48,240
 tr 28,3,33888
 tr 30,3,34144
 mf 124,36,56,124
 tr 32,3,33920
 tr 34,3,34176
 mf 124,40,64,124
 tr 36,3,33952
 tr 38,3,34208
 mf 124,44,72,124
 tr 40,3,33984
 tr 42,3,34240
 s_waitcnt lgkmcnt(10)
 mf 144,16,80,144
 tr 44,3,34016
 tr 46,3,34272
 mf 248,6,80,248
 v_max3_f32 v10,v112,v113,v114
 mf 148,20,80,148
 tr 16,3,34304
 tr 18,3,34560
 v_max3_f32 v10,v10,v115,v116
 s_waitcnt lgkmcnt(10)
 mf 152,24,80,152
 tr 20,3,34336
 tr 22,3,34592
 v_max3_f32 v10,v10,v117,v118
 mf 156,28,80,156
 tr 24,3,34368
 tr 26,3,34624
 v_max3_f32 v10,v10,v119,v120
 s_waitcnt lgkmcnt(10)
 mf 160,32,80,160
 tr 28,3,34400
 tr 30,3,34656
 v_max3_f32 v10,v10,v121,v122
 mf 164,36,80,164
 tr 32,3,34432
 tr 34,3,34688
 ds_read_b128 v[48:51],v4
 s_waitcnt lgkmcnt(11)
 mf 168,40,80,168
 tr 36,3,34464
 tr 38,3,34720
 mf 172,44,80,172
 tr 40,3,34496
 tr 42,3,34752
 ds_read_b128 v[56:59],v4 offset:7168
 s_waitcnt lgkmcnt(12)
 mf 144,16,88,144
 tr 44,3,34528
 tr 46,3,34784
 mf 248,6,88,248
 ds_read_b128 v[64:67],v4 offset:14336
 mf 148,20,88,148
 s_waitcnt lgkmcnt(11)
 mf 152,24,88,152
 ds_read_b128 v[72:75],v4 offset:21504
 mf 156,28,88,156
 s_cmp_eq_u32 s39,3
 s_waitcnt lgkmcnt(0)
 s_cbranch_scc1 L_alast_ys
 s_barrier
 ds_read_b128 v[16:19],v2 offset:16896
 ds_read_b128 v[20:23],v2 offset:16960
 ds_read_b128 v[24:27],v2 offset:17024
 mf 160,32,88,160
 ds_read_b128 v[28:31],v2 offset:17088
 v_max3_f32 v10,v10,v123,v124
 v_max3_f32 v10,v10,v125,v126
 v_max_f32 v12,v10,v127
 mf 164,36,88,164
 ds_read_b128 v[32:35],v2 offset:17152
 v_cmp_nge_f32 vcc,s4,v12
 mf 168,40,88,168
 ds_read_b128 v[36:39],v2 offset:17216
 mf 172,44,88,172
 ds_read_b128 v[40:43],v2 offset:17280
 s_cbranch_vccnz L_resc7_ys
L_ret7_ys:
 v_exp_f32 v112,v112
 v_exp_f32 v113,v113
 s_waitcnt lgkmcnt(5)
 mf 80,16,48,240
 ds_read_b128 v[44:47],v2 offset:17344
 v_exp_f32 v114,v114
 v_exp_f32 v115,v115
 mf 80,20,56,80
 ds_read_b128 v[16:19],v2 offset:17408
 v_exp_f32 v116,v116
 s_waitcnt lgkmcnt(5)
 mf 80,24,64,80
 ds_read_b128 v[20:23],v2 offset:17472
 v_exp_f32 v117,v117
 v_exp_f32 v118,v118
 mf 80,28,72,80
 ds_read_b128 v[24:27],v2 offset:17536
 v_exp_f32 v119,v119
 cv 112,112,113
 s_waitcnt lgkmcnt(5)
 mf 84,32,48,240
 ds_read_b128 v[28:31],v2 offset:17600
 cv 113,114,115
 cv 114,116,117
 cv 115,118,119
 mf 84,36,56,84
 ds_read_b128 v[32:35],v2 offset:17664
 v_exp_f32 v120,v120
 s_waitcnt lgkmcnt(5)
 mf 84,40,64,84
 ds_read_b128 v[36:39],v2 offset:17728
 v_exp_f32 v121,v121
 v_exp_f32 v122,v122
 mf 84,44,72,84
 ds_read_b128 v[40:43],v2 offset:17792
 v_exp_f32 v123,v123
 s_waitcnt lgkmcnt(5)
 mf 88,16,48,240
 ds_read_b128 v[44:47],v2 offset:17856
 v_exp_f32 v124,v124
 v_exp_f32 v125,v125
 mf 88,20,56,88
 v_exp_f32 v126,v126
 s_waitcnt lgkmcnt(4)
 mf 88,24,64,88
 v_exp_f32 v127,v127
 cv 120,120,121
 mf 88,28,72,88
 cv 121,122,123
 cv 122,124,125
 cv 123,126,127
 s_waitcnt lgkmcnt(0)
 s_barrier
 tr 16,3,50688
 tr 18,3,50944
 tr 20,3,50720
 tr 22,3,50976
 tr 24,3,50752
 tr 26,3,51008
 mf 92,32,48,240
 tr 28,3,50784
 tr 30,3,51040
 mf 92,36,56,92
 tr 32,3,50816
 tr 34,3,51072
 mf 92,40,64,92
 tr 36,3,50848
 tr 38,3,51104
 mf 92,44,72,92
 tr 40,3,50880
 tr 42,3,51136
 s_waitcnt lgkmcnt(10)
 mf 144,16,112,144
 tr 44,3,50912
 tr 46,3,51168
 mf 248,6,112,248
 mf 148,20,112,148
 tr 16,3,51200
 tr 18,3,51456
 v_max3_f32 v10,v80,v81,v82
 s_waitcnt lgkmcnt(10)
 mf 152,24,112,152
 tr 20,3,51232
 tr 22,3,51488
 mf 156,28,112,156
 tr 24,3,51264
 tr 26,3,51520
 v_max3_f32 v10,v10,v83,v84
 s_waitcnt lgkmcnt(10)
 mf 160,32,112,160
 tr 28,3,51296
 tr 30,3,51552
 mf 164,36,112,164
 tr 32,3,51328
 tr 34,3,51584
 v_max3_f32 v10,v10,v85,v86
 s_waitcnt lgkmcnt(10)
 mf 168,40,112,168
 tr 36,3,51360
 tr 38,3,51616
 mf 172,44,112,172
 tr 40,3,51392
 tr 42,3,51648
 v_max3_f32 v10,v10,v87,v88
 s_waitcnt lgkmcnt(10)
 mf 144,16,120,144
 tr 44,3,51424
 tr 46,3,51680
 mf 248,6,120,248
 v_max3_f32 v10,v10,v89,v90
 mf 148,20,120,148
 s_waitcnt lgkmcnt(8)
 mf 152,24,120,152
 v_max3_f32 v10,v10,v91,v92
 mf 156,28,120,156
 s_add_u32 s39,s39,1
 s_waitcnt lgkmcnt(0)
 s_branch L_aloop_ys
L_alast_ys:
 s_barrier
 tr 16,3,50688
 tr 18,3,50944
 tr 20,3,50720
 tr 22,3,50976
 tr 24,3,50752
 tr 26,3,51008
 mf 160,32,88,160
 tr 28,3,50784
 tr 30,3,51040
 v_max3_f32 v10,v10,v123,v124
 v_max3_f32 v10,v10,v125,v126
 v_max_f32 v12,v10,v127
 v_cmp_nge_f32 vcc,s4,v12
 mf 164,36,88,164
 tr 32,3,50816
 tr 34,3,51072
 mf 168,40,88,168
 tr 36,3,50848
 tr 38,3,51104
 mf 172,44,88,172
 tr 40,3,50880
 tr 42,3,51136
 s_cbranch_vccnz L_resc7last_ys
L_ret7last_ys:
 v_exp_f32 v112,v112
 v_exp_f32 v113,v113
 v_exp_f32 v114,v114
 v_exp_f32 v115,v115
 v_exp_f32 v116,v116
 v_exp_f32 v117,v117
 v_exp_f32 v118,v118
 v_exp_f32 v119,v119
 cv 112,112,113
 cv 113,114,115
 cv 114,116,117
 cv 115,118,119
 s_waitcnt lgkmcnt(10)
 s_nop 0
 mf 144,16,112,144
 tr 44,3,50912
 tr 46,3,51168
 v_exp_f32 v120,v120
 mf 248,6,112,248
 v_exp_f32 v121,v121
 mf 148,20,112,148
 tr 16,3,51200
 tr 18,3,51456
 v_exp_f32 v122,v122
 s_waitcnt lgkmcnt(10)
 mf 152,24,112,152
 tr 20,3,51232
 tr 22,3,51488
 v_exp_f32 v123,v123
 mf 156,28,112,156
 tr 24,3,51264
 tr 26,3,51520
 v_exp_f32 v124,v124
 s_waitcnt lgkmcnt(10)
 mf 160,32,112,160
 tr 28,3,51296
 tr 30,3,51552
 v_exp_f32 v125,v125
 mf 164,36,112,164
 tr 32,3,51328
 tr 34,3,51584
 v_exp_f32 v126,v126
 s_waitcnt lgkmcnt(10)
 mf 168,40,112,168
 tr 36,3,51360
 tr 38,3,51616
 v_exp_f32 v127,v127
 cv 120,120,121
 mf 172,44,112,172
 tr 40,3,51392
 tr 42,3,51648
 cv 121,122,123
 cv 122,124,125
 cv 123,126,127
 s_waitcnt lgkmcnt(10)
 s_nop 0
 mf 144,16,120,144
 tr 44,3,51424
 tr 46,3,51680
 mf 248,6,120,248
 mf 148,20,120,148
 s_waitcnt lgkmcnt(8)
 mf 152,24,120,152
 mf 156,28,120,156
 s_lshl_b32 s42,s54,2
 v_mov_b32 v9,0
 buffer_load_dword v9,v9,s[64:67],s42 offen sc1
 s_waitcnt lgkmcnt(0)
 s_barrier
 mf 160,32,120,160
 ds_read_b128 v[80:83],v4
 ds_read_b128 v[88:91],v4 offset:7168
 ds_read_b128 v[96:99],v4 offset:14336
 ds_read_b128 v[104:107],v4 offset:21504
 v_mbcnt_lo_u32_b32 v13,-1,0
 v_mbcnt_hi_u32_b32 v13,-1,v13
 v_bfe_u32 v11,v13,3,2
 v_mul_u32_u24 v2,1056,v11
 v_lshrrev_b32 v11,5,v13
 v_lshl_add_u32 v2,v11,8,v2
 v_bfe_u32 v11,v13,2,1
 v_lshl_add_u32 v2,v11,7,v2
 v_and_b32 v11,3,v13
 v_lshl_add_u32 v2,v11,3,v2
 mf 164,36,120,164
 mf 168,40,120,168
 mf 172,44,120,172
 v_rcp_f32 v10,v248
 s_nop 0
 v_mul_f32 v144,v10,v144
 v_mul_f32 v145,v10,v145
 v_mul_f32 v146,v10,v146
 v_mul_f32 v147,v10,v147
 v_mul_f32 v148,v10,v148
 v_mul_f32 v149,v10,v149
 v_mul_f32 v150,v10,v150
 v_mul_f32 v151,v10,v151
 cv 144,144,145
 cv 145,146,147
 cv 146,148,149
 cv 147,150,151
 ds_write_b128 v4,v[144:147]
 v_mul_f32 v152,v10,v152
 v_mul_f32 v153,v10,v153
 v_mul_f32 v154,v10,v154
 v_mul_f32 v155,v10,v155
 v_mul_f32 v156,v10,v156
 v_mul_f32 v157,v10,v157
 v_mul_f32 v158,v10,v158
 v_mul_f32 v159,v10,v159
 cv 152,152,153
 cv 153,154,155
 cv 154,156,157
 cv 155,158,159
 ds_write_b128 v4,v[152:155] offset:7168
 v_mul_f32 v160,v10,v160
 v_mul_f32 v161,v10,v161
 v_mul_f32 v162,v10,v162
 v_mul_f32 v163,v10,v163
 v_mul_f32 v164,v10,v164
 v_mul_f32 v165,v10,v165
 v_mul_f32 v166,v10,v166
 v_mul_f32 v167,v10,v167
 cv 160,160,161
 cv 161,162,163
 cv 162,164,165
 cv 163,166,167
 ds_write_b128 v4,v[160:163] offset:14336
 v_mul_f32 v168,v10,v168
 v_mul_f32 v169,v10,v169
 v_mul_f32 v170,v10,v170
 v_mul_f32 v171,v10,v171
 v_mul_f32 v172,v10,v172
 v_mul_f32 v173,v10,v173
 v_mul_f32 v174,v10,v174
 v_mul_f32 v175,v10,v175
 cv 168,168,169
 cv 169,170,171
 cv 170,172,173
 cv 171,174,175
 ds_write_b128 v4,v[168:171] offset:21504
 s_setprio 0
 s_waitcnt lgkmcnt(0)
 s_barrier
 ds_read_b64_tr_b16 v[16:17],v2
 tr 18,2,512
 tr 20,2,32
 tr 22,2,544
 tr 24,2,64
 tr 26,2,576
 tr 28,2,96
 tr 30,2,608
 tr 148,2,4224
 tr 150,2,4736
 tr 156,2,4256
 tr 158,2,4768
 tr 164,2,4288
 tr 166,2,4800
 s_waitcnt lgkmcnt(10)
 mz 112,16,208
 tr 172,2,4320
 tr 174,2,4832
 mz 116,20,208
 tr 16,2,8448
 tr 18,2,8960
 s_waitcnt lgkmcnt(10)
 mz 120,24,208
 tr 20,2,8480
 tr 22,2,8992
 mz 124,28,208
 tr 24,2,8512
 tr 26,2,9024
 s_waitcnt lgkmcnt(10)
 mf 112,148,216,112
 tr 28,2,8544
 tr 30,2,9056
 mf 116,156,216,116
 tr 148,2,12672
 tr 150,2,13184
 s_waitcnt lgkmcnt(10)
 mf 120,164,216,120
 tr 156,2,12704
 tr 158,2,13216
 mf 124,172,216,124
 tr 164,2,12736
 tr 166,2,13248
 s_waitcnt lgkmcnt(10)
 mf 112,16,224,112
 tr 172,2,12768
 tr 174,2,13280
 mf 116,20,224,116
 s_waitcnt lgkmcnt(8)
 mf 120,24,224,120
 mf 124,28,224,124
 s_waitcnt vmcnt(0)
 s_waitcnt lgkmcnt(0)
L_rdy_ys:
 v_readfirstlane_b32 s55,v9
 s_add_u32 s100,s100,1
 s_cmp_gt_u32 s100,0x40000
 s_cbranch_scc1 L_rdyok_ys
 s_cmp_ge_u32 s55,8
 s_cbranch_scc1 L_rdyok_ys
 v_mov_b32 v9,0
 buffer_load_dword v9,v9,s[64:67],s42 offen sc1
 s_waitcnt vmcnt(0)
 s_branch L_rdy_ys
L_rdyok_ys:
 s_barrier
 tr 16,2,16896
 tr 18,2,17408
 tr 20,2,16928
 tr 22,2,17440
 tr 24,2,16960
 tr 26,2,17472
 mf 112,148,232,112
 tr 28,2,16992
 tr 30,2,17504
 v_mbcnt_lo_u32_b32 v10,-1,0
 mf 116,156,232,116
 tr 148,2,21120
 tr 150,2,21632
 v_mbcnt_hi_u32_b32 v10,-1,v10
 mf 120,164,232,120
 tr 156,2,21152
 tr 158,2,21664
 s_lshl_b32 s47,s37,2
 s_add_u32 s47,s47,s33
 s_lshl_b32 s47,s47,2
 v_cmp_eq_u32 vcc,0,v10
 mf 124,172,232,124
 tr 164,2,21184
 tr 166,2,21696
 v_mov_b32 v10,s47
 s_waitcnt lgkmcnt(10)
 mf 112,16,48,112
 tr 172,2,21216
 tr 174,2,21728
 v_mov_b32 v7,0x40000000
 mf 116,20,48,116
 tr 16,2,25344
 tr 18,2,25856
 s_waitcnt lgkmcnt(10)
 mf 120,24,48,120
 tr 20,2,25376
 tr 22,2,25888
 v_cndmask_b32 v7,v7,v10,vcc
 mf 124,28,48,124
 tr 24,2,25408
 tr 26,2,25920
 s_lshl_b32 s40,s33,12
 s_waitcnt lgkmcnt(10)
 mf 112,148,56,112
 tr 28,2,25440
 tr 30,2,25952
 v_lshlrev_b32 v3,4,v13
 mf 116,156,56,116
 tr 148,2,29568
 tr 150,2,30080
 s_waitcnt lgkmcnt(10)
 mf 120,164,56,120
 tr 156,2,29600
 tr 158,2,30112
 v_add_u32 v3,s40,v3
 mf 124,172,56,124
 tr 164,2,29632
 tr 166,2,30144
 s_mov_b32 s40,0
 s_cmp_eq_u32 s33,3
 s_cselect_b32 s40,0x40000000,s40
 s_waitcnt lgkmcnt(10)
 mf 112,16,64,112
 tr 172,2,29664
 tr 174,2,30176
 v_add_u32 v6,s40,v3
 mf 116,20,64,116
 s_waitcnt lgkmcnt(8)
 mf 120,24,64,120
 v_add_u32 v8,67584,v2
 mf 124,28,64,124
 s_waitcnt lgkmcnt(0)
 s_barrier
 tr 16,2,33792
 tr 18,2,34304
 tr 20,2,33824
 tr 22,2,34336
 tr 24,2,33856
 tr 26,2,34368
 mf 112,148,72,112
 tr 28,2,33888
 tr 30,2,34400
 mf 116,156,72,116
 tr 148,2,38016
 tr 150,2,38528
 mf 120,164,72,120
 tr 156,2,38048
 tr 158,2,38560
 mf 124,172,72,124
 tr 164,2,38080
 tr 166,2,38592
 s_waitcnt lgkmcnt(10)
 mf 112,16,80,112
 tr 172,2,38112
 tr 174,2,38624
 mf 116,20,80,116
 tr 16,2,42240
 tr 18,2,42752
 s_waitcnt lgkmcnt(10)
 mf 120,24,80,120
 tr 20,2,42272
 tr 22,2,42784
 mf 124,28,80,124
 tr 24,2,42304
 tr 26,2,42816
 s_waitcnt lgkmcnt(10)
 mf 112,148,88,112
 tr 28,2,42336
 tr 30,2,42848
 mf 116,156,88,116
 tr 148,2,46464
 tr 150,2,46976
 s_waitcnt lgkmcnt(10)
 mf 120,164,88,120
 tr 156,2,46496
 tr 158,2,47008
 mf 124,172,88,124
 tr 164,2,46528
 tr 166,2,47040
 s_waitcnt lgkmcnt(10)
 mf 112,16,96,112
 tr 172,2,46560
 tr 174,2,47072
 mf 116,20,96,116
 s_waitcnt lgkmcnt(8)
 mf 120,24,96,120
 mf 124,28,96,124
 s_waitcnt lgkmcnt(0)
 s_barrier
 tr 16,2,50688
 tr 18,2,51200
 tr 20,2,50720
 tr 22,2,51232
 tr 24,2,50752
 tr 26,2,51264
 mf 112,148,104,112
 tr 28,2,50784
 tr 30,2,51296
 mf 116,156,104,116
 tr 148,2,54912
 tr 150,2,55424
 mf 120,164,104,120
 tr 156,2,54944
 tr 158,2,55456
 mf 124,172,104,124
 tr 164,2,54976
 tr 166,2,55488
 s_waitcnt lgkmcnt(10)
 mf 112,16,144,112
 tr 172,2,55008
 tr 174,2,55520
 mf 116,20,144,116
 tr 16,2,59136
 tr 18,2,59648
 s_waitcnt lgkmcnt(10)
 mf 120,24,144,120
 tr 20,2,59168
 tr 22,2,59680
 mf 124,28,144,124
 tr 24,2,59200
 tr 26,2,59712
 s_waitcnt lgkmcnt(10)
 mf 112,148,152,112
 tr 28,2,59232
 tr 30,2,59744
 mf 116,156,152,116
 tr 148,2,63360
 tr 150,2,63872
 s_waitcnt lgkmcnt(10)
 mf 120,164,152,120
 tr 156,2,63392
 tr 158,2,63904
 mf 124,172,152,124
 tr 164,2,63424
 tr 166,2,63936
 s_waitcnt lgkmcnt(10)
 mf 112,16,160,112
 tr 172,2,63456
 tr 174,2,63968
 mf 116,20,160,116
 s_waitcnt lgkmcnt(8)
 mf 120,24,160,120
 mf 124,28,160,124
 s_waitcnt lgkmcnt(0)
 s_barrier
 ds_read_b64_tr_b16 v[16:17],v2
 tr 18,2,512
 tr 20,2,32
 tr 22,2,544
 tr 24,2,64
 tr 26,2,576
 mf 112,148,168,112
 tr 28,2,96
 tr 30,2,608
 mf 116,156,168,116
 tr 148,2,4224
 tr 150,2,4736
 mf 120,164,168,120
 tr 156,2,4256
 tr 158,2,4768
 mf 124,172,168,124
 tr 164,2,4288
 tr 166,2,4800
 s_waitcnt lgkmcnt(10)
 mz 32,16,208
 tr 172,2,4320
 tr 174,2,4832
 cv 112,112,113
 cv 113,114,115
 mz 36,20,208
 tr 16,2,8448
 tr 18,2,8960
 cv 114,116,117
 cv 115,118,119
 s_waitcnt lgkmcnt(10)
 mz 40,24,208
 tr 20,2,8480
 tr 22,2,8992
 ds_write_b128 v4,v[112:115]
 mz 44,28,208
 tr 24,2,8512
 tr 26,2,9024
 cv 120,120,121
 s_waitcnt lgkmcnt(11)
 mf 32,148,216,32
 tr 28,2,8544
 tr 30,2,9056
 cv 121,122,123
 cv 122,124,125
 mf 36,156,216,36
 tr 148,2,12672
 tr 150,2,13184
 cv 123,126,127
 s_waitcnt lgkmcnt(11)
 mf 40,164,216,40
 tr 156,2,12704
 tr 158,2,13216
 ds_write_b128 v4,v[120:123] offset:7168
 mf 44,172,216,44
 tr 164,2,12736
 tr 166,2,13248
 s_waitcnt lgkmcnt(12)
 mf 32,16,224,32
 tr 172,2,12768
 tr 174,2,13280
 mf 36,20,224,36
 s_waitcnt lgkmcnt(9)
 mf 40,24,224,40
 mf 44,28,224,44
 s_waitcnt lgkmcnt(0)
 s_barrier
 tr 16,2,16896
 tr 18,2,17408
 tr 20,2,16928
 tr 22,2,17440
 tr 24,2,16960
 tr 26,2,17472
 mf 32,148,232,32
 tr 28,2,16992
 tr 30,2,17504
 mf 36,156,232,36
 tr 148,2,21120
 tr 150,2,21632
 mf 40,164,232,40
 tr 156,2,21152
 tr 158,2,21664
 mf 44,172,232,44
 tr 164,2,21184
 tr 166,2,21696
 s_waitcnt lgkmcnt(10)
 mf 32,16,48,32
 tr 172,2,21216
 tr 174,2,21728
 mf 36,20,48,36
 tr 16,2,25344
 tr 18,2,25856
 s_waitcnt lgkmcnt(10)
 mf 40,24,48,40
 tr 20,2,25376
 tr 22,2,25888
 mf 44,28,48,44
 tr 24,2,25408
 tr 26,2,25920
 s_waitcnt lgkmcnt(10)
 mf 32,148,56,32
 tr 28,2,25440
 tr 30,2,25952
 mf 36,156,56,36
 tr 148,2,29568
 tr 150,2,30080
 s_waitcnt lgkmcnt(10)
 mf 40,164,56,40
 tr 156,2,29600
 tr 158,2,30112
 mf 44,172,56,44
 tr 164,2,29632
 tr 166,2,30144
 s_waitcnt lgkmcnt(10)
 mf 32,16,64,32
 tr 172,2,29664
 tr 174,2,30176
 mf 36,20,64,36
 s_waitcnt lgkmcnt(8)
 mf 40,24,64,40
 mf 44,28,64,44
 tr 16,2,33792
 tr 18,2,34304
 tr 20,2,33824
 tr 22,2,34336
 tr 24,2,33856
 tr 26,2,34368
 s_waitcnt lgkmcnt(10)
 mf 32,148,72,32
 tr 28,2,33888
 tr 30,2,34400
 mf 36,156,72,36
 tr 148,2,38016
 tr 150,2,38528
 s_waitcnt lgkmcnt(10)
 mf 40,164,72,40
 tr 156,2,38048
 tr 158,2,38560
 mf 44,172,72,44
 tr 164,2,38080
 tr 166,2,38592
 s_waitcnt lgkmcnt(10)
 mf 32,16,80,32
 tr 172,2,38112
 tr 174,2,38624
 mf 36,20,80,36
 tr 16,2,42240
 tr 18,2,42752
 s_waitcnt lgkmcnt(10)
 mf 40,24,80,40
 tr 20,2,42272
 tr 22,2,42784
 mf 44,28,80,44
 tr 24,2,42304
 tr 26,2,42816
 s_waitcnt lgkmcnt(10)
 mf 32,148,88,32
 tr 28,2,42336
 tr 30,2,42848
 mf 36,156,88,36
 tr 148,2,46464
 tr 150,2,46976
 s_waitcnt lgkmcnt(10)
 mf 40,164,88,40
 tr 156,2,46496
 tr 158,2,47008
 mf 44,172,88,44
 tr 164,2,46528
 tr 166,2,47040
 s_waitcnt lgkmcnt(10)
 mf 32,16,96,32
 tr 172,2,46560
 tr 174,2,47072
 mf 36,20,96,36
 s_waitcnt lgkmcnt(8)
 mf 40,24,96,40
 mf 44,28,96,44
 tr 16,2,50688
 tr 18,2,51200
 tr 20,2,50720
 tr 22,2,51232
 tr 24,2,50752
 tr 26,2,51264
 s_waitcnt lgkmcnt(10)
 mf 32,148,104,32
 tr 28,2,50784
 tr 30,2,51296
 mf 36,156,104,36
 tr 148,2,54912
 tr 150,2,55424
 s_waitcnt lgkmcnt(10)
 mf 40,164,104,40
 tr 156,2,54944
 tr 158,2,55456
 mf 44,172,104,44
 tr 164,2,54976
 tr 166,2,55488
 s_waitcnt lgkmcnt(10)
 mf 32,16,144,32
 tr 172,2,55008
 tr 174,2,55520
 mf 36,20,144,36
 tr 16,2,59136
 tr 18,2,59648
 s_waitcnt lgkmcnt(10)
 mf 40,24,144,40
 tr 20,2,59168
 tr 22,2,59680
 mf 44,28,144,44
 tr 24,2,59200
 tr 26,2,59712
 s_waitcnt lgkmcnt(10)
 mf 32,148,152,32
 tr 28,2,59232
 tr 30,2,59744
 mf 36,156,152,36
 tr 148,2,63360
 tr 150,2,63872
 s_waitcnt lgkmcnt(10)
 mf 40,164,152,40
 tr 156,2,63392
 tr 158,2,63904
 mf 44,172,152,44
 tr 164,2,63424
 tr 166,2,63936
 s_waitcnt lgkmcnt(10)
 mf 32,16,160,32
 tr 172,2,63456
 tr 174,2,63968
 mf 36,20,160,36
 s_waitcnt lgkmcnt(8)
 mf 40,24,160,40
 mf 44,28,160,44
 s_waitcnt lgkmcnt(4)
 mf 32,148,168,32
 mf 36,156,168,36
 s_waitcnt lgkmcnt(0)
 mf 40,164,168,40
 mf 44,172,168,44
 s_nop 3
 cv 32,32,33
 cv 33,34,35
 cv 34,36,37
 cv 35,38,39
 ds_write_b128 v4,v[32:35] offset:14336
 cv 40,40,41
 cv 41,42,43
 cv 42,44,45
 cv 43,46,47
 ds_write_b128 v4,v[40:43] offset:21504
 s_waitcnt lgkmcnt(0)
 s_barrier
 ds_read_b64_tr_b16 v[16:17],v8
 tr 18,8,512
 tr 20,8,32
 tr 22,8,544
 tr 24,8,64
 tr 26,8,576
 tr 28,8,96
 tr 30,8,608
 tr 148,8,4224
 tr 150,8,4736
 tr 156,8,4256
 tr 158,8,4768
 tr 164,8,4288
 tr 166,8,4800
 s_waitcnt lgkmcnt(10)
 mz 112,16,208
 tr 172,8,4320
 tr 174,8,4832
 mz 116,20,208
 tr 16,8,8448
 tr 18,8,8960
 s_waitcnt lgkmcnt(10)
 mz 120,24,208
 tr 20,8,8480
 tr 22,8,8992
 mz 124,28,208
 tr 24,8,8512
 tr 26,8,9024
 s_waitcnt lgkmcnt(10)
 mf 112,148,216,112
 tr 28,8,8544
 tr 30,8,9056
 mf 116,156,216,116
 tr 148,8,12672
 tr 150,8,13184
 s_waitcnt lgkmcnt(10)
 mf 120,164,216,120
 tr 156,8,12704
 tr 158,8,13216
 mf 124,172,216,124
 tr 164,8,12736
 tr 166,8,13248
 s_waitcnt lgkmcnt(10)
 mf 112,16,224,112
 tr 172,8,12768
 tr 174,8,13280
 mf 116,20,224,116
 s_waitcnt lgkmcnt(8)
 mf 120,24,224,120
 mf 124,28,224,124
 tr 16,8,16896
 tr 18,8,17408
 tr 20,8,16928
 tr 22,8,17440
 tr 24,8,16960
 tr 26,8,17472
 s_waitcnt lgkmcnt(10)
 mf 112,148,232,112
 tr 28,8,16992
 tr 30,8,17504
 mf 116,156,232,116
 tr 148,8,21120
 tr 150,8,21632
 s_waitcnt lgkmcnt(10)
 mf 120,164,232,120
 tr 156,8,21152
 tr 158,8,21664
 mf 124,172,232,124
 tr 164,8,21184
 tr 166,8,21696
 s_waitcnt lgkmcnt(10)
 mf 112,16,48,112
 tr 172,8,21216
 tr 174,8,21728
 mf 116,20,48,116
 tr 16,8,25344
 tr 18,8,25856
 s_waitcnt lgkmcnt(10)
 mf 120,24,48,120
 tr 20,8,25376
 tr 22,8,25888
 mf 124,28,48,124
 tr 24,8,25408
 tr 26,8,25920
 s_waitcnt lgkmcnt(10)
 mf 112,148,56,112
 tr 28,8,25440
 tr 30,8,25952
 mf 116,156,56,116
 tr 148,8,29568
 tr 150,8,30080
 s_waitcnt lgkmcnt(10)
 mf 120,164,56,120
 tr 156,8,29600
 tr 158,8,30112
 mf 124,172,56,124
 tr 164,8,29632
 tr 166,8,30144
 s_waitcnt lgkmcnt(10)
 mf 112,16,64,112
 tr 172,8,29664
 tr 174,8,30176
 mf 116,20,64,116
 s_waitcnt lgkmcnt(8)
 mf 120,24,64,120
 mf 124,28,64,124
 tr 16,8,33792
 tr 18,8,34304
 tr 20,8,33824
 tr 22,8,34336
 tr 24,8,33856
 tr 26,8,34368
 s_waitcnt lgkmcnt(10)
 mf 112,148,72,112
 tr 28,8,33888
 tr 30,8,34400
 mf 116,156,72,116
 tr 148,8,38016
 tr 150,8,38528
 s_waitcnt lgkmcnt(10)
 mf 120,164,72,120
 tr 156,8,38048
 tr 158,8,38560
 mf 124,172,72,124
 tr 164,8,38080
 tr 166,8,38592
 s_waitcnt lgkmcnt(10)
 mf 112,16,80,112
 tr 172,8,38112
 tr 174,8,38624
 mf 116,20,80,116
 tr 16,8,42240
 tr 18,8,42752
 s_waitcnt lgkmcnt(10)
 mf 120,24,80,120
 tr 20,8,42272
 tr 22,8,42784
 mf 124,28,80,124
 tr 24,8,42304
 tr 26,8,42816
 s_waitcnt lgkmcnt(10)
 mf 112,148,88,112
 tr 28,8,42336
 tr 30,8,42848
 mf 116,156,88,116
 tr 148,8,46464
 tr 150,8,46976
 s_waitcnt lgkmcnt(10)
 mf 120,164,88,120
 tr 156,8,46496
 tr 158,8,47008
 mf 124,172,88,124
 tr 164,8,46528
 tr 166,8,47040
 s_waitcnt lgkmcnt(10)
 mf 112,16,96,112
 tr 172,8,46560
 tr 174,8,47072
 mf 116,20,96,116
 s_waitcnt lgkmcnt(8)
 mf 120,24,96,120
 mf 124,28,96,124
 ds_read_b64_tr_b16 v[16:17],v2
 tr 18,2,512
 tr 20,2,32
 tr 22,2,544
 tr 24,2,64
 tr 26,2,576
 s_waitcnt lgkmcnt(10)
 mf 112,148,104,112
 tr 28,2,96
 tr 30,2,608
 mf 116,156,104,116
 tr 148,2,4224
 tr 150,2,4736
 s_waitcnt lgkmcnt(10)
 mf 120,164,104,120
 tr 156,2,4256
 tr 158,2,4768
 mf 124,172,104,124
 tr 164,2,4288
 tr 166,2,4800
 s_waitcnt lgkmcnt(10)
 mf 112,16,144,112
 tr 172,2,4320
 tr 174,2,4832
 mf 116,20,144,116
 tr 16,2,8448
 tr 18,2,8960
 s_waitcnt lgkmcnt(10)
 mf 120,24,144,120
 tr 20,2,8480
 tr 22,2,8992
 mf 124,28,144,124
 tr 24,2,8512
 tr 26,2,9024
 s_waitcnt lgkmcnt(10)
 mf 112,148,152,112
 tr 28,2,8544
 tr 30,2,9056
 mf 116,156,152,116
 tr 148,2,12672
 tr 150,2,13184
 s_waitcnt lgkmcnt(10)
 mf 120,164,152,120
 tr 156,2,12704
 tr 158,2,13216
 mf 124,172,152,124
 tr 164,2,12736
 tr 166,2,13248
 s_waitcnt lgkmcnt(10)
 mf 112,16,160,112
 tr 172,2,12768
 tr 174,2,13280
 mf 116,20,160,116
 s_waitcnt lgkmcnt(8)
 mf 120,24,160,120
 mf 124,28,160,124
 s_waitcnt lgkmcnt(4)
 mf 112,148,168,112
 mf 116,156,168,116
 s_waitcnt lgkmcnt(0)
 mf 120,164,168,120
 mf 124,172,168,124
 s_nop 3
 cv 112,112,113
 cv 113,114,115
 cv 114,116,117
 cv 115,118,119
 ds_write_b128 v4,v[112:115]
 cv 120,120,121
 cv 121,122,123
 cv 122,124,125
 cv 123,126,127
 ds_write_b128 v4,v[120:123] offset:7168
 s_waitcnt lgkmcnt(0)
 s_barrier
 s_endpgm
L_resc0first_ys:
 s_nop 7
 v_max_f32 v10,v10,v95
 v_mov_b32 v12,v10
 s_nop 1
 v_permlane16_swap_b32 v10,v12
 v_max_f32 v10,v10,v12
 v_mov_b32 v12,v10
 s_nop 1
 v_permlane32_swap_b32 v10,v12
 v_max_f32 v10,v10,v12
 v_sub_f32 v80,v80,v10
 v_sub_f32 v81,v81,v10
 v_sub_f32 v82,v82,v10
 v_sub_f32 v83,v83,v10
 v_sub_f32 v84,v84,v10
 v_sub_f32 v85,v85,v10
 v_sub_f32 v86,v86,v10
 v_sub_f32 v87,v87,v10
 v_sub_f32 v88,v88,v10
 v_sub_f32 v89,v89,v10
 v_sub_f32 v90,v90,v10
 v_sub_f32 v91,v91,v10
 v_sub_f32 v92,v92,v10
 v_sub_f32 v93,v93,v10
 v_sub_f32 v94,v94,v10
 v_sub_f32 v95,v95,v10
 v_sub_f32 v240,v240,v10
 v_sub_f32 v241,v241,v10
 v_sub_f32 v242,v242,v10
 v_sub_f32 v243,v243,v10
 s_nop 1
 s_branch L_ret0first_ys
L_resc0_ys:
 s_nop 7
 v_max_f32 v10,v10,v95
 v_mov_b32 v12,v10
 s_nop 1
 v_permlane16_swap_b32 v10,v12
 v_max_f32 v10,v10,v12
 v_mov_b32 v12,v10
 s_nop 1
 v_permlane32_swap_b32 v10,v12
 v_max_f32 v10,v10,v12
 v_sub_f32 v80,v80,v10
 v_sub_f32 v81,v81,v10
 v_sub_f32 v82,v82,v10
 v_sub_f32 v83,v83,v10
 v_sub_f32 v84,v84,v10
 v_sub_f32 v85,v85,v10
 v_sub_f32 v86,v86,v10
 v_sub_f32 v87,v87,v10
 v_sub_f32 v88,v88,v10
 v_sub_f32 v89,v89,v10
 v_sub_f32 v90,v90,v10
 v_sub_f32 v91,v91,v10
 v_sub_f32 v92,v92,v10
 v_sub_f32 v93,v93,v10
 v_sub_f32 v94,v94,v10
 v_sub_f32 v95,v95,v10
 v_sub_f32 v240,v240,v10
 v_sub_f32 v241,v241,v10
 v_sub_f32 v242,v242,v10
 v_sub_f32 v243,v243,v10
 s_nop 1
 s_branch L_ret0_ys
L_resc1_ys:
 s_nop 7
 v_max3_f32 v10,v10,v127,0
 v_mov_b32 v12,v10
 s_nop 1
 v_permlane16_swap_b32 v10,v12
 v_max_f32 v10,v10,v12
 v_mov_b32 v12,v10
 s_nop 1
 v_permlane32_swap_b32 v10,v12
 v_max_f32 v10,v10,v12
 v_sub_f32 v12,0,v10
 v_exp_f32 v12,v12
 v_sub_f32 v112,v112,v10
 v_sub_f32 v113,v113,v10
 v_sub_f32 v114,v114,v10
 v_sub_f32 v115,v115,v10
 v_sub_f32 v116,v116,v10
 v_sub_f32 v117,v117,v10
 v_sub_f32 v118,v118,v10
 v_sub_f32 v119,v119,v10
 v_sub_f32 v120,v120,v10
 v_sub_f32 v121,v121,v10
 v_sub_f32 v122,v122,v10
 v_sub_f32 v123,v123,v10
 v_sub_f32 v124,v124,v10
 v_sub_f32 v125,v125,v10
 v_sub_f32 v126,v126,v10
 v_sub_f32 v127,v127,v10
 v_sub_f32 v240,v240,v10
 v_sub_f32 v241,v241,v10
 v_sub_f32 v242,v242,v10
 v_sub_f32 v243,v243,v10
 v_mul_f32 v144,v12,v144
 v_mul_f32 v145,v12,v145
 v_mul_f32 v146,v12,v146
 v_mul_f32 v147,v12,v147
 v_mul_f32 v148,v12,v148
 v_mul_f32 v149,v12,v149
 v_mul_f32 v150,v12,v150
 v_mul_f32 v151,v12,v151
 v_mul_f32 v152,v12,v152
 v_mul_f32 v153,v12,v153
 v_mul_f32 v154,v12,v154
 v_mul_f32 v155,v12,v155
 v_mul_f32 v156,v12,v156
 v_mul_f32 v157,v12,v157
 v_mul_f32 v158,v12,v158
 v_mul_f32 v159,v12,v159
 v_mul_f32 v160,v12,v160
 v_mul_f32 v161,v12,v161
 v_mul_f32 v162,v12,v162
 v_mul_f32 v163,v12,v163
 v_mul_f32 v164,v12,v164
 v_mul_f32 v165,v12,v165
 v_mul_f32 v166,v12,v166
 v_mul_f32 v167,v12,v167
 v_mul_f32 v168,v12,v168
 v_mul_f32 v169,v12,v169
 v_mul_f32 v170,v12,v170
 v_mul_f32 v171,v12,v171
 v_mul_f32 v172,v12,v172
 v_mul_f32 v173,v12,v173
 v_mul_f32 v174,v12,v174
 v_mul_f32 v175,v12,v175
 v_mul_f32 v248,v12,v248
 s_nop 1
 s_branch L_ret1_ys
L_resc2_ys:
 s_nop 7
 v_max3_f32 v10,v10,v95,0
 v_mov_b32 v12,v10
 s_nop 1
 v_permlane16_swap_b32 v10,v12
 v_max_f32 v10,v10,v12
 v_mov_b32 v12,v10
 s_nop 1
 v_permlane32_swap_b32 v10,v12
 v_max_f32 v10,v10,v12
 v_sub_f32 v12,0,v10
 v_exp_f32 v12,v12
 v_sub_f32 v80,v80,v10
 v_sub_f32 v81,v81,v10
 v_sub_f32 v82,v82,v10
 v_sub_f32 v83,v83,v10
 v_sub_f32 v84,v84,v10
 v_sub_f32 v85,v85,v10
 v_sub_f32 v86,v86,v10
 v_sub_f32 v87,v87,v10
 v_sub_f32 v88,v88,v10
 v_sub_f32 v89,v89,v10
 v_sub_f32 v90,v90,v10
 v_sub_f32 v91,v91,v10
 v_sub_f32 v92,v92,v10
 v_sub_f32 v93,v93,v10
 v_sub_f32 v94,v94,v10
 v_sub_f32 v95,v95,v10
 v_sub_f32 v240,v240,v10
 v_sub_f32 v241,v241,v10
 v_sub_f32 v242,v242,v10
 v_sub_f32 v243,v243,v10
 v_mul_f32 v144,v12,v144
 v_mul_f32 v145,v12,v145
 v_mul_f32 v146,v12,v146
 v_mul_f32 v147,v12,v147
 v_mul_f32 v148,v12,v148
 v_mul_f32 v149,v12,v149
 v_mul_f32 v150,v12,v150
 v_mul_f32 v151,v12,v151
 v_mul_f32 v152,v12,v152
 v_mul_f32 v153,v12,v153
 v_mul_f32 v154,v12,v154
 v_mul_f32 v155,v12,v155
 v_mul_f32 v156,v12,v156
 v_mul_f32 v157,v12,v157
 v_mul_f32 v158,v12,v158
 v_mul_f32 v159,v12,v159
 v_mul_f32 v160,v12,v160
 v_mul_f32 v161,v12,v161
 v_mul_f32 v162,v12,v162
 v_mul_f32 v163,v12,v163
 v_mul_f32 v164,v12,v164
 v_mul_f32 v165,v12,v165
 v_mul_f32 v166,v12,v166
 v_mul_f32 v167,v12,v167
 v_mul_f32 v168,v12,v168
 v_mul_f32 v169,v12,v169
 v_mul_f32 v170,v12,v170
 v_mul_f32 v171,v12,v171
 v_mul_f32 v172,v12,v172
 v_mul_f32 v173,v12,v173
 v_mul_f32 v174,v12,v174
 v_mul_f32 v175,v12,v175
 v_mul_f32 v248,v12,v248
 s_nop 1
 s_branch L_ret2_ys
L_resc3_ys:
 s_nop 7
 v_max3_f32 v10,v10,v127,0
 v_mov_b32 v12,v10
 s_nop 1
 v_permlane16_swap_b32 v10,v12
 v_max_f32 v10,v10,v12
 v_mov_b32 v12,v10
 s_nop 1
 v_permlane32_swap_b32 v10,v12
 v_max_f32 v10,v10,v12
 v_sub_f32 v12,0,v10
 v_exp_f32 v12,v12
 v_sub_f32 v112,v112,v10
 v_sub_f32 v113,v113,v10
 v_sub_f32 v114,v114,v10
 v_sub_f32 v115,v115,v10
 v_sub_f32 v116,v116,v10
 v_sub_f32 v117,v117,v10
 v_sub_f32 v118,v118,v10
 v_sub_f32 v119,v119,v10
 v_sub_f32 v120,v120,v10
 v_sub_f32 v121,v121,v10
 v_sub_f32 v122,v122,v10
 v_sub_f32 v123,v123,v10
 v_sub_f32 v124,v124,v10
 v_sub_f32 v125,v125,v10
 v_sub_f32 v126,v126,v10
 v_sub_f32 v127,v127,v10
 v_sub_f32 v240,v240,v10
 v_sub_f32 v241,v241,v10
 v_sub_f32 v242,v242,v10
 v_sub_f32 v243,v243,v10
 v_mul_f32 v144,v12,v144
 v_mul_f32 v145,v12,v145
 v_mul_f32 v146,v12,v146
 v_mul_f32 v147,v12,v147
 v_mul_f32 v148,v12,v148
 v_mul_f32 v149,v12,v149
 v_mul_f32 v150,v12,v150
 v_mul_f32 v151,v12,v151
 v_mul_f32 v152,v12,v152
 v_mul_f32 v153,v12,v153
 v_mul_f32 v154,v12,v154
 v_mul_f32 v155,v12,v155
 v_mul_f32 v156,v12,v156
 v_mul_f32 v157,v12,v157
 v_mul_f32 v158,v12,v158
 v_mul_f32 v159,v12,v159
 v_mul_f32 v160,v12,v160
 v_mul_f32 v161,v12,v161
 v_mul_f32 v162,v12,v162
 v_mul_f32 v163,v12,v163
 v_mul_f32 v164,v12,v164
 v_mul_f32 v165,v12,v165
 v_mul_f32 v166,v12,v166
 v_mul_f32 v167,v12,v167
 v_mul_f32 v168,v12,v168
 v_mul_f32 v169,v12,v169
 v_mul_f32 v170,v12,v170
 v_mul_f32 v171,v12,v171
 v_mul_f32 v172,v12,v172
 v_mul_f32 v173,v12,v173
 v_mul_f32 v174,v12,v174
 v_mul_f32 v175,v12,v175
 v_mul_f32 v248,v12,v248
 s_nop 1
 s_branch L_ret3_ys
L_resc4_ys:
 s_nop 7
 v_max3_f32 v10,v10,v95,0
 v_mov_b32 v12,v10
 s_nop 1
 v_permlane16_swap_b32 v10,v12
 v_max_f32 v10,v10,v12
 v_mov_b32 v12,v10
 s_nop 1
 v_permlane32_swap_b32 v10,v12
 v_max_f32 v10,v10,v12
 v_sub_f32 v12,0,v10
 v_exp_f32 v12,v12
 v_sub_f32 v80,v80,v10
 v_sub_f32 v81,v81,v10
 v_sub_f32 v82,v82,v10
 v_sub_f32 v83,v83,v10
 v_sub_f32 v84,v84,v10
 v_sub_f32 v85,v85,v10
 v_sub_f32 v86,v86,v10
 v_sub_f32 v87,v87,v10
 v_sub_f32 v88,v88,v10
 v_sub_f32 v89,v89,v10
 v_sub_f32 v90,v90,v10
 v_sub_f32 v91,v91,v10
 v_sub_f32 v92,v92,v10
 v_sub_f32 v93,v93,v10
 v_sub_f32 v94,v94,v10
 v_sub_f32 v95,v95,v10
 v_sub_f32 v240,v240,v10
 v_sub_f32 v241,v241,v10
 v_sub_f32 v242,v242,v10
 v_sub_f32 v243,v243,v10
 v_mul_f32 v144,v12,v144
 v_mul_f32 v145,v12,v145
 v_mul_f32 v146,v12,v146
 v_mul_f32 v147,v12,v147
 v_mul_f32 v148,v12,v148
 v_mul_f32 v149,v12,v149
 v_mul_f32 v150,v12,v150
 v_mul_f32 v151,v12,v151
 v_mul_f32 v152,v12,v152
 v_mul_f32 v153,v12,v153
 v_mul_f32 v154,v12,v154
 v_mul_f32 v155,v12,v155
 v_mul_f32 v156,v12,v156
 v_mul_f32 v157,v12,v157
 v_mul_f32 v158,v12,v158
 v_mul_f32 v159,v12,v159
 v_mul_f32 v160,v12,v160
 v_mul_f32 v161,v12,v161
 v_mul_f32 v162,v12,v162
 v_mul_f32 v163,v12,v163
 v_mul_f32 v164,v12,v164
 v_mul_f32 v165,v12,v165
 v_mul_f32 v166,v12,v166
 v_mul_f32 v167,v12,v167
 v_mul_f32 v168,v12,v168
 v_mul_f32 v169,v12,v169
 v_mul_f32 v170,v12,v170
 v_mul_f32 v171,v12,v171
 v_mul_f32 v172,v12,v172
 v_mul_f32 v173,v12,v173
 v_mul_f32 v174,v12,v174
 v_mul_f32 v175,v12,v175
 v_mul_f32 v248,v12,v248
 s_nop 1
 s_branch L_ret4_ys
L_resc5_ys:
 s_nop 7
 v_max3_f32 v10,v10,v127,0
 v_mov_b32 v12,v10
 s_nop 1
 v_permlane16_swap_b32 v10,v12
 v_max_f32 v10,v10,v12
 v_mov_b32 v12,v10
 s_nop 1
 v_permlane32_swap_b32 v10,v12
 v_max_f32 v10,v10,v12
 v_sub_f32 v12,0,v10
 v_exp_f32 v12,v12
 v_sub_f32 v112,v112,v10
 v_sub_f32 v113,v113,v10
 v_sub_f32 v114,v114,v10
 v_sub_f32 v115,v115,v10
 v_sub_f32 v116,v116,v10
 v_sub_f32 v117,v117,v10
 v_sub_f32 v118,v118,v10
 v_sub_f32 v119,v119,v10
 v_sub_f32 v120,v120,v10
 v_sub_f32 v121,v121,v10
 v_sub_f32 v122,v122,v10
 v_sub_f32 v123,v123,v10
 v_sub_f32 v124,v124,v10
 v_sub_f32 v125,v125,v10
 v_sub_f32 v126,v126,v10
 v_sub_f32 v127,v127,v10
 v_sub_f32 v240,v240,v10
 v_sub_f32 v241,v241,v10
 v_sub_f32 v242,v242,v10
 v_sub_f32 v243,v243,v10
 v_mul_f32 v144,v12,v144
 v_mul_f32 v145,v12,v145
 v_mul_f32 v146,v12,v146
 v_mul_f32 v147,v12,v147
 v_mul_f32 v148,v12,v148
 v_mul_f32 v149,v12,v149
 v_mul_f32 v150,v12,v150
 v_mul_f32 v151,v12,v151
 v_mul_f32 v152,v12,v152
 v_mul_f32 v153,v12,v153
 v_mul_f32 v154,v12,v154
 v_mul_f32 v155,v12,v155
 v_mul_f32 v156,v12,v156
 v_mul_f32 v157,v12,v157
 v_mul_f32 v158,v12,v158
 v_mul_f32 v159,v12,v159
 v_mul_f32 v160,v12,v160
 v_mul_f32 v161,v12,v161
 v_mul_f32 v162,v12,v162
 v_mul_f32 v163,v12,v163
 v_mul_f32 v164,v12,v164
 v_mul_f32 v165,v12,v165
 v_mul_f32 v166,v12,v166
 v_mul_f32 v167,v12,v167
 v_mul_f32 v168,v12,v168
 v_mul_f32 v169,v12,v169
 v_mul_f32 v170,v12,v170
 v_mul_f32 v171,v12,v171
 v_mul_f32 v172,v12,v172
 v_mul_f32 v173,v12,v173
 v_mul_f32 v174,v12,v174
 v_mul_f32 v175,v12,v175
 v_mul_f32 v248,v12,v248
 s_nop 1
 s_branch L_ret5_ys
L_resc6_ys:
 s_nop 7
 v_max3_f32 v10,v10,v95,0
 v_mov_b32 v12,v10
 s_nop 1
 v_permlane16_swap_b32 v10,v12
 v_max_f32 v10,v10,v12
 v_mov_b32 v12,v10
 s_nop 1
 v_permlane32_swap_b32 v10,v12
 v_max_f32 v10,v10,v12
 v_sub_f32 v12,0,v10
 v_exp_f32 v12,v12
 v_sub_f32 v80,v80,v10
 v_sub_f32 v81,v81,v10
 v_sub_f32 v82,v82,v10
 v_sub_f32 v83,v83,v10
 v_sub_f32 v84,v84,v10
 v_sub_f32 v85,v85,v10
 v_sub_f32 v86,v86,v10
 v_sub_f32 v87,v87,v10
 v_sub_f32 v88,v88,v10
 v_sub_f32 v89,v89,v10
 v_sub_f32 v90,v90,v10
 v_sub_f32 v91,v91,v10
 v_sub_f32 v92,v92,v10
 v_sub_f32 v93,v93,v10
 v_sub_f32 v94,v94,v10
 v_sub_f32 v95,v95,v10
 v_sub_f32 v240,v240,v10
 v_sub_f32 v241,v241,v10
 v_sub_f32 v242,v242,v10
 v_sub_f32 v243,v243,v10
 v_mul_f32 v144,v12,v144
 v_mul_f32 v145,v12,v145
 v_mul_f32 v146,v12,v146
 v_mul_f32 v147,v12,v147
 v_mul_f32 v148,v12,v148
 v_mul_f32 v149,v12,v149
 v_mul_f32 v150,v12,v150
 v_mul_f32 v151,v12,v151
 v_mul_f32 v152,v12,v152
 v_mul_f32 v153,v12,v153
 v_mul_f32 v154,v12,v154
 v_mul_f32 v155,v12,v155
 v_mul_f32 v156,v12,v156
 v_mul_f32 v157,v12,v157
 v_mul_f32 v158,v12,v158
 v_mul_f32 v159,v12,v159
 v_mul_f32 v160,v12,v160
 v_mul_f32 v161,v12,v161
 v_mul_f32 v162,v12,v162
 v_mul_f32 v163,v12,v163
 v_mul_f32 v164,v12,v164
 v_mul_f32 v165,v12,v165
 v_mul_f32 v166,v12,v166
 v_mul_f32 v167,v12,v167
 v_mul_f32 v168,v12,v168
 v_mul_f32 v169,v12,v169
 v_mul_f32 v170,v12,v170
 v_mul_f32 v171,v12,v171
 v_mul_f32 v172,v12,v172
 v_mul_f32 v173,v12,v173
 v_mul_f32 v174,v12,v174
 v_mul_f32 v175,v12,v175
 v_mul_f32 v248,v12,v248
 s_nop 1
 s_branch L_ret6_ys
L_resc7_ys:
 s_nop 7
 v_max3_f32 v10,v10,v127,0
 v_mov_b32 v12,v10
 s_nop 1
 v_permlane16_swap_b32 v10,v12
 v_max_f32 v10,v10,v12
 v_mov_b32 v12,v10
 s_nop 1
 v_permlane32_swap_b32 v10,v12
 v_max_f32 v10,v10,v12
 v_sub_f32 v12,0,v10
 v_exp_f32 v12,v12
 v_sub_f32 v112,v112,v10
 v_sub_f32 v113,v113,v10
 v_sub_f32 v114,v114,v10
 v_sub_f32 v115,v115,v10
 v_sub_f32 v116,v116,v10
 v_sub_f32 v117,v117,v10
 v_sub_f32 v118,v118,v10
 v_sub_f32 v119,v119,v10
 v_sub_f32 v120,v120,v10
 v_sub_f32 v121,v121,v10
 v_sub_f32 v122,v122,v10
 v_sub_f32 v123,v123,v10
 v_sub_f32 v124,v124,v10
 v_sub_f32 v125,v125,v10
 v_sub_f32 v126,v126,v10
 v_sub_f32 v127,v127,v10
 v_sub_f32 v240,v240,v10
 v_sub_f32 v241,v241,v10
 v_sub_f32 v242,v242,v10
 v_sub_f32 v243,v243,v10
 v_mul_f32 v144,v12,v144
 v_mul_f32 v145,v12,v145
 v_mul_f32 v146,v12,v146
 v_mul_f32 v147,v12,v147
 v_mul_f32 v148,v12,v148
 v_mul_f32 v149,v12,v149
 v_mul_f32 v150,v12,v150
 v_mul_f32 v151,v12,v151
 v_mul_f32 v152,v12,v152
 v_mul_f32 v153,v12,v153
 v_mul_f32 v154,v12,v154
 v_mul_f32 v155,v12,v155
 v_mul_f32 v156,v12,v156
 v_mul_f32 v157,v12,v157
 v_mul_f32 v158,v12,v158
 v_mul_f32 v159,v12,v159
 v_mul_f32 v160,v12,v160
 v_mul_f32 v161,v12,v161
 v_mul_f32 v162,v12,v162
 v_mul_f32 v163,v12,v163
 v_mul_f32 v164,v12,v164
 v_mul_f32 v165,v12,v165
 v_mul_f32 v166,v12,v166
 v_mul_f32 v167,v12,v167
 v_mul_f32 v168,v12,v168
 v_mul_f32 v169,v12,v169
 v_mul_f32 v170,v12,v170
 v_mul_f32 v171,v12,v171
 v_mul_f32 v172,v12,v172
 v_mul_f32 v173,v12,v173
 v_mul_f32 v174,v12,v174
 v_mul_f32 v175,v12,v175
 v_mul_f32 v248,v12,v248
 s_nop 1
 s_branch L_ret7_ys
L_resc7last_ys:
 s_nop 7
 v_max3_f32 v10,v10,v127,0
 v_mov_b32 v12,v10
 s_nop 1
 v_permlane16_swap_b32 v10,v12
 v_max_f32 v10,v10,v12
 v_mov_b32 v12,v10
 s_nop 1
 v_permlane32_swap_b32 v10,v12
 v_max_f32 v10,v10,v12
 v_sub_f32 v12,0,v10
 v_exp_f32 v12,v12
 v_sub_f32 v112,v112,v10
 v_sub_f32 v113,v113,v10
 v_sub_f32 v114,v114,v10
 v_sub_f32 v115,v115,v10
 v_sub_f32 v116,v116,v10
 v_sub_f32 v117,v117,v10
 v_sub_f32 v118,v118,v10
 v_sub_f32 v119,v119,v10
 v_sub_f32 v120,v120,v10
 v_sub_f32 v121,v121,v10
 v_sub_f32 v122,v122,v10
 v_sub_f32 v123,v123,v10
 v_sub_f32 v124,v124,v10
 v_sub_f32 v125,v125,v10
 v_sub_f32 v126,v126,v10
 v_sub_f32 v127,v127,v10
 v_sub_f32 v240,v240,v10
 v_sub_f32 v241,v241,v10
 v_sub_f32 v242,v242,v10
 v_sub_f32 v243,v243,v10
 v_mul_f32 v144,v12,v144
 v_mul_f32 v145,v12,v145
 v_mul_f32 v146,v12,v146
 v_mul_f32 v147,v12,v147
 v_mul_f32 v148,v12,v148
 v_mul_f32 v149,v12,v149
 v_mul_f32 v150,v12,v150
 v_mul_f32 v151,v12,v151
 v_mul_f32 v152,v12,v152
 v_mul_f32 v153,v12,v153
 v_mul_f32 v154,v12,v154
 v_mul_f32 v155,v12,v155
 v_mul_f32 v156,v12,v156
 v_mul_f32 v157,v12,v157
 v_mul_f32 v158,v12,v158
 v_mul_f32 v159,v12,v159
 v_mul_f32 v160,v12,v160
 v_mul_f32 v161,v12,v161
 v_mul_f32 v162,v12,v162
 v_mul_f32 v163,v12,v163
 v_mul_f32 v164,v12,v164
 v_mul_f32 v165,v12,v165
 v_mul_f32 v166,v12,v166
 v_mul_f32 v167,v12,v167
 v_mul_f32 v168,v12,v168
 v_mul_f32 v169,v12,v169
 v_mul_f32 v170,v12,v170
 v_mul_f32 v171,v12,v171
 v_mul_f32 v172,v12,v172
 v_mul_f32 v173,v12,v173
 v_mul_f32 v174,v12,v174
 v_mul_f32 v175,v12,v175
 v_mul_f32 v248,v12,v248
 s_nop 1
 s_branch L_ret7last_ys
.section .rodata,"a"
.p2align 6
.amdhsa_kernel concat_heads__mha_block_cached__gqa_block_cached__near_ridge_kernel
  .amdhsa_next_free_vgpr 256
  .amdhsa_next_free_sgpr 102
  .amdhsa_accum_offset 256
  .amdhsa_group_segment_fixed_size 0
  .amdhsa_kernarg_size 104
  .amdhsa_user_sgpr_count 2
  .amdhsa_user_sgpr_kernarg_segment_ptr 1
  .amdhsa_system_sgpr_workgroup_id_x 1
.end_amdhsa_kernel
```
